```python
import torch

def _softmax(x, axis=-1):
    return torch.softmax(x, dim=axis)

def _gelu(x):
    return torch.nn.functional.gelu(x, approximate='tanh')

def _silu(x):
    return torch.nn.functional.silu(x)

def _sigmoid(x):
    return torch.sigmoid(x)

def _layernorm(x, axis=-1, eps=1e-05):
    m = x.mean(dim=axis, keepdim=True)
    v = x.var(dim=axis, keepdim=True, unbiased=False)
    return (x - m) / torch.sqrt(v + eps)

def _scatter_add(tgt, idx, src, axis=0):
    return tgt.clone().index_add_(axis, idx, src)

def _segment_sum(src, seg, n):
    out = torch.zeros((n,) + src.shape[1:], dtype=src.dtype)
    return out.index_add_(0, seg, src)

def _pad(x, pw):
    flat = tuple((v for pair in reversed(pw) for v in pair))
    return torch.nn.functional.pad(x, flat)
kernel_name = 'adaLN_cond__gqa_block_cached__glu_gated_geglu__prompt'

def setup_inputs():

    _w = lambda a: (lambda t: t.to(torch.bfloat16) if t.is_floating_point() else t)(torch.as_tensor(a))

    def _A_setup():
        B, Sq, D = (1, 2048, 576)
        Hq, Hkv, Sk, Dh = (32, 16, 2048, 128)
        assert Hq % Hkv == 0, (Hq, Hkv)
        return {'x': _w((lambda *s: torch.randn(*s, dtype=torch.bfloat16) * 0.05)(B, Sq, D)), 'k_cache': _w((lambda *s: torch.randn(*s, dtype=torch.bfloat16) * 0.8)(B, Hkv, Sk, Dh)), 'v_cache': _w((lambda *s: torch.randn(*s, dtype=torch.bfloat16) * 3.2)(B, Hkv, Sk, Dh)), 'wq': _w((lambda *s: torch.randn(*s, dtype=torch.bfloat16) * 0.8)(D, Hq * Dh) * D ** (-0.5)), 'wo': _w((lambda *s: torch.randn(*s, dtype=torch.bfloat16) * 3.2)(Hq * Dh, D) * (Hq * Dh) ** (-0.5))}
    _A_in = _A_setup()

    def _B_setup():
        B, S, Dm, Df = (1, 2048, 576, 4608)
        return {'x': _w((lambda *s: torch.randn(*s, dtype=torch.bfloat16) * 0.05)(B, S, Dm)), 'w_gate': _w((lambda *s: torch.randn(*s, dtype=torch.bfloat16) * 3.2)(Dm, Df) * Dm ** (-0.5)), 'w_up': _w((lambda *s: torch.randn(*s, dtype=torch.bfloat16) * 3.2)(Dm, Df) * Dm ** (-0.5)), 'w_down': _w((lambda *s: torch.randn(*s, dtype=torch.bfloat16) * 3.2)(Df, Dm) * Df ** (-0.5))}
    _B_in = _B_setup()
    return {'A_x': _A_in['x'], 'A_k_cache': _A_in['k_cache'], 'A_v_cache': _A_in['v_cache'], 'A_wq': _A_in['wq'], 'A_wo': _A_in['wo'], 'B_x': _B_in['x'], 'B_w_gate': _B_in['w_gate'], 'B_w_up': _B_in['w_up'], 'B_w_down': _B_in['w_down'], 'c': _w((lambda *s: torch.randn(*s, dtype=torch.bfloat16) * 0.4)(1, 576) * 8.0), 'w_mod': _w((lambda *s: torch.randn(*s, dtype=torch.bfloat16) * 0.4)(576, 6 * 576) * 576 ** (-0.5) * 8.0)}

def reference(A_x, A_k_cache, A_v_cache, A_wq, A_wo, B_x, B_w_gate, B_w_up, B_w_down, c, w_mod):

    def _A_ref(x, k_cache, v_cache, wq, wo):
        B, Sq, D = x.shape
        Hq, Dh = (32, 128)
        Hkv = k_cache.shape[1]
        rep = Hq // Hkv
        q = (lambda x, *d: x.permute(*d))((x @ wq).reshape(B, Sq, Hq, Dh), 0, 2, 1, 3)
        k = (lambda x, n, axis: torch.repeat_interleave(x, n, dim=axis))(k_cache, rep, axis=1)
        v = (lambda x, n, axis: torch.repeat_interleave(x, n, dim=axis))(v_cache, rep, axis=1)
        scores = torch.einsum('bhqd,bhkd->bhqk', q, k) * Dh ** (-0.5)
        p = _softmax(scores, axis=-1)
        o = torch.einsum('bhqk,bhkd->bhqd', p, v)
        return (lambda x, *d: x.permute(*d))(o, 0, 2, 1, 3).reshape(B, Sq, Hq * Dh) @ wo

    def _B_ref(x, w_gate, w_up, w_down):
        g = torch.einsum('bsd,df->bsf', x, w_gate)
        u = torch.einsum('bsd,df->bsf', x, w_up)
        h = _gelu(g) * u
        return torch.einsum('bsf,fd->bsd', h, w_down)
    x = A_x
    mod = (_silu(c) @ w_mod).reshape(c.shape[0], 6, 1, -1)
    sa, ca, ga, sb, cb, gb = (mod[:, 0].clone(), mod[:, 1].clone(), mod[:, 2].clone(), mod[:, 3].clone(), mod[:, 4].clone(), mod[:, 5].clone())
    h = _layernorm(x, axis=-1) * (1 + ca) + sa
    x = x + ga * _A_ref(h, A_k_cache, A_v_cache, A_wq, A_wo)
    h = _layernorm(x, axis=-1) * (1 + cb) + sb
    x = x + gb * _B_ref(h, B_w_gate, B_w_up, B_w_down)
    return x
```

```asm
; @launch grid=(256,1,1) block=(256,1,1) lds=160000
.amdgcn_target "amdgcn-amd-amdhsa--gfx950"
.text
.globl adaLN_cond__gqa_block_cached__glu_gated_geglu__prompt_kernel
.p2align 8
.type adaLN_cond__gqa_block_cached__glu_gated_geglu__prompt_kernel,@function
adaLN_cond__gqa_block_cached__glu_gated_geglu__prompt_kernel:
s_cmp_ge_u32 s2, 256
s_cbranch_scc1 K1_end
s_load_dwordx2 s[16:17], s[0:1], 80
s_load_dwordx2 s[56:57], s[0:1], 0
s_load_dwordx2 s[12:13], s[0:1], 72
s_load_dwordx2 s[24:25], s[0:1], 104
s_getpc_b64 s[78:79]
K1_pc:
s_lshr_b32 s51, s2, 3
s_lshl_b32 s6, s51, 7
v_min_u32 v24, 15, v0
v_lshl_add_u32 v24, v24, 12, s6
global_load_dword a255, v24, s[78:79]
s_and_b32 s7, s2, 7
s_mul_i32 s50, s51, 124416
v_and_b32 v24, 31, v0
v_lshrrev_b32 v25, 5, v0
v_lshl_add_u32 v25, v25, 3, s7
v_mul_u32_u24 v30, 6912, v24
v_lshl_add_u32 v30, v25, 7, v30
v_max_u32 v24, v24, v25
v_cmp_gt_u32 vcc, 18, v24
v_bfrev_b32 v31, 2
v_lshrrev_b32 v20, 3, v0
v_cndmask_b32 v30, v31, v30, vcc
v_mul_u32_u24 v21, 1152, v20
v_and_b32 v24, 15, v0
v_lshrrev_b32 v17, 4, v0
v_mul_u32_u24 v17, 1152, v17
v_lshl_add_u32 v17, v24, 7, v17
v_cmp_gt_u32 vcc, 9, v24
s_and_b32 s4, s2, 1
s_bfe_u32 s6, s2, 0x30003
s_lshl3_add_u32 s4, s4, s6
s_bfe_u32 s6, s2, 0x20001
s_lshr_b32 s5, s2, 6
s_lshl2_add_u32 s5, s6, s5
v_cndmask_b32 v25, v31, v17, vcc
s_and_b32 s6, s4, 7
s_lshl3_add_u32 s6, s5, s6
s_mul_i32 s49, s6, 18432
s_mov_b32 s19, 0x20000
s_mov_b32 s18, 3981312
s_mov_b32 s59, s19
s_mov_b32 s58, 2359296
v_lshrrev_b32 v26, 1, v0
v_lshlrev_b32 v27, 3, v26
v_lshlrev_b32 v23, 1, v26
s_mov_b32 s15, s19
s_movk_i32 s14, 1152
s_waitcnt lgkmcnt(0)
buffer_load_dword a255, v30, s[16:19], s50 offen
buffer_load_dwordx2 v[212:213], v27, s[12:15], 0 offen
buffer_load_ushort v214, v23, s[12:15], 0 offen offset:1024
buffer_load_dword a255, v25, s[56:59], s49 offen offset:0
s_load_dwordx2 s[72:73], s[24:25], 2048
s_load_dwordx8 s[64:71], s[0:1], 8
s_load_dwordx4 s[28:31], s[0:1], 48
s_load_dwordx2 s[32:33], s[0:1], 64
s_load_dwordx2 s[62:63], s[0:1], 88
v_lshrrev_b32 v16, 6, v0
v_and_b32 v1, 63, v0
v_readfirstlane_b32 s3, v16
v_cmp_gt_u32 vcc, 0, v24
s_mov_b64 s[74:75], s[16:17]
s_mov_b64 s[34:35], s[56:57]
s_mov_b64 s[36:37], s[24:25]
s_mov_b32 s26, 0x10000000
s_mov_b32 s27, s19
v_cndmask_b32 v17, v31, v17, vcc
s_lshr_b32 s6, s2, 5
s_lshl3_add_u32 s7, s6, s7
s_and_b32 s6, s51, 3
s_lshl2_add_u32 s54, s7, s6
s_lshl_b32 s40, s3, 10
v_lshlrev_b32 v4, 4, v0
s_mul_i32 s7, s5, 147456
s_mul_i32 s38, s3, 27648
s_add_u32 s38, s38, s7
s_mul_i32 s39, s3, 36864
v_mov_b32 v32, 0
v_mov_b32 v33, 0
v_mov_b32 v34, 0
v_mov_b32 v35, 0
s_lshl_b32 s7, s54, 12
s_add_u32 s7, s7, 131072
s_cmp_lt_u32 s54, 64
s_cselect_b32 s7, s7, 0x10000000
buffer_store_dwordx4 v[32:35], v4, s[24:27], s7 offen sc1
v_bfe_u32 v18, v1, 1, 2
v_lshrrev_b32 v19, 4, v1
v_xor_b32 v18, v18, v19
v_and_b32 v22, 1, v1
v_lshlrev_b32 v22, 4, v22
v_lshl_add_u32 v18, v18, 5, v22
v_add_u32 v3, v21, v18
v_mul_u32_u24 v28, 6912, v26
v_lshl_add_u32 v29, v28, 2, v22
v_add_u32 v28, v28, v22
v_lshlrev_b32 v36, 4, v26
v_add_u32 v36, 152064, v36
v_lshlrev_b32 v37, 2, v26
v_add_u32 v37, 152064, v37
v_lshlrev_b32 v38, 3, v19
v_lshl_add_u32 v38, v22, 1, v38
s_lshl_b32 s6, s3, 6
s_add_u32 s6, s6, 156160
v_add_u32 v38, s6, v38
v_and_b32 v39, 3, v1
v_lshlrev_b32 v39, 4, v39
v_cmp_gt_u32 vcc, 4, v0
v_min_u32 v246, 35, v1
s_nop 0
v_cndmask_b32 v33, v31, v39, vcc
v_add_u32 v39, 156160, v39
s_mul_i32 s6, s3, 1152
v_lshl_add_u32 v246, v246, 5, s6
s_cmp_lt_u32 s3, 2
s_cselect_b32 s6, 2308, 0
s_add_u32 s6, s6, 145152
v_add_u32 v247, s6, v246
s_mul_i32 s6, s3, 7168
v_add_u32 v4, s6, v4
s_mul_i32 s41, s3, 8320
s_mul_i32 s42, s3, 8448
s_mov_b32 s43, 0
s_mov_b32 s44, 0
s_mov_b32 s47, 0
s_add_u32 s52, s36, 131072
s_addc_u32 s53, s37, 0
v_and_b32 v21, 3, v20
v_bfe_u32 v22, v20, 2, 2
v_lshl_add_u32 v21, v22, 3, v21
v_lshrrev_b32 v22, 4, v20
v_lshl_add_u32 v21, v22, 2, v21
v_lshl_add_u32 v2, v21, 13, v18
s_lshl_b32 s6, s5, 3
s_lshl_b32 s7, s3, 1
s_add_u32 s6, s6, s7
s_mul_i32 s7, s6, 18432
s_mul_i32 s6, s4, 2359296
s_add_u32 s48, s6, s7
s_add_u32 s48, s48, 16777216
v_and_b32 v20, 15, v1
v_lshlrev_b32 v11, 2, v20
v_lshrrev_b32 v21, 3, v20
v_mul_u32_u24 v21, 9216, v21
v_and_b32 v22, 7, v1
v_lshl_add_u32 v22, v19, 3, v22
v_lshl_add_u32 v9, v22, 4, v21
v_lshrrev_b32 v23, 2, v20
v_lshrrev_b32 v24, 3, v20
v_xor_b32 v23, v23, v24
v_and_b32 v23, 1, v23
v_and_b32 v24, 3, v20
v_lshl_add_u32 v23, v24, 1, v23
v_and_b32 v24, 8, v20
v_add_u32 v25, v23, v24
v_mul_u32_u24 v25, 1040, v25
v_and_b32 v23, 1, v19
v_lshrrev_b32 v24, 1, v19
v_lshl_add_u32 v23, v23, 1, v24
v_lshl_add_u32 v5, v23, 4, v25
v_add_u32 v6, 73728, v5
v_lshrrev_b32 v26, 2, v1
v_lshrrev_b32 v23, 2, v26
v_lshrrev_b32 v24, 3, v26
v_xor_b32 v23, v23, v24
v_and_b32 v23, 1, v23
v_and_b32 v24, 3, v26
v_lshl_add_u32 v23, v24, 1, v23
v_and_b32 v24, 8, v26
v_add_u32 v25, v23, v24
v_mul_u32_u24 v25, 1056, v25
v_and_b32 v27, 3, v1
v_lshl_add_u32 v7, v27, 3, v25
v_add_u32 v8, 73728, v7
v_lshlrev_b32 v25, 7, v26
v_lshl_add_u32 v25, v27, 3, v25
v_bfe_u32 v24, v1, 3, 2
v_xor_b32 v23, 0, v24
v_lshl_add_u32 v12, v23, 5, v25
v_xor_b32 v23, 1, v24
v_lshl_add_u32 v13, v23, 5, v25
v_xor_b32 v23, 2, v24
v_lshl_add_u32 v14, v23, 5, v25
v_xor_b32 v23, 3, v24
v_lshl_add_u32 v15, v23, 5, v25
v_and_b32 v23, 1, v1
v_mov_b32 v24, 0x44444444
v_mov_b32 v25, 0xeeeeeeee
v_cmp_eq_u32 vcc, 1, v23
s_nop 1
v_cndmask_b32 v10, v24, v25, vcc
v_mov_b32 v24, 0
v_mov_b32 v25, 0x3f803f80
v_cmp_gt_u32 vcc, 2, v20
s_nop 1
v_cndmask_b32 v23, v24, v25, vcc
v_accvgpr_write_b32 a216, v23
v_accvgpr_write_b32 a217, v23
v_accvgpr_write_b32 a218, v23
v_accvgpr_write_b32 a219, v23
v_accvgpr_write_b32 a0, 0
v_accvgpr_write_b32 a1, 0
v_accvgpr_write_b32 a2, 0
v_accvgpr_write_b32 a3, 0
v_accvgpr_write_b32 a4, 0
v_accvgpr_write_b32 a5, 0
v_accvgpr_write_b32 a6, 0
v_accvgpr_write_b32 a7, 0
v_accvgpr_write_b32 a8, 0
v_accvgpr_write_b32 a9, 0
v_accvgpr_write_b32 a10, 0
v_accvgpr_write_b32 a11, 0
v_accvgpr_write_b32 a12, 0
v_accvgpr_write_b32 a13, 0
v_accvgpr_write_b32 a14, 0
v_accvgpr_write_b32 a15, 0
v_accvgpr_write_b32 a16, 0
v_accvgpr_write_b32 a17, 0
v_accvgpr_write_b32 a18, 0
v_accvgpr_write_b32 a19, 0
v_accvgpr_write_b32 a20, 0
v_accvgpr_write_b32 a21, 0
v_accvgpr_write_b32 a22, 0
v_accvgpr_write_b32 a23, 0
v_accvgpr_write_b32 a24, 0
v_accvgpr_write_b32 a25, 0
v_accvgpr_write_b32 a26, 0
v_accvgpr_write_b32 a27, 0
v_accvgpr_write_b32 a28, 0
v_accvgpr_write_b32 a29, 0
v_accvgpr_write_b32 a30, 0
v_accvgpr_write_b32 a31, 0
v_accvgpr_write_b32 a32, 0
v_accvgpr_write_b32 a33, 0
v_accvgpr_write_b32 a34, 0
v_accvgpr_write_b32 a35, 0
v_accvgpr_write_b32 a36, 0
v_accvgpr_write_b32 a37, 0
v_accvgpr_write_b32 a38, 0
v_accvgpr_write_b32 a39, 0
v_accvgpr_write_b32 a40, 0
v_accvgpr_write_b32 a41, 0
v_accvgpr_write_b32 a42, 0
v_accvgpr_write_b32 a43, 0
v_accvgpr_write_b32 a44, 0
v_accvgpr_write_b32 a45, 0
v_accvgpr_write_b32 a46, 0
v_accvgpr_write_b32 a47, 0
v_accvgpr_write_b32 a48, 0
v_accvgpr_write_b32 a49, 0
v_accvgpr_write_b32 a50, 0
v_accvgpr_write_b32 a51, 0
v_accvgpr_write_b32 a52, 0
v_accvgpr_write_b32 a53, 0
v_accvgpr_write_b32 a54, 0
v_accvgpr_write_b32 a55, 0
v_accvgpr_write_b32 a56, 0
v_accvgpr_write_b32 a57, 0
v_accvgpr_write_b32 a58, 0
v_accvgpr_write_b32 a59, 0
v_accvgpr_write_b32 a60, 0
v_accvgpr_write_b32 a61, 0
v_accvgpr_write_b32 a62, 0
v_accvgpr_write_b32 a63, 0
v_accvgpr_write_b32 a64, 0
v_accvgpr_write_b32 a65, 0
v_accvgpr_write_b32 a66, 0
v_accvgpr_write_b32 a67, 0
v_accvgpr_write_b32 a68, 0
v_accvgpr_write_b32 a69, 0
v_accvgpr_write_b32 a70, 0
v_accvgpr_write_b32 a71, 0
v_accvgpr_write_b32 a72, 0
v_accvgpr_write_b32 a73, 0
v_accvgpr_write_b32 a74, 0
v_accvgpr_write_b32 a75, 0
v_accvgpr_write_b32 a76, 0
v_accvgpr_write_b32 a77, 0
v_accvgpr_write_b32 a78, 0
v_accvgpr_write_b32 a79, 0
v_accvgpr_write_b32 a80, 0
v_accvgpr_write_b32 a81, 0
v_accvgpr_write_b32 a82, 0
v_accvgpr_write_b32 a83, 0
v_accvgpr_write_b32 a84, 0
v_accvgpr_write_b32 a85, 0
v_accvgpr_write_b32 a86, 0
v_accvgpr_write_b32 a87, 0
v_accvgpr_write_b32 a88, 0
v_accvgpr_write_b32 a89, 0
v_accvgpr_write_b32 a90, 0
v_accvgpr_write_b32 a91, 0
v_accvgpr_write_b32 a92, 0
v_accvgpr_write_b32 a93, 0
v_accvgpr_write_b32 a94, 0
v_accvgpr_write_b32 a95, 0
v_accvgpr_write_b32 a96, 0
v_accvgpr_write_b32 a97, 0
v_accvgpr_write_b32 a98, 0
v_accvgpr_write_b32 a99, 0
v_accvgpr_write_b32 a100, 0
v_accvgpr_write_b32 a101, 0
v_accvgpr_write_b32 a102, 0
v_accvgpr_write_b32 a103, 0
v_accvgpr_write_b32 a104, 0
v_accvgpr_write_b32 a105, 0
v_accvgpr_write_b32 a106, 0
v_accvgpr_write_b32 a107, 0
v_accvgpr_write_b32 a108, 0
v_accvgpr_write_b32 a109, 0
v_accvgpr_write_b32 a110, 0
v_accvgpr_write_b32 a111, 0
v_accvgpr_write_b32 a112, 0
v_accvgpr_write_b32 a113, 0
v_accvgpr_write_b32 a114, 0
v_accvgpr_write_b32 a115, 0
v_accvgpr_write_b32 a116, 0
v_accvgpr_write_b32 a117, 0
v_accvgpr_write_b32 a118, 0
v_accvgpr_write_b32 a119, 0
v_accvgpr_write_b32 a120, 0
v_accvgpr_write_b32 a121, 0
v_accvgpr_write_b32 a122, 0
v_accvgpr_write_b32 a123, 0
v_accvgpr_write_b32 a124, 0
v_accvgpr_write_b32 a125, 0
v_accvgpr_write_b32 a126, 0
v_accvgpr_write_b32 a127, 0
v_accvgpr_write_b32 a200, 0
v_accvgpr_write_b32 a201, 0
v_accvgpr_write_b32 a202, 0
v_accvgpr_write_b32 a203, 0
v_accvgpr_write_b32 a204, 0
v_accvgpr_write_b32 a205, 0
v_accvgpr_write_b32 a206, 0
v_accvgpr_write_b32 a207, 0
v_accvgpr_write_b32 a208, 0
v_accvgpr_write_b32 a209, 0
v_accvgpr_write_b32 a210, 0
v_accvgpr_write_b32 a211, 0
v_accvgpr_write_b32 a212, 0
v_accvgpr_write_b32 a213, 0
v_accvgpr_write_b32 a214, 0
v_accvgpr_write_b32 a215, 0
v_bfe_u32 v23, v1, 1, 2
v_lshlrev_b32 v23, 1, v23
v_xor_b32 v23, v23, v19
v_lshlrev_b32 v23, 4, v23
v_lshl_add_u32 v23, v20, 7, v23
v_add_u32 v44, s39, v23
v_xor_b32 v45, 64, v44
v_lshrrev_b32 v23, 2, v20
v_lshl_add_u32 v46, v23, 6, v11
v_lshlrev_b32 v47, 3, v20
v_add_u32 v47, 147456, v47
v_mov_b32 v40, 0x3f803f80
v_mov_b32 v41, 0x3f803f80
v_mov_b32 v42, 0x3f803f80
v_mov_b32 v43, 0x3f803f80
s_lshl_b32 s7, s54, 5
s_cmp_lt_u32 s54, 72
s_cselect_b32 s7, s7, 0x10000000
s_add_u32 s45, s7, 0
buffer_load_dwordx4 v[192:195], v29, s[16:19], s45 offen
s_add_u32 s45, s7, 6912
buffer_load_dwordx4 v[196:199], v29, s[16:19], s45 offen
s_add_u32 s45, s7, 13824
buffer_load_dwordx4 v[200:203], v29, s[16:19], s45 offen
s_add_u32 s45, s7, 20736
buffer_load_dwordx4 v[204:207], v29, s[16:19], s45 offen
s_add_u32 s45, s7, 3538944
buffer_load_dwordx4 v[208:211], v28, s[16:19], s45 offen
s_add_u32 s49, s48, 18432
s_mov_b32 s50, 0
s_waitcnt vmcnt(8)
v_lshlrev_b32 v216, 16, v212
v_and_b32 v217, 0xffff0000, v212
v_lshlrev_b32 v218, 16, v213
v_and_b32 v219, 0xffff0000, v213
s_waitcnt vmcnt(7)
v_lshlrev_b32 v220, 16, v214
v_mul_f32 v230, 0xbfb8aa3b, v216
v_mul_f32 v231, 0xbfb8aa3b, v217
v_mul_f32 v232, 0xbfb8aa3b, v218
v_mul_f32 v233, 0xbfb8aa3b, v219
v_mul_f32 v234, 0xbfb8aa3b, v220
v_exp_f32 v230, v230
v_exp_f32 v231, v231
v_exp_f32 v232, v232
v_exp_f32 v233, v233
v_exp_f32 v234, v234
v_add_f32 v230, 1.0, v230
v_add_f32 v231, 1.0, v231
v_add_f32 v232, 1.0, v232
v_add_f32 v233, 1.0, v233
v_add_f32 v234, 1.0, v234
v_rcp_f32 v230, v230
v_rcp_f32 v231, v231
v_rcp_f32 v232, v232
v_rcp_f32 v233, v233
v_rcp_f32 v234, v234
v_mul_f32 v216, v216, v230
v_mul_f32 v217, v217, v231
v_mul_f32 v218, v218, v232
v_mul_f32 v219, v219, v233
v_mul_f32 v220, v220, v234
v_cvt_pk_bf16_f32 v212, v216, v217
v_cvt_pk_bf16_f32 v213, v218, v219
v_cvt_pk_bf16_f32 v214, v220, v220
v_lshlrev_b32 v216, 16, v212
v_and_b32 v217, 0xffff0000, v212
v_lshlrev_b32 v218, 16, v213
v_and_b32 v219, 0xffff0000, v213
v_lshlrev_b32 v220, 16, v214
v_and_b32 v221, 0xffff0000, v214
s_waitcnt lgkmcnt(0)
ds_write_b128 v36, v[216:219]
ds_write_b32 v37, v220 offset:2048
ds_write_b32 v37, v32 offset:2560
ds_write_b32 v37, v32 offset:3072
s_add_u32 s72, s72, 0x7f4a7c15
s_addc_u32 s73, s73, 0x9e3779b9
s_lshl_b32 s7, s4, 19
s_mul_i32 s6, s4, 294912
s_sub_u32 s64, s64, 48
s_subb_u32 s65, s65, 0
s_sub_u32 s66, s66, 96
s_subb_u32 s67, s67, 0
s_add_u32 s92, s64, s7
s_addc_u32 s93, s65, 0
s_mov_b32 s94, 524336
s_mov_b32 s95, 0x20000
s_add_u32 s96, s66, s7
s_addc_u32 s97, s67, 0
s_mov_b32 s98, 524384
s_mov_b32 s99, 0x20000
s_add_u32 s12, s92, 32
s_addc_u32 s13, s93, 0
s_mov_b32 s14, 524304
s_mov_b32 s15, 0x20000
s_add_u32 s16, s96, 64
s_addc_u32 s17, s97, 0
s_mov_b32 s18, 524320
s_mov_b32 s19, 0x20000
s_add_u32 s20, s70, s6
s_addc_u32 s21, s71, 0
s_mov_b32 s22, 294912
s_mov_b32 s23, 0x20000
s_lshl_b32 s6, s4, 9
s_add_u32 s8, s68, s6
s_addc_u32 s9, s69, 0
s_mov_b32 s10, 4710912
s_mov_b32 s11, 0x20000
s_add_u32 m0, s39, 0
s_add_u32 s45, s38, 0
buffer_load_dwordx4 v3, s[56:59], s45 offen lds
s_waitcnt vmcnt(5)
v_lshlrev_b32 v230, 16, v192
v_and_b32 v231, 0xffff0000, v192
v_lshlrev_b32 v232, 16, v193
v_and_b32 v233, 0xffff0000, v193
v_lshlrev_b32 v234, 16, v194
v_and_b32 v235, 0xffff0000, v194
v_lshlrev_b32 v236, 16, v195
s_add_u32 m0, s39, 1024
s_add_u32 s45, s38, 9216
buffer_load_dwordx4 v3, s[56:59], s45 offen lds
v_and_b32 v237, 0xffff0000, v195
v_pk_mul_f32 v[222:223], v[230:231], v[216:217] op_sel_hi:[1,0]
v_pk_mul_f32 v[224:225], v[232:233], v[216:217] op_sel_hi:[1,0]
v_pk_mul_f32 v[226:227], v[234:235], v[216:217] op_sel_hi:[1,0]
v_pk_mul_f32 v[228:229], v[236:237], v[216:217] op_sel_hi:[1,0]
s_waitcnt vmcnt(5)
v_lshlrev_b32 v238, 16, v196
v_and_b32 v239, 0xffff0000, v196
s_add_u32 m0, s39, 2048
s_add_u32 s45, s38, 18432
buffer_load_dwordx4 v3, s[56:59], s45 offen lds
v_lshlrev_b32 v240, 16, v197
v_and_b32 v241, 0xffff0000, v197
v_lshlrev_b32 v242, 16, v198
v_and_b32 v243, 0xffff0000, v198
v_lshlrev_b32 v244, 16, v199
v_and_b32 v245, 0xffff0000, v199
v_pk_fma_f32 v[222:223], v[238:239], v[216:217], v[222:223] op_sel:[0,1,0] op_sel_hi:[1,1,1]
s_add_u32 m0, s39, 3072
s_add_u32 s45, s38, 27648
buffer_load_dwordx4 v3, s[56:59], s45 offen lds
v_pk_fma_f32 v[224:225], v[240:241], v[216:217], v[224:225] op_sel:[0,1,0] op_sel_hi:[1,1,1]
v_pk_fma_f32 v[226:227], v[242:243], v[216:217], v[226:227] op_sel:[0,1,0] op_sel_hi:[1,1,1]
v_pk_fma_f32 v[228:229], v[244:245], v[216:217], v[228:229] op_sel:[0,1,0] op_sel_hi:[1,1,1]
s_waitcnt vmcnt(6)
v_lshlrev_b32 v230, 16, v200
v_and_b32 v231, 0xffff0000, v200
v_lshlrev_b32 v232, 16, v201
v_and_b32 v233, 0xffff0000, v201
s_add_u32 m0, s39, 4096
s_add_u32 s45, s38, 128
buffer_load_dwordx4 v3, s[56:59], s45 offen lds
v_lshlrev_b32 v234, 16, v202
v_and_b32 v235, 0xffff0000, v202
v_lshlrev_b32 v236, 16, v203
v_and_b32 v237, 0xffff0000, v203
v_pk_fma_f32 v[222:223], v[230:231], v[218:219], v[222:223] op_sel:[0,0,0] op_sel_hi:[1,0,1]
v_pk_fma_f32 v[224:225], v[232:233], v[218:219], v[224:225] op_sel:[0,0,0] op_sel_hi:[1,0,1]
v_pk_fma_f32 v[226:227], v[234:235], v[218:219], v[226:227] op_sel:[0,0,0] op_sel_hi:[1,0,1]
s_add_u32 m0, s39, 5120
s_add_u32 s45, s38, 9344
buffer_load_dwordx4 v3, s[56:59], s45 offen lds
v_pk_fma_f32 v[228:229], v[236:237], v[218:219], v[228:229] op_sel:[0,0,0] op_sel_hi:[1,0,1]
s_waitcnt vmcnt(7)
v_lshlrev_b32 v238, 16, v204
v_and_b32 v239, 0xffff0000, v204
v_lshlrev_b32 v240, 16, v205
v_and_b32 v241, 0xffff0000, v205
v_lshlrev_b32 v242, 16, v206
v_and_b32 v243, 0xffff0000, v206
s_add_u32 m0, s39, 6144
s_add_u32 s45, s38, 18560
buffer_load_dwordx4 v3, s[56:59], s45 offen lds
v_lshlrev_b32 v244, 16, v207
v_and_b32 v245, 0xffff0000, v207
v_pk_fma_f32 v[222:223], v[238:239], v[218:219], v[222:223] op_sel:[0,1,0] op_sel_hi:[1,1,1]
v_pk_fma_f32 v[224:225], v[240:241], v[218:219], v[224:225] op_sel:[0,1,0] op_sel_hi:[1,1,1]
v_pk_fma_f32 v[226:227], v[242:243], v[218:219], v[226:227] op_sel:[0,1,0] op_sel_hi:[1,1,1]
v_pk_fma_f32 v[228:229], v[244:245], v[218:219], v[228:229] op_sel:[0,1,0] op_sel_hi:[1,1,1]
s_waitcnt vmcnt(7)
v_lshlrev_b32 v230, 16, v208
s_add_u32 m0, s39, 7168
s_add_u32 s45, s38, 27776
buffer_load_dwordx4 v3, s[56:59], s45 offen lds
v_and_b32 v231, 0xffff0000, v208
v_lshlrev_b32 v232, 16, v209
v_and_b32 v233, 0xffff0000, v209
v_lshlrev_b32 v234, 16, v210
v_and_b32 v235, 0xffff0000, v210
v_lshlrev_b32 v236, 16, v211
v_and_b32 v237, 0xffff0000, v211
s_add_u32 m0, s39, 8192
s_add_u32 s45, s38, 256
buffer_load_dwordx4 v3, s[56:59], s45 offen lds
v_pk_fma_f32 v[222:223], v[230:231], v[220:221], v[222:223] op_sel:[0,0,0] op_sel_hi:[1,0,1]
v_pk_fma_f32 v[224:225], v[232:233], v[220:221], v[224:225] op_sel:[0,0,0] op_sel_hi:[1,0,1]
v_pk_fma_f32 v[226:227], v[234:235], v[220:221], v[226:227] op_sel:[0,0,0] op_sel_hi:[1,0,1]
v_pk_fma_f32 v[228:229], v[236:237], v[220:221], v[228:229] op_sel:[0,0,0] op_sel_hi:[1,0,1]
s_nop 0
v_permlane32_swap_b32 v222, v226
v_permlane32_swap_b32 v223, v227
v_permlane32_swap_b32 v224, v228
s_add_u32 m0, s39, 9216
s_add_u32 s45, s38, 9472
buffer_load_dwordx4 v3, s[56:59], s45 offen lds
v_permlane32_swap_b32 v225, v229
v_pk_add_f32 v[222:223], v[222:223], v[226:227]
v_pk_add_f32 v[224:225], v[224:225], v[228:229]
s_nop 1
v_permlane16_swap_b32 v222, v224
v_permlane16_swap_b32 v223, v225
v_pk_add_f32 v[222:223], v[222:223], v[224:225]
s_nop 1
v_add_f32_dpp v222, v222, v222 row_ror:8 row_mask:0xf bank_mask:0xf
s_add_u32 m0, s39, 10240
s_add_u32 s45, s38, 18688
buffer_load_dwordx4 v3, s[56:59], s45 offen lds
v_add_f32_dpp v223, v223, v223 row_ror:8 row_mask:0xf bank_mask:0xf
v_add_f32_dpp v222, v222, v222 row_ror:4 row_mask:0xf bank_mask:0xf
s_nop 0
v_add_f32_dpp v223, v223, v223 row_ror:4 row_mask:0xf bank_mask:0xf
v_add_f32_dpp v222, v222, v222 row_ror:2 row_mask:0xf bank_mask:0xf
s_nop 0
v_add_f32_dpp v223, v223, v223 row_ror:2 row_mask:0xf bank_mask:0xf
ds_write_b64 v38, v[222:223]
s_add_u32 m0, s39, 11264
s_add_u32 s45, s38, 27904
buffer_load_dwordx4 v3, s[56:59], s45 offen lds
s_cmp_lt_u32 s54, 36
s_cselect_b32 s6, 0, 1.0
s_lshl_b32 s7, s54, 6
s_add_u32 s7, s7, 36864
s_cmp_lt_u32 s54, 72
s_cselect_b32 s7, s7, 0x10000000
v_mov_b32 v218, s72
v_mov_b32 v219, s73
s_waitcnt lgkmcnt(0)
s_barrier
ds_read_b128 v[192:195], v39 offset:0
ds_read_b128 v[196:199], v39 offset:64
ds_read_b128 v[200:203], v39 offset:128
ds_read_b128 v[204:207], v39 offset:192
s_waitcnt lgkmcnt(2)
v_pk_add_f32 v[192:193], v[192:193], v[196:197]
v_pk_add_f32 v[194:195], v[194:195], v[198:199]
s_waitcnt lgkmcnt(0)
v_pk_add_f32 v[200:201], v[200:201], v[204:205]
v_pk_add_f32 v[202:203], v[202:203], v[206:207]
v_pk_add_f32 v[192:193], v[192:193], v[200:201]
v_pk_add_f32 v[194:195], v[194:195], v[202:203]
v_cvt_pk_bf16_f32 v216, v192, v193
v_cvt_pk_bf16_f32 v217, v194, v195
v_lshlrev_b32 v192, 16, v216
v_and_b32 v193, 0xffff0000, v216
v_lshlrev_b32 v194, 16, v217
v_and_b32 v195, 0xffff0000, v217
v_add_f32 v192, s6, v192
v_add_f32 v193, s6, v193
v_add_f32 v194, s6, v194
v_add_f32 v195, s6, v195
v_cvt_pk_bf16_f32 v216, v192, v193
v_cvt_pk_bf16_f32 v217, v194, v195
buffer_store_dwordx4 v[216:219], v33, s[24:27], s7 offen sc1
v_and_b32 v36, 1, v1
v_mov_b32 v37, 0x0c0c0c0c
v_cmp_eq_u32 vcc, 1, v36
v_mov_b32 v38, 0x0c0c0100
v_mov_b32 v39, 0x01000c0c
v_cndmask_b32 v36, v38, v39, vcc
v_mov_b32 v38, 0x0c0c0302
v_mov_b32 v39, 0x03020c0c
v_cndmask_b32 v38, v38, v39, vcc
v_lshrrev_b32 v39, 4, v1
v_bfe_u32 v33, v1, 1, 3
v_lshlrev_b32 v32, 1, v39
v_sub_u32 v33, v33, v32
v_cmp_eq_u32 vcc, 0, v33
s_nop 1
v_cndmask_b32 v236, v37, v36, vcc
v_cndmask_b32 v238, v37, v38, vcc
v_cmp_eq_u32 vcc, 1, v33
s_nop 1
v_cndmask_b32 v237, v37, v36, vcc
v_cndmask_b32 v239, v37, v38, vcc
v_mov_b32 v37, 0xffff0000
v_cmp_eq_u32 vcc, 1, v39
s_nop 1
v_cndmask_b32 v34, 0, v37, vcc
v_cmp_gt_u32 vcc, 2, v39
s_nop 1
v_cndmask_b32 v35, 0, v37, vcc
s_waitcnt vmcnt(9)
ds_read_b128 v[48:51], v44 offset:0
ds_read_b128 v[120:123], v44 offset:2048
ds_read_b128 v[52:55], v45 offset:0
ds_read_b128 v[124:127], v45 offset:2048
s_add_u32 m0, s39, 12288
s_add_u32 s45, s38, 384
buffer_load_dwordx4 v3, s[56:59], s45 offen lds
s_add_u32 m0, s39, 13312
s_add_u32 s45, s38, 9600
buffer_load_dwordx4 v3, s[56:59], s45 offen lds
s_add_u32 m0, s39, 14336
s_add_u32 s45, s38, 18816
buffer_load_dwordx4 v3, s[56:59], s45 offen lds
s_add_u32 m0, s39, 15360
s_add_u32 s45, s38, 28032
buffer_load_dwordx4 v3, s[56:59], s45 offen lds
s_waitcnt vmcnt(9)
ds_read_b128 v[56:59], v44 offset:4096
ds_read_b128 v[128:131], v44 offset:6144
ds_read_b128 v[60:63], v45 offset:4096
ds_read_b128 v[132:135], v45 offset:6144
s_add_u32 m0, s39, 16384
s_add_u32 s45, s38, 512
buffer_load_dwordx4 v3, s[56:59], s45 offen lds
s_waitcnt lgkmcnt(7)
v_mfma_f32_16x16x32_bf16 v[16:19], v[40:43], v[48:51], 0
v_mfma_f32_16x16x32_bf16 v[24:27], v[48:51], v[48:51], 0
s_waitcnt lgkmcnt(6)
s_add_u32 m0, s39, 17408
s_add_u32 s45, s38, 9728
buffer_load_dwordx4 v3, s[56:59], s45 offen lds
v_mfma_f32_16x16x32_bf16 v[20:23], v[40:43], v[120:123], 0
v_mfma_f32_16x16x32_bf16 v[28:31], v[120:123], v[120:123], 0
s_waitcnt lgkmcnt(5)
s_add_u32 m0, s39, 18432
s_add_u32 s45, s38, 18944
buffer_load_dwordx4 v3, s[56:59], s45 offen lds
v_mfma_f32_16x16x32_bf16 v[16:19], v[40:43], v[52:55], v[16:19]
v_mfma_f32_16x16x32_bf16 v[24:27], v[52:55], v[52:55], v[24:27]
s_waitcnt lgkmcnt(0)
s_add_u32 m0, s39, 19456
s_add_u32 s45, s38, 28160
buffer_load_dwordx4 v3, s[56:59], s45 offen lds
v_mfma_f32_16x16x32_bf16 v[20:23], v[40:43], v[124:127], v[20:23]
v_mfma_f32_16x16x32_bf16 v[28:31], v[124:127], v[124:127], v[28:31]
s_waitcnt vmcnt(9)
ds_read_b128 v[64:67], v44 offset:8192
ds_read_b128 v[136:139], v44 offset:10240
ds_read_b128 v[68:71], v45 offset:8192
ds_read_b128 v[140:143], v45 offset:10240
s_add_u32 m0, s39, 20480
s_add_u32 s45, s38, 640
buffer_load_dwordx4 v3, s[56:59], s45 offen lds
v_mfma_f32_16x16x32_bf16 v[16:19], v[40:43], v[56:59], v[16:19]
v_mfma_f32_16x16x32_bf16 v[24:27], v[56:59], v[56:59], v[24:27]
s_add_u32 m0, s39, 21504
s_add_u32 s45, s38, 9856
buffer_load_dwordx4 v3, s[56:59], s45 offen lds
v_mfma_f32_16x16x32_bf16 v[20:23], v[40:43], v[128:131], v[20:23]
v_mfma_f32_16x16x32_bf16 v[28:31], v[128:131], v[128:131], v[28:31]
s_add_u32 m0, s39, 22528
s_add_u32 s45, s38, 19072
buffer_load_dwordx4 v3, s[56:59], s45 offen lds
v_mfma_f32_16x16x32_bf16 v[16:19], v[40:43], v[60:63], v[16:19]
v_mfma_f32_16x16x32_bf16 v[24:27], v[60:63], v[60:63], v[24:27]
s_add_u32 m0, s39, 23552
s_add_u32 s45, s38, 28288
buffer_load_dwordx4 v3, s[56:59], s45 offen lds
v_mfma_f32_16x16x32_bf16 v[20:23], v[40:43], v[132:135], v[20:23]
v_mfma_f32_16x16x32_bf16 v[28:31], v[132:135], v[132:135], v[28:31]
s_waitcnt lgkmcnt(0)
s_waitcnt vmcnt(8)
ds_read_b128 v[72:75], v44 offset:12288
ds_read_b128 v[144:147], v44 offset:14336
ds_read_b128 v[76:79], v45 offset:12288
ds_read_b128 v[148:151], v45 offset:14336
s_add_u32 m0, s39, 24576
s_add_u32 s45, s38, 768
buffer_load_dwordx4 v3, s[56:59], s45 offen lds
v_mfma_f32_16x16x32_bf16 v[16:19], v[40:43], v[64:67], v[16:19]
v_mfma_f32_16x16x32_bf16 v[24:27], v[64:67], v[64:67], v[24:27]
s_add_u32 m0, s39, 25600
s_add_u32 s45, s38, 9984
buffer_load_dwordx4 v3, s[56:59], s45 offen lds
v_mfma_f32_16x16x32_bf16 v[20:23], v[40:43], v[136:139], v[20:23]
v_mfma_f32_16x16x32_bf16 v[28:31], v[136:139], v[136:139], v[28:31]
s_add_u32 m0, s39, 26624
s_add_u32 s45, s38, 19200
buffer_load_dwordx4 v3, s[56:59], s45 offen lds
v_mfma_f32_16x16x32_bf16 v[16:19], v[40:43], v[68:71], v[16:19]
v_mfma_f32_16x16x32_bf16 v[24:27], v[68:71], v[68:71], v[24:27]
s_add_u32 m0, s39, 27648
s_add_u32 s45, s38, 28416
buffer_load_dwordx4 v3, s[56:59], s45 offen lds
v_mfma_f32_16x16x32_bf16 v[20:23], v[40:43], v[140:143], v[20:23]
v_mfma_f32_16x16x32_bf16 v[28:31], v[140:143], v[140:143], v[28:31]
s_waitcnt lgkmcnt(0)
s_waitcnt vmcnt(8)
ds_read_b128 v[80:83], v44 offset:16384
ds_read_b128 v[152:155], v44 offset:18432
ds_read_b128 v[84:87], v45 offset:16384
ds_read_b128 v[156:159], v45 offset:18432
s_add_u32 m0, s39, 28672
s_add_u32 s45, s38, 896
buffer_load_dwordx4 v3, s[56:59], s45 offen lds
v_mfma_f32_16x16x32_bf16 v[16:19], v[40:43], v[72:75], v[16:19]
v_mfma_f32_16x16x32_bf16 v[24:27], v[72:75], v[72:75], v[24:27]
s_add_u32 m0, s39, 29696
s_add_u32 s45, s38, 10112
buffer_load_dwordx4 v3, s[56:59], s45 offen lds
v_mfma_f32_16x16x32_bf16 v[20:23], v[40:43], v[144:147], v[20:23]
v_mfma_f32_16x16x32_bf16 v[28:31], v[144:147], v[144:147], v[28:31]
s_add_u32 m0, s39, 30720
s_add_u32 s45, s38, 19328
buffer_load_dwordx4 v3, s[56:59], s45 offen lds
v_mfma_f32_16x16x32_bf16 v[16:19], v[40:43], v[76:79], v[16:19]
v_mfma_f32_16x16x32_bf16 v[24:27], v[76:79], v[76:79], v[24:27]
s_add_u32 m0, s39, 31744
s_add_u32 s45, s38, 28544
buffer_load_dwordx4 v3, s[56:59], s45 offen lds
v_mfma_f32_16x16x32_bf16 v[20:23], v[40:43], v[148:151], v[20:23]
v_mfma_f32_16x16x32_bf16 v[28:31], v[148:151], v[148:151], v[28:31]
s_waitcnt lgkmcnt(0)
s_waitcnt vmcnt(8)
ds_read_b128 v[88:91], v44 offset:20480
ds_read_b128 v[160:163], v44 offset:22528
ds_read_b128 v[92:95], v45 offset:20480
ds_read_b128 v[164:167], v45 offset:22528
s_add_u32 m0, s39, 32768
s_add_u32 s45, s38, 1024
buffer_load_dwordx4 v3, s[56:59], s45 offen lds
v_mfma_f32_16x16x32_bf16 v[16:19], v[40:43], v[80:83], v[16:19]
v_mfma_f32_16x16x32_bf16 v[24:27], v[80:83], v[80:83], v[24:27]
s_add_u32 m0, s39, 33792
s_add_u32 s45, s38, 10240
buffer_load_dwordx4 v3, s[56:59], s45 offen lds
v_mfma_f32_16x16x32_bf16 v[20:23], v[40:43], v[152:155], v[20:23]
v_mfma_f32_16x16x32_bf16 v[28:31], v[152:155], v[152:155], v[28:31]
s_add_u32 m0, s39, 34816
s_add_u32 s45, s38, 19456
buffer_load_dwordx4 v3, s[56:59], s45 offen lds
v_mfma_f32_16x16x32_bf16 v[16:19], v[40:43], v[84:87], v[16:19]
v_mfma_f32_16x16x32_bf16 v[24:27], v[84:87], v[84:87], v[24:27]
s_add_u32 m0, s39, 35840
s_add_u32 s45, s38, 28672
buffer_load_dwordx4 v3, s[56:59], s45 offen lds
v_mfma_f32_16x16x32_bf16 v[20:23], v[40:43], v[156:159], v[20:23]
v_mfma_f32_16x16x32_bf16 v[28:31], v[156:159], v[156:159], v[28:31]
s_waitcnt lgkmcnt(0)
s_mov_b32 s45, 36864
buffer_load_dwordx4 v[248:251], v246, s[24:27], s45 offen offset:0 sc1
buffer_load_dwordx4 v[252:255], v246, s[24:27], s45 offen offset:16 sc1
s_waitcnt vmcnt(10)
ds_read_b128 v[96:99], v44 offset:24576
ds_read_b128 v[168:171], v44 offset:26624
ds_read_b128 v[100:103], v45 offset:24576
ds_read_b128 v[172:175], v45 offset:26624
v_mfma_f32_16x16x32_bf16 v[16:19], v[40:43], v[88:91], v[16:19]
v_mfma_f32_16x16x32_bf16 v[24:27], v[88:91], v[88:91], v[24:27]
v_mfma_f32_16x16x32_bf16 v[20:23], v[40:43], v[160:163], v[20:23]
v_mfma_f32_16x16x32_bf16 v[28:31], v[160:163], v[160:163], v[28:31]
v_mfma_f32_16x16x32_bf16 v[16:19], v[40:43], v[92:95], v[16:19]
v_mfma_f32_16x16x32_bf16 v[24:27], v[92:95], v[92:95], v[24:27]
v_mfma_f32_16x16x32_bf16 v[20:23], v[40:43], v[164:167], v[20:23]
v_mfma_f32_16x16x32_bf16 v[28:31], v[164:167], v[164:167], v[28:31]
s_waitcnt lgkmcnt(0)
s_waitcnt vmcnt(6)
ds_read_b128 v[104:107], v44 offset:28672
ds_read_b128 v[176:179], v44 offset:30720
ds_read_b128 v[108:111], v45 offset:28672
ds_read_b128 v[180:183], v45 offset:30720
v_mfma_f32_16x16x32_bf16 v[16:19], v[40:43], v[96:99], v[16:19]
v_mfma_f32_16x16x32_bf16 v[24:27], v[96:99], v[96:99], v[24:27]
v_mfma_f32_16x16x32_bf16 v[20:23], v[40:43], v[168:171], v[20:23]
v_mfma_f32_16x16x32_bf16 v[28:31], v[168:171], v[168:171], v[28:31]
v_mfma_f32_16x16x32_bf16 v[16:19], v[40:43], v[100:103], v[16:19]
v_mfma_f32_16x16x32_bf16 v[24:27], v[100:103], v[100:103], v[24:27]
v_mfma_f32_16x16x32_bf16 v[20:23], v[40:43], v[172:175], v[20:23]
v_mfma_f32_16x16x32_bf16 v[28:31], v[172:175], v[172:175], v[28:31]
s_waitcnt lgkmcnt(0)
s_waitcnt vmcnt(2)
ds_read_b128 v[112:115], v44 offset:32768
ds_read_b128 v[184:187], v44 offset:34816
ds_read_b128 v[116:119], v45 offset:32768
ds_read_b128 v[188:191], v45 offset:34816
v_mfma_f32_16x16x32_bf16 v[16:19], v[40:43], v[104:107], v[16:19]
v_mfma_f32_16x16x32_bf16 v[24:27], v[104:107], v[104:107], v[24:27]
v_mfma_f32_16x16x32_bf16 v[20:23], v[40:43], v[176:179], v[20:23]
v_mfma_f32_16x16x32_bf16 v[28:31], v[176:179], v[176:179], v[28:31]
v_mfma_f32_16x16x32_bf16 v[16:19], v[40:43], v[108:111], v[16:19]
v_mfma_f32_16x16x32_bf16 v[24:27], v[108:111], v[108:111], v[24:27]
v_mfma_f32_16x16x32_bf16 v[20:23], v[40:43], v[180:183], v[20:23]
v_mfma_f32_16x16x32_bf16 v[28:31], v[180:183], v[180:183], v[28:31]
s_waitcnt lgkmcnt(0)
v_mfma_f32_16x16x32_bf16 v[16:19], v[40:43], v[112:115], v[16:19]
v_mfma_f32_16x16x32_bf16 v[24:27], v[112:115], v[112:115], v[24:27]
v_mfma_f32_16x16x32_bf16 v[20:23], v[40:43], v[184:187], v[20:23]
v_mfma_f32_16x16x32_bf16 v[28:31], v[184:187], v[184:187], v[28:31]
v_mfma_f32_16x16x32_bf16 v[16:19], v[40:43], v[116:119], v[16:19]
v_mfma_f32_16x16x32_bf16 v[24:27], v[116:119], v[116:119], v[24:27]
v_mfma_f32_16x16x32_bf16 v[20:23], v[40:43], v[188:191], v[20:23]
v_mfma_f32_16x16x32_bf16 v[28:31], v[188:191], v[188:191], v[28:31]
s_waitcnt vmcnt(0)
s_mov_b32 s51, 0x20000
v_cmp_ne_u64 vcc, s[72:73], v[250:251]
v_cmp_ne_u64 s[6:7], s[72:73], v[254:255]
s_nop 1
s_or_b64 vcc, vcc, s[6:7]
s_cbranch_scc0 K1_tg1
K1_tg0:
s_mov_b32 s45, 36864
buffer_load_dwordx4 v[248:251], v246, s[24:27], s45 offen offset:0 sc1
buffer_load_dwordx4 v[252:255], v246, s[24:27], s45 offen offset:16 sc1
s_waitcnt vmcnt(0)
v_cmp_ne_u64 vcc, s[72:73], v[250:251]
v_cmp_ne_u64 s[6:7], s[72:73], v[254:255]
s_nop 1
s_or_b64 vcc, vcc, s[6:7]
s_cbranch_scc0 K1_tg1
s_sub_u32 s51, s51, 1
s_cbranch_scc0 K1_tg0
K1_tg1:
s_mov_b32 s6, 0x05040100
s_mov_b32 s7, 0x07060302
v_perm_b32 v192, v252, v248, s6
v_perm_b32 v193, v252, v248, s7
v_perm_b32 v194, v253, v249, s6
v_perm_b32 v195, v253, v249, s7
ds_write2_b32 v247, v192, v193 offset0:0 offset1:2
ds_write2_b32 v247, v194, v195 offset0:4 offset1:6
v_and_b32 v32, 3, v1
v_cmp_eq_u32 vcc, 1, v32
s_nop 1
v_cndmask_b32 v24, v24, v25, vcc
v_cndmask_b32 v28, v28, v29, vcc
v_cmp_eq_u32 vcc, 2, v32
s_nop 1
v_cndmask_b32 v24, v24, v26, vcc
v_cndmask_b32 v28, v28, v30, vcc
v_cmp_eq_u32 vcc, 3, v32
s_nop 1
v_cndmask_b32 v24, v24, v27, vcc
v_cndmask_b32 v28, v28, v31, vcc
ds_bpermute_b32 v25, v46, v24
ds_bpermute_b32 v29, v46, v28
v_mul_f32 v17, 0xbae38e39, v16
v_mul_f32 v16, v17, v17
v_mul_f32 v21, 0xbae38e39, v20
v_mul_f32 v20, v21, v21
s_waitcnt lgkmcnt(0)
s_barrier
ds_read2_b64 v[192:195], v47 offset0:0 offset1:16
ds_read2_b64 v[196:199], v47 offset0:32 offset1:48
ds_read2_b64 v[200:203], v47 offset0:64 offset1:80
ds_read2_b64 v[204:207], v47 offset0:96 offset1:112
ds_read2_b64 v[208:211], v47 offset0:128 offset1:144
ds_read2_b64 v[212:215], v47 offset0:160 offset1:176
ds_read2_b64 v[216:219], v47 offset0:192 offset1:208
ds_read_b64 v[220:221], v47 offset:1792
ds_read_b64 v[222:223], v47 offset:1920
ds_read_b64 v[224:225], v47 offset:2048
ds_read_b64 v[226:227], v47 offset:2176
v_mul_f32 v25, 0x3ae38e39, v25
v_sub_f32 v16, v25, v16
v_max_f32 v16, 0, v16
v_add_f32 v16, 0x3727c5ac, v16
v_mul_f32 v29, 0x3ae38e39, v29
v_sub_f32 v20, v29, v20
v_max_f32 v20, 0, v20
v_add_f32 v20, 0x3727c5ac, v20
v_rsq_f32 v254, v16
v_rsq_f32 v255, v20
v_mul_f32 v18, v16, v254
v_mul_f32 v22, v20, v255
v_and_b32 v228, v17, v34
v_and_b32 v232, v21, v34
v_and_b32 v229, v18, v34
v_and_b32 v233, v22, v34
v_sub_f32 v17, v17, v228
v_sub_f32 v21, v21, v232
v_sub_f32 v18, v18, v229
v_sub_f32 v22, v22, v233
v_and_b32 v230, v17, v35
v_and_b32 v234, v21, v35
v_and_b32 v231, v18, v35
v_and_b32 v235, v22, v35
v_lshrrev_b32 v228, 16, v230
v_lshrrev_b32 v232, 16, v234
v_lshrrev_b32 v229, 16, v231
v_lshrrev_b32 v233, 16, v235
v_mul_f32 v254, 0x3e0293ee, v254
v_mul_f32 v255, 0x3e0293ee, v255
s_waitcnt lgkmcnt(10)
v_mfma_f32_16x16x16_bf16 v[16:19], v[192:193], v[228:229], 0
v_perm_b32 v240, v192, v192, v236
v_perm_b32 v241, v192, v192, v237
v_mfma_f32_16x16x16_bf16 v[20:23], v[192:193], v[230:231], 0
v_perm_b32 v242, v192, v192, v238
v_perm_b32 v243, v192, v192, v239
s_add_u32 m0, s40, 0
v_mfma_f32_16x16x16_bf16 v[24:27], v[192:193], v[232:233], 0
s_mov_b32 s45, 0
buffer_load_dwordx4 v2, s[8:11], s45 offen lds
s_add_u32 m0, s40, 4096
v_mfma_f32_16x16x16_bf16 v[28:31], v[192:193], v[234:235], 0
s_mov_b32 s45, 262144
buffer_load_dwordx4 v2, s[8:11], s45 offen lds
s_add_u32 m0, s40, 8192
v_mfma_f32_16x16x16_bf16 v[16:19], v[240:241], v[48:49], v[16:19]
s_mov_b32 s45, 524288
buffer_load_dwordx4 v2, s[8:11], s45 offen lds
s_add_u32 m0, s40, 12288
v_mfma_f32_16x16x16_bf16 v[20:23], v[242:243], v[50:51], v[20:23]
s_mov_b32 s45, 786432
buffer_load_dwordx4 v2, s[8:11], s45 offen lds
s_add_u32 m0, s40, 16384
v_mfma_f32_16x16x16_bf16 v[24:27], v[240:241], v[120:121], v[24:27]
s_mov_b32 s45, 1048576
buffer_load_dwordx4 v2, s[8:11], s45 offen lds
s_add_u32 m0, s40, 20480
v_mfma_f32_16x16x16_bf16 v[28:31], v[242:243], v[122:123], v[28:31]
s_mov_b32 s45, 1310720
buffer_load_dwordx4 v2, s[8:11], s45 offen lds
v_mfma_f32_16x16x16_bf16 v[32:35], v[194:195], v[228:229], 0
v_perm_b32 v244, v194, v194, v236
v_perm_b32 v245, v194, v194, v237
v_mfma_f32_16x16x16_bf16 v[36:39], v[194:195], v[230:231], 0
v_perm_b32 v246, v194, v194, v238
v_perm_b32 v247, v194, v194, v239
v_mfma_f32_16x16x16_bf16 v[40:43], v[194:195], v[232:233], 0
v_cvt_pk_bf16_f32 v48, v16, v17
v_cvt_pk_bf16_f32 v49, v18, v19
v_mfma_f32_16x16x16_bf16 v[44:47], v[194:195], v[234:235], 0
v_cvt_pk_bf16_f32 v50, v20, v21
v_cvt_pk_bf16_f32 v51, v22, v23
v_mfma_f32_16x16x16_bf16 v[32:35], v[244:245], v[52:53], v[32:35]
v_cvt_pk_bf16_f32 v120, v24, v25
v_cvt_pk_bf16_f32 v121, v26, v27
v_mfma_f32_16x16x16_bf16 v[36:39], v[246:247], v[54:55], v[36:39]
v_cvt_pk_bf16_f32 v122, v28, v29
v_cvt_pk_bf16_f32 v123, v30, v31
s_add_u32 m0, s40, 24576
v_mfma_f32_16x16x16_bf16 v[40:43], v[244:245], v[124:125], v[40:43]
s_mov_b32 s45, 1572864
buffer_load_dwordx4 v2, s[8:11], s45 offen lds
s_add_u32 m0, s40, 28672
v_mfma_f32_16x16x16_bf16 v[44:47], v[246:247], v[126:127], v[44:47]
s_waitcnt lgkmcnt(0)
s_mov_b32 s45, 1835008
buffer_load_dwordx4 v2, s[8:11], s45 offen lds
v_mfma_f32_16x16x16_bf16 v[16:19], v[196:197], v[228:229], 0
v_perm_b32 v240, v196, v196, v236
v_perm_b32 v241, v196, v196, v237
v_mfma_f32_16x16x16_bf16 v[20:23], v[196:197], v[230:231], 0
v_perm_b32 v242, v196, v196, v238
v_perm_b32 v243, v196, v196, v239
v_mfma_f32_16x16x16_bf16 v[24:27], v[196:197], v[232:233], 0
v_cvt_pk_bf16_f32 v52, v32, v33
v_cvt_pk_bf16_f32 v53, v34, v35
v_mfma_f32_16x16x16_bf16 v[28:31], v[196:197], v[234:235], 0
v_cvt_pk_bf16_f32 v54, v36, v37
v_cvt_pk_bf16_f32 v55, v38, v39
v_mfma_f32_16x16x16_bf16 v[16:19], v[240:241], v[56:57], v[16:19]
v_cvt_pk_bf16_f32 v124, v40, v41
v_cvt_pk_bf16_f32 v125, v42, v43
v_mfma_f32_16x16x16_bf16 v[20:23], v[242:243], v[58:59], v[20:23]
v_cvt_pk_bf16_f32 v126, v44, v45
v_cvt_pk_bf16_f32 v127, v46, v47
s_add_u32 m0, s40, 32768
v_mfma_f32_16x16x16_bf16 v[24:27], v[240:241], v[128:129], v[24:27]
s_mov_b32 s45, 2097152
buffer_load_dwordx4 v2, s[8:11], s45 offen lds
v_mfma_f32_16x16x16_bf16 v[28:31], v[242:243], v[130:131], v[28:31]
v_mfma_f32_16x16x16_bf16 v[32:35], v[198:199], v[228:229], 0
v_perm_b32 v244, v198, v198, v236
v_perm_b32 v245, v198, v198, v237
v_mfma_f32_16x16x16_bf16 v[36:39], v[198:199], v[230:231], 0
v_perm_b32 v246, v198, v198, v238
v_perm_b32 v247, v198, v198, v239
v_mfma_f32_16x16x16_bf16 v[40:43], v[198:199], v[232:233], 0
v_cvt_pk_bf16_f32 v56, v16, v17
v_cvt_pk_bf16_f32 v57, v18, v19
v_mfma_f32_16x16x16_bf16 v[44:47], v[198:199], v[234:235], 0
v_cvt_pk_bf16_f32 v58, v20, v21
v_cvt_pk_bf16_f32 v59, v22, v23
v_mfma_f32_16x16x16_bf16 v[32:35], v[244:245], v[60:61], v[32:35]
v_cvt_pk_bf16_f32 v128, v24, v25
v_cvt_pk_bf16_f32 v129, v26, v27
v_mfma_f32_16x16x16_bf16 v[36:39], v[246:247], v[62:63], v[36:39]
v_cvt_pk_bf16_f32 v130, v28, v29
v_cvt_pk_bf16_f32 v131, v30, v31
v_mfma_f32_16x16x16_bf16 v[40:43], v[244:245], v[132:133], v[40:43]
v_mfma_f32_16x16x16_bf16 v[44:47], v[246:247], v[134:135], v[44:47]
v_mfma_f32_16x16x16_bf16 v[16:19], v[200:201], v[228:229], 0
v_perm_b32 v240, v200, v200, v236
v_perm_b32 v241, v200, v200, v237
v_mfma_f32_16x16x16_bf16 v[20:23], v[200:201], v[230:231], 0
v_perm_b32 v242, v200, v200, v238
v_perm_b32 v243, v200, v200, v239
v_mfma_f32_16x16x16_bf16 v[24:27], v[200:201], v[232:233], 0
v_cvt_pk_bf16_f32 v60, v32, v33
v_cvt_pk_bf16_f32 v61, v34, v35
v_mfma_f32_16x16x16_bf16 v[28:31], v[200:201], v[234:235], 0
v_cvt_pk_bf16_f32 v62, v36, v37
v_cvt_pk_bf16_f32 v63, v38, v39
v_mfma_f32_16x16x16_bf16 v[16:19], v[240:241], v[64:65], v[16:19]
v_cvt_pk_bf16_f32 v132, v40, v41
v_cvt_pk_bf16_f32 v133, v42, v43
v_mfma_f32_16x16x16_bf16 v[20:23], v[242:243], v[66:67], v[20:23]
v_cvt_pk_bf16_f32 v134, v44, v45
v_cvt_pk_bf16_f32 v135, v46, v47
v_mfma_f32_16x16x16_bf16 v[24:27], v[240:241], v[136:137], v[24:27]
v_mfma_f32_16x16x16_bf16 v[28:31], v[242:243], v[138:139], v[28:31]
v_mfma_f32_16x16x16_bf16 v[32:35], v[202:203], v[228:229], 0
v_perm_b32 v244, v202, v202, v236
v_perm_b32 v245, v202, v202, v237
v_mfma_f32_16x16x16_bf16 v[36:39], v[202:203], v[230:231], 0
v_perm_b32 v246, v202, v202, v238
v_perm_b32 v247, v202, v202, v239
v_mfma_f32_16x16x16_bf16 v[40:43], v[202:203], v[232:233], 0
v_cvt_pk_bf16_f32 v64, v16, v17
v_cvt_pk_bf16_f32 v65, v18, v19
v_mfma_f32_16x16x16_bf16 v[44:47], v[202:203], v[234:235], 0
v_cvt_pk_bf16_f32 v66, v20, v21
v_cvt_pk_bf16_f32 v67, v22, v23
v_mfma_f32_16x16x16_bf16 v[32:35], v[244:245], v[68:69], v[32:35]
v_cvt_pk_bf16_f32 v136, v24, v25
v_cvt_pk_bf16_f32 v137, v26, v27
v_mfma_f32_16x16x16_bf16 v[36:39], v[246:247], v[70:71], v[36:39]
v_cvt_pk_bf16_f32 v138, v28, v29
v_cvt_pk_bf16_f32 v139, v30, v31
v_mfma_f32_16x16x16_bf16 v[40:43], v[244:245], v[140:141], v[40:43]
v_mfma_f32_16x16x16_bf16 v[44:47], v[246:247], v[142:143], v[44:47]
v_mfma_f32_16x16x16_bf16 v[16:19], v[204:205], v[228:229], 0
v_perm_b32 v240, v204, v204, v236
v_perm_b32 v241, v204, v204, v237
v_mfma_f32_16x16x16_bf16 v[20:23], v[204:205], v[230:231], 0
v_perm_b32 v242, v204, v204, v238
v_perm_b32 v243, v204, v204, v239
v_mfma_f32_16x16x16_bf16 v[24:27], v[204:205], v[232:233], 0
v_cvt_pk_bf16_f32 v68, v32, v33
v_cvt_pk_bf16_f32 v69, v34, v35
v_mfma_f32_16x16x16_bf16 v[28:31], v[204:205], v[234:235], 0
v_cvt_pk_bf16_f32 v70, v36, v37
v_cvt_pk_bf16_f32 v71, v38, v39
v_mfma_f32_16x16x16_bf16 v[16:19], v[240:241], v[72:73], v[16:19]
v_cvt_pk_bf16_f32 v140, v40, v41
v_cvt_pk_bf16_f32 v141, v42, v43
v_mfma_f32_16x16x16_bf16 v[20:23], v[242:243], v[74:75], v[20:23]
v_cvt_pk_bf16_f32 v142, v44, v45
v_cvt_pk_bf16_f32 v143, v46, v47
v_mfma_f32_16x16x16_bf16 v[24:27], v[240:241], v[144:145], v[24:27]
v_mfma_f32_16x16x16_bf16 v[28:31], v[242:243], v[146:147], v[28:31]
v_mfma_f32_16x16x16_bf16 v[32:35], v[206:207], v[228:229], 0
v_perm_b32 v244, v206, v206, v236
v_perm_b32 v245, v206, v206, v237
v_mfma_f32_16x16x16_bf16 v[36:39], v[206:207], v[230:231], 0
v_perm_b32 v246, v206, v206, v238
v_perm_b32 v247, v206, v206, v239
v_mfma_f32_16x16x16_bf16 v[40:43], v[206:207], v[232:233], 0
v_cvt_pk_bf16_f32 v72, v16, v17
v_cvt_pk_bf16_f32 v73, v18, v19
v_mfma_f32_16x16x16_bf16 v[44:47], v[206:207], v[234:235], 0
v_cvt_pk_bf16_f32 v74, v20, v21
v_cvt_pk_bf16_f32 v75, v22, v23
v_mfma_f32_16x16x16_bf16 v[32:35], v[244:245], v[76:77], v[32:35]
v_cvt_pk_bf16_f32 v144, v24, v25
v_cvt_pk_bf16_f32 v145, v26, v27
v_mfma_f32_16x16x16_bf16 v[36:39], v[246:247], v[78:79], v[36:39]
v_cvt_pk_bf16_f32 v146, v28, v29
v_cvt_pk_bf16_f32 v147, v30, v31
v_mfma_f32_16x16x16_bf16 v[40:43], v[244:245], v[148:149], v[40:43]
v_mfma_f32_16x16x16_bf16 v[44:47], v[246:247], v[150:151], v[44:47]
v_mfma_f32_16x16x16_bf16 v[16:19], v[208:209], v[228:229], 0
v_perm_b32 v240, v208, v208, v236
v_perm_b32 v241, v208, v208, v237
v_mfma_f32_16x16x16_bf16 v[20:23], v[208:209], v[230:231], 0
v_perm_b32 v242, v208, v208, v238
v_perm_b32 v243, v208, v208, v239
v_mfma_f32_16x16x16_bf16 v[24:27], v[208:209], v[232:233], 0
v_cvt_pk_bf16_f32 v76, v32, v33
v_cvt_pk_bf16_f32 v77, v34, v35
v_mfma_f32_16x16x16_bf16 v[28:31], v[208:209], v[234:235], 0
v_cvt_pk_bf16_f32 v78, v36, v37
v_cvt_pk_bf16_f32 v79, v38, v39
v_mfma_f32_16x16x16_bf16 v[16:19], v[240:241], v[80:81], v[16:19]
v_cvt_pk_bf16_f32 v148, v40, v41
v_cvt_pk_bf16_f32 v149, v42, v43
v_mfma_f32_16x16x16_bf16 v[20:23], v[242:243], v[82:83], v[20:23]
v_cvt_pk_bf16_f32 v150, v44, v45
v_cvt_pk_bf16_f32 v151, v46, v47
v_mfma_f32_16x16x16_bf16 v[24:27], v[240:241], v[152:153], v[24:27]
v_mfma_f32_16x16x16_bf16 v[28:31], v[242:243], v[154:155], v[28:31]
v_mfma_f32_16x16x16_bf16 v[32:35], v[210:211], v[228:229], 0
v_perm_b32 v244, v210, v210, v236
v_perm_b32 v245, v210, v210, v237
v_mfma_f32_16x16x16_bf16 v[36:39], v[210:211], v[230:231], 0
v_perm_b32 v246, v210, v210, v238
v_perm_b32 v247, v210, v210, v239
v_mfma_f32_16x16x16_bf16 v[40:43], v[210:211], v[232:233], 0
v_cvt_pk_bf16_f32 v80, v16, v17
v_cvt_pk_bf16_f32 v81, v18, v19
v_mfma_f32_16x16x16_bf16 v[44:47], v[210:211], v[234:235], 0
v_cvt_pk_bf16_f32 v82, v20, v21
v_cvt_pk_bf16_f32 v83, v22, v23
v_mfma_f32_16x16x16_bf16 v[32:35], v[244:245], v[84:85], v[32:35]
v_cvt_pk_bf16_f32 v152, v24, v25
v_cvt_pk_bf16_f32 v153, v26, v27
v_mfma_f32_16x16x16_bf16 v[36:39], v[246:247], v[86:87], v[36:39]
v_cvt_pk_bf16_f32 v154, v28, v29
v_cvt_pk_bf16_f32 v155, v30, v31
v_mfma_f32_16x16x16_bf16 v[40:43], v[244:245], v[156:157], v[40:43]
v_mfma_f32_16x16x16_bf16 v[44:47], v[246:247], v[158:159], v[44:47]
s_add_u32 m0, s40, 36864
s_mov_b32 s45, 2359296
v_mfma_f32_16x16x16_bf16 v[16:19], v[212:213], v[228:229], 0
v_perm_b32 v240, v212, v212, v236
v_perm_b32 v241, v212, v212, v237
v_mfma_f32_16x16x16_bf16 v[20:23], v[212:213], v[230:231], 0
v_perm_b32 v242, v212, v212, v238
v_perm_b32 v243, v212, v212, v239
v_mfma_f32_16x16x16_bf16 v[24:27], v[212:213], v[232:233], 0
v_cvt_pk_bf16_f32 v84, v32, v33
v_cvt_pk_bf16_f32 v85, v34, v35
v_mfma_f32_16x16x16_bf16 v[28:31], v[212:213], v[234:235], 0
v_cvt_pk_bf16_f32 v86, v36, v37
v_cvt_pk_bf16_f32 v87, v38, v39
v_mfma_f32_16x16x16_bf16 v[16:19], v[240:241], v[88:89], v[16:19]
v_cvt_pk_bf16_f32 v156, v40, v41
v_cvt_pk_bf16_f32 v157, v42, v43
v_mfma_f32_16x16x16_bf16 v[20:23], v[242:243], v[90:91], v[20:23]
v_cvt_pk_bf16_f32 v158, v44, v45
v_cvt_pk_bf16_f32 v159, v46, v47
v_mfma_f32_16x16x16_bf16 v[24:27], v[240:241], v[160:161], v[24:27]
buffer_load_dwordx4 v2, s[8:11], s45 offen lds
s_add_u32 m0, s40, 40960
v_mfma_f32_16x16x16_bf16 v[28:31], v[242:243], v[162:163], v[28:31]
s_mov_b32 s45, 2621440
buffer_load_dwordx4 v2, s[8:11], s45 offen lds
v_mfma_f32_16x16x16_bf16 v[32:35], v[214:215], v[228:229], 0
v_perm_b32 v244, v214, v214, v236
v_perm_b32 v245, v214, v214, v237
v_mfma_f32_16x16x16_bf16 v[36:39], v[214:215], v[230:231], 0
v_perm_b32 v246, v214, v214, v238
v_perm_b32 v247, v214, v214, v239
v_mfma_f32_16x16x16_bf16 v[40:43], v[214:215], v[232:233], 0
v_cvt_pk_bf16_f32 v88, v16, v17
v_cvt_pk_bf16_f32 v89, v18, v19
v_mfma_f32_16x16x16_bf16 v[44:47], v[214:215], v[234:235], 0
v_cvt_pk_bf16_f32 v90, v20, v21
v_cvt_pk_bf16_f32 v91, v22, v23
v_mfma_f32_16x16x16_bf16 v[32:35], v[244:245], v[92:93], v[32:35]
v_cvt_pk_bf16_f32 v160, v24, v25
v_cvt_pk_bf16_f32 v161, v26, v27
v_mfma_f32_16x16x16_bf16 v[36:39], v[246:247], v[94:95], v[36:39]
v_cvt_pk_bf16_f32 v162, v28, v29
v_cvt_pk_bf16_f32 v163, v30, v31
s_add_u32 m0, s40, 45056
v_mfma_f32_16x16x16_bf16 v[40:43], v[244:245], v[164:165], v[40:43]
s_mov_b32 s45, 2883584
buffer_load_dwordx4 v2, s[8:11], s45 offen lds
s_add_u32 m0, s40, 49152
v_mfma_f32_16x16x16_bf16 v[44:47], v[246:247], v[166:167], v[44:47]
s_mov_b32 s45, 3145728
buffer_load_dwordx4 v2, s[8:11], s45 offen lds
v_mfma_f32_16x16x16_bf16 v[16:19], v[216:217], v[228:229], 0
v_perm_b32 v240, v216, v216, v236
v_perm_b32 v241, v216, v216, v237
v_mfma_f32_16x16x16_bf16 v[20:23], v[216:217], v[230:231], 0
v_perm_b32 v242, v216, v216, v238
v_perm_b32 v243, v216, v216, v239
v_mfma_f32_16x16x16_bf16 v[24:27], v[216:217], v[232:233], 0
v_cvt_pk_bf16_f32 v92, v32, v33
v_cvt_pk_bf16_f32 v93, v34, v35
v_mfma_f32_16x16x16_bf16 v[28:31], v[216:217], v[234:235], 0
v_cvt_pk_bf16_f32 v94, v36, v37
v_cvt_pk_bf16_f32 v95, v38, v39
v_mfma_f32_16x16x16_bf16 v[16:19], v[240:241], v[96:97], v[16:19]
v_cvt_pk_bf16_f32 v164, v40, v41
v_cvt_pk_bf16_f32 v165, v42, v43
v_mfma_f32_16x16x16_bf16 v[20:23], v[242:243], v[98:99], v[20:23]
v_cvt_pk_bf16_f32 v166, v44, v45
v_cvt_pk_bf16_f32 v167, v46, v47
s_add_u32 m0, s40, 53248
v_mfma_f32_16x16x16_bf16 v[24:27], v[240:241], v[168:169], v[24:27]
s_mov_b32 s45, 3407872
buffer_load_dwordx4 v2, s[8:11], s45 offen lds
s_add_u32 m0, s40, 57344
v_mfma_f32_16x16x16_bf16 v[28:31], v[242:243], v[170:171], v[28:31]
s_mov_b32 s45, 3670016
buffer_load_dwordx4 v2, s[8:11], s45 offen lds
v_mfma_f32_16x16x16_bf16 v[32:35], v[218:219], v[228:229], 0
v_perm_b32 v244, v218, v218, v236
v_perm_b32 v245, v218, v218, v237
v_mfma_f32_16x16x16_bf16 v[36:39], v[218:219], v[230:231], 0
v_perm_b32 v246, v218, v218, v238
v_perm_b32 v247, v218, v218, v239
v_mfma_f32_16x16x16_bf16 v[40:43], v[218:219], v[232:233], 0
v_cvt_pk_bf16_f32 v96, v16, v17
v_cvt_pk_bf16_f32 v97, v18, v19
v_mfma_f32_16x16x16_bf16 v[44:47], v[218:219], v[234:235], 0
v_cvt_pk_bf16_f32 v98, v20, v21
v_cvt_pk_bf16_f32 v99, v22, v23
v_mfma_f32_16x16x16_bf16 v[32:35], v[244:245], v[100:101], v[32:35]
v_cvt_pk_bf16_f32 v168, v24, v25
v_cvt_pk_bf16_f32 v169, v26, v27
v_mfma_f32_16x16x16_bf16 v[36:39], v[246:247], v[102:103], v[36:39]
v_cvt_pk_bf16_f32 v170, v28, v29
v_cvt_pk_bf16_f32 v171, v30, v31
s_add_u32 m0, s40, 61440
v_mfma_f32_16x16x16_bf16 v[40:43], v[244:245], v[172:173], v[40:43]
s_mov_b32 s45, 3932160
buffer_load_dwordx4 v2, s[8:11], s45 offen lds
s_add_u32 m0, s40, 65536
v_mfma_f32_16x16x16_bf16 v[44:47], v[246:247], v[174:175], v[44:47]
s_mov_b32 s45, 4194304
buffer_load_dwordx4 v2, s[8:11], s45 offen lds
v_mfma_f32_16x16x16_bf16 v[16:19], v[220:221], v[228:229], 0
v_perm_b32 v240, v220, v220, v236
v_perm_b32 v241, v220, v220, v237
v_mfma_f32_16x16x16_bf16 v[20:23], v[220:221], v[230:231], 0
v_perm_b32 v242, v220, v220, v238
v_perm_b32 v243, v220, v220, v239
v_mfma_f32_16x16x16_bf16 v[24:27], v[220:221], v[232:233], 0
v_cvt_pk_bf16_f32 v100, v32, v33
v_cvt_pk_bf16_f32 v101, v34, v35
v_mfma_f32_16x16x16_bf16 v[28:31], v[220:221], v[234:235], 0
v_cvt_pk_bf16_f32 v102, v36, v37
v_cvt_pk_bf16_f32 v103, v38, v39
v_mfma_f32_16x16x16_bf16 v[16:19], v[240:241], v[104:105], v[16:19]
v_cvt_pk_bf16_f32 v172, v40, v41
v_cvt_pk_bf16_f32 v173, v42, v43
v_mfma_f32_16x16x16_bf16 v[20:23], v[242:243], v[106:107], v[20:23]
v_cvt_pk_bf16_f32 v174, v44, v45
v_cvt_pk_bf16_f32 v175, v46, v47
s_add_u32 m0, s40, 69632
v_mfma_f32_16x16x16_bf16 v[24:27], v[240:241], v[176:177], v[24:27]
s_mov_b32 s45, 4456448
buffer_load_dwordx4 v2, s[8:11], s45 offen lds
v_mfma_f32_16x16x16_bf16 v[28:31], v[242:243], v[178:179], v[28:31]
v_mfma_f32_16x16x16_bf16 v[32:35], v[222:223], v[228:229], 0
v_perm_b32 v244, v222, v222, v236
v_perm_b32 v245, v222, v222, v237
v_mfma_f32_16x16x16_bf16 v[36:39], v[222:223], v[230:231], 0
v_perm_b32 v246, v222, v222, v238
v_perm_b32 v247, v222, v222, v239
v_mfma_f32_16x16x16_bf16 v[40:43], v[222:223], v[232:233], 0
v_cvt_pk_bf16_f32 v104, v16, v17
v_cvt_pk_bf16_f32 v105, v18, v19
v_mfma_f32_16x16x16_bf16 v[44:47], v[222:223], v[234:235], 0
v_cvt_pk_bf16_f32 v106, v20, v21
v_cvt_pk_bf16_f32 v107, v22, v23
v_mfma_f32_16x16x16_bf16 v[32:35], v[244:245], v[108:109], v[32:35]
v_cvt_pk_bf16_f32 v176, v24, v25
v_cvt_pk_bf16_f32 v177, v26, v27
v_mfma_f32_16x16x16_bf16 v[36:39], v[246:247], v[110:111], v[36:39]
v_cvt_pk_bf16_f32 v178, v28, v29
v_cvt_pk_bf16_f32 v179, v30, v31
v_mfma_f32_16x16x16_bf16 v[40:43], v[244:245], v[180:181], v[40:43]
v_mfma_f32_16x16x16_bf16 v[44:47], v[246:247], v[182:183], v[44:47]
v_mfma_f32_16x16x16_bf16 v[16:19], v[224:225], v[228:229], 0
v_perm_b32 v240, v224, v224, v236
v_perm_b32 v241, v224, v224, v237
v_mfma_f32_16x16x16_bf16 v[20:23], v[224:225], v[230:231], 0
v_perm_b32 v242, v224, v224, v238
v_perm_b32 v243, v224, v224, v239
v_mfma_f32_16x16x16_bf16 v[24:27], v[224:225], v[232:233], 0
v_cvt_pk_bf16_f32 v108, v32, v33
v_cvt_pk_bf16_f32 v109, v34, v35
v_mfma_f32_16x16x16_bf16 v[28:31], v[224:225], v[234:235], 0
v_cvt_pk_bf16_f32 v110, v36, v37
v_cvt_pk_bf16_f32 v111, v38, v39
v_mfma_f32_16x16x16_bf16 v[16:19], v[240:241], v[112:113], v[16:19]
v_cvt_pk_bf16_f32 v180, v40, v41
v_cvt_pk_bf16_f32 v181, v42, v43
v_mfma_f32_16x16x16_bf16 v[20:23], v[242:243], v[114:115], v[20:23]
v_cvt_pk_bf16_f32 v182, v44, v45
v_cvt_pk_bf16_f32 v183, v46, v47
v_mfma_f32_16x16x16_bf16 v[24:27], v[240:241], v[184:185], v[24:27]
v_mfma_f32_16x16x16_bf16 v[28:31], v[242:243], v[186:187], v[28:31]
v_mfma_f32_16x16x16_bf16 v[32:35], v[226:227], v[228:229], 0
v_perm_b32 v244, v226, v226, v236
v_perm_b32 v245, v226, v226, v237
v_mfma_f32_16x16x16_bf16 v[36:39], v[226:227], v[230:231], 0
v_perm_b32 v246, v226, v226, v238
v_perm_b32 v247, v226, v226, v239
v_mfma_f32_16x16x16_bf16 v[40:43], v[226:227], v[232:233], 0
v_cvt_pk_bf16_f32 v112, v16, v17
v_cvt_pk_bf16_f32 v113, v18, v19
v_mfma_f32_16x16x16_bf16 v[44:47], v[226:227], v[234:235], 0
v_cvt_pk_bf16_f32 v114, v20, v21
v_cvt_pk_bf16_f32 v115, v22, v23
v_mfma_f32_16x16x16_bf16 v[32:35], v[244:245], v[116:117], v[32:35]
v_cvt_pk_bf16_f32 v184, v24, v25
v_cvt_pk_bf16_f32 v185, v26, v27
v_mfma_f32_16x16x16_bf16 v[36:39], v[246:247], v[118:119], v[36:39]
v_cvt_pk_bf16_f32 v186, v28, v29
v_cvt_pk_bf16_f32 v187, v30, v31
v_mfma_f32_16x16x16_bf16 v[40:43], v[244:245], v[188:189], v[40:43]
v_mfma_f32_16x16x16_bf16 v[44:47], v[246:247], v[190:191], v[44:47]
s_waitcnt vmcnt(9)
s_barrier
ds_read_b64_tr_b16 a[128:129], v12 offset:0
ds_read_b64_tr_b16 a[130:131], v12 offset:2048
ds_read_b64_tr_b16 a[132:133], v12 offset:4096
ds_read_b64_tr_b16 a[134:135], v12 offset:6144
ds_read_b64_tr_b16 a[136:137], v12 offset:8192
ds_read_b64_tr_b16 a[138:139], v12 offset:10240
ds_read_b64_tr_b16 a[140:141], v12 offset:12288
ds_read_b64_tr_b16 a[142:143], v12 offset:14336
ds_read_b64_tr_b16 a[144:145], v12 offset:16384
ds_read_b64_tr_b16 a[146:147], v12 offset:18432
ds_read_b64_tr_b16 a[148:149], v12 offset:20480
ds_read_b64_tr_b16 a[150:151], v12 offset:22528
ds_read_b64_tr_b16 a[152:153], v12 offset:24576
ds_read_b64_tr_b16 a[154:155], v12 offset:26624
ds_read_b64_tr_b16 a[156:157], v12 offset:28672
ds_read_b64_tr_b16 a[158:159], v12 offset:30720
ds_read_b64_tr_b16 a[160:161], v12 offset:32768
ds_read_b64_tr_b16 a[162:163], v12 offset:34816
v_cvt_pk_bf16_f32 v116, v32, v33
v_cvt_pk_bf16_f32 v117, v34, v35
v_cvt_pk_bf16_f32 v118, v36, v37
v_cvt_pk_bf16_f32 v119, v38, v39
v_cvt_pk_bf16_f32 v188, v40, v41
v_cvt_pk_bf16_f32 v189, v42, v43
v_cvt_pk_bf16_f32 v190, v44, v45
v_cvt_pk_bf16_f32 v191, v46, v47
s_waitcnt lgkmcnt(15)
v_mfma_f32_16x16x32_bf16 v[16:19], a[128:131], v[48:51], 0
s_waitcnt lgkmcnt(14)
ds_read_b64_tr_b16 a[164:165], v13 offset:0
ds_read_b64_tr_b16 a[166:167], v13 offset:2048
s_add_u32 m0, s40, 73728
v_mfma_f32_16x16x32_bf16 v[16:19], a[132:135], v[52:55], v[16:19]
s_waitcnt lgkmcnt(14)
s_mov_b32 s45, 128
buffer_load_dwordx4 v2, s[8:11], s45 offen lds
v_mfma_f32_16x16x32_bf16 v[16:19], a[136:139], v[56:59], v[16:19]
s_waitcnt lgkmcnt(12)
ds_read_b64_tr_b16 a[168:169], v13 offset:4096
ds_read_b64_tr_b16 a[170:171], v13 offset:6144
v_mfma_f32_16x16x32_bf16 v[16:19], a[140:143], v[60:63], v[16:19]
s_waitcnt lgkmcnt(12)
v_add_u32 v12, 0x9000, v12
v_mfma_f32_16x16x32_bf16 v[16:19], a[144:147], v[64:67], v[16:19]
s_waitcnt lgkmcnt(10)
ds_read_b64_tr_b16 a[172:173], v13 offset:8192
ds_read_b64_tr_b16 a[174:175], v13 offset:10240
v_mfma_f32_16x16x32_bf16 v[16:19], a[148:151], v[68:71], v[16:19]
s_waitcnt lgkmcnt(6)
s_add_u32 m0, s40, 77824
s_mov_b32 s45, 262272
v_mfma_f32_16x16x32_bf16 v[16:19], a[152:155], v[72:75], v[16:19]
ds_read_b64_tr_b16 a[176:177], v13 offset:12288
ds_read_b64_tr_b16 a[178:179], v13 offset:14336
v_mfma_f32_16x16x32_bf16 v[16:19], a[156:159], v[76:79], v[16:19]
buffer_load_dwordx4 v2, s[8:11], s45 offen lds
v_mfma_f32_16x16x32_bf16 v[16:19], a[160:163], v[80:83], v[16:19]
ds_read_b64_tr_b16 a[180:181], v13 offset:16384
ds_read_b64_tr_b16 a[182:183], v13 offset:18432
v_mfma_f32_16x16x32_bf16 v[20:23], a[128:131], v[120:123], 0
v_mfma_f32_16x16x32_bf16 v[20:23], a[132:135], v[124:127], v[20:23]
ds_read_b64_tr_b16 a[184:185], v13 offset:20480
ds_read_b64_tr_b16 a[186:187], v13 offset:22528
v_mfma_f32_16x16x32_bf16 v[20:23], a[136:139], v[128:131], v[20:23]
s_add_u32 m0, s40, 81920
s_mov_b32 s45, 524416
v_mfma_f32_16x16x32_bf16 v[20:23], a[140:143], v[132:135], v[20:23]
ds_read_b64_tr_b16 a[188:189], v13 offset:24576
ds_read_b64_tr_b16 a[190:191], v13 offset:26624
v_mfma_f32_16x16x32_bf16 v[20:23], a[144:147], v[136:139], v[20:23]
buffer_load_dwordx4 v2, s[8:11], s45 offen lds
v_mfma_f32_16x16x32_bf16 v[20:23], a[148:151], v[140:143], v[20:23]
ds_read_b64_tr_b16 a[192:193], v13 offset:28672
ds_read_b64_tr_b16 a[194:195], v13 offset:30720
v_mfma_f32_16x16x32_bf16 v[20:23], a[152:155], v[144:147], v[20:23]
v_mfma_f32_16x16x32_bf16 v[20:23], a[156:159], v[148:151], v[20:23]
ds_read_b64_tr_b16 a[196:197], v13 offset:32768
ds_read_b64_tr_b16 a[198:199], v13 offset:34816
v_mfma_f32_16x16x32_bf16 v[20:23], a[160:163], v[152:155], v[20:23]
s_waitcnt lgkmcnt(6)
s_add_u32 m0, s40, 86016
s_mov_b32 s45, 786560
v_mfma_f32_16x16x32_bf16 v[24:27], a[164:167], v[48:51], 0
ds_read_b64_tr_b16 a[128:129], v14 offset:0
ds_read_b64_tr_b16 a[130:131], v14 offset:2048
v_mfma_f32_16x16x32_bf16 v[24:27], a[168:171], v[52:55], v[24:27]
buffer_load_dwordx4 v2, s[8:11], s45 offen lds
v_mfma_f32_16x16x32_bf16 v[24:27], a[172:175], v[56:59], v[24:27]
ds_read_b64_tr_b16 a[132:133], v14 offset:4096
ds_read_b64_tr_b16 a[134:135], v14 offset:6144
v_mfma_f32_16x16x32_bf16 v[24:27], a[176:179], v[60:63], v[24:27]
v_add_u32 v13, 0x9000, v13
v_min_u32 v252, 15, v0
v_mfma_f32_16x16x32_bf16 v[24:27], a[180:183], v[64:67], v[24:27]
ds_read_b64_tr_b16 a[136:137], v14 offset:8192
ds_read_b64_tr_b16 a[138:139], v14 offset:10240
v_mfma_f32_16x16x32_bf16 v[24:27], a[184:187], v[68:71], v[24:27]
s_waitcnt lgkmcnt(6)
s_lshr_b32 s6, s2, 3
s_lshl_b32 s6, s6, 7
v_lshl_add_u32 v252, v252, 12, s6
v_add_u32 v252, 0x10000, v252
v_mfma_f32_16x16x32_bf16 v[24:27], a[188:191], v[72:75], v[24:27]
ds_read_b64_tr_b16 a[140:141], v14 offset:12288
ds_read_b64_tr_b16 a[142:143], v14 offset:14336
s_add_u32 m0, s40, 90112
v_mfma_f32_16x16x32_bf16 v[24:27], a[192:195], v[76:79], v[24:27]
s_mov_b32 s45, 1048704
buffer_load_dwordx4 v2, s[8:11], s45 offen lds
v_mfma_f32_16x16x32_bf16 v[24:27], a[196:199], v[80:83], v[24:27]
ds_read_b64_tr_b16 a[144:145], v14 offset:16384
ds_read_b64_tr_b16 a[146:147], v14 offset:18432
v_mfma_f32_16x16x32_bf16 v[28:31], a[164:167], v[120:123], 0
v_min_u32 v252, K1_last-K1_pc-4, v252
v_mfma_f32_16x16x32_bf16 v[28:31], a[168:171], v[124:127], v[28:31]
ds_read_b64_tr_b16 a[148:149], v14 offset:20480
ds_read_b64_tr_b16 a[150:151], v14 offset:22528
v_mfma_f32_16x16x32_bf16 v[28:31], a[172:175], v[128:131], v[28:31]
s_add_u32 m0, s40, 94208
s_mov_b32 s45, 1310848
v_mfma_f32_16x16x32_bf16 v[28:31], a[176:179], v[132:135], v[28:31]
ds_read_b64_tr_b16 a[152:153], v14 offset:24576
ds_read_b64_tr_b16 a[154:155], v14 offset:26624
v_mfma_f32_16x16x32_bf16 v[28:31], a[180:183], v[136:139], v[28:31]
buffer_load_dwordx4 v2, s[8:11], s45 offen lds
v_mfma_f32_16x16x32_bf16 v[28:31], a[184:187], v[140:143], v[28:31]
ds_read_b64_tr_b16 a[156:157], v14 offset:28672
ds_read_b64_tr_b16 a[158:159], v14 offset:30720
v_mfma_f32_16x16x32_bf16 v[28:31], a[188:191], v[144:147], v[28:31]
v_mfma_f32_16x16x32_bf16 v[28:31], a[192:195], v[148:151], v[28:31]
ds_read_b64_tr_b16 a[160:161], v14 offset:32768
ds_read_b64_tr_b16 a[162:163], v14 offset:34816
v_mfma_f32_16x16x32_bf16 v[28:31], a[196:199], v[152:155], v[28:31]
s_waitcnt lgkmcnt(6)
s_add_u32 m0, s40, 98304
s_mov_b32 s45, 1572992
v_mfma_f32_16x16x32_bf16 v[32:35], a[128:131], v[48:51], 0
ds_read_b64_tr_b16 a[164:165], v15 offset:0
ds_read_b64_tr_b16 a[166:167], v15 offset:2048
v_mfma_f32_16x16x32_bf16 v[32:35], a[132:135], v[52:55], v[32:35]
buffer_load_dwordx4 v2, s[8:11], s45 offen lds
v_mfma_f32_16x16x32_bf16 v[32:35], a[136:139], v[56:59], v[32:35]
ds_read_b64_tr_b16 a[168:169], v15 offset:4096
ds_read_b64_tr_b16 a[170:171], v15 offset:6144
v_mfma_f32_16x16x32_bf16 v[32:35], a[140:143], v[60:63], v[32:35]
v_add_u32 v14, 0x9000, v14
v_mfma_f32_16x16x32_bf16 v[32:35], a[144:147], v[64:67], v[32:35]
ds_read_b64_tr_b16 a[172:173], v15 offset:8192
ds_read_b64_tr_b16 a[174:175], v15 offset:10240
v_mfma_f32_16x16x32_bf16 v[32:35], a[148:151], v[68:71], v[32:35]
s_waitcnt lgkmcnt(6)
s_add_u32 m0, s40, 102400
s_mov_b32 s45, 1835136
v_mfma_f32_16x16x32_bf16 v[32:35], a[152:155], v[72:75], v[32:35]
ds_read_b64_tr_b16 a[176:177], v15 offset:12288
ds_read_b64_tr_b16 a[178:179], v15 offset:14336
v_mfma_f32_16x16x32_bf16 v[32:35], a[156:159], v[76:79], v[32:35]
buffer_load_dwordx4 v2, s[8:11], s45 offen lds
v_mfma_f32_16x16x32_bf16 v[32:35], a[160:163], v[80:83], v[32:35]
ds_read_b64_tr_b16 a[180:181], v15 offset:16384
ds_read_b64_tr_b16 a[182:183], v15 offset:18432
v_mfma_f32_16x16x32_bf16 v[36:39], a[128:131], v[120:123], 0
v_mfma_f32_16x16x32_bf16 v[36:39], a[132:135], v[124:127], v[36:39]
ds_read_b64_tr_b16 a[184:185], v15 offset:20480
ds_read_b64_tr_b16 a[186:187], v15 offset:22528
v_mfma_f32_16x16x32_bf16 v[36:39], a[136:139], v[128:131], v[36:39]
s_add_u32 m0, s40, 106496
s_mov_b32 s45, 2097280
v_mfma_f32_16x16x32_bf16 v[36:39], a[140:143], v[132:135], v[36:39]
ds_read_b64_tr_b16 a[188:189], v15 offset:24576
ds_read_b64_tr_b16 a[190:191], v15 offset:26624
v_mfma_f32_16x16x32_bf16 v[36:39], a[144:147], v[136:139], v[36:39]
buffer_load_dwordx4 v2, s[8:11], s45 offen lds
v_mfma_f32_16x16x32_bf16 v[36:39], a[148:151], v[140:143], v[36:39]
ds_read_b64_tr_b16 a[192:193], v15 offset:28672
ds_read_b64_tr_b16 a[194:195], v15 offset:30720
v_mfma_f32_16x16x32_bf16 v[36:39], a[152:155], v[144:147], v[36:39]
v_mfma_f32_16x16x32_bf16 v[36:39], a[156:159], v[148:151], v[36:39]
ds_read_b64_tr_b16 a[196:197], v15 offset:32768
ds_read_b64_tr_b16 a[198:199], v15 offset:34816
v_mfma_f32_16x16x32_bf16 v[36:39], a[160:163], v[152:155], v[36:39]
s_waitcnt lgkmcnt(6)
s_mov_b32 s45, 2359424
v_mfma_f32_16x16x32_bf16 v[40:43], a[164:167], v[48:51], 0
s_waitcnt vmcnt(9)
s_barrier
ds_read_b64_tr_b16 a[128:129], v12 offset:0
ds_read_b64_tr_b16 a[130:131], v12 offset:2048
v_mfma_f32_16x16x32_bf16 v[40:43], a[168:171], v[52:55], v[40:43]
v_add_u32 v15, 0x9000, v15
s_add_u32 m0, s40, 110592
v_mfma_f32_16x16x32_bf16 v[40:43], a[172:175], v[56:59], v[40:43]
ds_read_b64_tr_b16 a[132:133], v12 offset:4096
ds_read_b64_tr_b16 a[134:135], v12 offset:6144
v_mfma_f32_16x16x32_bf16 v[40:43], a[176:179], v[60:63], v[40:43]
buffer_load_dwordx4 v2, s[8:11], s45 offen lds
v_mfma_f32_16x16x32_bf16 v[40:43], a[180:183], v[64:67], v[40:43]
ds_read_b64_tr_b16 a[136:137], v12 offset:8192
ds_read_b64_tr_b16 a[138:139], v12 offset:10240
v_mfma_f32_16x16x32_bf16 v[40:43], a[184:187], v[68:71], v[40:43]
s_waitcnt lgkmcnt(6)
v_mfma_f32_16x16x32_bf16 v[40:43], a[188:191], v[72:75], v[40:43]
ds_read_b64_tr_b16 a[140:141], v12 offset:12288
ds_read_b64_tr_b16 a[142:143], v12 offset:14336
v_mfma_f32_16x16x32_bf16 v[40:43], a[192:195], v[76:79], v[40:43]
v_mfma_f32_16x16x32_bf16 v[40:43], a[196:199], v[80:83], v[40:43]
ds_read_b64_tr_b16 a[144:145], v12 offset:16384
ds_read_b64_tr_b16 a[146:147], v12 offset:18432
v_mfma_f32_16x16x32_bf16 v[44:47], a[164:167], v[120:123], 0
s_add_u32 m0, s40, 114688
s_mov_b32 s45, 2621568
v_mfma_f32_16x16x32_bf16 v[44:47], a[168:171], v[124:127], v[44:47]
ds_read_b64_tr_b16 a[148:149], v12 offset:20480
ds_read_b64_tr_b16 a[150:151], v12 offset:22528
v_mfma_f32_16x16x32_bf16 v[44:47], a[172:175], v[128:131], v[44:47]
buffer_load_dwordx4 v2, s[8:11], s45 offen lds
v_mfma_f32_16x16x32_bf16 v[44:47], a[176:179], v[132:135], v[44:47]
ds_read_b64_tr_b16 a[152:153], v12 offset:24576
ds_read_b64_tr_b16 a[154:155], v12 offset:26624
v_mfma_f32_16x16x32_bf16 v[44:47], a[180:183], v[136:139], v[44:47]
v_mfma_f32_16x16x32_bf16 v[44:47], a[184:187], v[140:143], v[44:47]
ds_read_b64_tr_b16 a[156:157], v12 offset:28672
ds_read_b64_tr_b16 a[158:159], v12 offset:30720
v_mfma_f32_16x16x32_bf16 v[44:47], a[188:191], v[144:147], v[44:47]
v_mfma_f32_16x16x32_bf16 v[44:47], a[192:195], v[148:151], v[44:47]
ds_read_b64_tr_b16 a[160:161], v12 offset:32768
ds_read_b64_tr_b16 a[162:163], v12 offset:34816
v_mfma_f32_16x16x32_bf16 v[44:47], a[196:199], v[152:155], v[44:47]
s_waitcnt lgkmcnt(6)
s_add_u32 m0, s40, 118784
s_mov_b32 s45, 2883712
v_mfma_f32_16x16x32_bf16 v[16:19], a[128:131], v[84:87], v[16:19]
ds_read_b64_tr_b16 a[164:165], v13 offset:0
ds_read_b64_tr_b16 a[166:167], v13 offset:2048
v_mfma_f32_16x16x32_bf16 v[16:19], a[132:135], v[88:91], v[16:19]
buffer_load_dwordx4 v2, s[8:11], s45 offen lds
v_mfma_f32_16x16x32_bf16 v[16:19], a[136:139], v[92:95], v[16:19]
ds_read_b64_tr_b16 a[168:169], v13 offset:4096
ds_read_b64_tr_b16 a[170:171], v13 offset:6144
v_mfma_f32_16x16x32_bf16 v[16:19], a[140:143], v[96:99], v[16:19]
v_add_u32 v12, 0x9000, v12
v_mfma_f32_16x16x32_bf16 v[16:19], a[144:147], v[100:103], v[16:19]
ds_read_b64_tr_b16 a[172:173], v13 offset:8192
ds_read_b64_tr_b16 a[174:175], v13 offset:10240
v_mfma_f32_16x16x32_bf16 v[16:19], a[148:151], v[104:107], v[16:19]
s_waitcnt lgkmcnt(6)
v_mfma_f32_16x16x32_bf16 v[16:19], a[152:155], v[108:111], v[16:19]
ds_read_b64_tr_b16 a[176:177], v13 offset:12288
ds_read_b64_tr_b16 a[178:179], v13 offset:14336
v_mfma_f32_16x16x32_bf16 v[16:19], a[156:159], v[112:115], v[16:19]
s_add_u32 m0, s40, 122880
s_mov_b32 s45, 3145856
v_mfma_f32_16x16x32_bf16 v[16:19], a[160:163], v[116:119], v[16:19]
ds_read_b64_tr_b16 a[180:181], v13 offset:16384
ds_read_b64_tr_b16 a[182:183], v13 offset:18432
v_mfma_f32_16x16x32_bf16 v[20:23], a[128:131], v[156:159], v[20:23]
buffer_load_dwordx4 v2, s[8:11], s45 offen lds
v_mfma_f32_16x16x32_bf16 v[20:23], a[132:135], v[160:163], v[20:23]
ds_read_b64_tr_b16 a[184:185], v13 offset:20480
ds_read_b64_tr_b16 a[186:187], v13 offset:22528
v_mfma_f32_16x16x32_bf16 v[20:23], a[136:139], v[164:167], v[20:23]
v_mfma_f32_16x16x32_bf16 v[20:23], a[140:143], v[168:171], v[20:23]
ds_read_b64_tr_b16 a[188:189], v13 offset:24576
ds_read_b64_tr_b16 a[190:191], v13 offset:26624
v_mfma_f32_16x16x32_bf16 v[20:23], a[144:147], v[172:175], v[20:23]
v_mfma_f32_16x16x32_bf16 v[20:23], a[148:151], v[176:179], v[20:23]
ds_read_b64_tr_b16 a[192:193], v13 offset:28672
ds_read_b64_tr_b16 a[194:195], v13 offset:30720
v_mfma_f32_16x16x32_bf16 v[20:23], a[152:155], v[180:183], v[20:23]
s_add_u32 m0, s40, 126976
s_mov_b32 s45, 3408000
v_mfma_f32_16x16x32_bf16 v[20:23], a[156:159], v[184:187], v[20:23]
ds_read_b64_tr_b16 a[196:197], v13 offset:32768
ds_read_b64_tr_b16 a[198:199], v13 offset:34816
v_mfma_f32_16x16x32_bf16 v[20:23], a[160:163], v[188:191], v[20:23]
s_waitcnt lgkmcnt(6)
buffer_load_dwordx4 v2, s[8:11], s45 offen lds
v_mfma_f32_16x16x32_bf16 v[24:27], a[164:167], v[84:87], v[24:27]
ds_read_b64_tr_b16 a[128:129], v14 offset:0
ds_read_b64_tr_b16 a[130:131], v14 offset:2048
v_mfma_f32_16x16x32_bf16 v[24:27], a[168:171], v[88:91], v[24:27]
v_add_u32 v13, 0x9000, v13
s_add_u32 m0, s40, 131072
v_mfma_f32_16x16x32_bf16 v[24:27], a[172:175], v[92:95], v[24:27]
ds_read_b64_tr_b16 a[132:133], v14 offset:4096
ds_read_b64_tr_b16 a[134:135], v14 offset:6144
v_mfma_f32_16x16x32_bf16 v[24:27], a[176:179], v[96:99], v[24:27]
v_mul_f32 v16, v16, v254
v_mul_f32 v17, v17, v254
v_mfma_f32_16x16x32_bf16 v[24:27], a[180:183], v[100:103], v[24:27]
ds_read_b64_tr_b16 a[136:137], v14 offset:8192
ds_read_b64_tr_b16 a[138:139], v14 offset:10240
v_mfma_f32_16x16x32_bf16 v[24:27], a[184:187], v[104:107], v[24:27]
s_waitcnt lgkmcnt(6)
v_mul_f32 v18, v18, v254
v_mul_f32 v19, v19, v254
v_mfma_f32_16x16x32_bf16 v[24:27], a[188:191], v[108:111], v[24:27]
ds_read_b64_tr_b16 a[140:141], v14 offset:12288
ds_read_b64_tr_b16 a[142:143], v14 offset:14336
v_mfma_f32_16x16x32_bf16 v[24:27], a[192:195], v[112:115], v[24:27]
s_mov_b32 s45, 3670144
buffer_load_dwordx4 v2, s[8:11], s45 offen lds
v_mfma_f32_16x16x32_bf16 v[24:27], a[196:199], v[116:119], v[24:27]
ds_read_b64_tr_b16 a[144:145], v14 offset:16384
ds_read_b64_tr_b16 a[146:147], v14 offset:18432
v_mfma_f32_16x16x32_bf16 v[28:31], a[164:167], v[156:159], v[28:31]
v_mul_f32 v20, v20, v255
v_mul_f32 v21, v21, v255
v_mfma_f32_16x16x32_bf16 v[28:31], a[168:171], v[160:163], v[28:31]
ds_read_b64_tr_b16 a[148:149], v14 offset:20480
ds_read_b64_tr_b16 a[150:151], v14 offset:22528
v_mfma_f32_16x16x32_bf16 v[28:31], a[172:175], v[164:167], v[28:31]
v_mul_f32 v22, v22, v255
v_mul_f32 v23, v23, v255
v_mfma_f32_16x16x32_bf16 v[28:31], a[176:179], v[168:171], v[28:31]
ds_read_b64_tr_b16 a[152:153], v14 offset:24576
ds_read_b64_tr_b16 a[154:155], v14 offset:26624
v_mfma_f32_16x16x32_bf16 v[28:31], a[180:183], v[172:175], v[28:31]
v_cvt_pk_bf16_f32 v192, v16, v17
v_cvt_pk_bf16_f32 v193, v18, v19
v_mfma_f32_16x16x32_bf16 v[28:31], a[184:187], v[176:179], v[28:31]
ds_read_b64_tr_b16 a[156:157], v14 offset:28672
ds_read_b64_tr_b16 a[158:159], v14 offset:30720
s_add_u32 m0, s40, 135168
v_mfma_f32_16x16x32_bf16 v[28:31], a[188:191], v[180:183], v[28:31]
s_mov_b32 s45, 3932288
buffer_load_dwordx4 v2, s[8:11], s45 offen lds
v_mfma_f32_16x16x32_bf16 v[28:31], a[192:195], v[184:187], v[28:31]
ds_read_b64_tr_b16 a[160:161], v14 offset:32768
ds_read_b64_tr_b16 a[162:163], v14 offset:34816
v_mfma_f32_16x16x32_bf16 v[28:31], a[196:199], v[188:191], v[28:31]
s_waitcnt lgkmcnt(6)
v_cvt_pk_bf16_f32 v208, v20, v21
v_cvt_pk_bf16_f32 v209, v22, v23
v_mfma_f32_16x16x32_bf16 v[32:35], a[128:131], v[84:87], v[32:35]
ds_read_b64_tr_b16 a[164:165], v15 offset:0
ds_read_b64_tr_b16 a[166:167], v15 offset:2048
v_mfma_f32_16x16x32_bf16 v[32:35], a[132:135], v[88:91], v[32:35]
v_add_u32 v14, 0x9000, v14
s_add_u32 m0, s40, 139264
v_mfma_f32_16x16x32_bf16 v[32:35], a[136:139], v[92:95], v[32:35]
ds_read_b64_tr_b16 a[168:169], v15 offset:4096
ds_read_b64_tr_b16 a[170:171], v15 offset:6144
v_mfma_f32_16x16x32_bf16 v[32:35], a[140:143], v[96:99], v[32:35]
v_mul_f32 v24, v24, v254
v_mul_f32 v25, v25, v254
v_mfma_f32_16x16x32_bf16 v[32:35], a[144:147], v[100:103], v[32:35]
ds_read_b64_tr_b16 a[172:173], v15 offset:8192
ds_read_b64_tr_b16 a[174:175], v15 offset:10240
v_mfma_f32_16x16x32_bf16 v[32:35], a[148:151], v[104:107], v[32:35]
s_waitcnt lgkmcnt(6)
s_mov_b32 s45, 4194432
buffer_load_dwordx4 v2, s[8:11], s45 offen lds
v_mfma_f32_16x16x32_bf16 v[32:35], a[152:155], v[108:111], v[32:35]
ds_read_b64_tr_b16 a[176:177], v15 offset:12288
ds_read_b64_tr_b16 a[178:179], v15 offset:14336
v_mfma_f32_16x16x32_bf16 v[32:35], a[156:159], v[112:115], v[32:35]
v_mul_f32 v26, v26, v254
v_mul_f32 v27, v27, v254
v_mfma_f32_16x16x32_bf16 v[32:35], a[160:163], v[116:119], v[32:35]
ds_read_b64_tr_b16 a[180:181], v15 offset:16384
ds_read_b64_tr_b16 a[182:183], v15 offset:18432
v_mfma_f32_16x16x32_bf16 v[36:39], a[128:131], v[156:159], v[36:39]
v_mul_f32 v28, v28, v255
v_mul_f32 v29, v29, v255
v_mfma_f32_16x16x32_bf16 v[36:39], a[132:135], v[160:163], v[36:39]
ds_read_b64_tr_b16 a[184:185], v15 offset:20480
ds_read_b64_tr_b16 a[186:187], v15 offset:22528
v_mfma_f32_16x16x32_bf16 v[36:39], a[136:139], v[164:167], v[36:39]
v_mul_f32 v30, v30, v255
v_mul_f32 v31, v31, v255
v_mfma_f32_16x16x32_bf16 v[36:39], a[140:143], v[168:171], v[36:39]
ds_read_b64_tr_b16 a[188:189], v15 offset:24576
ds_read_b64_tr_b16 a[190:191], v15 offset:26624
s_add_u32 m0, s40, 143360
v_mfma_f32_16x16x32_bf16 v[36:39], a[144:147], v[172:175], v[36:39]
s_mov_b32 s45, 4456576
buffer_load_dwordx4 v2, s[8:11], s45 offen lds
v_mfma_f32_16x16x32_bf16 v[36:39], a[148:151], v[176:179], v[36:39]
ds_read_b64_tr_b16 a[192:193], v15 offset:28672
ds_read_b64_tr_b16 a[194:195], v15 offset:30720
v_mfma_f32_16x16x32_bf16 v[36:39], a[152:155], v[180:183], v[36:39]
v_cvt_pk_bf16_f32 v194, v24, v25
v_cvt_pk_bf16_f32 v195, v26, v27
v_mfma_f32_16x16x32_bf16 v[36:39], a[156:159], v[184:187], v[36:39]
ds_read_b64_tr_b16 a[196:197], v15 offset:32768
ds_read_b64_tr_b16 a[198:199], v15 offset:34816
v_mfma_f32_16x16x32_bf16 v[36:39], a[160:163], v[188:191], v[36:39]
s_waitcnt lgkmcnt(6)
v_cvt_pk_bf16_f32 v210, v28, v29
v_cvt_pk_bf16_f32 v211, v30, v31
v_mfma_f32_16x16x32_bf16 v[40:43], a[164:167], v[84:87], v[40:43]
s_waitcnt vmcnt(9)
s_barrier
ds_read_b64_tr_b16 a[128:129], v12 offset:0
ds_read_b64_tr_b16 a[130:131], v12 offset:2048
v_mfma_f32_16x16x32_bf16 v[40:43], a[168:171], v[88:91], v[40:43]
v_add_u32 v15, 0x9000, v15
v_permlane16_swap_b32 v192, v194
v_mfma_f32_16x16x32_bf16 v[40:43], a[172:175], v[92:95], v[40:43]
ds_read_b64_tr_b16 a[132:133], v12 offset:4096
ds_read_b64_tr_b16 a[134:135], v12 offset:6144
s_add_u32 m0, s40, 0
v_mfma_f32_16x16x32_bf16 v[40:43], a[176:179], v[96:99], v[40:43]
s_mov_b32 s45, 256
buffer_load_dwordx4 v2, s[8:11], s45 offen lds
v_mfma_f32_16x16x32_bf16 v[40:43], a[180:183], v[100:103], v[40:43]
ds_read_b64_tr_b16 a[136:137], v12 offset:8192
ds_read_b64_tr_b16 a[138:139], v12 offset:10240
v_mfma_f32_16x16x32_bf16 v[40:43], a[184:187], v[104:107], v[40:43]
s_waitcnt lgkmcnt(6)
v_permlane16_swap_b32 v193, v195
v_permlane16_swap_b32 v208, v210
v_mfma_f32_16x16x32_bf16 v[40:43], a[188:191], v[108:111], v[40:43]
ds_read_b64_tr_b16 a[140:141], v12 offset:12288
ds_read_b64_tr_b16 a[142:143], v12 offset:14336
v_mfma_f32_16x16x32_bf16 v[40:43], a[192:195], v[112:115], v[40:43]
v_permlane16_swap_b32 v209, v211
v_mul_f32 v32, v32, v254
v_mfma_f32_16x16x32_bf16 v[40:43], a[196:199], v[116:119], v[40:43]
ds_read_b64_tr_b16 a[144:145], v12 offset:16384
ds_read_b64_tr_b16 a[146:147], v12 offset:18432
v_mfma_f32_16x16x32_bf16 v[44:47], a[164:167], v[156:159], v[44:47]
v_mul_f32 v33, v33, v254
v_mul_f32 v34, v34, v254
v_mfma_f32_16x16x32_bf16 v[44:47], a[168:171], v[160:163], v[44:47]
ds_read_b64_tr_b16 a[148:149], v12 offset:20480
ds_read_b64_tr_b16 a[150:151], v12 offset:22528
s_add_u32 m0, s40, 4096
v_mfma_f32_16x16x32_bf16 v[44:47], a[172:175], v[164:167], v[44:47]
s_mov_b32 s45, 262400
buffer_load_dwordx4 v2, s[8:11], s45 offen lds
v_mfma_f32_16x16x32_bf16 v[44:47], a[176:179], v[168:171], v[44:47]
ds_read_b64_tr_b16 a[152:153], v12 offset:24576
ds_read_b64_tr_b16 a[154:155], v12 offset:26624
v_mfma_f32_16x16x32_bf16 v[44:47], a[180:183], v[172:175], v[44:47]
v_mul_f32 v35, v35, v254
v_mul_f32 v36, v36, v255
v_mfma_f32_16x16x32_bf16 v[44:47], a[184:187], v[176:179], v[44:47]
ds_read_b64_tr_b16 a[156:157], v12 offset:28672
ds_read_b64_tr_b16 a[158:159], v12 offset:30720
v_mfma_f32_16x16x32_bf16 v[44:47], a[188:191], v[180:183], v[44:47]
v_mul_f32 v37, v37, v255
v_mul_f32 v38, v38, v255
v_mfma_f32_16x16x32_bf16 v[44:47], a[192:195], v[184:187], v[44:47]
ds_read_b64_tr_b16 a[160:161], v12 offset:32768
ds_read_b64_tr_b16 a[162:163], v12 offset:34816
v_mfma_f32_16x16x32_bf16 v[44:47], a[196:199], v[188:191], v[44:47]
s_waitcnt lgkmcnt(6)
v_mul_f32 v39, v39, v255
v_cvt_pk_bf16_f32 v196, v32, v33
v_mfma_f32_16x16x32_bf16 v[16:19], a[128:131], v[48:51], 0
ds_read_b64_tr_b16 a[164:165], v13 offset:0
ds_read_b64_tr_b16 a[166:167], v13 offset:2048
s_add_u32 m0, s40, 8192
v_mfma_f32_16x16x32_bf16 v[16:19], a[132:135], v[52:55], v[16:19]
s_mov_b32 s45, 524544
buffer_load_dwordx4 v2, s[8:11], s45 offen lds
v_mfma_f32_16x16x32_bf16 v[16:19], a[136:139], v[56:59], v[16:19]
ds_read_b64_tr_b16 a[168:169], v13 offset:4096
ds_read_b64_tr_b16 a[170:171], v13 offset:6144
v_mfma_f32_16x16x32_bf16 v[16:19], a[140:143], v[60:63], v[16:19]
v_add_u32 v12, 0x9000, v12
v_cvt_pk_bf16_f32 v197, v34, v35
v_mfma_f32_16x16x32_bf16 v[16:19], a[144:147], v[64:67], v[16:19]
ds_read_b64_tr_b16 a[172:173], v13 offset:8192
ds_read_b64_tr_b16 a[174:175], v13 offset:10240
v_mfma_f32_16x16x32_bf16 v[16:19], a[148:151], v[68:71], v[16:19]
s_waitcnt lgkmcnt(6)
v_cvt_pk_bf16_f32 v212, v36, v37
v_cvt_pk_bf16_f32 v213, v38, v39
v_mfma_f32_16x16x32_bf16 v[16:19], a[152:155], v[72:75], v[16:19]
ds_read_b64_tr_b16 a[176:177], v13 offset:12288
ds_read_b64_tr_b16 a[178:179], v13 offset:14336
v_mfma_f32_16x16x32_bf16 v[16:19], a[156:159], v[76:79], v[16:19]
v_mul_f32 v40, v40, v254
v_mul_f32 v41, v41, v254
v_mfma_f32_16x16x32_bf16 v[16:19], a[160:163], v[80:83], v[16:19]
ds_read_b64_tr_b16 a[180:181], v13 offset:16384
ds_read_b64_tr_b16 a[182:183], v13 offset:18432
s_add_u32 m0, s40, 12288
v_mfma_f32_16x16x32_bf16 v[20:23], a[128:131], v[120:123], 0
s_mov_b32 s45, 786688
buffer_load_dwordx4 v2, s[8:11], s45 offen lds
v_mfma_f32_16x16x32_bf16 v[20:23], a[132:135], v[124:127], v[20:23]
ds_read_b64_tr_b16 a[184:185], v13 offset:20480
ds_read_b64_tr_b16 a[186:187], v13 offset:22528
v_mfma_f32_16x16x32_bf16 v[20:23], a[136:139], v[128:131], v[20:23]
v_mul_f32 v42, v42, v254
v_mul_f32 v43, v43, v254
v_mfma_f32_16x16x32_bf16 v[20:23], a[140:143], v[132:135], v[20:23]
ds_read_b64_tr_b16 a[188:189], v13 offset:24576
ds_read_b64_tr_b16 a[190:191], v13 offset:26624
v_mfma_f32_16x16x32_bf16 v[20:23], a[144:147], v[136:139], v[20:23]
v_mul_f32 v44, v44, v255
v_mul_f32 v45, v45, v255
v_mfma_f32_16x16x32_bf16 v[20:23], a[148:151], v[140:143], v[20:23]
ds_read_b64_tr_b16 a[192:193], v13 offset:28672
ds_read_b64_tr_b16 a[194:195], v13 offset:30720
v_mfma_f32_16x16x32_bf16 v[20:23], a[152:155], v[144:147], v[20:23]
v_mul_f32 v46, v46, v255
v_mul_f32 v47, v47, v255
v_mfma_f32_16x16x32_bf16 v[20:23], a[156:159], v[148:151], v[20:23]
ds_read_b64_tr_b16 a[196:197], v13 offset:32768
ds_read_b64_tr_b16 a[198:199], v13 offset:34816
s_add_u32 m0, s40, 16384
v_mfma_f32_16x16x32_bf16 v[20:23], a[160:163], v[152:155], v[20:23]
s_waitcnt lgkmcnt(6)
s_mov_b32 s45, 1048832
buffer_load_dwordx4 v2, s[8:11], s45 offen lds
v_mfma_f32_16x16x32_bf16 v[24:27], a[164:167], v[48:51], 0
ds_read_b64_tr_b16 a[128:129], v14 offset:0
ds_read_b64_tr_b16 a[130:131], v14 offset:2048
v_mfma_f32_16x16x32_bf16 v[24:27], a[168:171], v[52:55], v[24:27]
v_add_u32 v13, 0x9000, v13
v_cvt_pk_bf16_f32 v198, v40, v41
v_mfma_f32_16x16x32_bf16 v[24:27], a[172:175], v[56:59], v[24:27]
ds_read_b64_tr_b16 a[132:133], v14 offset:4096
ds_read_b64_tr_b16 a[134:135], v14 offset:6144
v_mfma_f32_16x16x32_bf16 v[24:27], a[176:179], v[60:63], v[24:27]
v_cvt_pk_bf16_f32 v199, v42, v43
v_cvt_pk_bf16_f32 v214, v44, v45
v_mfma_f32_16x16x32_bf16 v[24:27], a[180:183], v[64:67], v[24:27]
ds_read_b64_tr_b16 a[136:137], v14 offset:8192
ds_read_b64_tr_b16 a[138:139], v14 offset:10240
v_mfma_f32_16x16x32_bf16 v[24:27], a[184:187], v[68:71], v[24:27]
s_waitcnt lgkmcnt(6)
v_cvt_pk_bf16_f32 v215, v46, v47
s_add_u32 m0, s40, 20480
v_mfma_f32_16x16x32_bf16 v[24:27], a[188:191], v[72:75], v[24:27]
ds_read_b64_tr_b16 a[140:141], v14 offset:12288
ds_read_b64_tr_b16 a[142:143], v14 offset:14336
v_mfma_f32_16x16x32_bf16 v[24:27], a[192:195], v[76:79], v[24:27]
s_mov_b32 s45, 1310976
buffer_load_dwordx4 v2, s[8:11], s45 offen lds
v_mfma_f32_16x16x32_bf16 v[24:27], a[196:199], v[80:83], v[24:27]
ds_read_b64_tr_b16 a[144:145], v14 offset:16384
ds_read_b64_tr_b16 a[146:147], v14 offset:18432
v_mfma_f32_16x16x32_bf16 v[28:31], a[164:167], v[120:123], 0
v_permlane16_swap_b32 v196, v198
v_permlane16_swap_b32 v197, v199
v_mfma_f32_16x16x32_bf16 v[28:31], a[168:171], v[124:127], v[28:31]
ds_read_b64_tr_b16 a[148:149], v14 offset:20480
ds_read_b64_tr_b16 a[150:151], v14 offset:22528
v_mfma_f32_16x16x32_bf16 v[28:31], a[172:175], v[128:131], v[28:31]
v_permlane16_swap_b32 v212, v214
v_permlane16_swap_b32 v213, v215
v_mfma_f32_16x16x32_bf16 v[28:31], a[176:179], v[132:135], v[28:31]
ds_read_b64_tr_b16 a[152:153], v14 offset:24576
ds_read_b64_tr_b16 a[154:155], v14 offset:26624
v_mfma_f32_16x16x32_bf16 v[28:31], a[180:183], v[136:139], v[28:31]
s_add_u32 m0, s40, 24576
s_mov_b32 s45, 1573120
v_mfma_f32_16x16x32_bf16 v[28:31], a[184:187], v[140:143], v[28:31]
ds_read_b64_tr_b16 a[156:157], v14 offset:28672
ds_read_b64_tr_b16 a[158:159], v14 offset:30720
v_mfma_f32_16x16x32_bf16 v[28:31], a[188:191], v[144:147], v[28:31]
buffer_load_dwordx4 v2, s[8:11], s45 offen lds
v_mfma_f32_16x16x32_bf16 v[28:31], a[192:195], v[148:151], v[28:31]
ds_read_b64_tr_b16 a[160:161], v14 offset:32768
ds_read_b64_tr_b16 a[162:163], v14 offset:34816
v_mfma_f32_16x16x32_bf16 v[28:31], a[196:199], v[152:155], v[28:31]
s_waitcnt lgkmcnt(6)
s_mov_b32 s45, 1835264
v_mfma_f32_16x16x32_bf16 v[32:35], a[128:131], v[48:51], 0
ds_read_b64_tr_b16 a[164:165], v15 offset:0
ds_read_b64_tr_b16 a[166:167], v15 offset:2048
v_mfma_f32_16x16x32_bf16 v[32:35], a[132:135], v[52:55], v[32:35]
v_add_u32 v14, 0x9000, v14
s_add_u32 m0, s40, 28672
v_mfma_f32_16x16x32_bf16 v[32:35], a[136:139], v[56:59], v[32:35]
ds_read_b64_tr_b16 a[168:169], v15 offset:4096
ds_read_b64_tr_b16 a[170:171], v15 offset:6144
v_mfma_f32_16x16x32_bf16 v[32:35], a[140:143], v[60:63], v[32:35]
global_load_dword a255, v252, s[78:79]
v_mfma_f32_16x16x32_bf16 v[32:35], a[144:147], v[64:67], v[32:35]
ds_read_b64_tr_b16 a[172:173], v15 offset:8192
ds_read_b64_tr_b16 a[174:175], v15 offset:10240
v_mfma_f32_16x16x32_bf16 v[32:35], a[148:151], v[68:71], v[32:35]
s_waitcnt lgkmcnt(6)
buffer_load_dwordx4 v2, s[8:11], s45 offen lds
v_mfma_f32_16x16x32_bf16 v[32:35], a[152:155], v[72:75], v[32:35]
ds_read_b64_tr_b16 a[176:177], v15 offset:12288
ds_read_b64_tr_b16 a[178:179], v15 offset:14336
v_mfma_f32_16x16x32_bf16 v[32:35], a[156:159], v[76:79], v[32:35]
v_mfma_f32_16x16x32_bf16 v[32:35], a[160:163], v[80:83], v[32:35]
ds_read_b64_tr_b16 a[180:181], v15 offset:16384
ds_read_b64_tr_b16 a[182:183], v15 offset:18432
v_mfma_f32_16x16x32_bf16 v[36:39], a[128:131], v[120:123], 0
v_mfma_f32_16x16x32_bf16 v[36:39], a[132:135], v[124:127], v[36:39]
ds_read_b64_tr_b16 a[184:185], v15 offset:20480
ds_read_b64_tr_b16 a[186:187], v15 offset:22528
v_mfma_f32_16x16x32_bf16 v[36:39], a[136:139], v[128:131], v[36:39]
s_add_u32 m0, s40, 32768
s_mov_b32 s45, 2097408
v_mfma_f32_16x16x32_bf16 v[36:39], a[140:143], v[132:135], v[36:39]
ds_read_b64_tr_b16 a[188:189], v15 offset:24576
ds_read_b64_tr_b16 a[190:191], v15 offset:26624
v_mfma_f32_16x16x32_bf16 v[36:39], a[144:147], v[136:139], v[36:39]
buffer_load_dwordx4 v2, s[8:11], s45 offen lds
v_mfma_f32_16x16x32_bf16 v[36:39], a[148:151], v[140:143], v[36:39]
ds_read_b64_tr_b16 a[192:193], v15 offset:28672
ds_read_b64_tr_b16 a[194:195], v15 offset:30720
v_mfma_f32_16x16x32_bf16 v[36:39], a[152:155], v[144:147], v[36:39]
v_mfma_f32_16x16x32_bf16 v[36:39], a[156:159], v[148:151], v[36:39]
ds_read_b64_tr_b16 a[196:197], v15 offset:32768
ds_read_b64_tr_b16 a[198:199], v15 offset:34816
v_mfma_f32_16x16x32_bf16 v[36:39], a[160:163], v[152:155], v[36:39]
s_waitcnt lgkmcnt(6)
s_mov_b32 s45, 2359552
v_mfma_f32_16x16x32_bf16 v[40:43], a[164:167], v[48:51], 0
s_waitcnt vmcnt(10)
s_barrier
ds_read_b64_tr_b16 a[128:129], v12 offset:0
ds_read_b64_tr_b16 a[130:131], v12 offset:2048
v_mfma_f32_16x16x32_bf16 v[40:43], a[168:171], v[52:55], v[40:43]
v_add_u32 v15, 0x9000, v15
s_add_u32 m0, s40, 36864
v_mfma_f32_16x16x32_bf16 v[40:43], a[172:175], v[56:59], v[40:43]
ds_read_b64_tr_b16 a[132:133], v12 offset:4096
ds_read_b64_tr_b16 a[134:135], v12 offset:6144
v_mfma_f32_16x16x32_bf16 v[40:43], a[176:179], v[60:63], v[40:43]
buffer_load_dwordx4 v2, s[8:11], s45 offen lds
v_mfma_f32_16x16x32_bf16 v[40:43], a[180:183], v[64:67], v[40:43]
ds_read_b64_tr_b16 a[136:137], v12 offset:8192
ds_read_b64_tr_b16 a[138:139], v12 offset:10240
v_mfma_f32_16x16x32_bf16 v[40:43], a[184:187], v[68:71], v[40:43]
s_waitcnt lgkmcnt(6)
v_mfma_f32_16x16x32_bf16 v[40:43], a[188:191], v[72:75], v[40:43]
ds_read_b64_tr_b16 a[140:141], v12 offset:12288
ds_read_b64_tr_b16 a[142:143], v12 offset:14336
v_mfma_f32_16x16x32_bf16 v[40:43], a[192:195], v[76:79], v[40:43]
v_mfma_f32_16x16x32_bf16 v[40:43], a[196:199], v[80:83], v[40:43]
ds_read_b64_tr_b16 a[144:145], v12 offset:16384
ds_read_b64_tr_b16 a[146:147], v12 offset:18432
v_mfma_f32_16x16x32_bf16 v[44:47], a[164:167], v[120:123], 0
s_add_u32 m0, s40, 40960
s_mov_b32 s45, 2621696
v_mfma_f32_16x16x32_bf16 v[44:47], a[168:171], v[124:127], v[44:47]
ds_read_b64_tr_b16 a[148:149], v12 offset:20480
ds_read_b64_tr_b16 a[150:151], v12 offset:22528
v_mfma_f32_16x16x32_bf16 v[44:47], a[172:175], v[128:131], v[44:47]
buffer_load_dwordx4 v2, s[8:11], s45 offen lds
v_mfma_f32_16x16x32_bf16 v[44:47], a[176:179], v[132:135], v[44:47]
ds_read_b64_tr_b16 a[152:153], v12 offset:24576
ds_read_b64_tr_b16 a[154:155], v12 offset:26624
v_mfma_f32_16x16x32_bf16 v[44:47], a[180:183], v[136:139], v[44:47]
v_mfma_f32_16x16x32_bf16 v[44:47], a[184:187], v[140:143], v[44:47]
ds_read_b64_tr_b16 a[156:157], v12 offset:28672
ds_read_b64_tr_b16 a[158:159], v12 offset:30720
v_mfma_f32_16x16x32_bf16 v[44:47], a[188:191], v[144:147], v[44:47]
v_mfma_f32_16x16x32_bf16 v[44:47], a[192:195], v[148:151], v[44:47]
ds_read_b64_tr_b16 a[160:161], v12 offset:32768
ds_read_b64_tr_b16 a[162:163], v12 offset:34816
v_mfma_f32_16x16x32_bf16 v[44:47], a[196:199], v[152:155], v[44:47]
s_waitcnt lgkmcnt(6)
s_add_u32 m0, s40, 45056
s_mov_b32 s45, 2883840
v_mfma_f32_16x16x32_bf16 v[16:19], a[128:131], v[84:87], v[16:19]
ds_read_b64_tr_b16 a[164:165], v13 offset:0
ds_read_b64_tr_b16 a[166:167], v13 offset:2048
v_mfma_f32_16x16x32_bf16 v[16:19], a[132:135], v[88:91], v[16:19]
buffer_load_dwordx4 v2, s[8:11], s45 offen lds
v_mfma_f32_16x16x32_bf16 v[16:19], a[136:139], v[92:95], v[16:19]
ds_read_b64_tr_b16 a[168:169], v13 offset:4096
ds_read_b64_tr_b16 a[170:171], v13 offset:6144
v_mfma_f32_16x16x32_bf16 v[16:19], a[140:143], v[96:99], v[16:19]
v_add_u32 v12, 0xfffe5000, v12
v_mfma_f32_16x16x32_bf16 v[16:19], a[144:147], v[100:103], v[16:19]
ds_read_b64_tr_b16 a[172:173], v13 offset:8192
ds_read_b64_tr_b16 a[174:175], v13 offset:10240
v_mfma_f32_16x16x32_bf16 v[16:19], a[148:151], v[104:107], v[16:19]
s_waitcnt lgkmcnt(6)
v_mfma_f32_16x16x32_bf16 v[16:19], a[152:155], v[108:111], v[16:19]
ds_read_b64_tr_b16 a[176:177], v13 offset:12288
ds_read_b64_tr_b16 a[178:179], v13 offset:14336
v_mfma_f32_16x16x32_bf16 v[16:19], a[156:159], v[112:115], v[16:19]
s_add_u32 m0, s40, 49152
s_mov_b32 s45, 3145984
v_mfma_f32_16x16x32_bf16 v[16:19], a[160:163], v[116:119], v[16:19]
ds_read_b64_tr_b16 a[180:181], v13 offset:16384
ds_read_b64_tr_b16 a[182:183], v13 offset:18432
v_mfma_f32_16x16x32_bf16 v[20:23], a[128:131], v[156:159], v[20:23]
buffer_load_dwordx4 v2, s[8:11], s45 offen lds
v_mfma_f32_16x16x32_bf16 v[20:23], a[132:135], v[160:163], v[20:23]
ds_read_b64_tr_b16 a[184:185], v13 offset:20480
ds_read_b64_tr_b16 a[186:187], v13 offset:22528
v_mfma_f32_16x16x32_bf16 v[20:23], a[136:139], v[164:167], v[20:23]
v_mfma_f32_16x16x32_bf16 v[20:23], a[140:143], v[168:171], v[20:23]
ds_read_b64_tr_b16 a[188:189], v13 offset:24576
ds_read_b64_tr_b16 a[190:191], v13 offset:26624
v_mfma_f32_16x16x32_bf16 v[20:23], a[144:147], v[172:175], v[20:23]
v_mfma_f32_16x16x32_bf16 v[20:23], a[148:151], v[176:179], v[20:23]
ds_read_b64_tr_b16 a[192:193], v13 offset:28672
ds_read_b64_tr_b16 a[194:195], v13 offset:30720
v_mfma_f32_16x16x32_bf16 v[20:23], a[152:155], v[180:183], v[20:23]
s_add_u32 m0, s40, 53248
s_mov_b32 s45, 3408128
v_mfma_f32_16x16x32_bf16 v[20:23], a[156:159], v[184:187], v[20:23]
ds_read_b64_tr_b16 a[196:197], v13 offset:32768
ds_read_b64_tr_b16 a[198:199], v13 offset:34816
v_mfma_f32_16x16x32_bf16 v[20:23], a[160:163], v[188:191], v[20:23]
s_waitcnt lgkmcnt(6)
buffer_load_dwordx4 v2, s[8:11], s45 offen lds
v_mfma_f32_16x16x32_bf16 v[24:27], a[164:167], v[84:87], v[24:27]
ds_read_b64_tr_b16 a[128:129], v14 offset:0
ds_read_b64_tr_b16 a[130:131], v14 offset:2048
v_mfma_f32_16x16x32_bf16 v[24:27], a[168:171], v[88:91], v[24:27]
v_add_u32 v13, 0xfffe5000, v13
s_add_u32 m0, s40, 57344
v_mfma_f32_16x16x32_bf16 v[24:27], a[172:175], v[92:95], v[24:27]
ds_read_b64_tr_b16 a[132:133], v14 offset:4096
ds_read_b64_tr_b16 a[134:135], v14 offset:6144
v_mfma_f32_16x16x32_bf16 v[24:27], a[176:179], v[96:99], v[24:27]
v_mul_f32 v16, v16, v254
v_mul_f32 v17, v17, v254
v_mfma_f32_16x16x32_bf16 v[24:27], a[180:183], v[100:103], v[24:27]
ds_read_b64_tr_b16 a[136:137], v14 offset:8192
ds_read_b64_tr_b16 a[138:139], v14 offset:10240
v_mfma_f32_16x16x32_bf16 v[24:27], a[184:187], v[104:107], v[24:27]
s_waitcnt lgkmcnt(6)
v_mul_f32 v18, v18, v254
v_mul_f32 v19, v19, v254
v_mfma_f32_16x16x32_bf16 v[24:27], a[188:191], v[108:111], v[24:27]
ds_read_b64_tr_b16 a[140:141], v14 offset:12288
ds_read_b64_tr_b16 a[142:143], v14 offset:14336
v_mfma_f32_16x16x32_bf16 v[24:27], a[192:195], v[112:115], v[24:27]
s_mov_b32 s45, 3670272
buffer_load_dwordx4 v2, s[8:11], s45 offen lds
v_mfma_f32_16x16x32_bf16 v[24:27], a[196:199], v[116:119], v[24:27]
ds_read_b64_tr_b16 a[144:145], v14 offset:16384
ds_read_b64_tr_b16 a[146:147], v14 offset:18432
v_mfma_f32_16x16x32_bf16 v[28:31], a[164:167], v[156:159], v[28:31]
v_mul_f32 v20, v20, v255
v_mul_f32 v21, v21, v255
v_mfma_f32_16x16x32_bf16 v[28:31], a[168:171], v[160:163], v[28:31]
ds_read_b64_tr_b16 a[148:149], v14 offset:20480
ds_read_b64_tr_b16 a[150:151], v14 offset:22528
v_mfma_f32_16x16x32_bf16 v[28:31], a[172:175], v[164:167], v[28:31]
v_mul_f32 v22, v22, v255
v_mul_f32 v23, v23, v255
v_mfma_f32_16x16x32_bf16 v[28:31], a[176:179], v[168:171], v[28:31]
ds_read_b64_tr_b16 a[152:153], v14 offset:24576
ds_read_b64_tr_b16 a[154:155], v14 offset:26624
v_mfma_f32_16x16x32_bf16 v[28:31], a[180:183], v[172:175], v[28:31]
v_cvt_pk_bf16_f32 v200, v16, v17
v_cvt_pk_bf16_f32 v201, v18, v19
v_mfma_f32_16x16x32_bf16 v[28:31], a[184:187], v[176:179], v[28:31]
ds_read_b64_tr_b16 a[156:157], v14 offset:28672
ds_read_b64_tr_b16 a[158:159], v14 offset:30720
s_add_u32 m0, s40, 61440
v_mfma_f32_16x16x32_bf16 v[28:31], a[188:191], v[180:183], v[28:31]
s_mov_b32 s45, 3932416
buffer_load_dwordx4 v2, s[8:11], s45 offen lds
v_mfma_f32_16x16x32_bf16 v[28:31], a[192:195], v[184:187], v[28:31]
ds_read_b64_tr_b16 a[160:161], v14 offset:32768
ds_read_b64_tr_b16 a[162:163], v14 offset:34816
v_mfma_f32_16x16x32_bf16 v[28:31], a[196:199], v[188:191], v[28:31]
s_waitcnt lgkmcnt(6)
v_cvt_pk_bf16_f32 v216, v20, v21
v_cvt_pk_bf16_f32 v217, v22, v23
v_mfma_f32_16x16x32_bf16 v[32:35], a[128:131], v[84:87], v[32:35]
ds_read_b64_tr_b16 a[164:165], v15 offset:0
ds_read_b64_tr_b16 a[166:167], v15 offset:2048
v_mfma_f32_16x16x32_bf16 v[32:35], a[132:135], v[88:91], v[32:35]
v_add_u32 v14, 0xfffe5000, v14
s_add_u32 m0, s40, 65536
v_mfma_f32_16x16x32_bf16 v[32:35], a[136:139], v[92:95], v[32:35]
ds_read_b64_tr_b16 a[168:169], v15 offset:4096
ds_read_b64_tr_b16 a[170:171], v15 offset:6144
v_mfma_f32_16x16x32_bf16 v[32:35], a[140:143], v[96:99], v[32:35]
v_mul_f32 v24, v24, v254
v_mul_f32 v25, v25, v254
v_mfma_f32_16x16x32_bf16 v[32:35], a[144:147], v[100:103], v[32:35]
ds_read_b64_tr_b16 a[172:173], v15 offset:8192
ds_read_b64_tr_b16 a[174:175], v15 offset:10240
v_mfma_f32_16x16x32_bf16 v[32:35], a[148:151], v[104:107], v[32:35]
s_waitcnt lgkmcnt(6)
s_mov_b32 s45, 4194560
buffer_load_dwordx4 v2, s[8:11], s45 offen lds
v_mfma_f32_16x16x32_bf16 v[32:35], a[152:155], v[108:111], v[32:35]
ds_read_b64_tr_b16 a[176:177], v15 offset:12288
ds_read_b64_tr_b16 a[178:179], v15 offset:14336
v_mfma_f32_16x16x32_bf16 v[32:35], a[156:159], v[112:115], v[32:35]
v_mul_f32 v26, v26, v254
v_mul_f32 v27, v27, v254
v_mfma_f32_16x16x32_bf16 v[32:35], a[160:163], v[116:119], v[32:35]
ds_read_b64_tr_b16 a[180:181], v15 offset:16384
ds_read_b64_tr_b16 a[182:183], v15 offset:18432
v_mfma_f32_16x16x32_bf16 v[36:39], a[128:131], v[156:159], v[36:39]
v_mul_f32 v28, v28, v255
v_mul_f32 v29, v29, v255
v_mfma_f32_16x16x32_bf16 v[36:39], a[132:135], v[160:163], v[36:39]
ds_read_b64_tr_b16 a[184:185], v15 offset:20480
ds_read_b64_tr_b16 a[186:187], v15 offset:22528
v_mfma_f32_16x16x32_bf16 v[36:39], a[136:139], v[164:167], v[36:39]
v_mul_f32 v30, v30, v255
v_mul_f32 v31, v31, v255
v_mfma_f32_16x16x32_bf16 v[36:39], a[140:143], v[168:171], v[36:39]
ds_read_b64_tr_b16 a[188:189], v15 offset:24576
ds_read_b64_tr_b16 a[190:191], v15 offset:26624
s_add_u32 m0, s40, 69632
v_mfma_f32_16x16x32_bf16 v[36:39], a[144:147], v[172:175], v[36:39]
s_mov_b32 s45, 4456704
buffer_load_dwordx4 v2, s[8:11], s45 offen lds
v_mfma_f32_16x16x32_bf16 v[36:39], a[148:151], v[176:179], v[36:39]
ds_read_b64_tr_b16 a[192:193], v15 offset:28672
ds_read_b64_tr_b16 a[194:195], v15 offset:30720
v_mfma_f32_16x16x32_bf16 v[36:39], a[152:155], v[180:183], v[36:39]
v_cvt_pk_bf16_f32 v202, v24, v25
v_cvt_pk_bf16_f32 v203, v26, v27
v_mfma_f32_16x16x32_bf16 v[36:39], a[156:159], v[184:187], v[36:39]
ds_read_b64_tr_b16 a[196:197], v15 offset:32768
ds_read_b64_tr_b16 a[198:199], v15 offset:34816
v_mfma_f32_16x16x32_bf16 v[36:39], a[160:163], v[188:191], v[36:39]
s_waitcnt lgkmcnt(6)
v_cvt_pk_bf16_f32 v218, v28, v29
v_cvt_pk_bf16_f32 v219, v30, v31
v_mfma_f32_16x16x32_bf16 v[40:43], a[164:167], v[84:87], v[40:43]
s_waitcnt vmcnt(9)
s_barrier
ds_read_b64_tr_b16 a[128:129], v12 offset:0
ds_read_b64_tr_b16 a[130:131], v12 offset:2048
v_mfma_f32_16x16x32_bf16 v[40:43], a[168:171], v[88:91], v[40:43]
v_add_u32 v15, 0xfffe5000, v15
v_permlane16_swap_b32 v200, v202
v_mfma_f32_16x16x32_bf16 v[40:43], a[172:175], v[92:95], v[40:43]
ds_read_b64_tr_b16 a[132:133], v12 offset:4096
ds_read_b64_tr_b16 a[134:135], v12 offset:6144
s_add_u32 m0, s40, 73728
v_mfma_f32_16x16x32_bf16 v[40:43], a[176:179], v[96:99], v[40:43]
s_mov_b32 s45, 384
buffer_load_dwordx4 v2, s[8:11], s45 offen lds
v_mfma_f32_16x16x32_bf16 v[40:43], a[180:183], v[100:103], v[40:43]
ds_read_b64_tr_b16 a[136:137], v12 offset:8192
ds_read_b64_tr_b16 a[138:139], v12 offset:10240
v_mfma_f32_16x16x32_bf16 v[40:43], a[184:187], v[104:107], v[40:43]
s_waitcnt lgkmcnt(6)
v_permlane16_swap_b32 v201, v203
v_permlane16_swap_b32 v216, v218
v_mfma_f32_16x16x32_bf16 v[40:43], a[188:191], v[108:111], v[40:43]
ds_read_b64_tr_b16 a[140:141], v12 offset:12288
ds_read_b64_tr_b16 a[142:143], v12 offset:14336
v_mfma_f32_16x16x32_bf16 v[40:43], a[192:195], v[112:115], v[40:43]
v_permlane16_swap_b32 v217, v219
v_mul_f32 v32, v32, v254
v_mfma_f32_16x16x32_bf16 v[40:43], a[196:199], v[116:119], v[40:43]
ds_read_b64_tr_b16 a[144:145], v12 offset:16384
ds_read_b64_tr_b16 a[146:147], v12 offset:18432
v_mfma_f32_16x16x32_bf16 v[44:47], a[164:167], v[156:159], v[44:47]
v_mul_f32 v33, v33, v254
v_mul_f32 v34, v34, v254
v_mfma_f32_16x16x32_bf16 v[44:47], a[168:171], v[160:163], v[44:47]
ds_read_b64_tr_b16 a[148:149], v12 offset:20480
ds_read_b64_tr_b16 a[150:151], v12 offset:22528
s_add_u32 m0, s40, 77824
v_mfma_f32_16x16x32_bf16 v[44:47], a[172:175], v[164:167], v[44:47]
s_mov_b32 s45, 262528
buffer_load_dwordx4 v2, s[8:11], s45 offen lds
v_mfma_f32_16x16x32_bf16 v[44:47], a[176:179], v[168:171], v[44:47]
ds_read_b64_tr_b16 a[152:153], v12 offset:24576
ds_read_b64_tr_b16 a[154:155], v12 offset:26624
v_mfma_f32_16x16x32_bf16 v[44:47], a[180:183], v[172:175], v[44:47]
v_mul_f32 v35, v35, v254
v_mul_f32 v36, v36, v255
v_mfma_f32_16x16x32_bf16 v[44:47], a[184:187], v[176:179], v[44:47]
ds_read_b64_tr_b16 a[156:157], v12 offset:28672
ds_read_b64_tr_b16 a[158:159], v12 offset:30720
v_mfma_f32_16x16x32_bf16 v[44:47], a[188:191], v[180:183], v[44:47]
v_mul_f32 v37, v37, v255
v_mul_f32 v38, v38, v255
v_mfma_f32_16x16x32_bf16 v[44:47], a[192:195], v[184:187], v[44:47]
ds_read_b64_tr_b16 a[160:161], v12 offset:32768
ds_read_b64_tr_b16 a[162:163], v12 offset:34816
v_mfma_f32_16x16x32_bf16 v[44:47], a[196:199], v[188:191], v[44:47]
s_waitcnt lgkmcnt(6)
v_mul_f32 v39, v39, v255
v_cvt_pk_bf16_f32 v204, v32, v33
v_mfma_f32_16x16x32_bf16 v[16:19], a[128:131], v[48:51], 0
ds_read_b64_tr_b16 a[164:165], v13 offset:0
ds_read_b64_tr_b16 a[166:167], v13 offset:2048
s_add_u32 m0, s40, 81920
v_mfma_f32_16x16x32_bf16 v[16:19], a[132:135], v[52:55], v[16:19]
s_mov_b32 s45, 524672
buffer_load_dwordx4 v2, s[8:11], s45 offen lds
v_mfma_f32_16x16x32_bf16 v[16:19], a[136:139], v[56:59], v[16:19]
ds_read_b64_tr_b16 a[168:169], v13 offset:4096
ds_read_b64_tr_b16 a[170:171], v13 offset:6144
v_mfma_f32_16x16x32_bf16 v[16:19], a[140:143], v[60:63], v[16:19]
v_add_u32 v12, 0x9000, v12
v_cvt_pk_bf16_f32 v205, v34, v35
v_mfma_f32_16x16x32_bf16 v[16:19], a[144:147], v[64:67], v[16:19]
ds_read_b64_tr_b16 a[172:173], v13 offset:8192
ds_read_b64_tr_b16 a[174:175], v13 offset:10240
v_mfma_f32_16x16x32_bf16 v[16:19], a[148:151], v[68:71], v[16:19]
s_waitcnt lgkmcnt(6)
v_cvt_pk_bf16_f32 v220, v36, v37
v_cvt_pk_bf16_f32 v221, v38, v39
v_mfma_f32_16x16x32_bf16 v[16:19], a[152:155], v[72:75], v[16:19]
ds_read_b64_tr_b16 a[176:177], v13 offset:12288
ds_read_b64_tr_b16 a[178:179], v13 offset:14336
v_mfma_f32_16x16x32_bf16 v[16:19], a[156:159], v[76:79], v[16:19]
v_mul_f32 v40, v40, v254
v_mul_f32 v41, v41, v254
v_mfma_f32_16x16x32_bf16 v[16:19], a[160:163], v[80:83], v[16:19]
ds_read_b64_tr_b16 a[180:181], v13 offset:16384
ds_read_b64_tr_b16 a[182:183], v13 offset:18432
s_add_u32 m0, s40, 86016
v_mfma_f32_16x16x32_bf16 v[20:23], a[128:131], v[120:123], 0
s_mov_b32 s45, 786816
buffer_load_dwordx4 v2, s[8:11], s45 offen lds
v_mfma_f32_16x16x32_bf16 v[20:23], a[132:135], v[124:127], v[20:23]
ds_read_b64_tr_b16 a[184:185], v13 offset:20480
ds_read_b64_tr_b16 a[186:187], v13 offset:22528
v_mfma_f32_16x16x32_bf16 v[20:23], a[136:139], v[128:131], v[20:23]
v_mul_f32 v42, v42, v254
v_mul_f32 v43, v43, v254
v_mfma_f32_16x16x32_bf16 v[20:23], a[140:143], v[132:135], v[20:23]
ds_read_b64_tr_b16 a[188:189], v13 offset:24576
ds_read_b64_tr_b16 a[190:191], v13 offset:26624
v_mfma_f32_16x16x32_bf16 v[20:23], a[144:147], v[136:139], v[20:23]
v_mul_f32 v44, v44, v255
v_mul_f32 v45, v45, v255
v_mfma_f32_16x16x32_bf16 v[20:23], a[148:151], v[140:143], v[20:23]
ds_read_b64_tr_b16 a[192:193], v13 offset:28672
ds_read_b64_tr_b16 a[194:195], v13 offset:30720
v_mfma_f32_16x16x32_bf16 v[20:23], a[152:155], v[144:147], v[20:23]
v_mul_f32 v46, v46, v255
v_mul_f32 v47, v47, v255
v_mfma_f32_16x16x32_bf16 v[20:23], a[156:159], v[148:151], v[20:23]
ds_read_b64_tr_b16 a[196:197], v13 offset:32768
ds_read_b64_tr_b16 a[198:199], v13 offset:34816
s_add_u32 m0, s40, 90112
v_mfma_f32_16x16x32_bf16 v[20:23], a[160:163], v[152:155], v[20:23]
s_waitcnt lgkmcnt(6)
s_mov_b32 s45, 1048960
buffer_load_dwordx4 v2, s[8:11], s45 offen lds
v_mfma_f32_16x16x32_bf16 v[24:27], a[164:167], v[48:51], 0
ds_read_b64_tr_b16 a[128:129], v14 offset:0
ds_read_b64_tr_b16 a[130:131], v14 offset:2048
v_mfma_f32_16x16x32_bf16 v[24:27], a[168:171], v[52:55], v[24:27]
v_add_u32 v13, 0x9000, v13
v_cvt_pk_bf16_f32 v206, v40, v41
v_mfma_f32_16x16x32_bf16 v[24:27], a[172:175], v[56:59], v[24:27]
ds_read_b64_tr_b16 a[132:133], v14 offset:4096
ds_read_b64_tr_b16 a[134:135], v14 offset:6144
v_mfma_f32_16x16x32_bf16 v[24:27], a[176:179], v[60:63], v[24:27]
v_cvt_pk_bf16_f32 v207, v42, v43
v_cvt_pk_bf16_f32 v222, v44, v45
v_mfma_f32_16x16x32_bf16 v[24:27], a[180:183], v[64:67], v[24:27]
ds_read_b64_tr_b16 a[136:137], v14 offset:8192
ds_read_b64_tr_b16 a[138:139], v14 offset:10240
v_mfma_f32_16x16x32_bf16 v[24:27], a[184:187], v[68:71], v[24:27]
s_waitcnt lgkmcnt(6)
v_cvt_pk_bf16_f32 v223, v46, v47
s_add_u32 m0, s40, 94208
v_mfma_f32_16x16x32_bf16 v[24:27], a[188:191], v[72:75], v[24:27]
ds_read_b64_tr_b16 a[140:141], v14 offset:12288
ds_read_b64_tr_b16 a[142:143], v14 offset:14336
v_mfma_f32_16x16x32_bf16 v[24:27], a[192:195], v[76:79], v[24:27]
s_mov_b32 s45, 1311104
buffer_load_dwordx4 v2, s[8:11], s45 offen lds
v_mfma_f32_16x16x32_bf16 v[24:27], a[196:199], v[80:83], v[24:27]
ds_read_b64_tr_b16 a[144:145], v14 offset:16384
ds_read_b64_tr_b16 a[146:147], v14 offset:18432
v_mfma_f32_16x16x32_bf16 v[28:31], a[164:167], v[120:123], 0
v_permlane16_swap_b32 v204, v206
v_permlane16_swap_b32 v205, v207
v_mfma_f32_16x16x32_bf16 v[28:31], a[168:171], v[124:127], v[28:31]
ds_read_b64_tr_b16 a[148:149], v14 offset:20480
ds_read_b64_tr_b16 a[150:151], v14 offset:22528
v_mfma_f32_16x16x32_bf16 v[28:31], a[172:175], v[128:131], v[28:31]
v_permlane16_swap_b32 v220, v222
v_permlane16_swap_b32 v221, v223
v_mfma_f32_16x16x32_bf16 v[28:31], a[176:179], v[132:135], v[28:31]
ds_read_b64_tr_b16 a[152:153], v14 offset:24576
ds_read_b64_tr_b16 a[154:155], v14 offset:26624
v_mfma_f32_16x16x32_bf16 v[28:31], a[180:183], v[136:139], v[28:31]
s_add_u32 m0, s40, 98304
s_mov_b32 s45, 1573248
v_mfma_f32_16x16x32_bf16 v[28:31], a[184:187], v[140:143], v[28:31]
ds_read_b64_tr_b16 a[156:157], v14 offset:28672
ds_read_b64_tr_b16 a[158:159], v14 offset:30720
v_mfma_f32_16x16x32_bf16 v[28:31], a[188:191], v[144:147], v[28:31]
buffer_load_dwordx4 v2, s[8:11], s45 offen lds
v_mfma_f32_16x16x32_bf16 v[28:31], a[192:195], v[148:151], v[28:31]
ds_read_b64_tr_b16 a[160:161], v14 offset:32768
ds_read_b64_tr_b16 a[162:163], v14 offset:34816
v_mfma_f32_16x16x32_bf16 v[28:31], a[196:199], v[152:155], v[28:31]
s_waitcnt lgkmcnt(6)
v_mfma_f32_16x16x32_bf16 v[32:35], a[128:131], v[48:51], 0
ds_read_b64_tr_b16 a[164:165], v15 offset:0
ds_read_b64_tr_b16 a[166:167], v15 offset:2048
v_mfma_f32_16x16x32_bf16 v[32:35], a[132:135], v[52:55], v[32:35]
v_add_u32 v14, 0x9000, v14
v_mfma_f32_16x16x32_bf16 v[32:35], a[136:139], v[56:59], v[32:35]
ds_read_b64_tr_b16 a[168:169], v15 offset:4096
ds_read_b64_tr_b16 a[170:171], v15 offset:6144
v_mfma_f32_16x16x32_bf16 v[32:35], a[140:143], v[60:63], v[32:35]
s_add_u32 m0, s40, 102400
s_mov_b32 s45, 1835392
v_mfma_f32_16x16x32_bf16 v[32:35], a[144:147], v[64:67], v[32:35]
ds_read_b64_tr_b16 a[172:173], v15 offset:8192
ds_read_b64_tr_b16 a[174:175], v15 offset:10240
v_mfma_f32_16x16x32_bf16 v[32:35], a[148:151], v[68:71], v[32:35]
s_waitcnt lgkmcnt(6)
buffer_load_dwordx4 v2, s[8:11], s45 offen lds
v_mfma_f32_16x16x32_bf16 v[32:35], a[152:155], v[72:75], v[32:35]
ds_read_b64_tr_b16 a[176:177], v15 offset:12288
ds_read_b64_tr_b16 a[178:179], v15 offset:14336
v_mfma_f32_16x16x32_bf16 v[32:35], a[156:159], v[76:79], v[32:35]
v_mfma_f32_16x16x32_bf16 v[32:35], a[160:163], v[80:83], v[32:35]
ds_read_b64_tr_b16 a[180:181], v15 offset:16384
ds_read_b64_tr_b16 a[182:183], v15 offset:18432
v_mfma_f32_16x16x32_bf16 v[36:39], a[128:131], v[120:123], 0
v_mfma_f32_16x16x32_bf16 v[36:39], a[132:135], v[124:127], v[36:39]
ds_read_b64_tr_b16 a[184:185], v15 offset:20480
ds_read_b64_tr_b16 a[186:187], v15 offset:22528
v_mfma_f32_16x16x32_bf16 v[36:39], a[136:139], v[128:131], v[36:39]
s_add_u32 m0, s40, 106496
s_mov_b32 s45, 2097536
v_mfma_f32_16x16x32_bf16 v[36:39], a[140:143], v[132:135], v[36:39]
ds_read_b64_tr_b16 a[188:189], v15 offset:24576
ds_read_b64_tr_b16 a[190:191], v15 offset:26624
v_mfma_f32_16x16x32_bf16 v[36:39], a[144:147], v[136:139], v[36:39]
buffer_load_dwordx4 v2, s[8:11], s45 offen lds
v_mfma_f32_16x16x32_bf16 v[36:39], a[148:151], v[140:143], v[36:39]
ds_read_b64_tr_b16 a[192:193], v15 offset:28672
ds_read_b64_tr_b16 a[194:195], v15 offset:30720
v_mfma_f32_16x16x32_bf16 v[36:39], a[152:155], v[144:147], v[36:39]
v_mfma_f32_16x16x32_bf16 v[36:39], a[156:159], v[148:151], v[36:39]
ds_read_b64_tr_b16 a[196:197], v15 offset:32768
ds_read_b64_tr_b16 a[198:199], v15 offset:34816
v_mfma_f32_16x16x32_bf16 v[36:39], a[160:163], v[152:155], v[36:39]
s_waitcnt lgkmcnt(6)
s_mov_b32 s45, 2359680
v_mfma_f32_16x16x32_bf16 v[40:43], a[164:167], v[48:51], 0
s_waitcnt vmcnt(9)
s_barrier
ds_read_b64_tr_b16 a[128:129], v12 offset:0
ds_read_b64_tr_b16 a[130:131], v12 offset:2048
v_mfma_f32_16x16x32_bf16 v[40:43], a[168:171], v[52:55], v[40:43]
v_add_u32 v15, 0x9000, v15
s_add_u32 m0, s40, 110592
v_mfma_f32_16x16x32_bf16 v[40:43], a[172:175], v[56:59], v[40:43]
ds_read_b64_tr_b16 a[132:133], v12 offset:4096
ds_read_b64_tr_b16 a[134:135], v12 offset:6144
v_mfma_f32_16x16x32_bf16 v[40:43], a[176:179], v[60:63], v[40:43]
buffer_load_dwordx4 v2, s[8:11], s45 offen lds
v_mfma_f32_16x16x32_bf16 v[40:43], a[180:183], v[64:67], v[40:43]
ds_read_b64_tr_b16 a[136:137], v12 offset:8192
ds_read_b64_tr_b16 a[138:139], v12 offset:10240
v_mfma_f32_16x16x32_bf16 v[40:43], a[184:187], v[68:71], v[40:43]
s_waitcnt lgkmcnt(6)
v_mfma_f32_16x16x32_bf16 v[40:43], a[188:191], v[72:75], v[40:43]
ds_read_b64_tr_b16 a[140:141], v12 offset:12288
ds_read_b64_tr_b16 a[142:143], v12 offset:14336
v_mfma_f32_16x16x32_bf16 v[40:43], a[192:195], v[76:79], v[40:43]
v_mfma_f32_16x16x32_bf16 v[40:43], a[196:199], v[80:83], v[40:43]
ds_read_b64_tr_b16 a[144:145], v12 offset:16384
ds_read_b64_tr_b16 a[146:147], v12 offset:18432
v_mfma_f32_16x16x32_bf16 v[44:47], a[164:167], v[120:123], 0
s_add_u32 m0, s40, 114688
s_mov_b32 s45, 2621824
v_mfma_f32_16x16x32_bf16 v[44:47], a[168:171], v[124:127], v[44:47]
ds_read_b64_tr_b16 a[148:149], v12 offset:20480
ds_read_b64_tr_b16 a[150:151], v12 offset:22528
v_mfma_f32_16x16x32_bf16 v[44:47], a[172:175], v[128:131], v[44:47]
buffer_load_dwordx4 v2, s[8:11], s45 offen lds
v_mfma_f32_16x16x32_bf16 v[44:47], a[176:179], v[132:135], v[44:47]
ds_read_b64_tr_b16 a[152:153], v12 offset:24576
ds_read_b64_tr_b16 a[154:155], v12 offset:26624
v_mfma_f32_16x16x32_bf16 v[44:47], a[180:183], v[136:139], v[44:47]
v_mfma_f32_16x16x32_bf16 v[44:47], a[184:187], v[140:143], v[44:47]
ds_read_b64_tr_b16 a[156:157], v12 offset:28672
ds_read_b64_tr_b16 a[158:159], v12 offset:30720
v_mfma_f32_16x16x32_bf16 v[44:47], a[188:191], v[144:147], v[44:47]
v_mfma_f32_16x16x32_bf16 v[44:47], a[192:195], v[148:151], v[44:47]
ds_read_b64_tr_b16 a[160:161], v12 offset:32768
ds_read_b64_tr_b16 a[162:163], v12 offset:34816
v_mfma_f32_16x16x32_bf16 v[44:47], a[196:199], v[152:155], v[44:47]
s_waitcnt lgkmcnt(6)
s_add_u32 m0, s40, 118784
s_mov_b32 s45, 2883968
v_mfma_f32_16x16x32_bf16 v[16:19], a[128:131], v[84:87], v[16:19]
ds_read_b64_tr_b16 a[164:165], v13 offset:0
ds_read_b64_tr_b16 a[166:167], v13 offset:2048
v_mfma_f32_16x16x32_bf16 v[16:19], a[132:135], v[88:91], v[16:19]
buffer_load_dwordx4 v2, s[8:11], s45 offen lds
v_mfma_f32_16x16x32_bf16 v[16:19], a[136:139], v[92:95], v[16:19]
ds_read_b64_tr_b16 a[168:169], v13 offset:4096
ds_read_b64_tr_b16 a[170:171], v13 offset:6144
v_mfma_f32_16x16x32_bf16 v[16:19], a[140:143], v[96:99], v[16:19]
v_add_u32 v12, 0x9000, v12
v_mfma_f32_16x16x32_bf16 v[16:19], a[144:147], v[100:103], v[16:19]
ds_read_b64_tr_b16 a[172:173], v13 offset:8192
ds_read_b64_tr_b16 a[174:175], v13 offset:10240
v_mfma_f32_16x16x32_bf16 v[16:19], a[148:151], v[104:107], v[16:19]
s_waitcnt lgkmcnt(6)
v_mfma_f32_16x16x32_bf16 v[16:19], a[152:155], v[108:111], v[16:19]
ds_read_b64_tr_b16 a[176:177], v13 offset:12288
ds_read_b64_tr_b16 a[178:179], v13 offset:14336
v_mfma_f32_16x16x32_bf16 v[16:19], a[156:159], v[112:115], v[16:19]
s_add_u32 m0, s40, 122880
s_mov_b32 s45, 3146112
v_mfma_f32_16x16x32_bf16 v[16:19], a[160:163], v[116:119], v[16:19]
ds_read_b64_tr_b16 a[180:181], v13 offset:16384
ds_read_b64_tr_b16 a[182:183], v13 offset:18432
v_mfma_f32_16x16x32_bf16 v[20:23], a[128:131], v[156:159], v[20:23]
buffer_load_dwordx4 v2, s[8:11], s45 offen lds
v_mfma_f32_16x16x32_bf16 v[20:23], a[132:135], v[160:163], v[20:23]
ds_read_b64_tr_b16 a[184:185], v13 offset:20480
ds_read_b64_tr_b16 a[186:187], v13 offset:22528
v_mfma_f32_16x16x32_bf16 v[20:23], a[136:139], v[164:167], v[20:23]
v_mfma_f32_16x16x32_bf16 v[20:23], a[140:143], v[168:171], v[20:23]
ds_read_b64_tr_b16 a[188:189], v13 offset:24576
ds_read_b64_tr_b16 a[190:191], v13 offset:26624
v_mfma_f32_16x16x32_bf16 v[20:23], a[144:147], v[172:175], v[20:23]
v_mfma_f32_16x16x32_bf16 v[20:23], a[148:151], v[176:179], v[20:23]
ds_read_b64_tr_b16 a[192:193], v13 offset:28672
ds_read_b64_tr_b16 a[194:195], v13 offset:30720
v_mfma_f32_16x16x32_bf16 v[20:23], a[152:155], v[180:183], v[20:23]
s_add_u32 m0, s40, 126976
s_mov_b32 s45, 3408256
v_mfma_f32_16x16x32_bf16 v[20:23], a[156:159], v[184:187], v[20:23]
ds_read_b64_tr_b16 a[196:197], v13 offset:32768
ds_read_b64_tr_b16 a[198:199], v13 offset:34816
v_mfma_f32_16x16x32_bf16 v[20:23], a[160:163], v[188:191], v[20:23]
s_waitcnt lgkmcnt(6)
buffer_load_dwordx4 v2, s[8:11], s45 offen lds
v_mfma_f32_16x16x32_bf16 v[24:27], a[164:167], v[84:87], v[24:27]
ds_read_b64_tr_b16 a[128:129], v14 offset:0
ds_read_b64_tr_b16 a[130:131], v14 offset:2048
v_mfma_f32_16x16x32_bf16 v[24:27], a[168:171], v[88:91], v[24:27]
v_add_u32 v13, 0x9000, v13
s_add_u32 m0, s40, 131072
v_mfma_f32_16x16x32_bf16 v[24:27], a[172:175], v[92:95], v[24:27]
ds_read_b64_tr_b16 a[132:133], v14 offset:4096
ds_read_b64_tr_b16 a[134:135], v14 offset:6144
v_mfma_f32_16x16x32_bf16 v[24:27], a[176:179], v[96:99], v[24:27]
v_mul_f32 v16, v16, v254
v_mul_f32 v17, v17, v254
v_mfma_f32_16x16x32_bf16 v[24:27], a[180:183], v[100:103], v[24:27]
ds_read_b64_tr_b16 a[136:137], v14 offset:8192
ds_read_b64_tr_b16 a[138:139], v14 offset:10240
v_mfma_f32_16x16x32_bf16 v[24:27], a[184:187], v[104:107], v[24:27]
s_waitcnt lgkmcnt(6)
v_mul_f32 v18, v18, v254
v_mul_f32 v19, v19, v254
v_mfma_f32_16x16x32_bf16 v[24:27], a[188:191], v[108:111], v[24:27]
ds_read_b64_tr_b16 a[140:141], v14 offset:12288
ds_read_b64_tr_b16 a[142:143], v14 offset:14336
v_mfma_f32_16x16x32_bf16 v[24:27], a[192:195], v[112:115], v[24:27]
s_mov_b32 s45, 3670400
buffer_load_dwordx4 v2, s[8:11], s45 offen lds
v_mfma_f32_16x16x32_bf16 v[24:27], a[196:199], v[116:119], v[24:27]
ds_read_b64_tr_b16 a[144:145], v14 offset:16384
ds_read_b64_tr_b16 a[146:147], v14 offset:18432
v_mfma_f32_16x16x32_bf16 v[28:31], a[164:167], v[156:159], v[28:31]
v_mul_f32 v20, v20, v255
v_mul_f32 v21, v21, v255
v_mfma_f32_16x16x32_bf16 v[28:31], a[168:171], v[160:163], v[28:31]
ds_read_b64_tr_b16 a[148:149], v14 offset:20480
ds_read_b64_tr_b16 a[150:151], v14 offset:22528
v_mfma_f32_16x16x32_bf16 v[28:31], a[172:175], v[164:167], v[28:31]
v_mul_f32 v22, v22, v255
v_mul_f32 v23, v23, v255
v_mfma_f32_16x16x32_bf16 v[28:31], a[176:179], v[168:171], v[28:31]
ds_read_b64_tr_b16 a[152:153], v14 offset:24576
ds_read_b64_tr_b16 a[154:155], v14 offset:26624
v_mfma_f32_16x16x32_bf16 v[28:31], a[180:183], v[172:175], v[28:31]
v_cvt_pk_bf16_f32 v224, v16, v17
v_cvt_pk_bf16_f32 v225, v18, v19
v_mfma_f32_16x16x32_bf16 v[28:31], a[184:187], v[176:179], v[28:31]
ds_read_b64_tr_b16 a[156:157], v14 offset:28672
ds_read_b64_tr_b16 a[158:159], v14 offset:30720
s_add_u32 m0, s40, 135168
v_mfma_f32_16x16x32_bf16 v[28:31], a[188:191], v[180:183], v[28:31]
s_mov_b32 s45, 3932544
buffer_load_dwordx4 v2, s[8:11], s45 offen lds
v_mfma_f32_16x16x32_bf16 v[28:31], a[192:195], v[184:187], v[28:31]
ds_read_b64_tr_b16 a[160:161], v14 offset:32768
ds_read_b64_tr_b16 a[162:163], v14 offset:34816
v_mfma_f32_16x16x32_bf16 v[28:31], a[196:199], v[188:191], v[28:31]
s_waitcnt lgkmcnt(6)
v_cvt_pk_bf16_f32 v240, v20, v21
v_cvt_pk_bf16_f32 v241, v22, v23
v_mfma_f32_16x16x32_bf16 v[32:35], a[128:131], v[84:87], v[32:35]
ds_read_b64_tr_b16 a[164:165], v15 offset:0
ds_read_b64_tr_b16 a[166:167], v15 offset:2048
v_mfma_f32_16x16x32_bf16 v[32:35], a[132:135], v[88:91], v[32:35]
v_add_u32 v14, 0x9000, v14
s_add_u32 m0, s40, 139264
v_mfma_f32_16x16x32_bf16 v[32:35], a[136:139], v[92:95], v[32:35]
ds_read_b64_tr_b16 a[168:169], v15 offset:4096
ds_read_b64_tr_b16 a[170:171], v15 offset:6144
v_mfma_f32_16x16x32_bf16 v[32:35], a[140:143], v[96:99], v[32:35]
v_mul_f32 v24, v24, v254
v_mul_f32 v25, v25, v254
v_mfma_f32_16x16x32_bf16 v[32:35], a[144:147], v[100:103], v[32:35]
ds_read_b64_tr_b16 a[172:173], v15 offset:8192
ds_read_b64_tr_b16 a[174:175], v15 offset:10240
v_mfma_f32_16x16x32_bf16 v[32:35], a[148:151], v[104:107], v[32:35]
s_waitcnt lgkmcnt(6)
s_mov_b32 s45, 4194688
buffer_load_dwordx4 v2, s[8:11], s45 offen lds
v_mfma_f32_16x16x32_bf16 v[32:35], a[152:155], v[108:111], v[32:35]
ds_read_b64_tr_b16 a[176:177], v15 offset:12288
ds_read_b64_tr_b16 a[178:179], v15 offset:14336
v_mfma_f32_16x16x32_bf16 v[32:35], a[156:159], v[112:115], v[32:35]
v_mul_f32 v26, v26, v254
v_mul_f32 v27, v27, v254
v_mfma_f32_16x16x32_bf16 v[32:35], a[160:163], v[116:119], v[32:35]
ds_read_b64_tr_b16 a[180:181], v15 offset:16384
ds_read_b64_tr_b16 a[182:183], v15 offset:18432
v_mfma_f32_16x16x32_bf16 v[36:39], a[128:131], v[156:159], v[36:39]
v_mul_f32 v28, v28, v255
v_mul_f32 v29, v29, v255
v_mfma_f32_16x16x32_bf16 v[36:39], a[132:135], v[160:163], v[36:39]
ds_read_b64_tr_b16 a[184:185], v15 offset:20480
ds_read_b64_tr_b16 a[186:187], v15 offset:22528
v_mfma_f32_16x16x32_bf16 v[36:39], a[136:139], v[164:167], v[36:39]
v_mul_f32 v30, v30, v255
v_mul_f32 v31, v31, v255
v_mfma_f32_16x16x32_bf16 v[36:39], a[140:143], v[168:171], v[36:39]
ds_read_b64_tr_b16 a[188:189], v15 offset:24576
ds_read_b64_tr_b16 a[190:191], v15 offset:26624
s_add_u32 m0, s40, 143360
v_mfma_f32_16x16x32_bf16 v[36:39], a[144:147], v[172:175], v[36:39]
s_mov_b32 s45, 4456832
buffer_load_dwordx4 v2, s[8:11], s45 offen lds
v_mfma_f32_16x16x32_bf16 v[36:39], a[148:151], v[176:179], v[36:39]
ds_read_b64_tr_b16 a[192:193], v15 offset:28672
ds_read_b64_tr_b16 a[194:195], v15 offset:30720
v_mfma_f32_16x16x32_bf16 v[36:39], a[152:155], v[180:183], v[36:39]
v_cvt_pk_bf16_f32 v226, v24, v25
v_cvt_pk_bf16_f32 v227, v26, v27
v_mfma_f32_16x16x32_bf16 v[36:39], a[156:159], v[184:187], v[36:39]
ds_read_b64_tr_b16 a[196:197], v15 offset:32768
ds_read_b64_tr_b16 a[198:199], v15 offset:34816
v_mfma_f32_16x16x32_bf16 v[36:39], a[160:163], v[188:191], v[36:39]
s_waitcnt lgkmcnt(6)
v_cvt_pk_bf16_f32 v242, v28, v29
v_cvt_pk_bf16_f32 v243, v30, v31
v_mfma_f32_16x16x32_bf16 v[40:43], a[164:167], v[84:87], v[40:43]
s_waitcnt vmcnt(9)
s_barrier
ds_read_b64_tr_b16 a[128:129], v12 offset:0
ds_read_b64_tr_b16 a[130:131], v12 offset:2048
v_mfma_f32_16x16x32_bf16 v[40:43], a[168:171], v[88:91], v[40:43]
v_add_u32 v15, 0x9000, v15
v_permlane16_swap_b32 v224, v226
v_mfma_f32_16x16x32_bf16 v[40:43], a[172:175], v[92:95], v[40:43]
ds_read_b64_tr_b16 a[132:133], v12 offset:4096
ds_read_b64_tr_b16 a[134:135], v12 offset:6144
s_add_u32 m0, s41, 0
v_mfma_f32_16x16x32_bf16 v[40:43], a[176:179], v[96:99], v[40:43]
s_add_u32 s45, s43, 16
buffer_load_dwordx4 v4, s[12:15], s45 offen offset:0 lds
v_mfma_f32_16x16x32_bf16 v[40:43], a[180:183], v[100:103], v[40:43]
ds_read_b64_tr_b16 a[136:137], v12 offset:8192
ds_read_b64_tr_b16 a[138:139], v12 offset:10240
v_mfma_f32_16x16x32_bf16 v[40:43], a[184:187], v[104:107], v[40:43]
s_waitcnt lgkmcnt(6)
v_permlane16_swap_b32 v225, v227
v_permlane16_swap_b32 v240, v242
v_mfma_f32_16x16x32_bf16 v[40:43], a[188:191], v[108:111], v[40:43]
ds_read_b64_tr_b16 a[140:141], v12 offset:12288
ds_read_b64_tr_b16 a[142:143], v12 offset:14336
v_mfma_f32_16x16x32_bf16 v[40:43], a[192:195], v[112:115], v[40:43]
v_permlane16_swap_b32 v241, v243
v_mul_f32 v32, v32, v254
v_mfma_f32_16x16x32_bf16 v[40:43], a[196:199], v[116:119], v[40:43]
ds_read_b64_tr_b16 a[144:145], v12 offset:16384
ds_read_b64_tr_b16 a[146:147], v12 offset:18432
v_mfma_f32_16x16x32_bf16 v[44:47], a[164:167], v[156:159], v[44:47]
v_mul_f32 v33, v33, v254
v_mul_f32 v34, v34, v254
v_mfma_f32_16x16x32_bf16 v[44:47], a[168:171], v[160:163], v[44:47]
ds_read_b64_tr_b16 a[148:149], v12 offset:20480
ds_read_b64_tr_b16 a[150:151], v12 offset:22528
s_add_u32 m0, s41, 16
v_mfma_f32_16x16x32_bf16 v[44:47], a[172:175], v[164:167], v[44:47]
buffer_load_dwordx4 v4, s[12:15], s45 offen offset:1024 lds
v_mfma_f32_16x16x32_bf16 v[44:47], a[176:179], v[168:171], v[44:47]
ds_read_b64_tr_b16 a[152:153], v12 offset:24576
ds_read_b64_tr_b16 a[154:155], v12 offset:26624
v_mfma_f32_16x16x32_bf16 v[44:47], a[180:183], v[172:175], v[44:47]
v_mul_f32 v35, v35, v254
v_mul_f32 v36, v36, v255
v_mfma_f32_16x16x32_bf16 v[44:47], a[184:187], v[176:179], v[44:47]
ds_read_b64_tr_b16 a[156:157], v12 offset:28672
ds_read_b64_tr_b16 a[158:159], v12 offset:30720
v_mfma_f32_16x16x32_bf16 v[44:47], a[188:191], v[180:183], v[44:47]
v_mul_f32 v37, v37, v255
v_mul_f32 v38, v38, v255
v_mfma_f32_16x16x32_bf16 v[44:47], a[192:195], v[184:187], v[44:47]
ds_read_b64_tr_b16 a[160:161], v12 offset:32768
ds_read_b64_tr_b16 a[162:163], v12 offset:34816
v_mfma_f32_16x16x32_bf16 v[44:47], a[196:199], v[188:191], v[44:47]
s_waitcnt lgkmcnt(6)
v_mul_f32 v39, v39, v255
v_cvt_pk_bf16_f32 v228, v32, v33
v_mfma_f32_16x16x32_bf16 v[16:19], a[128:131], v[48:51], 0
ds_read_b64_tr_b16 a[164:165], v13 offset:0
ds_read_b64_tr_b16 a[166:167], v13 offset:2048
s_add_u32 m0, s41, 32
v_mfma_f32_16x16x32_bf16 v[16:19], a[132:135], v[52:55], v[16:19]
buffer_load_dwordx4 v4, s[12:15], s45 offen offset:2048 lds
v_mfma_f32_16x16x32_bf16 v[16:19], a[136:139], v[56:59], v[16:19]
ds_read_b64_tr_b16 a[168:169], v13 offset:4096
ds_read_b64_tr_b16 a[170:171], v13 offset:6144
v_mfma_f32_16x16x32_bf16 v[16:19], a[140:143], v[60:63], v[16:19]
v_add_u32 v12, 0x9000, v12
v_cvt_pk_bf16_f32 v229, v34, v35
v_mfma_f32_16x16x32_bf16 v[16:19], a[144:147], v[64:67], v[16:19]
ds_read_b64_tr_b16 a[172:173], v13 offset:8192
ds_read_b64_tr_b16 a[174:175], v13 offset:10240
v_mfma_f32_16x16x32_bf16 v[16:19], a[148:151], v[68:71], v[16:19]
s_waitcnt lgkmcnt(6)
v_cvt_pk_bf16_f32 v244, v36, v37
v_cvt_pk_bf16_f32 v245, v38, v39
v_mfma_f32_16x16x32_bf16 v[16:19], a[152:155], v[72:75], v[16:19]
ds_read_b64_tr_b16 a[176:177], v13 offset:12288
ds_read_b64_tr_b16 a[178:179], v13 offset:14336
v_mfma_f32_16x16x32_bf16 v[16:19], a[156:159], v[76:79], v[16:19]
v_mul_f32 v40, v40, v254
v_mul_f32 v41, v41, v254
v_mfma_f32_16x16x32_bf16 v[16:19], a[160:163], v[80:83], v[16:19]
ds_read_b64_tr_b16 a[180:181], v13 offset:16384
ds_read_b64_tr_b16 a[182:183], v13 offset:18432
s_add_u32 m0, s41, 48
v_mfma_f32_16x16x32_bf16 v[20:23], a[128:131], v[120:123], 0
buffer_load_dwordx4 v4, s[12:15], s45 offen offset:3072 lds
v_mfma_f32_16x16x32_bf16 v[20:23], a[132:135], v[124:127], v[20:23]
ds_read_b64_tr_b16 a[184:185], v13 offset:20480
ds_read_b64_tr_b16 a[186:187], v13 offset:22528
v_mfma_f32_16x16x32_bf16 v[20:23], a[136:139], v[128:131], v[20:23]
v_mul_f32 v42, v42, v254
v_mul_f32 v43, v43, v254
v_mfma_f32_16x16x32_bf16 v[20:23], a[140:143], v[132:135], v[20:23]
ds_read_b64_tr_b16 a[188:189], v13 offset:24576
ds_read_b64_tr_b16 a[190:191], v13 offset:26624
v_mfma_f32_16x16x32_bf16 v[20:23], a[144:147], v[136:139], v[20:23]
v_mul_f32 v44, v44, v255
v_mul_f32 v45, v45, v255
v_mfma_f32_16x16x32_bf16 v[20:23], a[148:151], v[140:143], v[20:23]
ds_read_b64_tr_b16 a[192:193], v13 offset:28672
ds_read_b64_tr_b16 a[194:195], v13 offset:30720
v_mfma_f32_16x16x32_bf16 v[20:23], a[152:155], v[144:147], v[20:23]
v_mul_f32 v46, v46, v255
v_mul_f32 v47, v47, v255
v_mfma_f32_16x16x32_bf16 v[20:23], a[156:159], v[148:151], v[20:23]
ds_read_b64_tr_b16 a[196:197], v13 offset:32768
ds_read_b64_tr_b16 a[198:199], v13 offset:34816
s_add_u32 m0, s41, 4160
v_mfma_f32_16x16x32_bf16 v[20:23], a[160:163], v[152:155], v[20:23]
s_waitcnt lgkmcnt(6)
s_add_u32 s45, s43, 4112
buffer_load_dwordx4 v4, s[12:15], s45 offen offset:0 lds
v_mfma_f32_16x16x32_bf16 v[24:27], a[164:167], v[48:51], 0
ds_read_b64_tr_b16 a[128:129], v14 offset:0
ds_read_b64_tr_b16 a[130:131], v14 offset:2048
v_mfma_f32_16x16x32_bf16 v[24:27], a[168:171], v[52:55], v[24:27]
v_add_u32 v13, 0x9000, v13
v_cvt_pk_bf16_f32 v230, v40, v41
v_mfma_f32_16x16x32_bf16 v[24:27], a[172:175], v[56:59], v[24:27]
ds_read_b64_tr_b16 a[132:133], v14 offset:4096
ds_read_b64_tr_b16 a[134:135], v14 offset:6144
v_mfma_f32_16x16x32_bf16 v[24:27], a[176:179], v[60:63], v[24:27]
v_cvt_pk_bf16_f32 v231, v42, v43
v_cvt_pk_bf16_f32 v246, v44, v45
v_mfma_f32_16x16x32_bf16 v[24:27], a[180:183], v[64:67], v[24:27]
ds_read_b64_tr_b16 a[136:137], v14 offset:8192
ds_read_b64_tr_b16 a[138:139], v14 offset:10240
v_mfma_f32_16x16x32_bf16 v[24:27], a[184:187], v[68:71], v[24:27]
s_waitcnt lgkmcnt(6)
v_cvt_pk_bf16_f32 v247, v46, v47
s_add_u32 m0, s41, 4176
v_mfma_f32_16x16x32_bf16 v[24:27], a[188:191], v[72:75], v[24:27]
ds_read_b64_tr_b16 a[140:141], v14 offset:12288
ds_read_b64_tr_b16 a[142:143], v14 offset:14336
v_mfma_f32_16x16x32_bf16 v[24:27], a[192:195], v[76:79], v[24:27]
buffer_load_dwordx4 v4, s[12:15], s45 offen offset:1024 lds
v_mfma_f32_16x16x32_bf16 v[24:27], a[196:199], v[80:83], v[24:27]
ds_read_b64_tr_b16 a[144:145], v14 offset:16384
ds_read_b64_tr_b16 a[146:147], v14 offset:18432
v_mfma_f32_16x16x32_bf16 v[28:31], a[164:167], v[120:123], 0
v_permlane16_swap_b32 v228, v230
v_permlane16_swap_b32 v229, v231
v_mfma_f32_16x16x32_bf16 v[28:31], a[168:171], v[124:127], v[28:31]
ds_read_b64_tr_b16 a[148:149], v14 offset:20480
ds_read_b64_tr_b16 a[150:151], v14 offset:22528
v_mfma_f32_16x16x32_bf16 v[28:31], a[172:175], v[128:131], v[28:31]
v_permlane16_swap_b32 v244, v246
v_permlane16_swap_b32 v245, v247
v_mfma_f32_16x16x32_bf16 v[28:31], a[176:179], v[132:135], v[28:31]
ds_read_b64_tr_b16 a[152:153], v14 offset:24576
ds_read_b64_tr_b16 a[154:155], v14 offset:26624
v_mfma_f32_16x16x32_bf16 v[28:31], a[180:183], v[136:139], v[28:31]
s_add_u32 m0, s41, 4192
v_mfma_f32_16x16x32_bf16 v[28:31], a[184:187], v[140:143], v[28:31]
ds_read_b64_tr_b16 a[156:157], v14 offset:28672
ds_read_b64_tr_b16 a[158:159], v14 offset:30720
v_mfma_f32_16x16x32_bf16 v[28:31], a[188:191], v[144:147], v[28:31]
buffer_load_dwordx4 v4, s[12:15], s45 offen offset:2048 lds
v_mfma_f32_16x16x32_bf16 v[28:31], a[192:195], v[148:151], v[28:31]
ds_read_b64_tr_b16 a[160:161], v14 offset:32768
ds_read_b64_tr_b16 a[162:163], v14 offset:34816
v_mfma_f32_16x16x32_bf16 v[28:31], a[196:199], v[152:155], v[28:31]
s_waitcnt lgkmcnt(6)
v_mfma_f32_16x16x32_bf16 v[32:35], a[128:131], v[48:51], 0
ds_read_b64_tr_b16 a[164:165], v15 offset:0
ds_read_b64_tr_b16 a[166:167], v15 offset:2048
v_mfma_f32_16x16x32_bf16 v[32:35], a[132:135], v[52:55], v[32:35]
v_add_u32 v14, 0x9000, v14
v_mfma_f32_16x16x32_bf16 v[32:35], a[136:139], v[56:59], v[32:35]
ds_read_b64_tr_b16 a[168:169], v15 offset:4096
ds_read_b64_tr_b16 a[170:171], v15 offset:6144
v_mfma_f32_16x16x32_bf16 v[32:35], a[140:143], v[60:63], v[32:35]
s_add_u32 m0, s41, 4208
v_mfma_f32_16x16x32_bf16 v[32:35], a[144:147], v[64:67], v[32:35]
ds_read_b64_tr_b16 a[172:173], v15 offset:8192
ds_read_b64_tr_b16 a[174:175], v15 offset:10240
v_mfma_f32_16x16x32_bf16 v[32:35], a[148:151], v[68:71], v[32:35]
s_waitcnt lgkmcnt(6)
buffer_load_dwordx4 v4, s[12:15], s45 offen offset:3072 lds
v_mfma_f32_16x16x32_bf16 v[32:35], a[152:155], v[72:75], v[32:35]
ds_read_b64_tr_b16 a[176:177], v15 offset:12288
ds_read_b64_tr_b16 a[178:179], v15 offset:14336
v_mfma_f32_16x16x32_bf16 v[32:35], a[156:159], v[76:79], v[32:35]
v_mfma_f32_16x16x32_bf16 v[32:35], a[160:163], v[80:83], v[32:35]
ds_read_b64_tr_b16 a[180:181], v15 offset:16384
ds_read_b64_tr_b16 a[182:183], v15 offset:18432
v_mfma_f32_16x16x32_bf16 v[36:39], a[128:131], v[120:123], 0
v_mfma_f32_16x16x32_bf16 v[36:39], a[132:135], v[124:127], v[36:39]
ds_read_b64_tr_b16 a[184:185], v15 offset:20480
ds_read_b64_tr_b16 a[186:187], v15 offset:22528
v_mfma_f32_16x16x32_bf16 v[36:39], a[136:139], v[128:131], v[36:39]
s_add_u32 s43, s43, 32768
s_and_b32 s43, s43, 0x7ffff
v_mfma_f32_16x16x32_bf16 v[36:39], a[140:143], v[132:135], v[36:39]
ds_read_b64_tr_b16 a[188:189], v15 offset:24576
ds_read_b64_tr_b16 a[190:191], v15 offset:26624
v_mfma_f32_16x16x32_bf16 v[36:39], a[144:147], v[136:139], v[36:39]
v_mfma_f32_16x16x32_bf16 v[36:39], a[148:151], v[140:143], v[36:39]
ds_read_b64_tr_b16 a[192:193], v15 offset:28672
ds_read_b64_tr_b16 a[194:195], v15 offset:30720
v_mfma_f32_16x16x32_bf16 v[36:39], a[152:155], v[144:147], v[36:39]
v_mfma_f32_16x16x32_bf16 v[36:39], a[156:159], v[148:151], v[36:39]
ds_read_b64_tr_b16 a[196:197], v15 offset:32768
ds_read_b64_tr_b16 a[198:199], v15 offset:34816
v_mfma_f32_16x16x32_bf16 v[36:39], a[160:163], v[152:155], v[36:39]
s_waitcnt lgkmcnt(6)
s_add_u32 s45, s43, 16
v_mfma_f32_16x16x32_bf16 v[40:43], a[164:167], v[48:51], 0
s_waitcnt vmcnt(8)
s_barrier
ds_read_b64_tr_b16 a[128:129], v12 offset:0
ds_read_b64_tr_b16 a[130:131], v12 offset:2048
v_mfma_f32_16x16x32_bf16 v[40:43], a[168:171], v[52:55], v[40:43]
v_add_u32 v15, 0x9000, v15
s_add_u32 m0, s41, 36864
v_mfma_f32_16x16x32_bf16 v[40:43], a[172:175], v[56:59], v[40:43]
ds_read_b64_tr_b16 a[132:133], v12 offset:4096
ds_read_b64_tr_b16 a[134:135], v12 offset:6144
v_mfma_f32_16x16x32_bf16 v[40:43], a[176:179], v[60:63], v[40:43]
buffer_load_dwordx4 v4, s[12:15], s45 offen offset:0 lds
v_mfma_f32_16x16x32_bf16 v[40:43], a[180:183], v[64:67], v[40:43]
ds_read_b64_tr_b16 a[136:137], v12 offset:8192
ds_read_b64_tr_b16 a[138:139], v12 offset:10240
v_mfma_f32_16x16x32_bf16 v[40:43], a[184:187], v[68:71], v[40:43]
s_waitcnt lgkmcnt(6)
v_mfma_f32_16x16x32_bf16 v[40:43], a[188:191], v[72:75], v[40:43]
ds_read_b64_tr_b16 a[140:141], v12 offset:12288
ds_read_b64_tr_b16 a[142:143], v12 offset:14336
v_mfma_f32_16x16x32_bf16 v[40:43], a[192:195], v[76:79], v[40:43]
s_add_u32 m0, s41, 36880
v_mfma_f32_16x16x32_bf16 v[40:43], a[196:199], v[80:83], v[40:43]
ds_read_b64_tr_b16 a[144:145], v12 offset:16384
ds_read_b64_tr_b16 a[146:147], v12 offset:18432
v_mfma_f32_16x16x32_bf16 v[44:47], a[164:167], v[120:123], 0
buffer_load_dwordx4 v4, s[12:15], s45 offen offset:1024 lds
v_mfma_f32_16x16x32_bf16 v[44:47], a[168:171], v[124:127], v[44:47]
ds_read_b64_tr_b16 a[148:149], v12 offset:20480
ds_read_b64_tr_b16 a[150:151], v12 offset:22528
v_mfma_f32_16x16x32_bf16 v[44:47], a[172:175], v[128:131], v[44:47]
v_mfma_f32_16x16x32_bf16 v[44:47], a[176:179], v[132:135], v[44:47]
ds_read_b64_tr_b16 a[152:153], v12 offset:24576
ds_read_b64_tr_b16 a[154:155], v12 offset:26624
v_mfma_f32_16x16x32_bf16 v[44:47], a[180:183], v[136:139], v[44:47]
s_add_u32 m0, s41, 36896
v_mfma_f32_16x16x32_bf16 v[44:47], a[184:187], v[140:143], v[44:47]
ds_read_b64_tr_b16 a[156:157], v12 offset:28672
ds_read_b64_tr_b16 a[158:159], v12 offset:30720
v_mfma_f32_16x16x32_bf16 v[44:47], a[188:191], v[144:147], v[44:47]
buffer_load_dwordx4 v4, s[12:15], s45 offen offset:2048 lds
v_mfma_f32_16x16x32_bf16 v[44:47], a[192:195], v[148:151], v[44:47]
ds_read_b64_tr_b16 a[160:161], v12 offset:32768
ds_read_b64_tr_b16 a[162:163], v12 offset:34816
v_mfma_f32_16x16x32_bf16 v[44:47], a[196:199], v[152:155], v[44:47]
s_waitcnt lgkmcnt(6)
v_mfma_f32_16x16x32_bf16 v[16:19], a[128:131], v[84:87], v[16:19]
ds_read_b64_tr_b16 a[164:165], v13 offset:0
ds_read_b64_tr_b16 a[166:167], v13 offset:2048
v_mfma_f32_16x16x32_bf16 v[16:19], a[132:135], v[88:91], v[16:19]
s_add_u32 m0, s41, 36912
v_mfma_f32_16x16x32_bf16 v[16:19], a[136:139], v[92:95], v[16:19]
ds_read_b64_tr_b16 a[168:169], v13 offset:4096
ds_read_b64_tr_b16 a[170:171], v13 offset:6144
v_mfma_f32_16x16x32_bf16 v[16:19], a[140:143], v[96:99], v[16:19]
buffer_load_dwordx4 v4, s[12:15], s45 offen offset:3072 lds
v_mfma_f32_16x16x32_bf16 v[16:19], a[144:147], v[100:103], v[16:19]
ds_read_b64_tr_b16 a[172:173], v13 offset:8192
ds_read_b64_tr_b16 a[174:175], v13 offset:10240
v_mfma_f32_16x16x32_bf16 v[16:19], a[148:151], v[104:107], v[16:19]
s_waitcnt lgkmcnt(6)
v_mfma_f32_16x16x32_bf16 v[16:19], a[152:155], v[108:111], v[16:19]
ds_read_b64_tr_b16 a[176:177], v13 offset:12288
ds_read_b64_tr_b16 a[178:179], v13 offset:14336
v_mfma_f32_16x16x32_bf16 v[16:19], a[156:159], v[112:115], v[16:19]
s_add_u32 m0, s41, 41024
s_add_u32 s45, s43, 4112
v_mfma_f32_16x16x32_bf16 v[16:19], a[160:163], v[116:119], v[16:19]
ds_read_b64_tr_b16 a[180:181], v13 offset:16384
ds_read_b64_tr_b16 a[182:183], v13 offset:18432
v_mfma_f32_16x16x32_bf16 v[20:23], a[128:131], v[156:159], v[20:23]
buffer_load_dwordx4 v4, s[12:15], s45 offen offset:0 lds
v_mfma_f32_16x16x32_bf16 v[20:23], a[132:135], v[160:163], v[20:23]
ds_read_b64_tr_b16 a[184:185], v13 offset:20480
ds_read_b64_tr_b16 a[186:187], v13 offset:22528
v_mfma_f32_16x16x32_bf16 v[20:23], a[136:139], v[164:167], v[20:23]
v_mfma_f32_16x16x32_bf16 v[20:23], a[140:143], v[168:171], v[20:23]
ds_read_b64_tr_b16 a[188:189], v13 offset:24576
ds_read_b64_tr_b16 a[190:191], v13 offset:26624
v_mfma_f32_16x16x32_bf16 v[20:23], a[144:147], v[172:175], v[20:23]
s_add_u32 m0, s41, 41040
v_mfma_f32_16x16x32_bf16 v[20:23], a[148:151], v[176:179], v[20:23]
ds_read_b64_tr_b16 a[192:193], v13 offset:28672
ds_read_b64_tr_b16 a[194:195], v13 offset:30720
v_mfma_f32_16x16x32_bf16 v[20:23], a[152:155], v[180:183], v[20:23]
buffer_load_dwordx4 v4, s[12:15], s45 offen offset:1024 lds
v_mfma_f32_16x16x32_bf16 v[20:23], a[156:159], v[184:187], v[20:23]
ds_read_b64_tr_b16 a[196:197], v13 offset:32768
ds_read_b64_tr_b16 a[198:199], v13 offset:34816
v_mfma_f32_16x16x32_bf16 v[20:23], a[160:163], v[188:191], v[20:23]
s_waitcnt lgkmcnt(6)
v_mfma_f32_16x16x32_bf16 v[24:27], a[164:167], v[84:87], v[24:27]
ds_read_b64_tr_b16 a[128:129], v14 offset:0
ds_read_b64_tr_b16 a[130:131], v14 offset:2048
v_mfma_f32_16x16x32_bf16 v[24:27], a[168:171], v[88:91], v[24:27]
s_add_u32 m0, s41, 41056
v_mfma_f32_16x16x32_bf16 v[24:27], a[172:175], v[92:95], v[24:27]
ds_read_b64_tr_b16 a[132:133], v14 offset:4096
ds_read_b64_tr_b16 a[134:135], v14 offset:6144
v_mfma_f32_16x16x32_bf16 v[24:27], a[176:179], v[96:99], v[24:27]
buffer_load_dwordx4 v4, s[12:15], s45 offen offset:2048 lds
v_mfma_f32_16x16x32_bf16 v[24:27], a[180:183], v[100:103], v[24:27]
ds_read_b64_tr_b16 a[136:137], v14 offset:8192
ds_read_b64_tr_b16 a[138:139], v14 offset:10240
v_mfma_f32_16x16x32_bf16 v[24:27], a[184:187], v[104:107], v[24:27]
s_waitcnt lgkmcnt(6)
v_mul_f32 v16, v16, v254
v_mul_f32 v17, v17, v254
v_mfma_f32_16x16x32_bf16 v[24:27], a[188:191], v[108:111], v[24:27]
ds_read_b64_tr_b16 a[140:141], v14 offset:12288
ds_read_b64_tr_b16 a[142:143], v14 offset:14336
v_mfma_f32_16x16x32_bf16 v[24:27], a[192:195], v[112:115], v[24:27]
v_mul_f32 v18, v18, v254
v_mul_f32 v19, v19, v254
v_mfma_f32_16x16x32_bf16 v[24:27], a[196:199], v[116:119], v[24:27]
ds_read_b64_tr_b16 a[144:145], v14 offset:16384
ds_read_b64_tr_b16 a[146:147], v14 offset:18432
s_add_u32 m0, s41, 41072
v_mfma_f32_16x16x32_bf16 v[28:31], a[164:167], v[156:159], v[28:31]
buffer_load_dwordx4 v4, s[12:15], s45 offen offset:3072 lds
v_mfma_f32_16x16x32_bf16 v[28:31], a[168:171], v[160:163], v[28:31]
ds_read_b64_tr_b16 a[148:149], v14 offset:20480
ds_read_b64_tr_b16 a[150:151], v14 offset:22528
v_mfma_f32_16x16x32_bf16 v[28:31], a[172:175], v[164:167], v[28:31]
v_mul_f32 v20, v20, v255
v_mul_f32 v21, v21, v255
v_mfma_f32_16x16x32_bf16 v[28:31], a[176:179], v[168:171], v[28:31]
ds_read_b64_tr_b16 a[152:153], v14 offset:24576
ds_read_b64_tr_b16 a[154:155], v14 offset:26624
v_mfma_f32_16x16x32_bf16 v[28:31], a[180:183], v[172:175], v[28:31]
v_mul_f32 v22, v22, v255
v_mul_f32 v23, v23, v255
v_mfma_f32_16x16x32_bf16 v[28:31], a[184:187], v[176:179], v[28:31]
s_add_u32 s43, s43, 32768
s_and_b32 s43, s43, 0x7ffff
ds_read_b64_tr_b16 a[156:157], v14 offset:28672
ds_read_b64_tr_b16 a[158:159], v14 offset:30720
v_mfma_f32_16x16x32_bf16 v[28:31], a[188:191], v[180:183], v[28:31]
v_cvt_pk_bf16_f32 v232, v16, v17
v_cvt_pk_bf16_f32 v233, v18, v19
v_mfma_f32_16x16x32_bf16 v[28:31], a[192:195], v[184:187], v[28:31]
ds_read_b64_tr_b16 a[160:161], v14 offset:32768
ds_read_b64_tr_b16 a[162:163], v14 offset:34816
v_mfma_f32_16x16x32_bf16 v[28:31], a[196:199], v[188:191], v[28:31]
s_waitcnt lgkmcnt(6)
v_cvt_pk_bf16_f32 v248, v20, v21
v_cvt_pk_bf16_f32 v249, v22, v23
v_mfma_f32_16x16x32_bf16 v[32:35], a[128:131], v[84:87], v[32:35]
ds_read_b64_tr_b16 a[164:165], v15 offset:0
ds_read_b64_tr_b16 a[166:167], v15 offset:2048
v_mfma_f32_16x16x32_bf16 v[32:35], a[132:135], v[88:91], v[32:35]
v_mfma_f32_16x16x32_bf16 v[32:35], a[136:139], v[92:95], v[32:35]
ds_read_b64_tr_b16 a[168:169], v15 offset:4096
ds_read_b64_tr_b16 a[170:171], v15 offset:6144
v_mfma_f32_16x16x32_bf16 v[32:35], a[140:143], v[96:99], v[32:35]
v_mul_f32 v24, v24, v254
v_mul_f32 v25, v25, v254
v_mfma_f32_16x16x32_bf16 v[32:35], a[144:147], v[100:103], v[32:35]
ds_read_b64_tr_b16 a[172:173], v15 offset:8192
ds_read_b64_tr_b16 a[174:175], v15 offset:10240
v_mfma_f32_16x16x32_bf16 v[32:35], a[148:151], v[104:107], v[32:35]
s_waitcnt lgkmcnt(6)
v_mul_f32 v26, v26, v254
v_mul_f32 v27, v27, v254
v_mfma_f32_16x16x32_bf16 v[32:35], a[152:155], v[108:111], v[32:35]
ds_read_b64_tr_b16 a[176:177], v15 offset:12288
ds_read_b64_tr_b16 a[178:179], v15 offset:14336
v_mfma_f32_16x16x32_bf16 v[32:35], a[156:159], v[112:115], v[32:35]
v_mul_f32 v28, v28, v255
v_mul_f32 v29, v29, v255
v_mfma_f32_16x16x32_bf16 v[32:35], a[160:163], v[116:119], v[32:35]
ds_read_b64_tr_b16 a[180:181], v15 offset:16384
ds_read_b64_tr_b16 a[182:183], v15 offset:18432
v_mfma_f32_16x16x32_bf16 v[36:39], a[128:131], v[156:159], v[36:39]
v_mul_f32 v30, v30, v255
v_mul_f32 v31, v31, v255
v_mfma_f32_16x16x32_bf16 v[36:39], a[132:135], v[160:163], v[36:39]
ds_read_b64_tr_b16 a[184:185], v15 offset:20480
ds_read_b64_tr_b16 a[186:187], v15 offset:22528
v_mfma_f32_16x16x32_bf16 v[36:39], a[136:139], v[164:167], v[36:39]
v_cvt_pk_bf16_f32 v234, v24, v25
v_cvt_pk_bf16_f32 v235, v26, v27
v_mfma_f32_16x16x32_bf16 v[36:39], a[140:143], v[168:171], v[36:39]
ds_read_b64_tr_b16 a[188:189], v15 offset:24576
ds_read_b64_tr_b16 a[190:191], v15 offset:26624
v_mfma_f32_16x16x32_bf16 v[36:39], a[144:147], v[172:175], v[36:39]
v_cvt_pk_bf16_f32 v250, v28, v29
v_cvt_pk_bf16_f32 v251, v30, v31
v_mfma_f32_16x16x32_bf16 v[36:39], a[148:151], v[176:179], v[36:39]
ds_read_b64_tr_b16 a[192:193], v15 offset:28672
ds_read_b64_tr_b16 a[194:195], v15 offset:30720
v_mfma_f32_16x16x32_bf16 v[36:39], a[152:155], v[180:183], v[36:39]
v_permlane16_swap_b32 v232, v234
v_permlane16_swap_b32 v233, v235
v_mfma_f32_16x16x32_bf16 v[36:39], a[156:159], v[184:187], v[36:39]
ds_read_b64_tr_b16 a[196:197], v15 offset:32768
ds_read_b64_tr_b16 a[198:199], v15 offset:34816
v_mfma_f32_16x16x32_bf16 v[36:39], a[160:163], v[188:191], v[36:39]
s_waitcnt lgkmcnt(6)
v_permlane16_swap_b32 v248, v250
v_permlane16_swap_b32 v249, v251
v_mfma_f32_16x16x32_bf16 v[40:43], a[164:167], v[84:87], v[40:43]
s_waitcnt vmcnt(8)
s_barrier
ds_read_b128 a[128:131], v5 offset:0
ds_read_b128 a[132:135], v5 offset:64
s_add_u32 m0, s42, 73728
v_mfma_f32_16x16x32_bf16 v[40:43], a[168:171], v[88:91], v[40:43]
s_add_u32 s45, s44, 32
buffer_load_dwordx4 v4, s[16:19], s45 offen offset:0 lds
v_mfma_f32_16x16x32_bf16 v[40:43], a[172:175], v[92:95], v[40:43]
ds_read_b128 a[136:139], v5 offset:128
ds_read_b128 a[140:143], v5 offset:192
v_mfma_f32_16x16x32_bf16 v[40:43], a[176:179], v[96:99], v[40:43]
v_mul_f32 v32, v32, v254
v_mul_f32 v33, v33, v254
v_mfma_f32_16x16x32_bf16 v[40:43], a[180:183], v[100:103], v[40:43]
ds_read_b128 a[144:147], v5 offset:256
ds_read_b128 a[148:151], v5 offset:320
v_mfma_f32_16x16x32_bf16 v[40:43], a[184:187], v[104:107], v[40:43]
s_waitcnt lgkmcnt(6)
v_mul_f32 v34, v34, v254
v_mul_f32 v35, v35, v254
v_mfma_f32_16x16x32_bf16 v[40:43], a[188:191], v[108:111], v[40:43]
ds_read_b128 a[152:155], v5 offset:384
ds_read_b128 a[156:159], v5 offset:448
v_mfma_f32_16x16x32_bf16 v[40:43], a[192:195], v[112:115], v[40:43]
v_mul_f32 v36, v36, v255
v_mul_f32 v37, v37, v255
v_mfma_f32_16x16x32_bf16 v[40:43], a[196:199], v[116:119], v[40:43]
v_mul_f32 v38, v38, v255
v_mul_f32 v39, v39, v255
v_mfma_f32_16x16x32_bf16 v[44:47], a[164:167], v[156:159], v[44:47]
v_cvt_pk_bf16_f32 v236, v32, v33
v_cvt_pk_bf16_f32 v237, v34, v35
v_mfma_f32_16x16x32_bf16 v[44:47], a[168:171], v[160:163], v[44:47]
v_cvt_pk_bf16_f32 v252, v36, v37
v_cvt_pk_bf16_f32 v253, v38, v39
s_add_u32 m0, s42, 73760
v_mfma_f32_16x16x32_bf16 v[44:47], a[172:175], v[164:167], v[44:47]
buffer_load_dwordx4 v4, s[16:19], s45 offen offset:1024 lds
s_add_u32 m0, s42, 73792
v_mfma_f32_16x16x32_bf16 v[44:47], a[176:179], v[168:171], v[44:47]
buffer_load_dwordx4 v4, s[16:19], s45 offen offset:2048 lds
s_add_u32 m0, s42, 73824
v_mfma_f32_16x16x32_bf16 v[44:47], a[180:183], v[172:175], v[44:47]
buffer_load_dwordx4 v4, s[16:19], s45 offen offset:3072 lds
s_add_u32 m0, s42, 77952
v_mfma_f32_16x16x32_bf16 v[44:47], a[184:187], v[176:179], v[44:47]
s_add_u32 s45, s44, 4128
buffer_load_dwordx4 v4, s[16:19], s45 offen offset:0 lds
s_add_u32 m0, s42, 77984
v_mfma_f32_16x16x32_bf16 v[44:47], a[188:191], v[180:183], v[44:47]
buffer_load_dwordx4 v4, s[16:19], s45 offen offset:1024 lds
s_add_u32 m0, s42, 78016
v_mfma_f32_16x16x32_bf16 v[44:47], a[192:195], v[184:187], v[44:47]
buffer_load_dwordx4 v4, s[16:19], s45 offen offset:2048 lds
s_add_u32 m0, s42, 78048
v_mfma_f32_16x16x32_bf16 v[44:47], a[196:199], v[188:191], v[44:47]
s_waitcnt lgkmcnt(0)
buffer_load_dwordx4 v4, s[16:19], s45 offen offset:3072 lds
v_mfma_f32_16x16x32_bf16 v[128:131], a[128:131], v[192:195], 0
s_add_u32 s44, s44, 32768
s_and_b32 s44, s44, 0x7ffff
v_mfma_f32_16x16x32_bf16 v[128:131], a[132:135], v[196:199], v[128:131]
s_cmp_eq_u32 s3, 1
s_cselect_b64 s[56:57], s[28:29], s[70:71]
s_cmp_eq_u32 s3, 2
v_mfma_f32_16x16x32_bf16 v[128:131], a[136:139], v[200:203], v[128:131]
s_cselect_b64 s[56:57], s[30:31], s[56:57]
v_mul_f32 v40, v40, v254
s_cmp_eq_u32 s3, 3
v_mfma_f32_16x16x32_bf16 v[128:131], a[140:143], v[204:207], v[128:131]
v_mul_f32 v41, v41, v254
s_cselect_b64 s[56:57], s[32:33], s[56:57]
v_mul_f32 v42, v42, v254
v_mfma_f32_16x16x32_bf16 v[144:147], a[144:147], v[192:195], 0
s_cselect_b32 s38, 27, 24
v_mul_f32 v43, v43, v254
s_lshl_b32 s60, s38, 7
v_mfma_f32_16x16x32_bf16 v[144:147], a[148:151], v[196:199], v[144:147]
v_mul_f32 v44, v44, v255
s_lshl_b32 s39, s4, 4
v_mul_f32 v45, v45, v255
v_mfma_f32_16x16x32_bf16 v[144:147], a[152:155], v[200:203], v[144:147]
s_add_u32 s39, s39, s5
v_mul_f32 v46, v46, v255
v_mfma_f32_16x16x32_bf16 v[144:147], a[156:159], v[204:207], v[144:147]
s_mul_i32 s39, s39, s60
v_mul_f32 v47, v47, v255
s_mul_i32 s55, s39, 6
v_mfma_f32_16x16x32_bf16 v[132:135], a[128:131], v[208:211], 0
v_cvt_pk_bf16_f32 v238, v40, v41
s_mul_i32 s39, s4, 576
v_cvt_pk_bf16_f32 v239, v42, v43
v_mfma_f32_16x16x32_bf16 v[132:135], a[132:135], v[212:215], v[132:135]
s_and_b32 s39, s39, 0xffffff80
v_cvt_pk_bf16_f32 v254, v44, v45
s_mul_i32 s6, s5, 331776
v_mfma_f32_16x16x32_bf16 v[132:135], a[136:139], v[216:219], v[132:135]
v_cvt_pk_bf16_f32 v255, v46, v47
s_add_u32 s39, s39, s6
v_permlane16_swap_b32 v236, v238
v_mfma_f32_16x16x32_bf16 v[132:135], a[140:143], v[220:223], v[132:135]
s_add_u32 s6, s3, 1
v_permlane16_swap_b32 v237, v239
s_bitcmp1_b32 s6, 1
v_mfma_f32_16x16x32_bf16 v[148:151], a[144:147], v[208:211], 0
v_permlane16_swap_b32 v252, v254
s_cselect_b32 s55, s39, s55
v_mfma_f32_16x16x32_bf16 v[148:151], a[148:151], v[212:215], v[148:151]
v_permlane16_swap_b32 v253, v255
s_cselect_b32 s60, 55296, s60
s_cselect_b32 s38, 30, s38
v_mfma_f32_16x16x32_bf16 v[148:151], a[152:155], v[216:219], v[148:151]
s_cselect_b32 s39, 8576, 0
s_mov_b32 s58, 5308416
s_cmp_eq_u32 s3, 0
v_mfma_f32_16x16x32_bf16 v[148:151], a[156:159], v[220:223], v[148:151]
s_cselect_b32 s58, 4718592, s58
s_mov_b32 s59, 0x20000
v_mul_u32_u24 v32, 52, v1
v_mfma_f32_16x16x32_bf16 v[136:139], a[128:131], v[224:227], 0
v_lshrrev_b32 v32, 8, v32
v_mul_u32_u24 v32, s39, v32
v_lshl_add_u32 v32, v1, 7, v32
v_mfma_f32_16x16x32_bf16 v[136:139], a[132:135], v[228:231], v[136:139]
v_mov_b32 v2, 0x40000000
v_cmp_gt_u32 vcc, s38, v1
s_nop 1
v_cndmask_b32 v2, v2, v32, vcc
v_mfma_f32_16x16x32_bf16 v[136:139], a[136:139], v[232:235], v[136:139]
v_max3_f32 v32, v128, v129, v130
s_mov_b32 s8, s74
v_max3_f32 v33, v132, v133, v134
v_mfma_f32_16x16x32_bf16 v[136:139], a[140:143], v[236:239], v[136:139]
s_mov_b32 s9, s75
v_max3_f32 v32, v32, v131, v144
s_mov_b32 s10, 3981312
v_mfma_f32_16x16x32_bf16 v[152:155], a[144:147], v[224:227], 0
v_max3_f32 v33, v33, v135, v148
s_mov_b32 s11, 0x20000
v_max3_f32 v32, v32, v145, v146
v_mfma_f32_16x16x32_bf16 v[152:155], a[148:151], v[228:231], v[152:155]
s_lshl_b32 s64, s54, 5
v_max3_f32 v33, v33, v149, v150
s_sub_u32 s64, s64, 440064
v_max_f32 v32, v32, v147
v_mfma_f32_16x16x32_bf16 v[152:155], a[152:155], v[232:235], v[152:155]
s_lshl_b32 s65, s54, 6
v_max_f32 v33, v33, v151
s_add_u32 s65, s65, 70144
v_mfma_f32_16x16x32_bf16 v[152:155], a[156:159], v[236:239], v[152:155]
v_mov_b32 v36, v32
s_cmp_lt_u32 s54, 144
v_mov_b32 v37, v33
v_mfma_f32_16x16x32_bf16 v[140:143], a[128:131], v[240:243], 0
s_cselect_b32 s64, s64, 0x10000000
v_permlane16_swap_b32 v32, v36
s_cselect_b32 s65, s65, 0x10000000
v_permlane16_swap_b32 v33, v37
v_mfma_f32_16x16x32_bf16 v[140:143], a[132:135], v[244:247], v[140:143]
s_cmp_lt_u32 s54, 36
v_max_f32 v32, v32, v36
s_cselect_b32 s66, 1.0, 0x3eeff558
v_mfma_f32_16x16x32_bf16 v[140:143], a[136:139], v[248:251], v[140:143]
v_max_f32 v33, v33, v37
s_cmp_ge_u32 s54, 72
v_mov_b32 v36, v32
v_mfma_f32_16x16x32_bf16 v[140:143], a[140:143], v[252:255], v[140:143]
s_cselect_b32 s67, 1.0, 0
v_mov_b32 v37, v33
s_cmp_ge_u32 s54, 108
v_mfma_f32_16x16x32_bf16 v[156:159], a[144:147], v[240:243], 0
v_permlane32_swap_b32 v32, v36
s_cselect_b32 s66, 0x4091afa4, s66
v_permlane32_swap_b32 v33, v37
s_cselect_b32 s67, 0, s67
v_mfma_f32_16x16x32_bf16 v[156:159], a[148:151], v[244:247], v[156:159]
v_max_f32 v32, v32, v36
v_max_f32 v33, v33, v37
v_sub_f32 v16, 0xc1c00000, v32
v_mfma_f32_16x16x32_bf16 v[156:159], a[152:155], v[248:251], v[156:159]
v_sub_f32 v20, 0xc1c00000, v33
v_sub_f32 v17, 0xc1c00000, v32
v_sub_f32 v21, 0xc1c00000, v33
v_mfma_f32_16x16x32_bf16 v[156:159], a[156:159], v[252:255], v[156:159]
v_sub_f32 v18, 0xc1c00000, v32
v_sub_f32 v22, 0xc1c00000, v33
v_sub_f32 v19, 0xc1c00000, v32
v_sub_f32 v23, 0xc1c00000, v33
v_max3_f32 v34, v136, v137, v138
v_max3_f32 v34, v34, v139, v152
v_max3_f32 v34, v34, v153, v154
v_max_f32 v34, v34, v155
v_mov_b32 v38, v34
v_lshrrev_b32 v45, 2, v0
v_max3_f32 v35, v140, v141, v142
v_and_b32 v42, 3, v0
v_permlane16_swap_b32 v34, v38
v_mul_u32_u24 v44, 6912, v45
v_max3_f32 v35, v35, v143, v156
v_lshl_add_u32 v44, v42, 3, v44
v_max_f32 v34, v34, v38
v_lshlrev_b32 v45, 2, v45
v_max3_f32 v35, v35, v157, v158
v_add_u32 v45, 152064, v45
v_mov_b32 v38, v34
v_max_f32 v35, v35, v159
s_nop 0
v_permlane32_swap_b32 v34, v38
v_mov_b32 v39, v35
v_max_f32 v34, v34, v38
s_nop 0
v_permlane16_swap_b32 v35, v39
v_sub_f32 v24, 0xc1c00000, v34
v_max_f32 v35, v35, v39
v_sub_f32 v25, 0xc1c00000, v34
v_mov_b32 v39, v35
v_sub_f32 v26, 0xc1c00000, v34
s_nop 0
v_permlane32_swap_b32 v35, v39
v_sub_f32 v27, 0xc1c00000, v34
v_max_f32 v35, v35, v39
v_sub_f32 v28, 0xc1c00000, v35
v_sub_f32 v29, 0xc1c00000, v35
v_sub_f32 v30, 0xc1c00000, v35
v_sub_f32 v31, 0xc1c00000, v35
v_mov_b32 v38, 0
v_mov_b32 v39, 0
v_mov_b32 v40, 0
v_mov_b32 v41, 0
s_nop 1
K1_stageP:
v_add_u32 v46, 16, v4
v_add_u32 v47, 32, v4
v_mfma_f32_16x16x32_bf16 v[48:51], a[128:131], v[192:195], v[16:19]
v_mfma_f32_16x16x32_bf16 v[48:51], a[132:135], v[196:199], v[48:51]
v_mfma_f32_16x16x32_bf16 v[48:51], a[136:139], v[200:203], v[48:51]
v_mfma_f32_16x16x32_bf16 v[48:51], a[140:143], v[204:207], v[48:51]
v_mfma_f32_16x16x32_bf16 v[52:55], a[128:131], v[208:211], v[20:23]
v_mfma_f32_16x16x32_bf16 v[52:55], a[132:135], v[212:215], v[52:55]
v_mfma_f32_16x16x32_bf16 v[52:55], a[136:139], v[216:219], v[52:55]
v_mfma_f32_16x16x32_bf16 v[52:55], a[140:143], v[220:223], v[52:55]
v_mfma_f32_16x16x32_bf16 v[56:59], a[128:131], v[224:227], v[24:27]
s_nop 2
v_exp_f32 v48, v48
v_mfma_f32_16x16x32_bf16 v[56:59], a[132:135], v[228:231], v[56:59]
v_exp_f32 v49, v49
v_mfma_f32_16x16x32_bf16 v[56:59], a[136:139], v[232:235], v[56:59]
v_exp_f32 v50, v50
v_mfma_f32_16x16x32_bf16 v[56:59], a[140:143], v[236:239], v[56:59]
v_exp_f32 v51, v51
v_mfma_f32_16x16x32_bf16 v[60:63], a[128:131], v[240:243], v[28:31]
v_cvt_pk_bf16_f32 v64, v48, v49
v_exp_f32 v52, v52
v_mfma_f32_16x16x32_bf16 v[60:63], a[132:135], v[244:247], v[60:63]
v_cvt_pk_bf16_f32 v65, v50, v51
v_exp_f32 v53, v53
v_mfma_f32_16x16x32_bf16 v[60:63], a[136:139], v[248:251], v[60:63]
v_exp_f32 v54, v54
v_mfma_f32_16x16x32_bf16 v[60:63], a[140:143], v[252:255], v[60:63]
s_waitcnt lgkmcnt(0)
v_exp_f32 v55, v55
v_mfma_f32_16x16x32_bf16 v[48:51], a[144:147], v[192:195], v[16:19]
ds_read_b128 a[128:131], v5 offset:512
v_cvt_pk_bf16_f32 v80, v52, v53
v_exp_f32 v56, v56
v_mfma_f32_16x16x32_bf16 v[48:51], a[148:151], v[196:199], v[48:51]
ds_read_b128 a[132:135], v5 offset:576
v_cvt_pk_bf16_f32 v81, v54, v55
v_exp_f32 v57, v57
v_mfma_f32_16x16x32_bf16 v[48:51], a[152:155], v[200:203], v[48:51]
ds_read_b128 a[136:139], v5 offset:640
v_exp_f32 v58, v58
v_mfma_f32_16x16x32_bf16 v[48:51], a[156:159], v[204:207], v[48:51]
ds_read_b128 a[140:143], v5 offset:704
v_exp_f32 v59, v59
v_mfma_f32_16x16x32_bf16 v[52:55], a[144:147], v[208:211], v[20:23]
v_cvt_pk_bf16_f32 v96, v56, v57
v_exp_f32 v60, v60
v_mfma_f32_16x16x32_bf16 v[52:55], a[148:151], v[212:215], v[52:55]
v_cvt_pk_bf16_f32 v97, v58, v59
v_exp_f32 v61, v61
v_mfma_f32_16x16x32_bf16 v[52:55], a[152:155], v[216:219], v[52:55]
v_exp_f32 v62, v62
v_mfma_f32_16x16x32_bf16 v[52:55], a[156:159], v[220:223], v[52:55]
v_exp_f32 v63, v63
v_mfma_f32_16x16x32_bf16 v[56:59], a[144:147], v[224:227], v[24:27]
v_cvt_pk_bf16_f32 v112, v60, v61
v_exp_f32 v48, v48
v_mfma_f32_16x16x32_bf16 v[56:59], a[148:151], v[228:231], v[56:59]
v_cvt_pk_bf16_f32 v113, v62, v63
v_exp_f32 v49, v49
v_mfma_f32_16x16x32_bf16 v[56:59], a[152:155], v[232:235], v[56:59]
v_exp_f32 v50, v50
v_mfma_f32_16x16x32_bf16 v[56:59], a[156:159], v[236:239], v[56:59]
v_exp_f32 v51, v51
v_mfma_f32_16x16x32_bf16 v[60:63], a[144:147], v[240:243], v[28:31]
v_cvt_pk_bf16_f32 v66, v48, v49
v_exp_f32 v52, v52
v_mfma_f32_16x16x32_bf16 v[60:63], a[148:151], v[244:247], v[60:63]
v_cvt_pk_bf16_f32 v67, v50, v51
v_exp_f32 v53, v53
v_mfma_f32_16x16x32_bf16 v[60:63], a[152:155], v[248:251], v[60:63]
v_exp_f32 v54, v54
v_mfma_f32_16x16x32_bf16 v[60:63], a[156:159], v[252:255], v[60:63]
s_waitcnt lgkmcnt(0)
v_exp_f32 v55, v55
v_mfma_f32_16x16x32_bf16 v[48:51], a[128:131], v[192:195], v[16:19]
ds_read_b128 a[144:147], v5 offset:768
v_cvt_pk_bf16_f32 v82, v52, v53
v_exp_f32 v56, v56
v_mfma_f32_16x16x32_bf16 v[48:51], a[132:135], v[196:199], v[48:51]
ds_read_b128 a[148:151], v5 offset:832
v_cvt_pk_bf16_f32 v83, v54, v55
v_exp_f32 v57, v57
v_mfma_f32_16x16x32_bf16 v[48:51], a[136:139], v[200:203], v[48:51]
ds_read_b128 a[152:155], v5 offset:896
v_exp_f32 v58, v58
v_mfma_f32_16x16x32_bf16 v[48:51], a[140:143], v[204:207], v[48:51]
ds_read_b128 a[156:159], v5 offset:960
v_exp_f32 v59, v59
v_mfma_f32_16x16x32_bf16 v[52:55], a[128:131], v[208:211], v[20:23]
v_cvt_pk_bf16_f32 v98, v56, v57
v_exp_f32 v60, v60
v_mfma_f32_16x16x32_bf16 v[52:55], a[132:135], v[212:215], v[52:55]
v_cvt_pk_bf16_f32 v99, v58, v59
v_exp_f32 v61, v61
v_mfma_f32_16x16x32_bf16 v[52:55], a[136:139], v[216:219], v[52:55]
v_exp_f32 v62, v62
v_mfma_f32_16x16x32_bf16 v[52:55], a[140:143], v[220:223], v[52:55]
v_exp_f32 v63, v63
v_mfma_f32_16x16x32_bf16 v[56:59], a[128:131], v[224:227], v[24:27]
v_cvt_pk_bf16_f32 v114, v60, v61
v_exp_f32 v48, v48
v_mfma_f32_16x16x32_bf16 v[56:59], a[132:135], v[228:231], v[56:59]
v_cvt_pk_bf16_f32 v115, v62, v63
v_exp_f32 v49, v49
v_mfma_f32_16x16x32_bf16 v[56:59], a[136:139], v[232:235], v[56:59]
v_exp_f32 v50, v50
v_mfma_f32_16x16x32_bf16 v[56:59], a[140:143], v[236:239], v[56:59]
v_exp_f32 v51, v51
v_mfma_f32_16x16x32_bf16 v[60:63], a[128:131], v[240:243], v[28:31]
v_cvt_pk_bf16_f32 v68, v48, v49
v_exp_f32 v52, v52
v_mfma_f32_16x16x32_bf16 v[60:63], a[132:135], v[244:247], v[60:63]
v_cvt_pk_bf16_f32 v69, v50, v51
v_exp_f32 v53, v53
v_mfma_f32_16x16x32_bf16 v[60:63], a[136:139], v[248:251], v[60:63]
v_exp_f32 v54, v54
v_mfma_f32_16x16x32_bf16 v[60:63], a[140:143], v[252:255], v[60:63]
s_waitcnt lgkmcnt(0)
v_exp_f32 v55, v55
v_mfma_f32_16x16x32_bf16 v[48:51], a[144:147], v[192:195], v[16:19]
ds_read_b128 a[128:131], v5 offset:16640
v_cvt_pk_bf16_f32 v84, v52, v53
v_exp_f32 v56, v56
v_mfma_f32_16x16x32_bf16 v[48:51], a[148:151], v[196:199], v[48:51]
ds_read_b128 a[132:135], v5 offset:16704
v_cvt_pk_bf16_f32 v85, v54, v55
v_exp_f32 v57, v57
v_mfma_f32_16x16x32_bf16 v[48:51], a[152:155], v[200:203], v[48:51]
ds_read_b128 a[136:139], v5 offset:16768
v_exp_f32 v58, v58
v_mfma_f32_16x16x32_bf16 v[48:51], a[156:159], v[204:207], v[48:51]
ds_read_b128 a[140:143], v5 offset:16832
v_exp_f32 v59, v59
v_mfma_f32_16x16x32_bf16 v[52:55], a[144:147], v[208:211], v[20:23]
v_cvt_pk_bf16_f32 v100, v56, v57
v_exp_f32 v60, v60
v_mfma_f32_16x16x32_bf16 v[52:55], a[148:151], v[212:215], v[52:55]
v_cvt_pk_bf16_f32 v101, v58, v59
v_exp_f32 v61, v61
v_mfma_f32_16x16x32_bf16 v[52:55], a[152:155], v[216:219], v[52:55]
v_exp_f32 v62, v62
v_mfma_f32_16x16x32_bf16 v[52:55], a[156:159], v[220:223], v[52:55]
v_exp_f32 v63, v63
v_mfma_f32_16x16x32_bf16 v[56:59], a[144:147], v[224:227], v[24:27]
v_cvt_pk_bf16_f32 v116, v60, v61
v_exp_f32 v48, v48
v_mfma_f32_16x16x32_bf16 v[56:59], a[148:151], v[228:231], v[56:59]
v_cvt_pk_bf16_f32 v117, v62, v63
v_exp_f32 v49, v49
v_mfma_f32_16x16x32_bf16 v[56:59], a[152:155], v[232:235], v[56:59]
v_exp_f32 v50, v50
v_mfma_f32_16x16x32_bf16 v[56:59], a[156:159], v[236:239], v[56:59]
v_exp_f32 v51, v51
v_mfma_f32_16x16x32_bf16 v[60:63], a[144:147], v[240:243], v[28:31]
v_cvt_pk_bf16_f32 v70, v48, v49
v_exp_f32 v52, v52
v_mfma_f32_16x16x32_bf16 v[60:63], a[148:151], v[244:247], v[60:63]
v_cvt_pk_bf16_f32 v71, v50, v51
v_exp_f32 v53, v53
v_mfma_f32_16x16x32_bf16 v[60:63], a[152:155], v[248:251], v[60:63]
v_exp_f32 v54, v54
v_mfma_f32_16x16x32_bf16 v[60:63], a[156:159], v[252:255], v[60:63]
s_waitcnt lgkmcnt(0)
v_exp_f32 v55, v55
v_mfma_f32_16x16x32_bf16 v[48:51], a[128:131], v[192:195], v[16:19]
ds_read_b128 a[144:147], v5 offset:16896
v_cvt_pk_bf16_f32 v86, v52, v53
v_exp_f32 v56, v56
v_mfma_f32_16x16x32_bf16 v[48:51], a[132:135], v[196:199], v[48:51]
ds_read_b128 a[148:151], v5 offset:16960
v_cvt_pk_bf16_f32 v87, v54, v55
v_exp_f32 v57, v57
v_mfma_f32_16x16x32_bf16 v[48:51], a[136:139], v[200:203], v[48:51]
ds_read_b128 a[152:155], v5 offset:17024
v_exp_f32 v58, v58
v_mfma_f32_16x16x32_bf16 v[48:51], a[140:143], v[204:207], v[48:51]
ds_read_b128 a[156:159], v5 offset:17088
v_exp_f32 v59, v59
v_mfma_f32_16x16x32_bf16 v[52:55], a[128:131], v[208:211], v[20:23]
v_cvt_pk_bf16_f32 v102, v56, v57
v_exp_f32 v60, v60
v_mfma_f32_16x16x32_bf16 v[52:55], a[132:135], v[212:215], v[52:55]
v_cvt_pk_bf16_f32 v103, v58, v59
v_exp_f32 v61, v61
v_mfma_f32_16x16x32_bf16 v[52:55], a[136:139], v[216:219], v[52:55]
v_exp_f32 v62, v62
v_mfma_f32_16x16x32_bf16 v[52:55], a[140:143], v[220:223], v[52:55]
v_exp_f32 v63, v63
v_mfma_f32_16x16x32_bf16 v[56:59], a[128:131], v[224:227], v[24:27]
v_cvt_pk_bf16_f32 v118, v60, v61
v_exp_f32 v48, v48
v_mfma_f32_16x16x32_bf16 v[56:59], a[132:135], v[228:231], v[56:59]
v_cvt_pk_bf16_f32 v119, v62, v63
v_exp_f32 v49, v49
v_mfma_f32_16x16x32_bf16 v[56:59], a[136:139], v[232:235], v[56:59]
v_exp_f32 v50, v50
v_mfma_f32_16x16x32_bf16 v[56:59], a[140:143], v[236:239], v[56:59]
v_exp_f32 v51, v51
v_mfma_f32_16x16x32_bf16 v[60:63], a[128:131], v[240:243], v[28:31]
v_cvt_pk_bf16_f32 v72, v48, v49
v_exp_f32 v52, v52
v_mfma_f32_16x16x32_bf16 v[60:63], a[132:135], v[244:247], v[60:63]
v_cvt_pk_bf16_f32 v73, v50, v51
v_exp_f32 v53, v53
v_mfma_f32_16x16x32_bf16 v[60:63], a[136:139], v[248:251], v[60:63]
v_exp_f32 v54, v54
v_mfma_f32_16x16x32_bf16 v[60:63], a[140:143], v[252:255], v[60:63]
s_waitcnt lgkmcnt(0)
v_exp_f32 v55, v55
v_mfma_f32_16x16x32_bf16 v[48:51], a[144:147], v[192:195], v[16:19]
ds_read_b128 a[128:131], v5 offset:17152
v_cvt_pk_bf16_f32 v88, v52, v53
v_exp_f32 v56, v56
v_mfma_f32_16x16x32_bf16 v[48:51], a[148:151], v[196:199], v[48:51]
ds_read_b128 a[132:135], v5 offset:17216
v_cvt_pk_bf16_f32 v89, v54, v55
v_exp_f32 v57, v57
v_mfma_f32_16x16x32_bf16 v[48:51], a[152:155], v[200:203], v[48:51]
ds_read_b128 a[136:139], v5 offset:17280
v_exp_f32 v58, v58
v_mfma_f32_16x16x32_bf16 v[48:51], a[156:159], v[204:207], v[48:51]
ds_read_b128 a[140:143], v5 offset:17344
v_exp_f32 v59, v59
v_mfma_f32_16x16x32_bf16 v[52:55], a[144:147], v[208:211], v[20:23]
v_cvt_pk_bf16_f32 v104, v56, v57
v_exp_f32 v60, v60
v_mfma_f32_16x16x32_bf16 v[52:55], a[148:151], v[212:215], v[52:55]
v_cvt_pk_bf16_f32 v105, v58, v59
v_exp_f32 v61, v61
v_mfma_f32_16x16x32_bf16 v[52:55], a[152:155], v[216:219], v[52:55]
v_exp_f32 v62, v62
v_mfma_f32_16x16x32_bf16 v[52:55], a[156:159], v[220:223], v[52:55]
v_exp_f32 v63, v63
v_mfma_f32_16x16x32_bf16 v[56:59], a[144:147], v[224:227], v[24:27]
v_cvt_pk_bf16_f32 v120, v60, v61
v_exp_f32 v48, v48
v_mfma_f32_16x16x32_bf16 v[56:59], a[148:151], v[228:231], v[56:59]
v_cvt_pk_bf16_f32 v121, v62, v63
v_exp_f32 v49, v49
v_mfma_f32_16x16x32_bf16 v[56:59], a[152:155], v[232:235], v[56:59]
v_exp_f32 v50, v50
v_mfma_f32_16x16x32_bf16 v[56:59], a[156:159], v[236:239], v[56:59]
v_exp_f32 v51, v51
v_mfma_f32_16x16x32_bf16 v[60:63], a[144:147], v[240:243], v[28:31]
v_cvt_pk_bf16_f32 v74, v48, v49
v_exp_f32 v52, v52
v_mfma_f32_16x16x32_bf16 v[60:63], a[148:151], v[244:247], v[60:63]
v_cvt_pk_bf16_f32 v75, v50, v51
v_exp_f32 v53, v53
v_mfma_f32_16x16x32_bf16 v[60:63], a[152:155], v[248:251], v[60:63]
v_exp_f32 v54, v54
v_mfma_f32_16x16x32_bf16 v[60:63], a[156:159], v[252:255], v[60:63]
s_waitcnt lgkmcnt(0)
v_exp_f32 v55, v55
v_mfma_f32_16x16x32_bf16 v[48:51], a[128:131], v[192:195], v[16:19]
ds_read_b128 a[144:147], v5 offset:17408
v_cvt_pk_bf16_f32 v90, v52, v53
v_exp_f32 v56, v56
v_mfma_f32_16x16x32_bf16 v[48:51], a[132:135], v[196:199], v[48:51]
ds_read_b128 a[148:151], v5 offset:17472
v_cvt_pk_bf16_f32 v91, v54, v55
v_exp_f32 v57, v57
v_mfma_f32_16x16x32_bf16 v[48:51], a[136:139], v[200:203], v[48:51]
ds_read_b128 a[152:155], v5 offset:17536
v_exp_f32 v58, v58
v_mfma_f32_16x16x32_bf16 v[48:51], a[140:143], v[204:207], v[48:51]
ds_read_b128 a[156:159], v5 offset:17600
v_exp_f32 v59, v59
v_mfma_f32_16x16x32_bf16 v[52:55], a[128:131], v[208:211], v[20:23]
v_cvt_pk_bf16_f32 v106, v56, v57
v_exp_f32 v60, v60
v_mfma_f32_16x16x32_bf16 v[52:55], a[132:135], v[212:215], v[52:55]
v_cvt_pk_bf16_f32 v107, v58, v59
v_exp_f32 v61, v61
v_mfma_f32_16x16x32_bf16 v[52:55], a[136:139], v[216:219], v[52:55]
v_exp_f32 v62, v62
v_mfma_f32_16x16x32_bf16 v[52:55], a[140:143], v[220:223], v[52:55]
v_exp_f32 v63, v63
v_mfma_f32_16x16x32_bf16 v[56:59], a[128:131], v[224:227], v[24:27]
v_cvt_pk_bf16_f32 v122, v60, v61
v_exp_f32 v48, v48
v_mfma_f32_16x16x32_bf16 v[56:59], a[132:135], v[228:231], v[56:59]
v_cvt_pk_bf16_f32 v123, v62, v63
v_exp_f32 v49, v49
v_mfma_f32_16x16x32_bf16 v[56:59], a[136:139], v[232:235], v[56:59]
v_exp_f32 v50, v50
v_mfma_f32_16x16x32_bf16 v[56:59], a[140:143], v[236:239], v[56:59]
v_exp_f32 v51, v51
v_mfma_f32_16x16x32_bf16 v[60:63], a[128:131], v[240:243], v[28:31]
v_cvt_pk_bf16_f32 v76, v48, v49
v_exp_f32 v52, v52
v_mfma_f32_16x16x32_bf16 v[60:63], a[132:135], v[244:247], v[60:63]
v_cvt_pk_bf16_f32 v77, v50, v51
v_exp_f32 v53, v53
v_mfma_f32_16x16x32_bf16 v[60:63], a[136:139], v[248:251], v[60:63]
v_exp_f32 v54, v54
v_mfma_f32_16x16x32_bf16 v[60:63], a[140:143], v[252:255], v[60:63]
s_waitcnt lgkmcnt(0)
v_exp_f32 v55, v55
v_mfma_f32_16x16x32_bf16 v[48:51], a[144:147], v[192:195], v[16:19]
s_waitcnt vmcnt(0)
s_barrier
ds_read_b128 a[128:131], v5 offset:36864
v_cvt_pk_bf16_f32 v92, v52, v53
v_exp_f32 v56, v56
v_mfma_f32_16x16x32_bf16 v[48:51], a[148:151], v[196:199], v[48:51]
ds_read_b128 a[132:135], v5 offset:36928
v_cvt_pk_bf16_f32 v93, v54, v55
v_exp_f32 v57, v57
v_mfma_f32_16x16x32_bf16 v[48:51], a[152:155], v[200:203], v[48:51]
ds_read_b128 a[136:139], v5 offset:36992
v_exp_f32 v58, v58
v_mfma_f32_16x16x32_bf16 v[48:51], a[156:159], v[204:207], v[48:51]
ds_read_b128 a[140:143], v5 offset:37056
v_exp_f32 v59, v59
v_mfma_f32_16x16x32_bf16 v[52:55], a[144:147], v[208:211], v[20:23]
ds_read_b64_tr_b16 a[160:161], v8 offset:0
v_cvt_pk_bf16_f32 v108, v56, v57
v_exp_f32 v60, v60
v_mfma_f32_16x16x32_bf16 v[52:55], a[148:151], v[212:215], v[52:55]
ds_read_b64_tr_b16 a[162:163], v8 offset:256
v_cvt_pk_bf16_f32 v109, v58, v59
v_exp_f32 v61, v61
v_mfma_f32_16x16x32_bf16 v[52:55], a[152:155], v[216:219], v[52:55]
ds_read_b64_tr_b16 a[164:165], v8 offset:512
v_exp_f32 v62, v62
v_mfma_f32_16x16x32_bf16 v[52:55], a[156:159], v[220:223], v[52:55]
ds_read_b64_tr_b16 a[166:167], v8 offset:768
v_exp_f32 v63, v63
v_mfma_f32_16x16x32_bf16 v[56:59], a[144:147], v[224:227], v[24:27]
ds_read_b64_tr_b16 a[168:169], v8 offset:16896
v_cvt_pk_bf16_f32 v124, v60, v61
v_exp_f32 v48, v48
v_mfma_f32_16x16x32_bf16 v[56:59], a[148:151], v[228:231], v[56:59]
ds_read_b64_tr_b16 a[170:171], v8 offset:17152
v_cvt_pk_bf16_f32 v125, v62, v63
v_exp_f32 v49, v49
v_mfma_f32_16x16x32_bf16 v[56:59], a[152:155], v[232:235], v[56:59]
ds_read_b64_tr_b16 a[172:173], v8 offset:17408
v_exp_f32 v50, v50
v_mfma_f32_16x16x32_bf16 v[56:59], a[156:159], v[236:239], v[56:59]
ds_read_b64_tr_b16 a[174:175], v8 offset:17664
v_exp_f32 v51, v51
v_mfma_f32_16x16x32_bf16 v[60:63], a[144:147], v[240:243], v[28:31]
v_cvt_pk_bf16_f32 v78, v48, v49
v_exp_f32 v52, v52
v_mfma_f32_16x16x32_bf16 v[60:63], a[148:151], v[244:247], v[60:63]
v_cvt_pk_bf16_f32 v79, v50, v51
v_exp_f32 v53, v53
v_mfma_f32_16x16x32_bf16 v[60:63], a[152:155], v[248:251], v[60:63]
v_exp_f32 v54, v54
v_mfma_f32_16x16x32_bf16 v[60:63], a[156:159], v[252:255], v[60:63]
v_exp_f32 v55, v55
v_cvt_pk_bf16_f32 v94, v52, v53
v_cvt_pk_bf16_f32 v95, v54, v55
v_exp_f32 v56, v56
v_exp_f32 v57, v57
v_exp_f32 v58, v58
v_exp_f32 v59, v59
s_waitcnt lgkmcnt(0)
v_cvt_pk_bf16_f32 v110, v56, v57
v_cvt_pk_bf16_f32 v111, v58, v59
s_add_u32 s64, s64, 442368
buffer_load_dwordx2 v[32:33], v44, s[8:11], s64 offen
s_mov_b32 s46, 7
.p2align 5
K1_loop:
v_mfma_f32_16x16x32_bf16 v[48:51], a[128:131], v[192:195], v[16:19]
v_exp_f32 v60, v60
v_mfma_f32_16x16x32_bf16 v[48:51], a[132:135], v[196:199], v[48:51]
ds_read_b128 a[144:147], v5 offset:37120
ds_read_b128 a[148:151], v5 offset:37184
v_mfma_f32_16x16x32_bf16 v[48:51], a[136:139], v[200:203], v[48:51]
v_exp_f32 v61, v61
v_mfma_f32_16x16x32_bf16 v[48:51], a[140:143], v[204:207], v[48:51]
ds_read_b128 a[152:155], v5 offset:37248
v_cvt_pk_bf16_f32 v126, v60, v61
v_mfma_f32_16x16x32_bf16 a[0:3], a[160:163], v[64:67], a[0:3]
v_exp_f32 v62, v62
s_add_u32 m0, s41, 110592
v_mfma_f32_16x16x32_bf16 a[0:3], a[164:167], v[68:71], a[0:3]
buffer_load_dwordx4 v46, s[12:15], s43 offen offset:0 lds
v_mfma_f32_16x16x32_bf16 a[0:3], a[168:171], v[72:75], a[0:3]
v_exp_f32 v63, v63
v_mfma_f32_16x16x32_bf16 a[0:3], a[172:175], v[76:79], a[0:3]
ds_read_b128 a[156:159], v5 offset:37312
v_cvt_pk_bf16_f32 v127, v62, v63
v_mfma_f32_16x16x32_bf16 v[52:55], a[128:131], v[208:211], v[20:23]
v_exp_f32 v48, v48
v_mfma_f32_16x16x32_bf16 v[52:55], a[132:135], v[212:215], v[52:55]
ds_read_b64_tr_b16 a[176:177], v8 offset:32
ds_read_b64_tr_b16 a[178:179], v8 offset:288
v_mfma_f32_16x16x32_bf16 v[52:55], a[136:139], v[216:219], v[52:55]
v_exp_f32 v49, v49
v_mfma_f32_16x16x32_bf16 v[52:55], a[140:143], v[220:223], v[52:55]
ds_read_b64_tr_b16 a[180:181], v8 offset:544
v_cvt_pk_bf16_f32 v128, v48, v49
v_mfma_f32_16x16x32_bf16 a[4:7], a[160:163], v[80:83], a[4:7]
v_exp_f32 v50, v50
v_mfma_f32_16x16x32_bf16 a[4:7], a[164:167], v[84:87], a[4:7]
buffer_load_dwordx4 v4, s[12:15], s43 offen offset:1040 lds
v_mfma_f32_16x16x32_bf16 a[4:7], a[168:171], v[88:91], a[4:7]
v_exp_f32 v51, v51
v_mfma_f32_16x16x32_bf16 a[4:7], a[172:175], v[92:95], a[4:7]
ds_read_b64_tr_b16 a[182:183], v8 offset:800
v_cvt_pk_bf16_f32 v129, v50, v51
v_mfma_f32_16x16x32_bf16 v[56:59], a[128:131], v[224:227], v[24:27]
v_exp_f32 v52, v52
v_mfma_f32_16x16x32_bf16 v[56:59], a[132:135], v[228:231], v[56:59]
ds_read_b64_tr_b16 a[184:185], v8 offset:16928
ds_read_b64_tr_b16 a[186:187], v8 offset:17184
v_mfma_f32_16x16x32_bf16 v[56:59], a[136:139], v[232:235], v[56:59]
v_exp_f32 v53, v53
v_mfma_f32_16x16x32_bf16 v[56:59], a[140:143], v[236:239], v[56:59]
ds_read_b64_tr_b16 a[188:189], v8 offset:17440
v_cvt_pk_bf16_f32 v144, v52, v53
v_mfma_f32_16x16x32_bf16 a[8:11], a[160:163], v[96:99], a[8:11]
v_exp_f32 v54, v54
v_mfma_f32_16x16x32_bf16 a[8:11], a[164:167], v[100:103], a[8:11]
buffer_load_dwordx4 v46, s[92:95], s43 offen offset:2080 lds
v_mfma_f32_16x16x32_bf16 a[8:11], a[168:171], v[104:107], a[8:11]
v_exp_f32 v55, v55
v_mfma_f32_16x16x32_bf16 a[8:11], a[172:175], v[108:111], a[8:11]
ds_read_b64_tr_b16 a[190:191], v8 offset:17696
v_cvt_pk_bf16_f32 v145, v54, v55
v_mfma_f32_16x16x32_bf16 v[60:63], a[128:131], v[240:243], v[28:31]
v_exp_f32 v56, v56
v_mfma_f32_16x16x32_bf16 v[60:63], a[132:135], v[244:247], v[60:63]
v_mfma_f32_16x16x32_bf16 v[60:63], a[136:139], v[248:251], v[60:63]
v_exp_f32 v57, v57
v_mfma_f32_16x16x32_bf16 v[60:63], a[140:143], v[252:255], v[60:63]
v_cvt_pk_bf16_f32 v160, v56, v57
v_mfma_f32_16x16x32_bf16 a[12:15], a[160:163], v[112:115], a[12:15]
v_exp_f32 v58, v58
v_mfma_f32_16x16x32_bf16 a[12:15], a[164:167], v[116:119], a[12:15]
buffer_load_dwordx4 v4, s[92:95], s43 offen offset:3120 lds
v_mfma_f32_16x16x32_bf16 a[12:15], a[168:171], v[120:123], a[12:15]
v_exp_f32 v59, v59
v_mfma_f32_16x16x32_bf16 a[12:15], a[172:175], v[124:127], a[12:15]
v_cvt_pk_bf16_f32 v161, v58, v59
v_smfmac_f32_16x16x64_bf16 a[200:203], a[216:219], v[64:71], v10
s_waitcnt lgkmcnt(0)
s_add_u32 m0, s41, 114752
s_add_u32 s45, s43, 4096
v_mfma_f32_16x16x32_bf16 v[48:51], a[144:147], v[192:195], v[16:19]
v_exp_f32 v60, v60
v_mfma_f32_16x16x32_bf16 v[48:51], a[148:151], v[196:199], v[48:51]
ds_read_b128 a[128:131], v5 offset:37376
ds_read_b128 a[132:135], v5 offset:37440
v_mfma_f32_16x16x32_bf16 v[48:51], a[152:155], v[200:203], v[48:51]
v_exp_f32 v61, v61
v_mfma_f32_16x16x32_bf16 v[48:51], a[156:159], v[204:207], v[48:51]
ds_read_b128 a[136:139], v5 offset:37504
v_cvt_pk_bf16_f32 v176, v60, v61
v_mfma_f32_16x16x32_bf16 a[16:19], a[176:179], v[64:67], a[16:19]
v_exp_f32 v62, v62
v_mfma_f32_16x16x32_bf16 a[16:19], a[180:183], v[68:71], a[16:19]
buffer_load_dwordx4 v46, s[12:15], s45 offen offset:0 lds
v_mfma_f32_16x16x32_bf16 a[16:19], a[184:187], v[72:75], a[16:19]
v_exp_f32 v63, v63
v_mfma_f32_16x16x32_bf16 a[16:19], a[188:191], v[76:79], a[16:19]
ds_read_b128 a[140:143], v5 offset:37568
v_cvt_pk_bf16_f32 v177, v62, v63
v_mfma_f32_16x16x32_bf16 v[52:55], a[144:147], v[208:211], v[20:23]
v_exp_f32 v48, v48
v_mfma_f32_16x16x32_bf16 v[52:55], a[148:151], v[212:215], v[52:55]
ds_read_b64_tr_b16 a[160:161], v8 offset:64
ds_read_b64_tr_b16 a[162:163], v8 offset:320
v_mfma_f32_16x16x32_bf16 v[52:55], a[152:155], v[216:219], v[52:55]
v_exp_f32 v49, v49
v_mfma_f32_16x16x32_bf16 v[52:55], a[156:159], v[220:223], v[52:55]
ds_read_b64_tr_b16 a[164:165], v8 offset:576
v_cvt_pk_bf16_f32 v130, v48, v49
v_mfma_f32_16x16x32_bf16 a[20:23], a[176:179], v[80:83], a[20:23]
v_exp_f32 v50, v50
v_mfma_f32_16x16x32_bf16 a[20:23], a[180:183], v[84:87], a[20:23]
buffer_load_dwordx4 v4, s[12:15], s45 offen offset:1040 lds
v_mfma_f32_16x16x32_bf16 a[20:23], a[184:187], v[88:91], a[20:23]
v_exp_f32 v51, v51
v_mfma_f32_16x16x32_bf16 a[20:23], a[188:191], v[92:95], a[20:23]
ds_read_b64_tr_b16 a[166:167], v8 offset:832
v_cvt_pk_bf16_f32 v131, v50, v51
v_mfma_f32_16x16x32_bf16 v[56:59], a[144:147], v[224:227], v[24:27]
v_exp_f32 v52, v52
v_mfma_f32_16x16x32_bf16 v[56:59], a[148:151], v[228:231], v[56:59]
ds_read_b64_tr_b16 a[168:169], v8 offset:16960
ds_read_b64_tr_b16 a[170:171], v8 offset:17216
v_mfma_f32_16x16x32_bf16 v[56:59], a[152:155], v[232:235], v[56:59]
v_exp_f32 v53, v53
v_mfma_f32_16x16x32_bf16 v[56:59], a[156:159], v[236:239], v[56:59]
ds_read_b64_tr_b16 a[172:173], v8 offset:17472
v_cvt_pk_bf16_f32 v146, v52, v53
v_mfma_f32_16x16x32_bf16 a[24:27], a[176:179], v[96:99], a[24:27]
v_exp_f32 v54, v54
v_mfma_f32_16x16x32_bf16 a[24:27], a[180:183], v[100:103], a[24:27]
buffer_load_dwordx4 v46, s[92:95], s45 offen offset:2080 lds
v_mfma_f32_16x16x32_bf16 a[24:27], a[184:187], v[104:107], a[24:27]
v_exp_f32 v55, v55
v_mfma_f32_16x16x32_bf16 a[24:27], a[188:191], v[108:111], a[24:27]
ds_read_b64_tr_b16 a[174:175], v8 offset:17728
v_cvt_pk_bf16_f32 v147, v54, v55
v_mfma_f32_16x16x32_bf16 v[60:63], a[144:147], v[240:243], v[28:31]
v_exp_f32 v56, v56
v_mfma_f32_16x16x32_bf16 v[60:63], a[148:151], v[244:247], v[60:63]
v_mfma_f32_16x16x32_bf16 v[60:63], a[152:155], v[248:251], v[60:63]
v_exp_f32 v57, v57
v_mfma_f32_16x16x32_bf16 v[60:63], a[156:159], v[252:255], v[60:63]
v_cvt_pk_bf16_f32 v162, v56, v57
v_mfma_f32_16x16x32_bf16 a[28:31], a[176:179], v[112:115], a[28:31]
v_exp_f32 v58, v58
v_mfma_f32_16x16x32_bf16 a[28:31], a[180:183], v[116:119], a[28:31]
buffer_load_dwordx4 v4, s[92:95], s45 offen offset:3120 lds
v_mfma_f32_16x16x32_bf16 a[28:31], a[184:187], v[120:123], a[28:31]
v_exp_f32 v59, v59
v_mfma_f32_16x16x32_bf16 a[28:31], a[188:191], v[124:127], a[28:31]
v_cvt_pk_bf16_f32 v163, v58, v59
v_smfmac_f32_16x16x64_bf16 a[200:203], a[216:219], v[72:79], v10
s_waitcnt lgkmcnt(0)
s_add_u32 m0, s42, 0
v_mfma_f32_16x16x32_bf16 v[48:51], a[128:131], v[192:195], v[16:19]
v_exp_f32 v60, v60
v_mfma_f32_16x16x32_bf16 v[48:51], a[132:135], v[196:199], v[48:51]
ds_read_b128 a[144:147], v5 offset:37632
ds_read_b128 a[148:151], v5 offset:37696
v_mfma_f32_16x16x32_bf16 v[48:51], a[136:139], v[200:203], v[48:51]
v_exp_f32 v61, v61
v_mfma_f32_16x16x32_bf16 v[48:51], a[140:143], v[204:207], v[48:51]
ds_read_b128 a[152:155], v5 offset:37760
v_cvt_pk_bf16_f32 v178, v60, v61
v_mfma_f32_16x16x32_bf16 a[32:35], a[160:163], v[64:67], a[32:35]
v_exp_f32 v62, v62
v_mfma_f32_16x16x32_bf16 a[32:35], a[164:167], v[68:71], a[32:35]
buffer_load_dwordx4 v47, s[16:19], s44 offen offset:0 lds
v_mfma_f32_16x16x32_bf16 a[32:35], a[168:171], v[72:75], a[32:35]
v_exp_f32 v63, v63
v_mfma_f32_16x16x32_bf16 a[32:35], a[172:175], v[76:79], a[32:35]
ds_read_b128 a[156:159], v5 offset:37824
v_cvt_pk_bf16_f32 v179, v62, v63
v_mfma_f32_16x16x32_bf16 v[52:55], a[128:131], v[208:211], v[20:23]
v_exp_f32 v48, v48
v_mfma_f32_16x16x32_bf16 v[52:55], a[132:135], v[212:215], v[52:55]
ds_read_b64_tr_b16 a[176:177], v8 offset:96
ds_read_b64_tr_b16 a[178:179], v8 offset:352
v_mfma_f32_16x16x32_bf16 v[52:55], a[136:139], v[216:219], v[52:55]
v_exp_f32 v49, v49
v_mfma_f32_16x16x32_bf16 v[52:55], a[140:143], v[220:223], v[52:55]
ds_read_b64_tr_b16 a[180:181], v8 offset:608
v_cvt_pk_bf16_f32 v132, v48, v49
v_mfma_f32_16x16x32_bf16 a[36:39], a[160:163], v[80:83], a[36:39]
v_exp_f32 v50, v50
v_mfma_f32_16x16x32_bf16 a[36:39], a[164:167], v[84:87], a[36:39]
buffer_load_dwordx4 v4, s[16:19], s44 offen offset:1056 lds
v_mfma_f32_16x16x32_bf16 a[36:39], a[168:171], v[88:91], a[36:39]
v_exp_f32 v51, v51
v_mfma_f32_16x16x32_bf16 a[36:39], a[172:175], v[92:95], a[36:39]
ds_read_b64_tr_b16 a[182:183], v8 offset:864
v_cvt_pk_bf16_f32 v133, v50, v51
v_mfma_f32_16x16x32_bf16 v[56:59], a[128:131], v[224:227], v[24:27]
v_exp_f32 v52, v52
v_mfma_f32_16x16x32_bf16 v[56:59], a[132:135], v[228:231], v[56:59]
ds_read_b64_tr_b16 a[184:185], v8 offset:16992
ds_read_b64_tr_b16 a[186:187], v8 offset:17248
v_mfma_f32_16x16x32_bf16 v[56:59], a[136:139], v[232:235], v[56:59]
v_exp_f32 v53, v53
v_mfma_f32_16x16x32_bf16 v[56:59], a[140:143], v[236:239], v[56:59]
ds_read_b64_tr_b16 a[188:189], v8 offset:17504
v_cvt_pk_bf16_f32 v148, v52, v53
v_mfma_f32_16x16x32_bf16 a[40:43], a[160:163], v[96:99], a[40:43]
v_exp_f32 v54, v54
v_mfma_f32_16x16x32_bf16 a[40:43], a[164:167], v[100:103], a[40:43]
buffer_load_dwordx4 v47, s[96:99], s44 offen offset:2112 lds
v_mfma_f32_16x16x32_bf16 a[40:43], a[168:171], v[104:107], a[40:43]
v_exp_f32 v55, v55
v_mfma_f32_16x16x32_bf16 a[40:43], a[172:175], v[108:111], a[40:43]
ds_read_b64_tr_b16 a[190:191], v8 offset:17760
v_cvt_pk_bf16_f32 v149, v54, v55
v_mfma_f32_16x16x32_bf16 v[60:63], a[128:131], v[240:243], v[28:31]
v_exp_f32 v56, v56
v_mfma_f32_16x16x32_bf16 v[60:63], a[132:135], v[244:247], v[60:63]
v_mfma_f32_16x16x32_bf16 v[60:63], a[136:139], v[248:251], v[60:63]
v_exp_f32 v57, v57
v_mfma_f32_16x16x32_bf16 v[60:63], a[140:143], v[252:255], v[60:63]
v_cvt_pk_bf16_f32 v164, v56, v57
v_mfma_f32_16x16x32_bf16 a[44:47], a[160:163], v[112:115], a[44:47]
v_exp_f32 v58, v58
v_mfma_f32_16x16x32_bf16 a[44:47], a[164:167], v[116:119], a[44:47]
buffer_load_dwordx4 v4, s[96:99], s44 offen offset:3168 lds
v_mfma_f32_16x16x32_bf16 a[44:47], a[168:171], v[120:123], a[44:47]
v_exp_f32 v59, v59
v_mfma_f32_16x16x32_bf16 a[44:47], a[172:175], v[124:127], a[44:47]
v_cvt_pk_bf16_f32 v165, v58, v59
v_smfmac_f32_16x16x64_bf16 a[204:207], a[216:219], v[80:87], v10
s_waitcnt lgkmcnt(0)
s_add_u32 m0, s42, 4224
s_add_u32 s45, s44, 4096
v_mfma_f32_16x16x32_bf16 v[48:51], a[144:147], v[192:195], v[16:19]
v_exp_f32 v60, v60
v_mfma_f32_16x16x32_bf16 v[48:51], a[148:151], v[196:199], v[48:51]
ds_read_b128 a[128:131], v5 offset:53504
ds_read_b128 a[132:135], v5 offset:53568
v_mfma_f32_16x16x32_bf16 v[48:51], a[152:155], v[200:203], v[48:51]
v_exp_f32 v61, v61
v_mfma_f32_16x16x32_bf16 v[48:51], a[156:159], v[204:207], v[48:51]
ds_read_b128 a[136:139], v5 offset:53632
v_cvt_pk_bf16_f32 v180, v60, v61
v_mfma_f32_16x16x32_bf16 a[48:51], a[176:179], v[64:67], a[48:51]
v_exp_f32 v62, v62
v_mfma_f32_16x16x32_bf16 a[48:51], a[180:183], v[68:71], a[48:51]
buffer_load_dwordx4 v47, s[16:19], s45 offen offset:0 lds
v_mfma_f32_16x16x32_bf16 a[48:51], a[184:187], v[72:75], a[48:51]
v_exp_f32 v63, v63
v_mfma_f32_16x16x32_bf16 a[48:51], a[188:191], v[76:79], a[48:51]
ds_read_b128 a[140:143], v5 offset:53696
v_cvt_pk_bf16_f32 v181, v62, v63
v_mfma_f32_16x16x32_bf16 v[52:55], a[144:147], v[208:211], v[20:23]
v_exp_f32 v48, v48
v_mfma_f32_16x16x32_bf16 v[52:55], a[148:151], v[212:215], v[52:55]
ds_read_b64_tr_b16 a[160:161], v8 offset:128
ds_read_b64_tr_b16 a[162:163], v8 offset:384
v_mfma_f32_16x16x32_bf16 v[52:55], a[152:155], v[216:219], v[52:55]
v_exp_f32 v49, v49
v_mfma_f32_16x16x32_bf16 v[52:55], a[156:159], v[220:223], v[52:55]
ds_read_b64_tr_b16 a[164:165], v8 offset:640
v_cvt_pk_bf16_f32 v134, v48, v49
v_mfma_f32_16x16x32_bf16 a[52:55], a[176:179], v[80:83], a[52:55]
v_exp_f32 v50, v50
v_mfma_f32_16x16x32_bf16 a[52:55], a[180:183], v[84:87], a[52:55]
buffer_load_dwordx4 v4, s[16:19], s45 offen offset:1056 lds
v_mfma_f32_16x16x32_bf16 a[52:55], a[184:187], v[88:91], a[52:55]
v_exp_f32 v51, v51
v_mfma_f32_16x16x32_bf16 a[52:55], a[188:191], v[92:95], a[52:55]
ds_read_b64_tr_b16 a[166:167], v8 offset:896
v_cvt_pk_bf16_f32 v135, v50, v51
v_mfma_f32_16x16x32_bf16 v[56:59], a[144:147], v[224:227], v[24:27]
v_exp_f32 v52, v52
v_mfma_f32_16x16x32_bf16 v[56:59], a[148:151], v[228:231], v[56:59]
ds_read_b64_tr_b16 a[168:169], v8 offset:17024
ds_read_b64_tr_b16 a[170:171], v8 offset:17280
v_mfma_f32_16x16x32_bf16 v[56:59], a[152:155], v[232:235], v[56:59]
v_exp_f32 v53, v53
v_mfma_f32_16x16x32_bf16 v[56:59], a[156:159], v[236:239], v[56:59]
ds_read_b64_tr_b16 a[172:173], v8 offset:17536
v_cvt_pk_bf16_f32 v150, v52, v53
v_mfma_f32_16x16x32_bf16 a[56:59], a[176:179], v[96:99], a[56:59]
v_exp_f32 v54, v54
v_mfma_f32_16x16x32_bf16 a[56:59], a[180:183], v[100:103], a[56:59]
buffer_load_dwordx4 v47, s[96:99], s45 offen offset:2112 lds
v_mfma_f32_16x16x32_bf16 a[56:59], a[184:187], v[104:107], a[56:59]
v_exp_f32 v55, v55
v_mfma_f32_16x16x32_bf16 a[56:59], a[188:191], v[108:111], a[56:59]
ds_read_b64_tr_b16 a[174:175], v8 offset:17792
v_cvt_pk_bf16_f32 v151, v54, v55
v_mfma_f32_16x16x32_bf16 v[60:63], a[144:147], v[240:243], v[28:31]
v_exp_f32 v56, v56
v_mfma_f32_16x16x32_bf16 v[60:63], a[148:151], v[244:247], v[60:63]
v_mfma_f32_16x16x32_bf16 v[60:63], a[152:155], v[248:251], v[60:63]
v_exp_f32 v57, v57
v_mfma_f32_16x16x32_bf16 v[60:63], a[156:159], v[252:255], v[60:63]
v_cvt_pk_bf16_f32 v166, v56, v57
v_mfma_f32_16x16x32_bf16 a[60:63], a[176:179], v[112:115], a[60:63]
v_exp_f32 v58, v58
v_mfma_f32_16x16x32_bf16 a[60:63], a[180:183], v[116:119], a[60:63]
buffer_load_dwordx4 v4, s[96:99], s45 offen offset:3168 lds
v_mfma_f32_16x16x32_bf16 a[60:63], a[184:187], v[120:123], a[60:63]
v_exp_f32 v59, v59
v_mfma_f32_16x16x32_bf16 a[60:63], a[188:191], v[124:127], a[60:63]
v_cvt_pk_bf16_f32 v167, v58, v59
v_smfmac_f32_16x16x64_bf16 a[204:207], a[216:219], v[88:95], v10
s_waitcnt lgkmcnt(0)
v_mfma_f32_16x16x32_bf16 v[48:51], a[128:131], v[192:195], v[16:19]
v_exp_f32 v60, v60
v_mfma_f32_16x16x32_bf16 v[48:51], a[132:135], v[196:199], v[48:51]
ds_read_b128 a[144:147], v5 offset:53760
ds_read_b128 a[148:151], v5 offset:53824
v_mfma_f32_16x16x32_bf16 v[48:51], a[136:139], v[200:203], v[48:51]
v_exp_f32 v61, v61
v_mfma_f32_16x16x32_bf16 v[48:51], a[140:143], v[204:207], v[48:51]
ds_read_b128 a[152:155], v5 offset:53888
v_cvt_pk_bf16_f32 v182, v60, v61
v_mfma_f32_16x16x32_bf16 a[64:67], a[160:163], v[64:67], a[64:67]
v_exp_f32 v62, v62
v_mfma_f32_16x16x32_bf16 a[64:67], a[164:167], v[68:71], a[64:67]
buffer_load_dword a255, v2, s[56:59], s55 offen
v_mfma_f32_16x16x32_bf16 a[64:67], a[168:171], v[72:75], a[64:67]
v_exp_f32 v63, v63
v_mfma_f32_16x16x32_bf16 a[64:67], a[172:175], v[76:79], a[64:67]
ds_read_b128 a[156:159], v5 offset:53952
v_cvt_pk_bf16_f32 v183, v62, v63
v_mfma_f32_16x16x32_bf16 v[52:55], a[128:131], v[208:211], v[20:23]
v_exp_f32 v48, v48
v_mfma_f32_16x16x32_bf16 v[52:55], a[132:135], v[212:215], v[52:55]
ds_read_b64_tr_b16 a[176:177], v8 offset:160
ds_read_b64_tr_b16 a[178:179], v8 offset:416
v_mfma_f32_16x16x32_bf16 v[52:55], a[136:139], v[216:219], v[52:55]
v_exp_f32 v49, v49
v_mfma_f32_16x16x32_bf16 v[52:55], a[140:143], v[220:223], v[52:55]
ds_read_b64_tr_b16 a[180:181], v8 offset:672
v_cvt_pk_bf16_f32 v136, v48, v49
v_mfma_f32_16x16x32_bf16 a[68:71], a[160:163], v[80:83], a[68:71]
v_exp_f32 v50, v50
v_mfma_f32_16x16x32_bf16 a[68:71], a[164:167], v[84:87], a[68:71]
v_mfma_f32_16x16x32_bf16 a[68:71], a[168:171], v[88:91], a[68:71]
v_exp_f32 v51, v51
v_mfma_f32_16x16x32_bf16 a[68:71], a[172:175], v[92:95], a[68:71]
ds_read_b64_tr_b16 a[182:183], v8 offset:928
v_cvt_pk_bf16_f32 v137, v50, v51
v_mfma_f32_16x16x32_bf16 v[56:59], a[128:131], v[224:227], v[24:27]
v_exp_f32 v52, v52
v_mfma_f32_16x16x32_bf16 v[56:59], a[132:135], v[228:231], v[56:59]
ds_read_b64_tr_b16 a[184:185], v8 offset:17056
ds_read_b64_tr_b16 a[186:187], v8 offset:17312
v_mfma_f32_16x16x32_bf16 v[56:59], a[136:139], v[232:235], v[56:59]
v_exp_f32 v53, v53
v_mfma_f32_16x16x32_bf16 v[56:59], a[140:143], v[236:239], v[56:59]
ds_read_b64_tr_b16 a[188:189], v8 offset:17568
v_cvt_pk_bf16_f32 v152, v52, v53
v_mfma_f32_16x16x32_bf16 a[72:75], a[160:163], v[96:99], a[72:75]
v_exp_f32 v54, v54
v_mfma_f32_16x16x32_bf16 a[72:75], a[164:167], v[100:103], a[72:75]
v_mfma_f32_16x16x32_bf16 a[72:75], a[168:171], v[104:107], a[72:75]
v_exp_f32 v55, v55
v_mfma_f32_16x16x32_bf16 a[72:75], a[172:175], v[108:111], a[72:75]
ds_read_b64_tr_b16 a[190:191], v8 offset:17824
v_cvt_pk_bf16_f32 v153, v54, v55
v_mfma_f32_16x16x32_bf16 v[60:63], a[128:131], v[240:243], v[28:31]
v_exp_f32 v56, v56
v_mfma_f32_16x16x32_bf16 v[60:63], a[132:135], v[244:247], v[60:63]
v_mfma_f32_16x16x32_bf16 v[60:63], a[136:139], v[248:251], v[60:63]
v_exp_f32 v57, v57
v_mfma_f32_16x16x32_bf16 v[60:63], a[140:143], v[252:255], v[60:63]
v_cvt_pk_bf16_f32 v168, v56, v57
v_mfma_f32_16x16x32_bf16 a[76:79], a[160:163], v[112:115], a[76:79]
v_exp_f32 v58, v58
v_mfma_f32_16x16x32_bf16 a[76:79], a[164:167], v[116:119], a[76:79]
v_mfma_f32_16x16x32_bf16 a[76:79], a[168:171], v[120:123], a[76:79]
v_exp_f32 v59, v59
v_mfma_f32_16x16x32_bf16 a[76:79], a[172:175], v[124:127], a[76:79]
v_cvt_pk_bf16_f32 v169, v58, v59
v_smfmac_f32_16x16x64_bf16 a[208:211], a[216:219], v[96:103], v10
s_waitcnt lgkmcnt(0)
v_mfma_f32_16x16x32_bf16 v[48:51], a[144:147], v[192:195], v[16:19]
v_exp_f32 v60, v60
v_mfma_f32_16x16x32_bf16 v[48:51], a[148:151], v[196:199], v[48:51]
ds_read_b128 a[128:131], v5 offset:54016
ds_read_b128 a[132:135], v5 offset:54080
v_mfma_f32_16x16x32_bf16 v[48:51], a[152:155], v[200:203], v[48:51]
v_exp_f32 v61, v61
v_mfma_f32_16x16x32_bf16 v[48:51], a[156:159], v[204:207], v[48:51]
ds_read_b128 a[136:139], v5 offset:54144
v_cvt_pk_bf16_f32 v184, v60, v61
v_mfma_f32_16x16x32_bf16 a[80:83], a[176:179], v[64:67], a[80:83]
v_exp_f32 v62, v62
v_mfma_f32_16x16x32_bf16 a[80:83], a[180:183], v[68:71], a[80:83]
v_mfma_f32_16x16x32_bf16 a[80:83], a[184:187], v[72:75], a[80:83]
v_exp_f32 v63, v63
v_mfma_f32_16x16x32_bf16 a[80:83], a[188:191], v[76:79], a[80:83]
ds_read_b128 a[140:143], v5 offset:54208
v_cvt_pk_bf16_f32 v185, v62, v63
v_mfma_f32_16x16x32_bf16 v[52:55], a[144:147], v[208:211], v[20:23]
v_exp_f32 v48, v48
v_mfma_f32_16x16x32_bf16 v[52:55], a[148:151], v[212:215], v[52:55]
ds_read_b64_tr_b16 a[160:161], v8 offset:192
ds_read_b64_tr_b16 a[162:163], v8 offset:448
v_mfma_f32_16x16x32_bf16 v[52:55], a[152:155], v[216:219], v[52:55]
v_exp_f32 v49, v49
v_mfma_f32_16x16x32_bf16 v[52:55], a[156:159], v[220:223], v[52:55]
ds_read_b64_tr_b16 a[164:165], v8 offset:704
v_cvt_pk_bf16_f32 v138, v48, v49
v_mfma_f32_16x16x32_bf16 a[84:87], a[176:179], v[80:83], a[84:87]
v_exp_f32 v50, v50
v_mfma_f32_16x16x32_bf16 a[84:87], a[180:183], v[84:87], a[84:87]
v_mfma_f32_16x16x32_bf16 a[84:87], a[184:187], v[88:91], a[84:87]
v_exp_f32 v51, v51
v_mfma_f32_16x16x32_bf16 a[84:87], a[188:191], v[92:95], a[84:87]
ds_read_b64_tr_b16 a[166:167], v8 offset:960
v_cvt_pk_bf16_f32 v139, v50, v51
v_mfma_f32_16x16x32_bf16 v[56:59], a[144:147], v[224:227], v[24:27]
v_exp_f32 v52, v52
v_mfma_f32_16x16x32_bf16 v[56:59], a[148:151], v[228:231], v[56:59]
ds_read_b64_tr_b16 a[168:169], v8 offset:17088
ds_read_b64_tr_b16 a[170:171], v8 offset:17344
v_mfma_f32_16x16x32_bf16 v[56:59], a[152:155], v[232:235], v[56:59]
v_exp_f32 v53, v53
v_mfma_f32_16x16x32_bf16 v[56:59], a[156:159], v[236:239], v[56:59]
ds_read_b64_tr_b16 a[172:173], v8 offset:17600
v_cvt_pk_bf16_f32 v154, v52, v53
v_mfma_f32_16x16x32_bf16 a[88:91], a[176:179], v[96:99], a[88:91]
v_exp_f32 v54, v54
v_mfma_f32_16x16x32_bf16 a[88:91], a[180:183], v[100:103], a[88:91]
v_mfma_f32_16x16x32_bf16 a[88:91], a[184:187], v[104:107], a[88:91]
v_exp_f32 v55, v55
v_mfma_f32_16x16x32_bf16 a[88:91], a[188:191], v[108:111], a[88:91]
ds_read_b64_tr_b16 a[174:175], v8 offset:17856
v_cvt_pk_bf16_f32 v155, v54, v55
v_mfma_f32_16x16x32_bf16 v[60:63], a[144:147], v[240:243], v[28:31]
v_exp_f32 v56, v56
v_mfma_f32_16x16x32_bf16 v[60:63], a[148:151], v[244:247], v[60:63]
v_mfma_f32_16x16x32_bf16 v[60:63], a[152:155], v[248:251], v[60:63]
v_exp_f32 v57, v57
v_mfma_f32_16x16x32_bf16 v[60:63], a[156:159], v[252:255], v[60:63]
v_cvt_pk_bf16_f32 v170, v56, v57
v_mfma_f32_16x16x32_bf16 a[92:95], a[176:179], v[112:115], a[92:95]
v_exp_f32 v58, v58
v_mfma_f32_16x16x32_bf16 a[92:95], a[180:183], v[116:119], a[92:95]
v_mfma_f32_16x16x32_bf16 a[92:95], a[184:187], v[120:123], a[92:95]
v_exp_f32 v59, v59
v_mfma_f32_16x16x32_bf16 a[92:95], a[188:191], v[124:127], a[92:95]
v_cvt_pk_bf16_f32 v171, v58, v59
s_add_u32 s44, s44, 32768
v_smfmac_f32_16x16x64_bf16 a[208:211], a[216:219], v[104:111], v10
s_waitcnt lgkmcnt(0)
s_add_u32 s43, s43, 32768
s_and_b32 s43, s43, 0x7ffff
v_mfma_f32_16x16x32_bf16 v[48:51], a[128:131], v[192:195], v[16:19]
v_exp_f32 v60, v60
v_mfma_f32_16x16x32_bf16 v[48:51], a[132:135], v[196:199], v[48:51]
ds_read_b128 a[144:147], v5 offset:54272
ds_read_b128 a[148:151], v5 offset:54336
v_mfma_f32_16x16x32_bf16 v[48:51], a[136:139], v[200:203], v[48:51]
v_exp_f32 v61, v61
v_mfma_f32_16x16x32_bf16 v[48:51], a[140:143], v[204:207], v[48:51]
ds_read_b128 a[152:155], v5 offset:54400
v_cvt_pk_bf16_f32 v186, v60, v61
v_mfma_f32_16x16x32_bf16 a[96:99], a[160:163], v[64:67], a[96:99]
v_exp_f32 v62, v62
v_mfma_f32_16x16x32_bf16 a[96:99], a[164:167], v[68:71], a[96:99]
s_and_b32 s44, s44, 0x7ffff
s_add_u32 s55, s55, s60
v_mfma_f32_16x16x32_bf16 a[96:99], a[168:171], v[72:75], a[96:99]
v_exp_f32 v63, v63
v_mfma_f32_16x16x32_bf16 a[96:99], a[172:175], v[76:79], a[96:99]
ds_read_b128 a[156:159], v5 offset:54464
v_cvt_pk_bf16_f32 v187, v62, v63
v_mfma_f32_16x16x32_bf16 v[52:55], a[128:131], v[208:211], v[20:23]
v_exp_f32 v48, v48
v_mfma_f32_16x16x32_bf16 v[52:55], a[132:135], v[212:215], v[52:55]
ds_read_b64_tr_b16 a[176:177], v8 offset:224
ds_read_b64_tr_b16 a[178:179], v8 offset:480
v_mfma_f32_16x16x32_bf16 v[52:55], a[136:139], v[216:219], v[52:55]
v_exp_f32 v49, v49
v_mfma_f32_16x16x32_bf16 v[52:55], a[140:143], v[220:223], v[52:55]
ds_read_b64_tr_b16 a[180:181], v8 offset:736
v_cvt_pk_bf16_f32 v140, v48, v49
v_mfma_f32_16x16x32_bf16 a[100:103], a[160:163], v[80:83], a[100:103]
v_exp_f32 v50, v50
v_mfma_f32_16x16x32_bf16 a[100:103], a[164:167], v[84:87], a[100:103]
v_mfma_f32_16x16x32_bf16 a[100:103], a[168:171], v[88:91], a[100:103]
v_exp_f32 v51, v51
v_mfma_f32_16x16x32_bf16 a[100:103], a[172:175], v[92:95], a[100:103]
ds_read_b64_tr_b16 a[182:183], v8 offset:992
v_cvt_pk_bf16_f32 v141, v50, v51
v_mfma_f32_16x16x32_bf16 v[56:59], a[128:131], v[224:227], v[24:27]
v_exp_f32 v52, v52
v_mfma_f32_16x16x32_bf16 v[56:59], a[132:135], v[228:231], v[56:59]
ds_read_b64_tr_b16 a[184:185], v8 offset:17120
ds_read_b64_tr_b16 a[186:187], v8 offset:17376
v_mfma_f32_16x16x32_bf16 v[56:59], a[136:139], v[232:235], v[56:59]
v_exp_f32 v53, v53
v_mfma_f32_16x16x32_bf16 v[56:59], a[140:143], v[236:239], v[56:59]
ds_read_b64_tr_b16 a[188:189], v8 offset:17632
v_cvt_pk_bf16_f32 v156, v52, v53
v_mfma_f32_16x16x32_bf16 a[104:107], a[160:163], v[96:99], a[104:107]
v_exp_f32 v54, v54
v_mfma_f32_16x16x32_bf16 a[104:107], a[164:167], v[100:103], a[104:107]
v_mfma_f32_16x16x32_bf16 a[104:107], a[168:171], v[104:107], a[104:107]
v_exp_f32 v55, v55
v_mfma_f32_16x16x32_bf16 a[104:107], a[172:175], v[108:111], a[104:107]
ds_read_b64_tr_b16 a[190:191], v8 offset:17888
v_cvt_pk_bf16_f32 v157, v54, v55
v_mfma_f32_16x16x32_bf16 v[60:63], a[128:131], v[240:243], v[28:31]
v_exp_f32 v56, v56
v_mfma_f32_16x16x32_bf16 v[60:63], a[132:135], v[244:247], v[60:63]
ds_read_b32 v42, v45 offset:0
v_mfma_f32_16x16x32_bf16 v[60:63], a[136:139], v[248:251], v[60:63]
v_exp_f32 v57, v57
v_mfma_f32_16x16x32_bf16 v[60:63], a[140:143], v[252:255], v[60:63]
v_cvt_pk_bf16_f32 v172, v56, v57
v_mfma_f32_16x16x32_bf16 a[108:111], a[160:163], v[112:115], a[108:111]
v_exp_f32 v58, v58
v_mfma_f32_16x16x32_bf16 a[108:111], a[164:167], v[116:119], a[108:111]
v_mfma_f32_16x16x32_bf16 a[108:111], a[168:171], v[120:123], a[108:111]
v_exp_f32 v59, v59
v_mfma_f32_16x16x32_bf16 a[108:111], a[172:175], v[124:127], a[108:111]
v_cvt_pk_bf16_f32 v173, v58, v59
v_smfmac_f32_16x16x64_bf16 a[212:215], a[216:219], v[112:119], v10
s_waitcnt lgkmcnt(0)
v_mfma_f32_16x16x32_bf16 v[48:51], a[144:147], v[192:195], v[16:19]
s_waitcnt vmcnt(1)
s_barrier
v_exp_f32 v60, v60
v_mfma_f32_16x16x32_bf16 v[48:51], a[148:151], v[196:199], v[48:51]
ds_read_b128 a[128:131], v6 offset:36864
ds_read_b128 a[132:135], v6 offset:36928
v_mfma_f32_16x16x32_bf16 v[48:51], a[152:155], v[200:203], v[48:51]
v_exp_f32 v61, v61
v_mfma_f32_16x16x32_bf16 v[48:51], a[156:159], v[204:207], v[48:51]
ds_read_b128 a[136:139], v6 offset:36992
v_cvt_pk_bf16_f32 v188, v60, v61
v_mfma_f32_16x16x32_bf16 a[112:115], a[176:179], v[64:67], a[112:115]
v_exp_f32 v62, v62
v_mfma_f32_16x16x32_bf16 a[112:115], a[180:183], v[68:71], a[112:115]
v_lshlrev_b32 v34, 16, v32
v_and_b32 v35, 0xffff0000, v32
v_mfma_f32_16x16x32_bf16 a[112:115], a[184:187], v[72:75], a[112:115]
v_exp_f32 v63, v63
v_mfma_f32_16x16x32_bf16 a[112:115], a[188:191], v[76:79], a[112:115]
ds_read_b128 a[140:143], v6 offset:37056
v_cvt_pk_bf16_f32 v189, v62, v63
v_mfma_f32_16x16x32_bf16 v[52:55], a[144:147], v[208:211], v[20:23]
v_exp_f32 v48, v48
v_mfma_f32_16x16x32_bf16 v[52:55], a[148:151], v[212:215], v[52:55]
ds_read_b64_tr_b16 a[160:161], v7 offset:0
ds_read_b64_tr_b16 a[162:163], v7 offset:256
v_mfma_f32_16x16x32_bf16 v[52:55], a[152:155], v[216:219], v[52:55]
v_exp_f32 v49, v49
v_mfma_f32_16x16x32_bf16 v[52:55], a[156:159], v[220:223], v[52:55]
ds_read_b64_tr_b16 a[164:165], v7 offset:512
v_cvt_pk_bf16_f32 v142, v48, v49
v_mfma_f32_16x16x32_bf16 a[116:119], a[176:179], v[80:83], a[116:119]
v_exp_f32 v50, v50
v_mfma_f32_16x16x32_bf16 a[116:119], a[180:183], v[84:87], a[116:119]
v_lshlrev_b32 v36, 16, v33
v_and_b32 v37, 0xffff0000, v33
v_mfma_f32_16x16x32_bf16 a[116:119], a[184:187], v[88:91], a[116:119]
v_exp_f32 v51, v51
v_mfma_f32_16x16x32_bf16 a[116:119], a[188:191], v[92:95], a[116:119]
ds_read_b64_tr_b16 a[166:167], v7 offset:768
v_cvt_pk_bf16_f32 v143, v50, v51
v_mfma_f32_16x16x32_bf16 v[56:59], a[144:147], v[224:227], v[24:27]
v_exp_f32 v52, v52
v_mfma_f32_16x16x32_bf16 v[56:59], a[148:151], v[228:231], v[56:59]
ds_read_b64_tr_b16 a[168:169], v7 offset:16896
ds_read_b64_tr_b16 a[170:171], v7 offset:17152
v_mfma_f32_16x16x32_bf16 v[56:59], a[152:155], v[232:235], v[56:59]
v_exp_f32 v53, v53
v_mfma_f32_16x16x32_bf16 v[56:59], a[156:159], v[236:239], v[56:59]
ds_read_b64_tr_b16 a[172:173], v7 offset:17408
v_cvt_pk_bf16_f32 v158, v52, v53
v_mfma_f32_16x16x32_bf16 a[120:123], a[176:179], v[96:99], a[120:123]
v_exp_f32 v54, v54
v_mfma_f32_16x16x32_bf16 a[120:123], a[180:183], v[100:103], a[120:123]
v_pk_fma_f32 v[38:39], v[34:35], v[42:43], v[38:39] op_sel_hi:[1,0,1]
v_pk_fma_f32 v[40:41], v[36:37], v[42:43], v[40:41] op_sel_hi:[1,0,1]
v_mfma_f32_16x16x32_bf16 a[120:123], a[184:187], v[104:107], a[120:123]
v_exp_f32 v55, v55
v_mfma_f32_16x16x32_bf16 a[120:123], a[188:191], v[108:111], a[120:123]
ds_read_b64_tr_b16 a[174:175], v7 offset:17664
v_cvt_pk_bf16_f32 v159, v54, v55
v_mfma_f32_16x16x32_bf16 v[60:63], a[144:147], v[240:243], v[28:31]
v_exp_f32 v56, v56
v_mfma_f32_16x16x32_bf16 v[60:63], a[148:151], v[244:247], v[60:63]
s_add_u32 s64, s64, 442368
buffer_load_dwordx2 v[32:33], v44, s[8:11], s64 offen
v_mfma_f32_16x16x32_bf16 v[60:63], a[152:155], v[248:251], v[60:63]
v_exp_f32 v57, v57
v_mfma_f32_16x16x32_bf16 v[60:63], a[156:159], v[252:255], v[60:63]
v_cvt_pk_bf16_f32 v174, v56, v57
v_mfma_f32_16x16x32_bf16 a[124:127], a[176:179], v[112:115], a[124:127]
v_exp_f32 v58, v58
v_mfma_f32_16x16x32_bf16 a[124:127], a[180:183], v[116:119], a[124:127]
v_mfma_f32_16x16x32_bf16 a[124:127], a[184:187], v[120:123], a[124:127]
v_exp_f32 v59, v59
v_mfma_f32_16x16x32_bf16 a[124:127], a[188:191], v[124:127], a[124:127]
v_cvt_pk_bf16_f32 v175, v58, v59
v_smfmac_f32_16x16x64_bf16 a[212:215], a[216:219], v[120:127], v10
s_waitcnt lgkmcnt(0)
v_mfma_f32_16x16x32_bf16 v[48:51], a[128:131], v[192:195], v[16:19]
v_exp_f32 v60, v60
v_mfma_f32_16x16x32_bf16 v[48:51], a[132:135], v[196:199], v[48:51]
ds_read_b128 a[144:147], v6 offset:37120
ds_read_b128 a[148:151], v6 offset:37184
v_mfma_f32_16x16x32_bf16 v[48:51], a[136:139], v[200:203], v[48:51]
v_exp_f32 v61, v61
v_mfma_f32_16x16x32_bf16 v[48:51], a[140:143], v[204:207], v[48:51]
ds_read_b128 a[152:155], v6 offset:37248
v_cvt_pk_bf16_f32 v190, v60, v61
v_mfma_f32_16x16x32_bf16 a[0:3], a[160:163], v[128:131], a[0:3]
v_exp_f32 v62, v62
s_add_u32 m0, s41, 36864
v_mfma_f32_16x16x32_bf16 a[0:3], a[164:167], v[132:135], a[0:3]
buffer_load_dwordx4 v46, s[12:15], s43 offen offset:0 lds
v_mfma_f32_16x16x32_bf16 a[0:3], a[168:171], v[136:139], a[0:3]
v_exp_f32 v63, v63
v_mfma_f32_16x16x32_bf16 a[0:3], a[172:175], v[140:143], a[0:3]
ds_read_b128 a[156:159], v6 offset:37312
v_cvt_pk_bf16_f32 v191, v62, v63
v_mfma_f32_16x16x32_bf16 v[52:55], a[128:131], v[208:211], v[20:23]
v_exp_f32 v48, v48
v_mfma_f32_16x16x32_bf16 v[52:55], a[132:135], v[212:215], v[52:55]
ds_read_b64_tr_b16 a[176:177], v7 offset:32
ds_read_b64_tr_b16 a[178:179], v7 offset:288
v_mfma_f32_16x16x32_bf16 v[52:55], a[136:139], v[216:219], v[52:55]
v_exp_f32 v49, v49
v_mfma_f32_16x16x32_bf16 v[52:55], a[140:143], v[220:223], v[52:55]
ds_read_b64_tr_b16 a[180:181], v7 offset:544
v_cvt_pk_bf16_f32 v64, v48, v49
v_mfma_f32_16x16x32_bf16 a[4:7], a[160:163], v[144:147], a[4:7]
v_exp_f32 v50, v50
v_mfma_f32_16x16x32_bf16 a[4:7], a[164:167], v[148:151], a[4:7]
buffer_load_dwordx4 v4, s[12:15], s43 offen offset:1040 lds
v_mfma_f32_16x16x32_bf16 a[4:7], a[168:171], v[152:155], a[4:7]
v_exp_f32 v51, v51
v_mfma_f32_16x16x32_bf16 a[4:7], a[172:175], v[156:159], a[4:7]
ds_read_b64_tr_b16 a[182:183], v7 offset:800
v_cvt_pk_bf16_f32 v65, v50, v51
v_mfma_f32_16x16x32_bf16 v[56:59], a[128:131], v[224:227], v[24:27]
v_exp_f32 v52, v52
v_mfma_f32_16x16x32_bf16 v[56:59], a[132:135], v[228:231], v[56:59]
ds_read_b64_tr_b16 a[184:185], v7 offset:16928
ds_read_b64_tr_b16 a[186:187], v7 offset:17184
v_mfma_f32_16x16x32_bf16 v[56:59], a[136:139], v[232:235], v[56:59]
v_exp_f32 v53, v53
v_mfma_f32_16x16x32_bf16 v[56:59], a[140:143], v[236:239], v[56:59]
ds_read_b64_tr_b16 a[188:189], v7 offset:17440
v_cvt_pk_bf16_f32 v80, v52, v53
v_mfma_f32_16x16x32_bf16 a[8:11], a[160:163], v[160:163], a[8:11]
v_exp_f32 v54, v54
v_mfma_f32_16x16x32_bf16 a[8:11], a[164:167], v[164:167], a[8:11]
buffer_load_dwordx4 v46, s[92:95], s43 offen offset:2080 lds
v_mfma_f32_16x16x32_bf16 a[8:11], a[168:171], v[168:171], a[8:11]
v_exp_f32 v55, v55
v_mfma_f32_16x16x32_bf16 a[8:11], a[172:175], v[172:175], a[8:11]
ds_read_b64_tr_b16 a[190:191], v7 offset:17696
v_cvt_pk_bf16_f32 v81, v54, v55
v_mfma_f32_16x16x32_bf16 v[60:63], a[128:131], v[240:243], v[28:31]
v_exp_f32 v56, v56
v_mfma_f32_16x16x32_bf16 v[60:63], a[132:135], v[244:247], v[60:63]
v_mfma_f32_16x16x32_bf16 v[60:63], a[136:139], v[248:251], v[60:63]
v_exp_f32 v57, v57
v_mfma_f32_16x16x32_bf16 v[60:63], a[140:143], v[252:255], v[60:63]
v_cvt_pk_bf16_f32 v96, v56, v57
v_mfma_f32_16x16x32_bf16 a[12:15], a[160:163], v[176:179], a[12:15]
v_exp_f32 v58, v58
v_mfma_f32_16x16x32_bf16 a[12:15], a[164:167], v[180:183], a[12:15]
buffer_load_dwordx4 v4, s[92:95], s43 offen offset:3120 lds
v_mfma_f32_16x16x32_bf16 a[12:15], a[168:171], v[184:187], a[12:15]
v_exp_f32 v59, v59
v_mfma_f32_16x16x32_bf16 a[12:15], a[172:175], v[188:191], a[12:15]
v_cvt_pk_bf16_f32 v97, v58, v59
v_smfmac_f32_16x16x64_bf16 a[200:203], a[216:219], v[128:135], v10
s_waitcnt lgkmcnt(0)
s_add_u32 m0, s41, 41024
s_add_u32 s45, s43, 4096
v_mfma_f32_16x16x32_bf16 v[48:51], a[144:147], v[192:195], v[16:19]
v_exp_f32 v60, v60
v_mfma_f32_16x16x32_bf16 v[48:51], a[148:151], v[196:199], v[48:51]
ds_read_b128 a[128:131], v6 offset:37376
ds_read_b128 a[132:135], v6 offset:37440
v_mfma_f32_16x16x32_bf16 v[48:51], a[152:155], v[200:203], v[48:51]
v_exp_f32 v61, v61
v_mfma_f32_16x16x32_bf16 v[48:51], a[156:159], v[204:207], v[48:51]
ds_read_b128 a[136:139], v6 offset:37504
v_cvt_pk_bf16_f32 v112, v60, v61
v_mfma_f32_16x16x32_bf16 a[16:19], a[176:179], v[128:131], a[16:19]
v_exp_f32 v62, v62
v_mfma_f32_16x16x32_bf16 a[16:19], a[180:183], v[132:135], a[16:19]
buffer_load_dwordx4 v46, s[12:15], s45 offen offset:0 lds
v_mfma_f32_16x16x32_bf16 a[16:19], a[184:187], v[136:139], a[16:19]
v_exp_f32 v63, v63
v_mfma_f32_16x16x32_bf16 a[16:19], a[188:191], v[140:143], a[16:19]
ds_read_b128 a[140:143], v6 offset:37568
v_cvt_pk_bf16_f32 v113, v62, v63
v_mfma_f32_16x16x32_bf16 v[52:55], a[144:147], v[208:211], v[20:23]
v_exp_f32 v48, v48
v_mfma_f32_16x16x32_bf16 v[52:55], a[148:151], v[212:215], v[52:55]
ds_read_b64_tr_b16 a[160:161], v7 offset:64
ds_read_b64_tr_b16 a[162:163], v7 offset:320
v_mfma_f32_16x16x32_bf16 v[52:55], a[152:155], v[216:219], v[52:55]
v_exp_f32 v49, v49
v_mfma_f32_16x16x32_bf16 v[52:55], a[156:159], v[220:223], v[52:55]
ds_read_b64_tr_b16 a[164:165], v7 offset:576
v_cvt_pk_bf16_f32 v66, v48, v49
v_mfma_f32_16x16x32_bf16 a[20:23], a[176:179], v[144:147], a[20:23]
v_exp_f32 v50, v50
v_mfma_f32_16x16x32_bf16 a[20:23], a[180:183], v[148:151], a[20:23]
buffer_load_dwordx4 v4, s[12:15], s45 offen offset:1040 lds
v_mfma_f32_16x16x32_bf16 a[20:23], a[184:187], v[152:155], a[20:23]
v_exp_f32 v51, v51
v_mfma_f32_16x16x32_bf16 a[20:23], a[188:191], v[156:159], a[20:23]
ds_read_b64_tr_b16 a[166:167], v7 offset:832
v_cvt_pk_bf16_f32 v67, v50, v51
v_mfma_f32_16x16x32_bf16 v[56:59], a[144:147], v[224:227], v[24:27]
v_exp_f32 v52, v52
v_mfma_f32_16x16x32_bf16 v[56:59], a[148:151], v[228:231], v[56:59]
ds_read_b64_tr_b16 a[168:169], v7 offset:16960
ds_read_b64_tr_b16 a[170:171], v7 offset:17216
v_mfma_f32_16x16x32_bf16 v[56:59], a[152:155], v[232:235], v[56:59]
v_exp_f32 v53, v53
v_mfma_f32_16x16x32_bf16 v[56:59], a[156:159], v[236:239], v[56:59]
ds_read_b64_tr_b16 a[172:173], v7 offset:17472
v_cvt_pk_bf16_f32 v82, v52, v53
v_mfma_f32_16x16x32_bf16 a[24:27], a[176:179], v[160:163], a[24:27]
v_exp_f32 v54, v54
v_mfma_f32_16x16x32_bf16 a[24:27], a[180:183], v[164:167], a[24:27]
buffer_load_dwordx4 v46, s[92:95], s45 offen offset:2080 lds
v_mfma_f32_16x16x32_bf16 a[24:27], a[184:187], v[168:171], a[24:27]
v_exp_f32 v55, v55
v_mfma_f32_16x16x32_bf16 a[24:27], a[188:191], v[172:175], a[24:27]
ds_read_b64_tr_b16 a[174:175], v7 offset:17728
v_cvt_pk_bf16_f32 v83, v54, v55
v_mfma_f32_16x16x32_bf16 v[60:63], a[144:147], v[240:243], v[28:31]
v_exp_f32 v56, v56
v_mfma_f32_16x16x32_bf16 v[60:63], a[148:151], v[244:247], v[60:63]
v_mfma_f32_16x16x32_bf16 v[60:63], a[152:155], v[248:251], v[60:63]
v_exp_f32 v57, v57
v_mfma_f32_16x16x32_bf16 v[60:63], a[156:159], v[252:255], v[60:63]
v_cvt_pk_bf16_f32 v98, v56, v57
v_mfma_f32_16x16x32_bf16 a[28:31], a[176:179], v[176:179], a[28:31]
v_exp_f32 v58, v58
v_mfma_f32_16x16x32_bf16 a[28:31], a[180:183], v[180:183], a[28:31]
buffer_load_dwordx4 v4, s[92:95], s45 offen offset:3120 lds
v_mfma_f32_16x16x32_bf16 a[28:31], a[184:187], v[184:187], a[28:31]
v_exp_f32 v59, v59
v_mfma_f32_16x16x32_bf16 a[28:31], a[188:191], v[188:191], a[28:31]
v_cvt_pk_bf16_f32 v99, v58, v59
v_smfmac_f32_16x16x64_bf16 a[200:203], a[216:219], v[136:143], v10
s_waitcnt lgkmcnt(0)
s_add_u32 m0, s42, 73728
v_mfma_f32_16x16x32_bf16 v[48:51], a[128:131], v[192:195], v[16:19]
v_exp_f32 v60, v60
v_mfma_f32_16x16x32_bf16 v[48:51], a[132:135], v[196:199], v[48:51]
ds_read_b128 a[144:147], v6 offset:37632
ds_read_b128 a[148:151], v6 offset:37696
v_mfma_f32_16x16x32_bf16 v[48:51], a[136:139], v[200:203], v[48:51]
v_exp_f32 v61, v61
v_mfma_f32_16x16x32_bf16 v[48:51], a[140:143], v[204:207], v[48:51]
ds_read_b128 a[152:155], v6 offset:37760
v_cvt_pk_bf16_f32 v114, v60, v61
v_mfma_f32_16x16x32_bf16 a[32:35], a[160:163], v[128:131], a[32:35]
v_exp_f32 v62, v62
v_mfma_f32_16x16x32_bf16 a[32:35], a[164:167], v[132:135], a[32:35]
buffer_load_dwordx4 v47, s[16:19], s44 offen offset:0 lds
v_mfma_f32_16x16x32_bf16 a[32:35], a[168:171], v[136:139], a[32:35]
v_exp_f32 v63, v63
v_mfma_f32_16x16x32_bf16 a[32:35], a[172:175], v[140:143], a[32:35]
ds_read_b128 a[156:159], v6 offset:37824
v_cvt_pk_bf16_f32 v115, v62, v63
v_mfma_f32_16x16x32_bf16 v[52:55], a[128:131], v[208:211], v[20:23]
v_exp_f32 v48, v48
v_mfma_f32_16x16x32_bf16 v[52:55], a[132:135], v[212:215], v[52:55]
ds_read_b64_tr_b16 a[176:177], v7 offset:96
ds_read_b64_tr_b16 a[178:179], v7 offset:352
v_mfma_f32_16x16x32_bf16 v[52:55], a[136:139], v[216:219], v[52:55]
v_exp_f32 v49, v49
v_mfma_f32_16x16x32_bf16 v[52:55], a[140:143], v[220:223], v[52:55]
ds_read_b64_tr_b16 a[180:181], v7 offset:608
v_cvt_pk_bf16_f32 v68, v48, v49
v_mfma_f32_16x16x32_bf16 a[36:39], a[160:163], v[144:147], a[36:39]
v_exp_f32 v50, v50
v_mfma_f32_16x16x32_bf16 a[36:39], a[164:167], v[148:151], a[36:39]
buffer_load_dwordx4 v4, s[16:19], s44 offen offset:1056 lds
v_mfma_f32_16x16x32_bf16 a[36:39], a[168:171], v[152:155], a[36:39]
v_exp_f32 v51, v51
v_mfma_f32_16x16x32_bf16 a[36:39], a[172:175], v[156:159], a[36:39]
ds_read_b64_tr_b16 a[182:183], v7 offset:864
v_cvt_pk_bf16_f32 v69, v50, v51
v_mfma_f32_16x16x32_bf16 v[56:59], a[128:131], v[224:227], v[24:27]
v_exp_f32 v52, v52
v_mfma_f32_16x16x32_bf16 v[56:59], a[132:135], v[228:231], v[56:59]
ds_read_b64_tr_b16 a[184:185], v7 offset:16992
ds_read_b64_tr_b16 a[186:187], v7 offset:17248
v_mfma_f32_16x16x32_bf16 v[56:59], a[136:139], v[232:235], v[56:59]
v_exp_f32 v53, v53
v_mfma_f32_16x16x32_bf16 v[56:59], a[140:143], v[236:239], v[56:59]
ds_read_b64_tr_b16 a[188:189], v7 offset:17504
v_cvt_pk_bf16_f32 v84, v52, v53
v_mfma_f32_16x16x32_bf16 a[40:43], a[160:163], v[160:163], a[40:43]
v_exp_f32 v54, v54
v_mfma_f32_16x16x32_bf16 a[40:43], a[164:167], v[164:167], a[40:43]
buffer_load_dwordx4 v47, s[96:99], s44 offen offset:2112 lds
v_mfma_f32_16x16x32_bf16 a[40:43], a[168:171], v[168:171], a[40:43]
v_exp_f32 v55, v55
v_mfma_f32_16x16x32_bf16 a[40:43], a[172:175], v[172:175], a[40:43]
ds_read_b64_tr_b16 a[190:191], v7 offset:17760
v_cvt_pk_bf16_f32 v85, v54, v55
v_mfma_f32_16x16x32_bf16 v[60:63], a[128:131], v[240:243], v[28:31]
v_exp_f32 v56, v56
v_mfma_f32_16x16x32_bf16 v[60:63], a[132:135], v[244:247], v[60:63]
v_mfma_f32_16x16x32_bf16 v[60:63], a[136:139], v[248:251], v[60:63]
v_exp_f32 v57, v57
v_mfma_f32_16x16x32_bf16 v[60:63], a[140:143], v[252:255], v[60:63]
v_cvt_pk_bf16_f32 v100, v56, v57
v_mfma_f32_16x16x32_bf16 a[44:47], a[160:163], v[176:179], a[44:47]
v_exp_f32 v58, v58
v_mfma_f32_16x16x32_bf16 a[44:47], a[164:167], v[180:183], a[44:47]
buffer_load_dwordx4 v4, s[96:99], s44 offen offset:3168 lds
v_mfma_f32_16x16x32_bf16 a[44:47], a[168:171], v[184:187], a[44:47]
v_exp_f32 v59, v59
v_mfma_f32_16x16x32_bf16 a[44:47], a[172:175], v[188:191], a[44:47]
v_cvt_pk_bf16_f32 v101, v58, v59
v_smfmac_f32_16x16x64_bf16 a[204:207], a[216:219], v[144:151], v10
s_waitcnt lgkmcnt(0)
s_add_u32 m0, s42, 77952
s_add_u32 s45, s44, 4096
v_mfma_f32_16x16x32_bf16 v[48:51], a[144:147], v[192:195], v[16:19]
v_exp_f32 v60, v60
v_mfma_f32_16x16x32_bf16 v[48:51], a[148:151], v[196:199], v[48:51]
ds_read_b128 a[128:131], v6 offset:53504
ds_read_b128 a[132:135], v6 offset:53568
v_mfma_f32_16x16x32_bf16 v[48:51], a[152:155], v[200:203], v[48:51]
v_exp_f32 v61, v61
v_mfma_f32_16x16x32_bf16 v[48:51], a[156:159], v[204:207], v[48:51]
ds_read_b128 a[136:139], v6 offset:53632
v_cvt_pk_bf16_f32 v116, v60, v61
v_mfma_f32_16x16x32_bf16 a[48:51], a[176:179], v[128:131], a[48:51]
v_exp_f32 v62, v62
v_mfma_f32_16x16x32_bf16 a[48:51], a[180:183], v[132:135], a[48:51]
buffer_load_dwordx4 v47, s[16:19], s45 offen offset:0 lds
v_mfma_f32_16x16x32_bf16 a[48:51], a[184:187], v[136:139], a[48:51]
v_exp_f32 v63, v63
v_mfma_f32_16x16x32_bf16 a[48:51], a[188:191], v[140:143], a[48:51]
ds_read_b128 a[140:143], v6 offset:53696
v_cvt_pk_bf16_f32 v117, v62, v63
v_mfma_f32_16x16x32_bf16 v[52:55], a[144:147], v[208:211], v[20:23]
v_exp_f32 v48, v48
v_mfma_f32_16x16x32_bf16 v[52:55], a[148:151], v[212:215], v[52:55]
ds_read_b64_tr_b16 a[160:161], v7 offset:128
ds_read_b64_tr_b16 a[162:163], v7 offset:384
v_mfma_f32_16x16x32_bf16 v[52:55], a[152:155], v[216:219], v[52:55]
v_exp_f32 v49, v49
v_mfma_f32_16x16x32_bf16 v[52:55], a[156:159], v[220:223], v[52:55]
ds_read_b64_tr_b16 a[164:165], v7 offset:640
v_cvt_pk_bf16_f32 v70, v48, v49
v_mfma_f32_16x16x32_bf16 a[52:55], a[176:179], v[144:147], a[52:55]
v_exp_f32 v50, v50
v_mfma_f32_16x16x32_bf16 a[52:55], a[180:183], v[148:151], a[52:55]
buffer_load_dwordx4 v4, s[16:19], s45 offen offset:1056 lds
v_mfma_f32_16x16x32_bf16 a[52:55], a[184:187], v[152:155], a[52:55]
v_exp_f32 v51, v51
v_mfma_f32_16x16x32_bf16 a[52:55], a[188:191], v[156:159], a[52:55]
ds_read_b64_tr_b16 a[166:167], v7 offset:896
v_cvt_pk_bf16_f32 v71, v50, v51
v_mfma_f32_16x16x32_bf16 v[56:59], a[144:147], v[224:227], v[24:27]
v_exp_f32 v52, v52
v_mfma_f32_16x16x32_bf16 v[56:59], a[148:151], v[228:231], v[56:59]
ds_read_b64_tr_b16 a[168:169], v7 offset:17024
ds_read_b64_tr_b16 a[170:171], v7 offset:17280
v_mfma_f32_16x16x32_bf16 v[56:59], a[152:155], v[232:235], v[56:59]
v_exp_f32 v53, v53
v_mfma_f32_16x16x32_bf16 v[56:59], a[156:159], v[236:239], v[56:59]
ds_read_b64_tr_b16 a[172:173], v7 offset:17536
v_cvt_pk_bf16_f32 v86, v52, v53
v_mfma_f32_16x16x32_bf16 a[56:59], a[176:179], v[160:163], a[56:59]
v_exp_f32 v54, v54
v_mfma_f32_16x16x32_bf16 a[56:59], a[180:183], v[164:167], a[56:59]
buffer_load_dwordx4 v47, s[96:99], s45 offen offset:2112 lds
v_mfma_f32_16x16x32_bf16 a[56:59], a[184:187], v[168:171], a[56:59]
v_exp_f32 v55, v55
v_mfma_f32_16x16x32_bf16 a[56:59], a[188:191], v[172:175], a[56:59]
ds_read_b64_tr_b16 a[174:175], v7 offset:17792
v_cvt_pk_bf16_f32 v87, v54, v55
v_mfma_f32_16x16x32_bf16 v[60:63], a[144:147], v[240:243], v[28:31]
v_exp_f32 v56, v56
v_mfma_f32_16x16x32_bf16 v[60:63], a[148:151], v[244:247], v[60:63]
v_mfma_f32_16x16x32_bf16 v[60:63], a[152:155], v[248:251], v[60:63]
v_exp_f32 v57, v57
v_mfma_f32_16x16x32_bf16 v[60:63], a[156:159], v[252:255], v[60:63]
v_cvt_pk_bf16_f32 v102, v56, v57
v_mfma_f32_16x16x32_bf16 a[60:63], a[176:179], v[176:179], a[60:63]
v_exp_f32 v58, v58
v_mfma_f32_16x16x32_bf16 a[60:63], a[180:183], v[180:183], a[60:63]
buffer_load_dwordx4 v4, s[96:99], s45 offen offset:3168 lds
v_mfma_f32_16x16x32_bf16 a[60:63], a[184:187], v[184:187], a[60:63]
v_exp_f32 v59, v59
v_mfma_f32_16x16x32_bf16 a[60:63], a[188:191], v[188:191], a[60:63]
v_cvt_pk_bf16_f32 v103, v58, v59
v_smfmac_f32_16x16x64_bf16 a[204:207], a[216:219], v[152:159], v10
s_waitcnt lgkmcnt(0)
v_mfma_f32_16x16x32_bf16 v[48:51], a[128:131], v[192:195], v[16:19]
v_exp_f32 v60, v60
v_mfma_f32_16x16x32_bf16 v[48:51], a[132:135], v[196:199], v[48:51]
ds_read_b128 a[144:147], v6 offset:53760
ds_read_b128 a[148:151], v6 offset:53824
v_mfma_f32_16x16x32_bf16 v[48:51], a[136:139], v[200:203], v[48:51]
v_exp_f32 v61, v61
v_mfma_f32_16x16x32_bf16 v[48:51], a[140:143], v[204:207], v[48:51]
ds_read_b128 a[152:155], v6 offset:53888
v_cvt_pk_bf16_f32 v118, v60, v61
v_mfma_f32_16x16x32_bf16 a[64:67], a[160:163], v[128:131], a[64:67]
v_exp_f32 v62, v62
v_mfma_f32_16x16x32_bf16 a[64:67], a[164:167], v[132:135], a[64:67]
v_mfma_f32_16x16x32_bf16 a[64:67], a[168:171], v[136:139], a[64:67]
v_exp_f32 v63, v63
v_mfma_f32_16x16x32_bf16 a[64:67], a[172:175], v[140:143], a[64:67]
ds_read_b128 a[156:159], v6 offset:53952
v_cvt_pk_bf16_f32 v119, v62, v63
v_mfma_f32_16x16x32_bf16 v[52:55], a[128:131], v[208:211], v[20:23]
v_exp_f32 v48, v48
v_mfma_f32_16x16x32_bf16 v[52:55], a[132:135], v[212:215], v[52:55]
ds_read_b64_tr_b16 a[176:177], v7 offset:160
ds_read_b64_tr_b16 a[178:179], v7 offset:416
v_mfma_f32_16x16x32_bf16 v[52:55], a[136:139], v[216:219], v[52:55]
v_exp_f32 v49, v49
v_mfma_f32_16x16x32_bf16 v[52:55], a[140:143], v[220:223], v[52:55]
ds_read_b64_tr_b16 a[180:181], v7 offset:672
v_cvt_pk_bf16_f32 v72, v48, v49
v_mfma_f32_16x16x32_bf16 a[68:71], a[160:163], v[144:147], a[68:71]
v_exp_f32 v50, v50
v_mfma_f32_16x16x32_bf16 a[68:71], a[164:167], v[148:151], a[68:71]
v_mfma_f32_16x16x32_bf16 a[68:71], a[168:171], v[152:155], a[68:71]
v_exp_f32 v51, v51
v_mfma_f32_16x16x32_bf16 a[68:71], a[172:175], v[156:159], a[68:71]
ds_read_b64_tr_b16 a[182:183], v7 offset:928
v_cvt_pk_bf16_f32 v73, v50, v51
v_mfma_f32_16x16x32_bf16 v[56:59], a[128:131], v[224:227], v[24:27]
v_exp_f32 v52, v52
v_mfma_f32_16x16x32_bf16 v[56:59], a[132:135], v[228:231], v[56:59]
ds_read_b64_tr_b16 a[184:185], v7 offset:17056
ds_read_b64_tr_b16 a[186:187], v7 offset:17312
v_mfma_f32_16x16x32_bf16 v[56:59], a[136:139], v[232:235], v[56:59]
v_exp_f32 v53, v53
v_mfma_f32_16x16x32_bf16 v[56:59], a[140:143], v[236:239], v[56:59]
ds_read_b64_tr_b16 a[188:189], v7 offset:17568
v_cvt_pk_bf16_f32 v88, v52, v53
v_mfma_f32_16x16x32_bf16 a[72:75], a[160:163], v[160:163], a[72:75]
v_exp_f32 v54, v54
v_mfma_f32_16x16x32_bf16 a[72:75], a[164:167], v[164:167], a[72:75]
v_mfma_f32_16x16x32_bf16 a[72:75], a[168:171], v[168:171], a[72:75]
v_exp_f32 v55, v55
v_mfma_f32_16x16x32_bf16 a[72:75], a[172:175], v[172:175], a[72:75]
ds_read_b64_tr_b16 a[190:191], v7 offset:17824
v_cvt_pk_bf16_f32 v89, v54, v55
v_mfma_f32_16x16x32_bf16 v[60:63], a[128:131], v[240:243], v[28:31]
v_exp_f32 v56, v56
v_mfma_f32_16x16x32_bf16 v[60:63], a[132:135], v[244:247], v[60:63]
v_mfma_f32_16x16x32_bf16 v[60:63], a[136:139], v[248:251], v[60:63]
v_exp_f32 v57, v57
v_mfma_f32_16x16x32_bf16 v[60:63], a[140:143], v[252:255], v[60:63]
v_cvt_pk_bf16_f32 v104, v56, v57
v_mfma_f32_16x16x32_bf16 a[76:79], a[160:163], v[176:179], a[76:79]
v_exp_f32 v58, v58
v_mfma_f32_16x16x32_bf16 a[76:79], a[164:167], v[180:183], a[76:79]
v_mfma_f32_16x16x32_bf16 a[76:79], a[168:171], v[184:187], a[76:79]
v_exp_f32 v59, v59
v_mfma_f32_16x16x32_bf16 a[76:79], a[172:175], v[188:191], a[76:79]
v_cvt_pk_bf16_f32 v105, v58, v59
v_smfmac_f32_16x16x64_bf16 a[208:211], a[216:219], v[160:167], v10
s_waitcnt lgkmcnt(0)
v_mfma_f32_16x16x32_bf16 v[48:51], a[144:147], v[192:195], v[16:19]
v_exp_f32 v60, v60
v_mfma_f32_16x16x32_bf16 v[48:51], a[148:151], v[196:199], v[48:51]
ds_read_b128 a[128:131], v6 offset:54016
ds_read_b128 a[132:135], v6 offset:54080
v_mfma_f32_16x16x32_bf16 v[48:51], a[152:155], v[200:203], v[48:51]
v_exp_f32 v61, v61
v_mfma_f32_16x16x32_bf16 v[48:51], a[156:159], v[204:207], v[48:51]
ds_read_b128 a[136:139], v6 offset:54144
v_cvt_pk_bf16_f32 v120, v60, v61
v_mfma_f32_16x16x32_bf16 a[80:83], a[176:179], v[128:131], a[80:83]
v_exp_f32 v62, v62
v_mfma_f32_16x16x32_bf16 a[80:83], a[180:183], v[132:135], a[80:83]
v_mfma_f32_16x16x32_bf16 a[80:83], a[184:187], v[136:139], a[80:83]
v_exp_f32 v63, v63
v_mfma_f32_16x16x32_bf16 a[80:83], a[188:191], v[140:143], a[80:83]
ds_read_b128 a[140:143], v6 offset:54208
v_cvt_pk_bf16_f32 v121, v62, v63
v_mfma_f32_16x16x32_bf16 v[52:55], a[144:147], v[208:211], v[20:23]
v_exp_f32 v48, v48
v_mfma_f32_16x16x32_bf16 v[52:55], a[148:151], v[212:215], v[52:55]
ds_read_b64_tr_b16 a[160:161], v7 offset:192
ds_read_b64_tr_b16 a[162:163], v7 offset:448
v_mfma_f32_16x16x32_bf16 v[52:55], a[152:155], v[216:219], v[52:55]
v_exp_f32 v49, v49
v_mfma_f32_16x16x32_bf16 v[52:55], a[156:159], v[220:223], v[52:55]
ds_read_b64_tr_b16 a[164:165], v7 offset:704
v_cvt_pk_bf16_f32 v74, v48, v49
v_mfma_f32_16x16x32_bf16 a[84:87], a[176:179], v[144:147], a[84:87]
v_exp_f32 v50, v50
v_mfma_f32_16x16x32_bf16 a[84:87], a[180:183], v[148:151], a[84:87]
v_mfma_f32_16x16x32_bf16 a[84:87], a[184:187], v[152:155], a[84:87]
v_exp_f32 v51, v51
v_mfma_f32_16x16x32_bf16 a[84:87], a[188:191], v[156:159], a[84:87]
ds_read_b64_tr_b16 a[166:167], v7 offset:960
v_cvt_pk_bf16_f32 v75, v50, v51
v_mfma_f32_16x16x32_bf16 v[56:59], a[144:147], v[224:227], v[24:27]
v_exp_f32 v52, v52
v_mfma_f32_16x16x32_bf16 v[56:59], a[148:151], v[228:231], v[56:59]
ds_read_b64_tr_b16 a[168:169], v7 offset:17088
ds_read_b64_tr_b16 a[170:171], v7 offset:17344
v_mfma_f32_16x16x32_bf16 v[56:59], a[152:155], v[232:235], v[56:59]
v_exp_f32 v53, v53
v_mfma_f32_16x16x32_bf16 v[56:59], a[156:159], v[236:239], v[56:59]
ds_read_b64_tr_b16 a[172:173], v7 offset:17600
v_cvt_pk_bf16_f32 v90, v52, v53
v_mfma_f32_16x16x32_bf16 a[88:91], a[176:179], v[160:163], a[88:91]
v_exp_f32 v54, v54
v_mfma_f32_16x16x32_bf16 a[88:91], a[180:183], v[164:167], a[88:91]
v_mfma_f32_16x16x32_bf16 a[88:91], a[184:187], v[168:171], a[88:91]
v_exp_f32 v55, v55
v_mfma_f32_16x16x32_bf16 a[88:91], a[188:191], v[172:175], a[88:91]
ds_read_b64_tr_b16 a[174:175], v7 offset:17856
v_cvt_pk_bf16_f32 v91, v54, v55
v_mfma_f32_16x16x32_bf16 v[60:63], a[144:147], v[240:243], v[28:31]
v_exp_f32 v56, v56
v_mfma_f32_16x16x32_bf16 v[60:63], a[148:151], v[244:247], v[60:63]
v_mfma_f32_16x16x32_bf16 v[60:63], a[152:155], v[248:251], v[60:63]
v_exp_f32 v57, v57
v_mfma_f32_16x16x32_bf16 v[60:63], a[156:159], v[252:255], v[60:63]
v_cvt_pk_bf16_f32 v106, v56, v57
v_mfma_f32_16x16x32_bf16 a[92:95], a[176:179], v[176:179], a[92:95]
v_exp_f32 v58, v58
v_mfma_f32_16x16x32_bf16 a[92:95], a[180:183], v[180:183], a[92:95]
v_mfma_f32_16x16x32_bf16 a[92:95], a[184:187], v[184:187], a[92:95]
v_exp_f32 v59, v59
v_mfma_f32_16x16x32_bf16 a[92:95], a[188:191], v[188:191], a[92:95]
v_cvt_pk_bf16_f32 v107, v58, v59
s_add_u32 s44, s44, 32768
v_smfmac_f32_16x16x64_bf16 a[208:211], a[216:219], v[168:175], v10
s_waitcnt lgkmcnt(0)
s_add_u32 s43, s43, 32768
s_and_b32 s43, s43, 0x7ffff
v_mfma_f32_16x16x32_bf16 v[48:51], a[128:131], v[192:195], v[16:19]
v_exp_f32 v60, v60
v_mfma_f32_16x16x32_bf16 v[48:51], a[132:135], v[196:199], v[48:51]
ds_read_b128 a[144:147], v6 offset:54272
ds_read_b128 a[148:151], v6 offset:54336
v_mfma_f32_16x16x32_bf16 v[48:51], a[136:139], v[200:203], v[48:51]
v_exp_f32 v61, v61
v_mfma_f32_16x16x32_bf16 v[48:51], a[140:143], v[204:207], v[48:51]
ds_read_b128 a[152:155], v6 offset:54400
v_cvt_pk_bf16_f32 v122, v60, v61
v_mfma_f32_16x16x32_bf16 a[96:99], a[160:163], v[128:131], a[96:99]
v_exp_f32 v62, v62
v_mfma_f32_16x16x32_bf16 a[96:99], a[164:167], v[132:135], a[96:99]
s_and_b32 s44, s44, 0x7ffff
v_mfma_f32_16x16x32_bf16 a[96:99], a[168:171], v[136:139], a[96:99]
s_sub_u32 s46, s46, 1
v_exp_f32 v63, v63
v_mfma_f32_16x16x32_bf16 a[96:99], a[172:175], v[140:143], a[96:99]
ds_read_b128 a[156:159], v6 offset:54464
v_cvt_pk_bf16_f32 v123, v62, v63
v_mfma_f32_16x16x32_bf16 v[52:55], a[128:131], v[208:211], v[20:23]
v_exp_f32 v48, v48
v_mfma_f32_16x16x32_bf16 v[52:55], a[132:135], v[212:215], v[52:55]
ds_read_b64_tr_b16 a[176:177], v7 offset:224
ds_read_b64_tr_b16 a[178:179], v7 offset:480
v_mfma_f32_16x16x32_bf16 v[52:55], a[136:139], v[216:219], v[52:55]
v_exp_f32 v49, v49
v_mfma_f32_16x16x32_bf16 v[52:55], a[140:143], v[220:223], v[52:55]
ds_read_b64_tr_b16 a[180:181], v7 offset:736
v_cvt_pk_bf16_f32 v76, v48, v49
v_mfma_f32_16x16x32_bf16 a[100:103], a[160:163], v[144:147], a[100:103]
v_exp_f32 v50, v50
v_mfma_f32_16x16x32_bf16 a[100:103], a[164:167], v[148:151], a[100:103]
v_mfma_f32_16x16x32_bf16 a[100:103], a[168:171], v[152:155], a[100:103]
v_exp_f32 v51, v51
v_mfma_f32_16x16x32_bf16 a[100:103], a[172:175], v[156:159], a[100:103]
ds_read_b64_tr_b16 a[182:183], v7 offset:992
v_cvt_pk_bf16_f32 v77, v50, v51
v_mfma_f32_16x16x32_bf16 v[56:59], a[128:131], v[224:227], v[24:27]
v_exp_f32 v52, v52
v_mfma_f32_16x16x32_bf16 v[56:59], a[132:135], v[228:231], v[56:59]
ds_read_b64_tr_b16 a[184:185], v7 offset:17120
ds_read_b64_tr_b16 a[186:187], v7 offset:17376
v_mfma_f32_16x16x32_bf16 v[56:59], a[136:139], v[232:235], v[56:59]
v_exp_f32 v53, v53
v_mfma_f32_16x16x32_bf16 v[56:59], a[140:143], v[236:239], v[56:59]
ds_read_b64_tr_b16 a[188:189], v7 offset:17632
v_cvt_pk_bf16_f32 v92, v52, v53
v_mfma_f32_16x16x32_bf16 a[104:107], a[160:163], v[160:163], a[104:107]
v_exp_f32 v54, v54
v_mfma_f32_16x16x32_bf16 a[104:107], a[164:167], v[164:167], a[104:107]
v_mfma_f32_16x16x32_bf16 a[104:107], a[168:171], v[168:171], a[104:107]
v_exp_f32 v55, v55
v_mfma_f32_16x16x32_bf16 a[104:107], a[172:175], v[172:175], a[104:107]
ds_read_b64_tr_b16 a[190:191], v7 offset:17888
v_cvt_pk_bf16_f32 v93, v54, v55
v_mfma_f32_16x16x32_bf16 v[60:63], a[128:131], v[240:243], v[28:31]
v_exp_f32 v56, v56
v_mfma_f32_16x16x32_bf16 v[60:63], a[132:135], v[244:247], v[60:63]
ds_read_b32 v42, v45 offset:256
v_add_u32 v45, 512, v45
v_mfma_f32_16x16x32_bf16 v[60:63], a[136:139], v[248:251], v[60:63]
v_exp_f32 v57, v57
v_mfma_f32_16x16x32_bf16 v[60:63], a[140:143], v[252:255], v[60:63]
v_cvt_pk_bf16_f32 v108, v56, v57
v_mfma_f32_16x16x32_bf16 a[108:111], a[160:163], v[176:179], a[108:111]
v_exp_f32 v58, v58
v_mfma_f32_16x16x32_bf16 a[108:111], a[164:167], v[180:183], a[108:111]
v_mfma_f32_16x16x32_bf16 a[108:111], a[168:171], v[184:187], a[108:111]
v_exp_f32 v59, v59
v_mfma_f32_16x16x32_bf16 a[108:111], a[172:175], v[188:191], a[108:111]
v_cvt_pk_bf16_f32 v109, v58, v59
v_smfmac_f32_16x16x64_bf16 a[212:215], a[216:219], v[176:183], v10
s_waitcnt lgkmcnt(0)
v_mfma_f32_16x16x32_bf16 v[48:51], a[144:147], v[192:195], v[16:19]
s_waitcnt vmcnt(0)
s_barrier
v_exp_f32 v60, v60
v_mfma_f32_16x16x32_bf16 v[48:51], a[148:151], v[196:199], v[48:51]
ds_read_b128 a[128:131], v5 offset:36864
ds_read_b128 a[132:135], v5 offset:36928
v_mfma_f32_16x16x32_bf16 v[48:51], a[152:155], v[200:203], v[48:51]
v_exp_f32 v61, v61
v_mfma_f32_16x16x32_bf16 v[48:51], a[156:159], v[204:207], v[48:51]
ds_read_b128 a[136:139], v5 offset:36992
v_cvt_pk_bf16_f32 v124, v60, v61
v_mfma_f32_16x16x32_bf16 a[112:115], a[176:179], v[128:131], a[112:115]
v_exp_f32 v62, v62
v_mfma_f32_16x16x32_bf16 a[112:115], a[180:183], v[132:135], a[112:115]
v_lshlrev_b32 v34, 16, v32
v_and_b32 v35, 0xffff0000, v32
v_mfma_f32_16x16x32_bf16 a[112:115], a[184:187], v[136:139], a[112:115]
v_exp_f32 v63, v63
v_mfma_f32_16x16x32_bf16 a[112:115], a[188:191], v[140:143], a[112:115]
ds_read_b128 a[140:143], v5 offset:37056
v_cvt_pk_bf16_f32 v125, v62, v63
v_mfma_f32_16x16x32_bf16 v[52:55], a[144:147], v[208:211], v[20:23]
v_exp_f32 v48, v48
v_mfma_f32_16x16x32_bf16 v[52:55], a[148:151], v[212:215], v[52:55]
ds_read_b64_tr_b16 a[160:161], v8 offset:0
ds_read_b64_tr_b16 a[162:163], v8 offset:256
v_mfma_f32_16x16x32_bf16 v[52:55], a[152:155], v[216:219], v[52:55]
v_exp_f32 v49, v49
v_mfma_f32_16x16x32_bf16 v[52:55], a[156:159], v[220:223], v[52:55]
ds_read_b64_tr_b16 a[164:165], v8 offset:512
v_cvt_pk_bf16_f32 v78, v48, v49
v_mfma_f32_16x16x32_bf16 a[116:119], a[176:179], v[144:147], a[116:119]
v_exp_f32 v50, v50
v_mfma_f32_16x16x32_bf16 a[116:119], a[180:183], v[148:151], a[116:119]
v_lshlrev_b32 v36, 16, v33
v_and_b32 v37, 0xffff0000, v33
v_mfma_f32_16x16x32_bf16 a[116:119], a[184:187], v[152:155], a[116:119]
v_exp_f32 v51, v51
v_mfma_f32_16x16x32_bf16 a[116:119], a[188:191], v[156:159], a[116:119]
ds_read_b64_tr_b16 a[166:167], v8 offset:768
v_cvt_pk_bf16_f32 v79, v50, v51
v_mfma_f32_16x16x32_bf16 v[56:59], a[144:147], v[224:227], v[24:27]
v_exp_f32 v52, v52
v_mfma_f32_16x16x32_bf16 v[56:59], a[148:151], v[228:231], v[56:59]
ds_read_b64_tr_b16 a[168:169], v8 offset:16896
ds_read_b64_tr_b16 a[170:171], v8 offset:17152
v_mfma_f32_16x16x32_bf16 v[56:59], a[152:155], v[232:235], v[56:59]
v_exp_f32 v53, v53
v_mfma_f32_16x16x32_bf16 v[56:59], a[156:159], v[236:239], v[56:59]
ds_read_b64_tr_b16 a[172:173], v8 offset:17408
v_cvt_pk_bf16_f32 v94, v52, v53
v_mfma_f32_16x16x32_bf16 a[120:123], a[176:179], v[160:163], a[120:123]
v_exp_f32 v54, v54
v_mfma_f32_16x16x32_bf16 a[120:123], a[180:183], v[164:167], a[120:123]
v_pk_fma_f32 v[38:39], v[34:35], v[42:43], v[38:39] op_sel_hi:[1,0,1]
v_pk_fma_f32 v[40:41], v[36:37], v[42:43], v[40:41] op_sel_hi:[1,0,1]
v_mfma_f32_16x16x32_bf16 a[120:123], a[184:187], v[168:171], a[120:123]
v_exp_f32 v55, v55
v_mfma_f32_16x16x32_bf16 a[120:123], a[188:191], v[172:175], a[120:123]
ds_read_b64_tr_b16 a[174:175], v8 offset:17664
v_cvt_pk_bf16_f32 v95, v54, v55
v_mfma_f32_16x16x32_bf16 v[60:63], a[144:147], v[240:243], v[28:31]
v_exp_f32 v56, v56
v_mfma_f32_16x16x32_bf16 v[60:63], a[148:151], v[244:247], v[60:63]
s_add_u32 s64, s64, 442368
buffer_load_dwordx2 v[32:33], v44, s[8:11], s64 offen
v_mfma_f32_16x16x32_bf16 v[60:63], a[152:155], v[248:251], v[60:63]
v_exp_f32 v57, v57
v_mfma_f32_16x16x32_bf16 v[60:63], a[156:159], v[252:255], v[60:63]
v_cvt_pk_bf16_f32 v110, v56, v57
v_mfma_f32_16x16x32_bf16 a[124:127], a[176:179], v[176:179], a[124:127]
v_exp_f32 v58, v58
v_mfma_f32_16x16x32_bf16 a[124:127], a[180:183], v[180:183], a[124:127]
v_mfma_f32_16x16x32_bf16 a[124:127], a[184:187], v[184:187], a[124:127]
v_exp_f32 v59, v59
v_mfma_f32_16x16x32_bf16 a[124:127], a[188:191], v[188:191], a[124:127]
v_cvt_pk_bf16_f32 v111, v58, v59
v_smfmac_f32_16x16x64_bf16 a[212:215], a[216:219], v[184:191], v10
s_waitcnt lgkmcnt(0)
s_cmp_lg_u32 s46, 0
s_cbranch_scc1 K1_loop
v_mfma_f32_16x16x32_bf16 v[48:51], a[128:131], v[192:195], v[16:19]
v_exp_f32 v60, v60
v_mfma_f32_16x16x32_bf16 v[48:51], a[132:135], v[196:199], v[48:51]
ds_read_b128 a[144:147], v5 offset:37120
ds_read_b128 a[148:151], v5 offset:37184
v_mfma_f32_16x16x32_bf16 v[48:51], a[136:139], v[200:203], v[48:51]
v_exp_f32 v61, v61
v_mfma_f32_16x16x32_bf16 v[48:51], a[140:143], v[204:207], v[48:51]
ds_read_b128 a[152:155], v5 offset:37248
v_cvt_pk_bf16_f32 v126, v60, v61
v_mfma_f32_16x16x32_bf16 a[0:3], a[160:163], v[64:67], a[0:3]
v_exp_f32 v62, v62
s_add_u32 m0, s42, 0
v_mfma_f32_16x16x32_bf16 a[0:3], a[164:167], v[68:71], a[0:3]
buffer_load_dwordx4 v47, s[16:19], s44 offen offset:0 lds
v_mfma_f32_16x16x32_bf16 a[0:3], a[168:171], v[72:75], a[0:3]
v_exp_f32 v63, v63
v_mfma_f32_16x16x32_bf16 a[0:3], a[172:175], v[76:79], a[0:3]
ds_read_b128 a[156:159], v5 offset:37312
v_cvt_pk_bf16_f32 v127, v62, v63
v_mfma_f32_16x16x32_bf16 v[52:55], a[128:131], v[208:211], v[20:23]
v_exp_f32 v48, v48
v_mfma_f32_16x16x32_bf16 v[52:55], a[132:135], v[212:215], v[52:55]
ds_read_b64_tr_b16 a[176:177], v8 offset:32
ds_read_b64_tr_b16 a[178:179], v8 offset:288
v_mfma_f32_16x16x32_bf16 v[52:55], a[136:139], v[216:219], v[52:55]
v_exp_f32 v49, v49
v_mfma_f32_16x16x32_bf16 v[52:55], a[140:143], v[220:223], v[52:55]
ds_read_b64_tr_b16 a[180:181], v8 offset:544
v_cvt_pk_bf16_f32 v128, v48, v49
v_mfma_f32_16x16x32_bf16 a[4:7], a[160:163], v[80:83], a[4:7]
v_exp_f32 v50, v50
v_mfma_f32_16x16x32_bf16 a[4:7], a[164:167], v[84:87], a[4:7]
buffer_load_dwordx4 v4, s[16:19], s44 offen offset:1056 lds
v_mfma_f32_16x16x32_bf16 a[4:7], a[168:171], v[88:91], a[4:7]
v_exp_f32 v51, v51
v_mfma_f32_16x16x32_bf16 a[4:7], a[172:175], v[92:95], a[4:7]
ds_read_b64_tr_b16 a[182:183], v8 offset:800
v_cvt_pk_bf16_f32 v129, v50, v51
v_mfma_f32_16x16x32_bf16 v[56:59], a[128:131], v[224:227], v[24:27]
v_exp_f32 v52, v52
v_mfma_f32_16x16x32_bf16 v[56:59], a[132:135], v[228:231], v[56:59]
ds_read_b64_tr_b16 a[184:185], v8 offset:16928
ds_read_b64_tr_b16 a[186:187], v8 offset:17184
v_mfma_f32_16x16x32_bf16 v[56:59], a[136:139], v[232:235], v[56:59]
v_exp_f32 v53, v53
v_mfma_f32_16x16x32_bf16 v[56:59], a[140:143], v[236:239], v[56:59]
ds_read_b64_tr_b16 a[188:189], v8 offset:17440
v_cvt_pk_bf16_f32 v144, v52, v53
v_mfma_f32_16x16x32_bf16 a[8:11], a[160:163], v[96:99], a[8:11]
v_exp_f32 v54, v54
v_mfma_f32_16x16x32_bf16 a[8:11], a[164:167], v[100:103], a[8:11]
buffer_load_dwordx4 v47, s[96:99], s44 offen offset:2112 lds
v_mfma_f32_16x16x32_bf16 a[8:11], a[168:171], v[104:107], a[8:11]
v_exp_f32 v55, v55
v_mfma_f32_16x16x32_bf16 a[8:11], a[172:175], v[108:111], a[8:11]
ds_read_b64_tr_b16 a[190:191], v8 offset:17696
v_cvt_pk_bf16_f32 v145, v54, v55
v_mfma_f32_16x16x32_bf16 v[60:63], a[128:131], v[240:243], v[28:31]
v_exp_f32 v56, v56
v_mfma_f32_16x16x32_bf16 v[60:63], a[132:135], v[244:247], v[60:63]
v_mfma_f32_16x16x32_bf16 v[60:63], a[136:139], v[248:251], v[60:63]
v_exp_f32 v57, v57
v_mfma_f32_16x16x32_bf16 v[60:63], a[140:143], v[252:255], v[60:63]
v_cvt_pk_bf16_f32 v160, v56, v57
v_mfma_f32_16x16x32_bf16 a[12:15], a[160:163], v[112:115], a[12:15]
v_exp_f32 v58, v58
v_mfma_f32_16x16x32_bf16 a[12:15], a[164:167], v[116:119], a[12:15]
buffer_load_dwordx4 v4, s[96:99], s44 offen offset:3168 lds
v_mfma_f32_16x16x32_bf16 a[12:15], a[168:171], v[120:123], a[12:15]
v_exp_f32 v59, v59
v_mfma_f32_16x16x32_bf16 a[12:15], a[172:175], v[124:127], a[12:15]
v_cvt_pk_bf16_f32 v161, v58, v59
v_smfmac_f32_16x16x64_bf16 a[200:203], a[216:219], v[64:71], v10
s_waitcnt lgkmcnt(0)
s_add_u32 m0, s42, 4224
s_add_u32 s45, s44, 4096
v_mfma_f32_16x16x32_bf16 v[48:51], a[144:147], v[192:195], v[16:19]
v_exp_f32 v60, v60
v_mfma_f32_16x16x32_bf16 v[48:51], a[148:151], v[196:199], v[48:51]
ds_read_b128 a[128:131], v5 offset:37376
ds_read_b128 a[132:135], v5 offset:37440
v_mfma_f32_16x16x32_bf16 v[48:51], a[152:155], v[200:203], v[48:51]
v_exp_f32 v61, v61
v_mfma_f32_16x16x32_bf16 v[48:51], a[156:159], v[204:207], v[48:51]
ds_read_b128 a[136:139], v5 offset:37504
v_cvt_pk_bf16_f32 v176, v60, v61
v_mfma_f32_16x16x32_bf16 a[16:19], a[176:179], v[64:67], a[16:19]
v_exp_f32 v62, v62
v_mfma_f32_16x16x32_bf16 a[16:19], a[180:183], v[68:71], a[16:19]
buffer_load_dwordx4 v47, s[16:19], s45 offen offset:0 lds
v_mfma_f32_16x16x32_bf16 a[16:19], a[184:187], v[72:75], a[16:19]
v_exp_f32 v63, v63
v_mfma_f32_16x16x32_bf16 a[16:19], a[188:191], v[76:79], a[16:19]
ds_read_b128 a[140:143], v5 offset:37568
v_cvt_pk_bf16_f32 v177, v62, v63
v_mfma_f32_16x16x32_bf16 v[52:55], a[144:147], v[208:211], v[20:23]
v_exp_f32 v48, v48
v_mfma_f32_16x16x32_bf16 v[52:55], a[148:151], v[212:215], v[52:55]
ds_read_b64_tr_b16 a[160:161], v8 offset:64
ds_read_b64_tr_b16 a[162:163], v8 offset:320
v_mfma_f32_16x16x32_bf16 v[52:55], a[152:155], v[216:219], v[52:55]
v_exp_f32 v49, v49
v_mfma_f32_16x16x32_bf16 v[52:55], a[156:159], v[220:223], v[52:55]
ds_read_b64_tr_b16 a[164:165], v8 offset:576
v_cvt_pk_bf16_f32 v130, v48, v49
v_mfma_f32_16x16x32_bf16 a[20:23], a[176:179], v[80:83], a[20:23]
v_exp_f32 v50, v50
v_mfma_f32_16x16x32_bf16 a[20:23], a[180:183], v[84:87], a[20:23]
buffer_load_dwordx4 v4, s[16:19], s45 offen offset:1056 lds
v_mfma_f32_16x16x32_bf16 a[20:23], a[184:187], v[88:91], a[20:23]
v_exp_f32 v51, v51
v_mfma_f32_16x16x32_bf16 a[20:23], a[188:191], v[92:95], a[20:23]
ds_read_b64_tr_b16 a[166:167], v8 offset:832
v_cvt_pk_bf16_f32 v131, v50, v51
v_mfma_f32_16x16x32_bf16 v[56:59], a[144:147], v[224:227], v[24:27]
v_exp_f32 v52, v52
v_mfma_f32_16x16x32_bf16 v[56:59], a[148:151], v[228:231], v[56:59]
ds_read_b64_tr_b16 a[168:169], v8 offset:16960
ds_read_b64_tr_b16 a[170:171], v8 offset:17216
v_mfma_f32_16x16x32_bf16 v[56:59], a[152:155], v[232:235], v[56:59]
v_exp_f32 v53, v53
v_mfma_f32_16x16x32_bf16 v[56:59], a[156:159], v[236:239], v[56:59]
ds_read_b64_tr_b16 a[172:173], v8 offset:17472
v_cvt_pk_bf16_f32 v146, v52, v53
v_mfma_f32_16x16x32_bf16 a[24:27], a[176:179], v[96:99], a[24:27]
v_exp_f32 v54, v54
v_mfma_f32_16x16x32_bf16 a[24:27], a[180:183], v[100:103], a[24:27]
buffer_load_dwordx4 v47, s[96:99], s45 offen offset:2112 lds
v_mfma_f32_16x16x32_bf16 a[24:27], a[184:187], v[104:107], a[24:27]
v_exp_f32 v55, v55
v_mfma_f32_16x16x32_bf16 a[24:27], a[188:191], v[108:111], a[24:27]
ds_read_b64_tr_b16 a[174:175], v8 offset:17728
v_cvt_pk_bf16_f32 v147, v54, v55
v_mfma_f32_16x16x32_bf16 v[60:63], a[144:147], v[240:243], v[28:31]
v_exp_f32 v56, v56
v_mfma_f32_16x16x32_bf16 v[60:63], a[148:151], v[244:247], v[60:63]
v_mfma_f32_16x16x32_bf16 v[60:63], a[152:155], v[248:251], v[60:63]
v_exp_f32 v57, v57
v_mfma_f32_16x16x32_bf16 v[60:63], a[156:159], v[252:255], v[60:63]
v_cvt_pk_bf16_f32 v162, v56, v57
v_mfma_f32_16x16x32_bf16 a[28:31], a[176:179], v[112:115], a[28:31]
v_exp_f32 v58, v58
v_mfma_f32_16x16x32_bf16 a[28:31], a[180:183], v[116:119], a[28:31]
buffer_load_dwordx4 v4, s[96:99], s45 offen offset:3168 lds
v_mfma_f32_16x16x32_bf16 a[28:31], a[184:187], v[120:123], a[28:31]
v_exp_f32 v59, v59
v_mfma_f32_16x16x32_bf16 a[28:31], a[188:191], v[124:127], a[28:31]
v_cvt_pk_bf16_f32 v163, v58, v59
v_smfmac_f32_16x16x64_bf16 a[200:203], a[216:219], v[72:79], v10
s_waitcnt lgkmcnt(0)
s_add_u32 m0, s40, 110592
s_mov_b32 s45, 0
v_mfma_f32_16x16x32_bf16 v[48:51], a[128:131], v[192:195], v[16:19]
v_exp_f32 v60, v60
v_mfma_f32_16x16x32_bf16 v[48:51], a[132:135], v[196:199], v[48:51]
ds_read_b128 a[144:147], v5 offset:37632
ds_read_b128 a[148:151], v5 offset:37696
v_mfma_f32_16x16x32_bf16 v[48:51], a[136:139], v[200:203], v[48:51]
v_exp_f32 v61, v61
v_mfma_f32_16x16x32_bf16 v[48:51], a[140:143], v[204:207], v[48:51]
ds_read_b128 a[152:155], v5 offset:37760
v_cvt_pk_bf16_f32 v178, v60, v61
v_mfma_f32_16x16x32_bf16 a[32:35], a[160:163], v[64:67], a[32:35]
v_exp_f32 v62, v62
v_mfma_f32_16x16x32_bf16 a[32:35], a[164:167], v[68:71], a[32:35]
buffer_load_dwordx4 v3, s[20:23], s45 offen lds
v_mfma_f32_16x16x32_bf16 a[32:35], a[168:171], v[72:75], a[32:35]
v_exp_f32 v63, v63
v_mfma_f32_16x16x32_bf16 a[32:35], a[172:175], v[76:79], a[32:35]
ds_read_b128 a[156:159], v5 offset:37824
v_cvt_pk_bf16_f32 v179, v62, v63
v_mfma_f32_16x16x32_bf16 v[52:55], a[128:131], v[208:211], v[20:23]
v_exp_f32 v48, v48
v_mfma_f32_16x16x32_bf16 v[52:55], a[132:135], v[212:215], v[52:55]
ds_read_b64_tr_b16 a[176:177], v8 offset:96
ds_read_b64_tr_b16 a[178:179], v8 offset:352
v_mfma_f32_16x16x32_bf16 v[52:55], a[136:139], v[216:219], v[52:55]
v_exp_f32 v49, v49
v_mfma_f32_16x16x32_bf16 v[52:55], a[140:143], v[220:223], v[52:55]
ds_read_b64_tr_b16 a[180:181], v8 offset:608
v_cvt_pk_bf16_f32 v132, v48, v49
v_mfma_f32_16x16x32_bf16 a[36:39], a[160:163], v[80:83], a[36:39]
v_exp_f32 v50, v50
s_add_u32 m0, s40, 114688
v_mfma_f32_16x16x32_bf16 a[36:39], a[164:167], v[84:87], a[36:39]
s_mov_b32 s45, 36864
buffer_load_dwordx4 v3, s[20:23], s45 offen lds
v_mfma_f32_16x16x32_bf16 a[36:39], a[168:171], v[88:91], a[36:39]
v_exp_f32 v51, v51
v_mfma_f32_16x16x32_bf16 a[36:39], a[172:175], v[92:95], a[36:39]
ds_read_b64_tr_b16 a[182:183], v8 offset:864
v_cvt_pk_bf16_f32 v133, v50, v51
v_mfma_f32_16x16x32_bf16 v[56:59], a[128:131], v[224:227], v[24:27]
v_exp_f32 v52, v52
v_mfma_f32_16x16x32_bf16 v[56:59], a[132:135], v[228:231], v[56:59]
ds_read_b64_tr_b16 a[184:185], v8 offset:16992
ds_read_b64_tr_b16 a[186:187], v8 offset:17248
v_mfma_f32_16x16x32_bf16 v[56:59], a[136:139], v[232:235], v[56:59]
v_exp_f32 v53, v53
v_mfma_f32_16x16x32_bf16 v[56:59], a[140:143], v[236:239], v[56:59]
ds_read_b64_tr_b16 a[188:189], v8 offset:17504
v_cvt_pk_bf16_f32 v148, v52, v53
v_mfma_f32_16x16x32_bf16 a[40:43], a[160:163], v[96:99], a[40:43]
v_exp_f32 v54, v54
s_add_u32 m0, s40, 118784
v_mfma_f32_16x16x32_bf16 a[40:43], a[164:167], v[100:103], a[40:43]
s_mov_b32 s45, 73728
buffer_load_dwordx4 v3, s[20:23], s45 offen lds
v_mfma_f32_16x16x32_bf16 a[40:43], a[168:171], v[104:107], a[40:43]
v_exp_f32 v55, v55
v_mfma_f32_16x16x32_bf16 a[40:43], a[172:175], v[108:111], a[40:43]
ds_read_b64_tr_b16 a[190:191], v8 offset:17760
v_cvt_pk_bf16_f32 v149, v54, v55
v_mfma_f32_16x16x32_bf16 v[60:63], a[128:131], v[240:243], v[28:31]
v_exp_f32 v56, v56
v_mfma_f32_16x16x32_bf16 v[60:63], a[132:135], v[244:247], v[60:63]
s_mov_b32 s45, 110592
v_mfma_f32_16x16x32_bf16 v[60:63], a[136:139], v[248:251], v[60:63]
v_exp_f32 v57, v57
v_mfma_f32_16x16x32_bf16 v[60:63], a[140:143], v[252:255], v[60:63]
v_cvt_pk_bf16_f32 v164, v56, v57
s_add_u32 m0, s40, 122880
v_mfma_f32_16x16x32_bf16 a[44:47], a[160:163], v[112:115], a[44:47]
v_exp_f32 v58, v58
v_mfma_f32_16x16x32_bf16 a[44:47], a[164:167], v[116:119], a[44:47]
buffer_load_dwordx4 v3, s[20:23], s45 offen lds
v_mfma_f32_16x16x32_bf16 a[44:47], a[168:171], v[120:123], a[44:47]
v_exp_f32 v59, v59
v_mfma_f32_16x16x32_bf16 a[44:47], a[172:175], v[124:127], a[44:47]
v_cvt_pk_bf16_f32 v165, v58, v59
v_smfmac_f32_16x16x64_bf16 a[204:207], a[216:219], v[80:87], v10
s_waitcnt lgkmcnt(0)
s_add_u32 m0, s40, 126976
s_mov_b32 s45, 147456
v_mfma_f32_16x16x32_bf16 v[48:51], a[144:147], v[192:195], v[16:19]
v_exp_f32 v60, v60
v_mfma_f32_16x16x32_bf16 v[48:51], a[148:151], v[196:199], v[48:51]
ds_read_b128 a[128:131], v5 offset:53504
ds_read_b128 a[132:135], v5 offset:53568
v_mfma_f32_16x16x32_bf16 v[48:51], a[152:155], v[200:203], v[48:51]
v_exp_f32 v61, v61
v_mfma_f32_16x16x32_bf16 v[48:51], a[156:159], v[204:207], v[48:51]
ds_read_b128 a[136:139], v5 offset:53632
v_cvt_pk_bf16_f32 v180, v60, v61
v_mfma_f32_16x16x32_bf16 a[48:51], a[176:179], v[64:67], a[48:51]
v_exp_f32 v62, v62
v_mfma_f32_16x16x32_bf16 a[48:51], a[180:183], v[68:71], a[48:51]
buffer_load_dwordx4 v3, s[20:23], s45 offen lds
v_mfma_f32_16x16x32_bf16 a[48:51], a[184:187], v[72:75], a[48:51]
v_exp_f32 v63, v63
v_mfma_f32_16x16x32_bf16 a[48:51], a[188:191], v[76:79], a[48:51]
ds_read_b128 a[140:143], v5 offset:53696
v_cvt_pk_bf16_f32 v181, v62, v63
v_mfma_f32_16x16x32_bf16 v[52:55], a[144:147], v[208:211], v[20:23]
v_exp_f32 v48, v48
v_mfma_f32_16x16x32_bf16 v[52:55], a[148:151], v[212:215], v[52:55]
ds_read_b64_tr_b16 a[160:161], v8 offset:128
ds_read_b64_tr_b16 a[162:163], v8 offset:384
v_mfma_f32_16x16x32_bf16 v[52:55], a[152:155], v[216:219], v[52:55]
v_exp_f32 v49, v49
v_mfma_f32_16x16x32_bf16 v[52:55], a[156:159], v[220:223], v[52:55]
ds_read_b64_tr_b16 a[164:165], v8 offset:640
v_cvt_pk_bf16_f32 v134, v48, v49
v_mfma_f32_16x16x32_bf16 a[52:55], a[176:179], v[80:83], a[52:55]
v_exp_f32 v50, v50
s_add_u32 m0, s40, 131072
v_mfma_f32_16x16x32_bf16 a[52:55], a[180:183], v[84:87], a[52:55]
s_mov_b32 s45, 184320
buffer_load_dwordx4 v3, s[20:23], s45 offen lds
v_mfma_f32_16x16x32_bf16 a[52:55], a[184:187], v[88:91], a[52:55]
v_exp_f32 v51, v51
v_mfma_f32_16x16x32_bf16 a[52:55], a[188:191], v[92:95], a[52:55]
ds_read_b64_tr_b16 a[166:167], v8 offset:896
v_cvt_pk_bf16_f32 v135, v50, v51
v_mfma_f32_16x16x32_bf16 v[56:59], a[144:147], v[224:227], v[24:27]
v_exp_f32 v52, v52
v_mfma_f32_16x16x32_bf16 v[56:59], a[148:151], v[228:231], v[56:59]
ds_read_b64_tr_b16 a[168:169], v8 offset:17024
ds_read_b64_tr_b16 a[170:171], v8 offset:17280
v_mfma_f32_16x16x32_bf16 v[56:59], a[152:155], v[232:235], v[56:59]
v_exp_f32 v53, v53
v_mfma_f32_16x16x32_bf16 v[56:59], a[156:159], v[236:239], v[56:59]
ds_read_b64_tr_b16 a[172:173], v8 offset:17536
v_cvt_pk_bf16_f32 v150, v52, v53
v_mfma_f32_16x16x32_bf16 a[56:59], a[176:179], v[96:99], a[56:59]
v_exp_f32 v54, v54
s_add_u32 m0, s40, 135168
v_mfma_f32_16x16x32_bf16 a[56:59], a[180:183], v[100:103], a[56:59]
s_mov_b32 s45, 221184
buffer_load_dwordx4 v3, s[20:23], s45 offen lds
v_mfma_f32_16x16x32_bf16 a[56:59], a[184:187], v[104:107], a[56:59]
v_exp_f32 v55, v55
v_mfma_f32_16x16x32_bf16 a[56:59], a[188:191], v[108:111], a[56:59]
ds_read_b64_tr_b16 a[174:175], v8 offset:17792
v_cvt_pk_bf16_f32 v151, v54, v55
v_mfma_f32_16x16x32_bf16 v[60:63], a[144:147], v[240:243], v[28:31]
v_exp_f32 v56, v56
v_mfma_f32_16x16x32_bf16 v[60:63], a[148:151], v[244:247], v[60:63]
v_permlane32_swap_b32 v38, v40
v_permlane32_swap_b32 v39, v41
v_mfma_f32_16x16x32_bf16 v[60:63], a[152:155], v[248:251], v[60:63]
v_exp_f32 v57, v57
v_mfma_f32_16x16x32_bf16 v[60:63], a[156:159], v[252:255], v[60:63]
v_cvt_pk_bf16_f32 v166, v56, v57
v_lshrrev_b32 v34, 4, v1
v_mfma_f32_16x16x32_bf16 a[60:63], a[176:179], v[112:115], a[60:63]
v_exp_f32 v58, v58
s_add_u32 m0, s40, 139264
v_mfma_f32_16x16x32_bf16 a[60:63], a[180:183], v[116:119], a[60:63]
s_mov_b32 s45, 258048
buffer_load_dwordx4 v3, s[20:23], s45 offen lds
v_mfma_f32_16x16x32_bf16 a[60:63], a[184:187], v[120:123], a[60:63]
v_exp_f32 v59, v59
v_mfma_f32_16x16x32_bf16 a[60:63], a[188:191], v[124:127], a[60:63]
v_cvt_pk_bf16_f32 v167, v58, v59
v_and_b32 v35, 3, v1
v_smfmac_f32_16x16x64_bf16 a[204:207], a[216:219], v[88:95], v10
s_waitcnt lgkmcnt(0)
v_pk_add_f32 v[38:39], v[38:39], v[40:41]
v_lshl_add_u32 v34, v35, 2, v34
v_mfma_f32_16x16x32_bf16 v[48:51], a[128:131], v[192:195], v[16:19]
v_exp_f32 v60, v60
v_mfma_f32_16x16x32_bf16 v[48:51], a[132:135], v[196:199], v[48:51]
ds_read_b128 a[144:147], v5 offset:53760
ds_read_b128 a[148:151], v5 offset:53824
v_mfma_f32_16x16x32_bf16 v[48:51], a[136:139], v[200:203], v[48:51]
v_exp_f32 v61, v61
v_mfma_f32_16x16x32_bf16 v[48:51], a[140:143], v[204:207], v[48:51]
ds_read_b128 a[152:155], v5 offset:53888
v_cvt_pk_bf16_f32 v182, v60, v61
v_mfma_f32_16x16x32_bf16 a[64:67], a[160:163], v[64:67], a[64:67]
v_exp_f32 v62, v62
v_mfma_f32_16x16x32_bf16 a[64:67], a[164:167], v[68:71], a[64:67]
v_lshl_add_u32 v34, v34, 2, s3
v_permlane16_swap_b32 v38, v39
v_mfma_f32_16x16x32_bf16 a[64:67], a[168:171], v[72:75], a[64:67]
v_exp_f32 v63, v63
v_mfma_f32_16x16x32_bf16 a[64:67], a[172:175], v[76:79], a[64:67]
ds_read_b128 a[156:159], v5 offset:53952
v_cvt_pk_bf16_f32 v183, v62, v63
v_mfma_f32_16x16x32_bf16 v[52:55], a[128:131], v[208:211], v[20:23]
v_exp_f32 v48, v48
v_mfma_f32_16x16x32_bf16 v[52:55], a[132:135], v[212:215], v[52:55]
ds_read_b64_tr_b16 a[176:177], v8 offset:160
ds_read_b64_tr_b16 a[178:179], v8 offset:416
v_mfma_f32_16x16x32_bf16 v[52:55], a[136:139], v[216:219], v[52:55]
v_exp_f32 v49, v49
v_mfma_f32_16x16x32_bf16 v[52:55], a[140:143], v[220:223], v[52:55]
ds_read_b64_tr_b16 a[180:181], v8 offset:672
v_cvt_pk_bf16_f32 v136, v48, v49
v_mfma_f32_16x16x32_bf16 a[68:71], a[160:163], v[80:83], a[68:71]
v_exp_f32 v50, v50
v_mfma_f32_16x16x32_bf16 a[68:71], a[164:167], v[84:87], a[68:71]
v_mov_b32 v35, 156160
v_lshl_add_u32 v34, v34, 2, v35
v_mfma_f32_16x16x32_bf16 a[68:71], a[168:171], v[88:91], a[68:71]
v_exp_f32 v51, v51
v_mfma_f32_16x16x32_bf16 a[68:71], a[172:175], v[92:95], a[68:71]
ds_read_b64_tr_b16 a[182:183], v8 offset:928
v_cvt_pk_bf16_f32 v137, v50, v51
v_mfma_f32_16x16x32_bf16 v[56:59], a[128:131], v[224:227], v[24:27]
v_exp_f32 v52, v52
v_mfma_f32_16x16x32_bf16 v[56:59], a[132:135], v[228:231], v[56:59]
ds_read_b64_tr_b16 a[184:185], v8 offset:17056
ds_read_b64_tr_b16 a[186:187], v8 offset:17312
v_mfma_f32_16x16x32_bf16 v[56:59], a[136:139], v[232:235], v[56:59]
v_exp_f32 v53, v53
v_mfma_f32_16x16x32_bf16 v[56:59], a[140:143], v[236:239], v[56:59]
ds_read_b64_tr_b16 a[188:189], v8 offset:17568
v_cvt_pk_bf16_f32 v152, v52, v53
v_mfma_f32_16x16x32_bf16 a[72:75], a[160:163], v[96:99], a[72:75]
v_exp_f32 v54, v54
v_mfma_f32_16x16x32_bf16 a[72:75], a[164:167], v[100:103], a[72:75]
v_add_f32 v38, v38, v39
v_lshl_add_u32 v45, v11, 2, v35
v_mfma_f32_16x16x32_bf16 a[72:75], a[168:171], v[104:107], a[72:75]
v_exp_f32 v55, v55
v_mfma_f32_16x16x32_bf16 a[72:75], a[172:175], v[108:111], a[72:75]
ds_read_b64_tr_b16 a[190:191], v8 offset:17824
v_cvt_pk_bf16_f32 v153, v54, v55
v_mfma_f32_16x16x32_bf16 v[60:63], a[128:131], v[240:243], v[28:31]
v_exp_f32 v56, v56
v_mfma_f32_16x16x32_bf16 v[60:63], a[132:135], v[244:247], v[60:63]
v_cmp_gt_u32 vcc, 16, v0
v_add_f32_dpp v38, v38, v38 row_ror:8 row_mask:0xf bank_mask:0xf
v_mfma_f32_16x16x32_bf16 v[60:63], a[136:139], v[248:251], v[60:63]
v_exp_f32 v57, v57
v_mfma_f32_16x16x32_bf16 v[60:63], a[140:143], v[252:255], v[60:63]
v_cvt_pk_bf16_f32 v168, v56, v57
v_mov_b32 v44, 1073741824
v_mfma_f32_16x16x32_bf16 a[76:79], a[160:163], v[112:115], a[76:79]
v_exp_f32 v58, v58
v_mfma_f32_16x16x32_bf16 a[76:79], a[164:167], v[116:119], a[76:79]
v_cndmask_b32 v44, v44, v11, vcc
v_add_f32_dpp v38, v38, v38 row_ror:4 row_mask:0xf bank_mask:0xf
v_mfma_f32_16x16x32_bf16 a[76:79], a[168:171], v[120:123], a[76:79]
v_exp_f32 v59, v59
v_mfma_f32_16x16x32_bf16 a[76:79], a[172:175], v[124:127], a[76:79]
ds_write_b32 v34, v38
v_cvt_pk_bf16_f32 v169, v58, v59
v_smfmac_f32_16x16x64_bf16 a[208:211], a[216:219], v[96:103], v10
s_waitcnt lgkmcnt(0)
v_mfma_f32_16x16x32_bf16 v[48:51], a[144:147], v[192:195], v[16:19]
v_exp_f32 v60, v60
v_mfma_f32_16x16x32_bf16 v[48:51], a[148:151], v[196:199], v[48:51]
ds_read_b128 a[128:131], v5 offset:54016
ds_read_b128 a[132:135], v5 offset:54080
v_mfma_f32_16x16x32_bf16 v[48:51], a[152:155], v[200:203], v[48:51]
v_exp_f32 v61, v61
v_mfma_f32_16x16x32_bf16 v[48:51], a[156:159], v[204:207], v[48:51]
ds_read_b128 a[136:139], v5 offset:54144
v_cvt_pk_bf16_f32 v184, v60, v61
v_mfma_f32_16x16x32_bf16 a[80:83], a[176:179], v[64:67], a[80:83]
v_exp_f32 v62, v62
v_mfma_f32_16x16x32_bf16 a[80:83], a[180:183], v[68:71], a[80:83]
v_mfma_f32_16x16x32_bf16 a[80:83], a[184:187], v[72:75], a[80:83]
v_exp_f32 v63, v63
v_mfma_f32_16x16x32_bf16 a[80:83], a[188:191], v[76:79], a[80:83]
ds_read_b128 a[140:143], v5 offset:54208
v_cvt_pk_bf16_f32 v185, v62, v63
v_mfma_f32_16x16x32_bf16 v[52:55], a[144:147], v[208:211], v[20:23]
v_exp_f32 v48, v48
v_mfma_f32_16x16x32_bf16 v[52:55], a[148:151], v[212:215], v[52:55]
ds_read_b64_tr_b16 a[160:161], v8 offset:192
ds_read_b64_tr_b16 a[162:163], v8 offset:448
v_mfma_f32_16x16x32_bf16 v[52:55], a[152:155], v[216:219], v[52:55]
v_exp_f32 v49, v49
v_mfma_f32_16x16x32_bf16 v[52:55], a[156:159], v[220:223], v[52:55]
ds_read_b64_tr_b16 a[164:165], v8 offset:704
v_cvt_pk_bf16_f32 v138, v48, v49
v_mfma_f32_16x16x32_bf16 a[84:87], a[176:179], v[80:83], a[84:87]
v_exp_f32 v50, v50
v_mfma_f32_16x16x32_bf16 a[84:87], a[180:183], v[84:87], a[84:87]
v_mfma_f32_16x16x32_bf16 a[84:87], a[184:187], v[88:91], a[84:87]
v_exp_f32 v51, v51
v_mfma_f32_16x16x32_bf16 a[84:87], a[188:191], v[92:95], a[84:87]
ds_read_b64_tr_b16 a[166:167], v8 offset:960
v_cvt_pk_bf16_f32 v139, v50, v51
v_mfma_f32_16x16x32_bf16 v[56:59], a[144:147], v[224:227], v[24:27]
v_exp_f32 v52, v52
v_mfma_f32_16x16x32_bf16 v[56:59], a[148:151], v[228:231], v[56:59]
ds_read_b64_tr_b16 a[168:169], v8 offset:17088
ds_read_b64_tr_b16 a[170:171], v8 offset:17344
v_mfma_f32_16x16x32_bf16 v[56:59], a[152:155], v[232:235], v[56:59]
v_exp_f32 v53, v53
v_mfma_f32_16x16x32_bf16 v[56:59], a[156:159], v[236:239], v[56:59]
ds_read_b64_tr_b16 a[172:173], v8 offset:17600
v_cvt_pk_bf16_f32 v154, v52, v53
v_mfma_f32_16x16x32_bf16 a[88:91], a[176:179], v[96:99], a[88:91]
v_exp_f32 v54, v54
v_mfma_f32_16x16x32_bf16 a[88:91], a[180:183], v[100:103], a[88:91]
v_mfma_f32_16x16x32_bf16 a[88:91], a[184:187], v[104:107], a[88:91]
v_exp_f32 v55, v55
v_mfma_f32_16x16x32_bf16 a[88:91], a[188:191], v[108:111], a[88:91]
ds_read_b64_tr_b16 a[174:175], v8 offset:17856
v_cvt_pk_bf16_f32 v155, v54, v55
v_mfma_f32_16x16x32_bf16 v[60:63], a[144:147], v[240:243], v[28:31]
v_exp_f32 v56, v56
v_mfma_f32_16x16x32_bf16 v[60:63], a[148:151], v[244:247], v[60:63]
v_mfma_f32_16x16x32_bf16 v[60:63], a[152:155], v[248:251], v[60:63]
v_exp_f32 v57, v57
v_mfma_f32_16x16x32_bf16 v[60:63], a[156:159], v[252:255], v[60:63]
v_cvt_pk_bf16_f32 v170, v56, v57
v_mfma_f32_16x16x32_bf16 a[92:95], a[176:179], v[112:115], a[92:95]
v_exp_f32 v58, v58
v_mfma_f32_16x16x32_bf16 a[92:95], a[180:183], v[116:119], a[92:95]
v_mfma_f32_16x16x32_bf16 a[92:95], a[184:187], v[120:123], a[92:95]
v_exp_f32 v59, v59
v_mfma_f32_16x16x32_bf16 a[92:95], a[188:191], v[124:127], a[92:95]
v_cvt_pk_bf16_f32 v171, v58, v59
v_smfmac_f32_16x16x64_bf16 a[208:211], a[216:219], v[104:111], v10
s_waitcnt lgkmcnt(0)
v_mfma_f32_16x16x32_bf16 v[48:51], a[128:131], v[192:195], v[16:19]
v_exp_f32 v60, v60
v_mfma_f32_16x16x32_bf16 v[48:51], a[132:135], v[196:199], v[48:51]
ds_read_b128 a[144:147], v5 offset:54272
ds_read_b128 a[148:151], v5 offset:54336
v_mfma_f32_16x16x32_bf16 v[48:51], a[136:139], v[200:203], v[48:51]
v_exp_f32 v61, v61
v_mfma_f32_16x16x32_bf16 v[48:51], a[140:143], v[204:207], v[48:51]
ds_read_b128 a[152:155], v5 offset:54400
v_cvt_pk_bf16_f32 v186, v60, v61
v_mfma_f32_16x16x32_bf16 a[96:99], a[160:163], v[64:67], a[96:99]
v_exp_f32 v62, v62
v_mfma_f32_16x16x32_bf16 a[96:99], a[164:167], v[68:71], a[96:99]
v_mfma_f32_16x16x32_bf16 a[96:99], a[168:171], v[72:75], a[96:99]
v_exp_f32 v63, v63
v_mfma_f32_16x16x32_bf16 a[96:99], a[172:175], v[76:79], a[96:99]
ds_read_b128 a[156:159], v5 offset:54464
v_cvt_pk_bf16_f32 v187, v62, v63
v_mfma_f32_16x16x32_bf16 v[52:55], a[128:131], v[208:211], v[20:23]
v_exp_f32 v48, v48
v_mfma_f32_16x16x32_bf16 v[52:55], a[132:135], v[212:215], v[52:55]
ds_read_b64_tr_b16 a[176:177], v8 offset:224
ds_read_b64_tr_b16 a[178:179], v8 offset:480
v_mfma_f32_16x16x32_bf16 v[52:55], a[136:139], v[216:219], v[52:55]
v_exp_f32 v49, v49
v_mfma_f32_16x16x32_bf16 v[52:55], a[140:143], v[220:223], v[52:55]
ds_read_b64_tr_b16 a[180:181], v8 offset:736
v_cvt_pk_bf16_f32 v140, v48, v49
v_mfma_f32_16x16x32_bf16 a[100:103], a[160:163], v[80:83], a[100:103]
v_exp_f32 v50, v50
v_mfma_f32_16x16x32_bf16 a[100:103], a[164:167], v[84:87], a[100:103]
v_mfma_f32_16x16x32_bf16 a[100:103], a[168:171], v[88:91], a[100:103]
v_exp_f32 v51, v51
v_mfma_f32_16x16x32_bf16 a[100:103], a[172:175], v[92:95], a[100:103]
ds_read_b64_tr_b16 a[182:183], v8 offset:992
v_cvt_pk_bf16_f32 v141, v50, v51
v_mfma_f32_16x16x32_bf16 v[56:59], a[128:131], v[224:227], v[24:27]
v_exp_f32 v52, v52
v_mfma_f32_16x16x32_bf16 v[56:59], a[132:135], v[228:231], v[56:59]
ds_read_b64_tr_b16 a[184:185], v8 offset:17120
ds_read_b64_tr_b16 a[186:187], v8 offset:17376
v_mfma_f32_16x16x32_bf16 v[56:59], a[136:139], v[232:235], v[56:59]
v_exp_f32 v53, v53
v_mfma_f32_16x16x32_bf16 v[56:59], a[140:143], v[236:239], v[56:59]
ds_read_b64_tr_b16 a[188:189], v8 offset:17632
v_cvt_pk_bf16_f32 v156, v52, v53
v_mfma_f32_16x16x32_bf16 a[104:107], a[160:163], v[96:99], a[104:107]
v_exp_f32 v54, v54
v_mfma_f32_16x16x32_bf16 a[104:107], a[164:167], v[100:103], a[104:107]
v_mfma_f32_16x16x32_bf16 a[104:107], a[168:171], v[104:107], a[104:107]
v_exp_f32 v55, v55
v_mfma_f32_16x16x32_bf16 a[104:107], a[172:175], v[108:111], a[104:107]
ds_read_b64_tr_b16 a[190:191], v8 offset:17888
v_cvt_pk_bf16_f32 v157, v54, v55
v_mfma_f32_16x16x32_bf16 v[60:63], a[128:131], v[240:243], v[28:31]
v_exp_f32 v56, v56
v_mfma_f32_16x16x32_bf16 v[60:63], a[132:135], v[244:247], v[60:63]
v_mfma_f32_16x16x32_bf16 v[60:63], a[136:139], v[248:251], v[60:63]
v_exp_f32 v57, v57
v_mfma_f32_16x16x32_bf16 v[60:63], a[140:143], v[252:255], v[60:63]
v_cvt_pk_bf16_f32 v172, v56, v57
v_mfma_f32_16x16x32_bf16 a[108:111], a[160:163], v[112:115], a[108:111]
v_exp_f32 v58, v58
v_mfma_f32_16x16x32_bf16 a[108:111], a[164:167], v[116:119], a[108:111]
v_mfma_f32_16x16x32_bf16 a[108:111], a[168:171], v[120:123], a[108:111]
v_exp_f32 v59, v59
v_mfma_f32_16x16x32_bf16 a[108:111], a[172:175], v[124:127], a[108:111]
v_cvt_pk_bf16_f32 v173, v58, v59
v_smfmac_f32_16x16x64_bf16 a[212:215], a[216:219], v[112:119], v10
s_waitcnt lgkmcnt(0)
v_mfma_f32_16x16x32_bf16 v[48:51], a[144:147], v[192:195], v[16:19]
s_waitcnt vmcnt(8)
s_barrier
v_exp_f32 v60, v60
v_mfma_f32_16x16x32_bf16 v[48:51], a[148:151], v[196:199], v[48:51]
ds_read_b64_tr_b16 a[160:161], v7 offset:0
ds_read_b64_tr_b16 a[162:163], v7 offset:256
v_mfma_f32_16x16x32_bf16 v[48:51], a[152:155], v[200:203], v[48:51]
v_exp_f32 v61, v61
v_mfma_f32_16x16x32_bf16 v[48:51], a[156:159], v[204:207], v[48:51]
ds_read_b64_tr_b16 a[164:165], v7 offset:512
v_cvt_pk_bf16_f32 v188, v60, v61
v_mfma_f32_16x16x32_bf16 a[112:115], a[176:179], v[64:67], a[112:115]
v_exp_f32 v62, v62
v_mfma_f32_16x16x32_bf16 a[112:115], a[180:183], v[68:71], a[112:115]
ds_read_b128 v[36:39], v45
v_mfma_f32_16x16x32_bf16 a[112:115], a[184:187], v[72:75], a[112:115]
v_exp_f32 v63, v63
v_mfma_f32_16x16x32_bf16 a[112:115], a[188:191], v[76:79], a[112:115]
ds_read_b64_tr_b16 a[166:167], v7 offset:768
v_cvt_pk_bf16_f32 v189, v62, v63
v_mfma_f32_16x16x32_bf16 v[52:55], a[144:147], v[208:211], v[20:23]
v_exp_f32 v48, v48
v_mfma_f32_16x16x32_bf16 v[52:55], a[148:151], v[212:215], v[52:55]
ds_read_b64_tr_b16 a[168:169], v7 offset:16896
ds_read_b64_tr_b16 a[170:171], v7 offset:17152
v_mfma_f32_16x16x32_bf16 v[52:55], a[152:155], v[216:219], v[52:55]
v_exp_f32 v49, v49
v_mfma_f32_16x16x32_bf16 v[52:55], a[156:159], v[220:223], v[52:55]
ds_read_b64_tr_b16 a[172:173], v7 offset:17408
v_cvt_pk_bf16_f32 v142, v48, v49
v_mfma_f32_16x16x32_bf16 a[116:119], a[176:179], v[80:83], a[116:119]
v_exp_f32 v50, v50
v_mfma_f32_16x16x32_bf16 a[116:119], a[180:183], v[84:87], a[116:119]
v_mfma_f32_16x16x32_bf16 a[116:119], a[184:187], v[88:91], a[116:119]
v_exp_f32 v51, v51
v_mfma_f32_16x16x32_bf16 a[116:119], a[188:191], v[92:95], a[116:119]
ds_read_b64_tr_b16 a[174:175], v7 offset:17664
v_cvt_pk_bf16_f32 v143, v50, v51
v_mfma_f32_16x16x32_bf16 v[56:59], a[144:147], v[224:227], v[24:27]
v_exp_f32 v52, v52
v_mfma_f32_16x16x32_bf16 v[56:59], a[148:151], v[228:231], v[56:59]
s_waitcnt lgkmcnt(1)
v_pk_add_f32 v[36:37], v[36:37], v[38:39]
v_add_f32 v36, v36, v37
v_mfma_f32_16x16x32_bf16 v[56:59], a[152:155], v[232:235], v[56:59]
v_exp_f32 v53, v53
v_mfma_f32_16x16x32_bf16 v[56:59], a[156:159], v[236:239], v[56:59]
v_cvt_pk_bf16_f32 v158, v52, v53
v_cvt_pk_bf16_f32 v36, v36, v36
v_mfma_f32_16x16x32_bf16 a[120:123], a[176:179], v[96:99], a[120:123]
v_exp_f32 v54, v54
v_mfma_f32_16x16x32_bf16 a[120:123], a[180:183], v[100:103], a[120:123]
v_lshlrev_b32 v36, 16, v36
v_add_f32 v36, s67, v36
v_mfma_f32_16x16x32_bf16 a[120:123], a[184:187], v[104:107], a[120:123]
v_exp_f32 v55, v55
v_mfma_f32_16x16x32_bf16 a[120:123], a[188:191], v[108:111], a[120:123]
v_cvt_pk_bf16_f32 v159, v54, v55
v_cvt_pk_bf16_f32 v36, v36, v36
v_mfma_f32_16x16x32_bf16 v[60:63], a[144:147], v[240:243], v[28:31]
v_exp_f32 v56, v56
v_mfma_f32_16x16x32_bf16 v[60:63], a[148:151], v[244:247], v[60:63]
v_lshlrev_b32 v36, 16, v36
v_mul_f32 v36, s66, v36
v_mfma_f32_16x16x32_bf16 v[60:63], a[152:155], v[248:251], v[60:63]
v_exp_f32 v57, v57
v_mfma_f32_16x16x32_bf16 v[60:63], a[156:159], v[252:255], v[60:63]
v_cvt_pk_bf16_f32 v174, v56, v57
v_mfma_f32_16x16x32_bf16 a[124:127], a[176:179], v[112:115], a[124:127]
v_exp_f32 v58, v58
v_mfma_f32_16x16x32_bf16 a[124:127], a[180:183], v[116:119], a[124:127]
v_mfma_f32_16x16x32_bf16 a[124:127], a[184:187], v[120:123], a[124:127]
v_exp_f32 v59, v59
v_mfma_f32_16x16x32_bf16 a[124:127], a[188:191], v[124:127], a[124:127]
v_cvt_pk_bf16_f32 v175, v58, v59
v_smfmac_f32_16x16x64_bf16 a[212:215], a[216:219], v[120:127], v10
s_waitcnt lgkmcnt(0)
buffer_store_dword v36, v44, s[24:27], s65 offen sc1
v_mfma_f32_16x16x32_bf16 a[0:3], a[160:163], v[128:131], a[0:3]
v_exp_f32 v60, v60
v_mfma_f32_16x16x32_bf16 a[0:3], a[164:167], v[132:135], a[0:3]
v_exp_f32 v61, v61
v_mfma_f32_16x16x32_bf16 a[0:3], a[168:171], v[136:139], a[0:3]
v_exp_f32 v62, v62
v_mfma_f32_16x16x32_bf16 a[0:3], a[172:175], v[140:143], a[0:3]
v_exp_f32 v63, v63
v_mfma_f32_16x16x32_bf16 a[4:7], a[160:163], v[144:147], a[4:7]
v_cvt_pk_bf16_f32 v190, v60, v61
v_cvt_pk_bf16_f32 v191, v62, v63
v_mfma_f32_16x16x32_bf16 a[4:7], a[164:167], v[148:151], a[4:7]
ds_read_b64_tr_b16 a[176:177], v7 offset:32
ds_read_b64_tr_b16 a[178:179], v7 offset:288
v_mfma_f32_16x16x32_bf16 a[4:7], a[168:171], v[152:155], a[4:7]
ds_read_b64_tr_b16 a[180:181], v7 offset:544
ds_read_b64_tr_b16 a[182:183], v7 offset:800
v_mfma_f32_16x16x32_bf16 a[4:7], a[172:175], v[156:159], a[4:7]
ds_read_b64_tr_b16 a[184:185], v7 offset:16928
ds_read_b64_tr_b16 a[186:187], v7 offset:17184
v_mfma_f32_16x16x32_bf16 a[8:11], a[160:163], v[160:163], a[8:11]
ds_read_b64_tr_b16 a[188:189], v7 offset:17440
ds_read_b64_tr_b16 a[190:191], v7 offset:17696
s_add_u32 m0, s40, 36864
v_mfma_f32_16x16x32_bf16 a[8:11], a[164:167], v[164:167], a[8:11]
s_mov_b32 s45, 128
buffer_load_dwordx4 v3, s[20:23], s45 offen lds
v_mfma_f32_16x16x32_bf16 a[8:11], a[168:171], v[168:171], a[8:11]
v_mfma_f32_16x16x32_bf16 a[8:11], a[172:175], v[172:175], a[8:11]
v_mfma_f32_16x16x32_bf16 a[12:15], a[160:163], v[176:179], a[12:15]
s_add_u32 m0, s40, 40960
s_mov_b32 s45, 36992
v_mfma_f32_16x16x32_bf16 a[12:15], a[164:167], v[180:183], a[12:15]
buffer_load_dwordx4 v3, s[20:23], s45 offen lds
v_mfma_f32_16x16x32_bf16 a[12:15], a[168:171], v[184:187], a[12:15]
v_mfma_f32_16x16x32_bf16 a[12:15], a[172:175], v[188:191], a[12:15]
v_smfmac_f32_16x16x64_bf16 a[200:203], a[216:219], v[128:135], v10
s_add_u32 m0, s40, 45056
s_mov_b32 s45, 73856
v_smfmac_f32_16x16x64_bf16 a[204:207], a[216:219], v[144:151], v10
buffer_load_dwordx4 v3, s[20:23], s45 offen lds
v_smfmac_f32_16x16x64_bf16 a[208:211], a[216:219], v[160:167], v10
v_smfmac_f32_16x16x64_bf16 a[212:215], a[216:219], v[176:183], v10
v_smfmac_f32_16x16x64_bf16 a[200:203], a[216:219], v[136:143], v10
s_add_u32 m0, s40, 49152
s_mov_b32 s45, 110720
v_smfmac_f32_16x16x64_bf16 a[204:207], a[216:219], v[152:159], v10
buffer_load_dwordx4 v3, s[20:23], s45 offen lds
v_smfmac_f32_16x16x64_bf16 a[208:211], a[216:219], v[168:175], v10
v_smfmac_f32_16x16x64_bf16 a[212:215], a[216:219], v[184:191], v10
s_waitcnt lgkmcnt(0)
v_mfma_f32_16x16x32_bf16 a[16:19], a[176:179], v[128:131], a[16:19]
ds_read_b64_tr_b16 a[160:161], v7 offset:64
ds_read_b64_tr_b16 a[162:163], v7 offset:320
v_mfma_f32_16x16x32_bf16 a[16:19], a[180:183], v[132:135], a[16:19]
ds_read_b64_tr_b16 a[164:165], v7 offset:576
ds_read_b64_tr_b16 a[166:167], v7 offset:832
v_mfma_f32_16x16x32_bf16 a[16:19], a[184:187], v[136:139], a[16:19]
ds_read_b64_tr_b16 a[168:169], v7 offset:16960
ds_read_b64_tr_b16 a[170:171], v7 offset:17216
v_mfma_f32_16x16x32_bf16 a[16:19], a[188:191], v[140:143], a[16:19]
ds_read_b64_tr_b16 a[172:173], v7 offset:17472
ds_read_b64_tr_b16 a[174:175], v7 offset:17728
v_mfma_f32_16x16x32_bf16 a[20:23], a[176:179], v[144:147], a[20:23]
v_accvgpr_read_b32 v16, a200
v_accvgpr_read_b32 v20, a201
v_mfma_f32_16x16x32_bf16 a[20:23], a[180:183], v[148:151], a[20:23]
v_accvgpr_read_b32 v17, a204
v_accvgpr_read_b32 v21, a205
v_mfma_f32_16x16x32_bf16 a[20:23], a[184:187], v[152:155], a[20:23]
v_accvgpr_read_b32 v18, a208
v_accvgpr_read_b32 v22, a209
v_mfma_f32_16x16x32_bf16 a[20:23], a[188:191], v[156:159], a[20:23]
v_accvgpr_read_b32 v19, a212
v_accvgpr_read_b32 v23, a213
v_mfma_f32_16x16x32_bf16 a[24:27], a[176:179], v[160:163], a[24:27]
v_add_f32 v16, v16, v20
v_add_f32 v17, v17, v21
v_mfma_f32_16x16x32_bf16 a[24:27], a[180:183], v[164:167], a[24:27]
v_add_f32 v18, v18, v22
v_add_f32 v19, v19, v23
v_mfma_f32_16x16x32_bf16 a[24:27], a[184:187], v[168:171], a[24:27]
ds_bpermute_b32 v20, v11, v16
ds_bpermute_b32 v21, v11, v17
v_mfma_f32_16x16x32_bf16 a[24:27], a[188:191], v[172:175], a[24:27]
ds_bpermute_b32 v22, v11, v18
ds_bpermute_b32 v23, v11, v19
s_add_u32 m0, s40, 53248
v_mfma_f32_16x16x32_bf16 a[28:31], a[176:179], v[176:179], a[28:31]
s_mov_b32 s45, 147584
buffer_load_dwordx4 v3, s[20:23], s45 offen lds
v_mfma_f32_16x16x32_bf16 a[28:31], a[180:183], v[180:183], a[28:31]
v_mfma_f32_16x16x32_bf16 a[28:31], a[184:187], v[184:187], a[28:31]
v_mfma_f32_16x16x32_bf16 a[28:31], a[188:191], v[188:191], a[28:31]
s_waitcnt lgkmcnt(0)
v_mfma_f32_16x16x32_bf16 a[32:35], a[160:163], v[128:131], a[32:35]
ds_read_b64_tr_b16 a[176:177], v7 offset:96
ds_read_b64_tr_b16 a[178:179], v7 offset:352
v_mfma_f32_16x16x32_bf16 a[32:35], a[164:167], v[132:135], a[32:35]
ds_read_b64_tr_b16 a[180:181], v7 offset:608
ds_read_b64_tr_b16 a[182:183], v7 offset:864
v_mfma_f32_16x16x32_bf16 a[32:35], a[168:171], v[136:139], a[32:35]
ds_read_b64_tr_b16 a[184:185], v7 offset:16992
ds_read_b64_tr_b16 a[186:187], v7 offset:17248
v_mfma_f32_16x16x32_bf16 a[32:35], a[172:175], v[140:143], a[32:35]
ds_read_b64_tr_b16 a[188:189], v7 offset:17504
ds_read_b64_tr_b16 a[190:191], v7 offset:17760
v_mfma_f32_16x16x32_bf16 a[36:39], a[160:163], v[144:147], a[36:39]
v_rcp_f32 v16, v20
v_mfma_f32_16x16x32_bf16 a[36:39], a[164:167], v[148:151], a[36:39]
v_rcp_f32 v17, v21
v_mfma_f32_16x16x32_bf16 a[36:39], a[168:171], v[152:155], a[36:39]
v_rcp_f32 v18, v22
v_mfma_f32_16x16x32_bf16 a[36:39], a[172:175], v[156:159], a[36:39]
v_rcp_f32 v19, v23
v_mfma_f32_16x16x32_bf16 a[40:43], a[160:163], v[160:163], a[40:43]
v_add_f32 v20, v20, v21
v_add_f32 v22, v22, v23
v_mfma_f32_16x16x32_bf16 a[40:43], a[164:167], v[164:167], a[40:43]
v_add_f32 v20, v20, v22
v_cmp_ngt_f32 vcc, 0x5f800000, v20
v_mfma_f32_16x16x32_bf16 a[40:43], a[168:171], v[168:171], a[40:43]
v_mov_b32 v28, 155648
v_lshl_add_u32 v21, s3, 2, v28
s_add_u32 m0, s40, 57344
v_mfma_f32_16x16x32_bf16 a[40:43], a[172:175], v[172:175], a[40:43]
s_mov_b32 s45, 184448
buffer_load_dwordx4 v3, s[20:23], s45 offen lds
v_mfma_f32_16x16x32_bf16 a[44:47], a[160:163], v[176:179], a[44:47]
s_cmp_lg_u64 vcc, 0
s_cselect_b32 s38, 1, 0
v_mfma_f32_16x16x32_bf16 a[44:47], a[164:167], v[180:183], a[44:47]
v_mov_b32 v20, s38
s_add_u32 m0, s40, 61440
v_mfma_f32_16x16x32_bf16 a[44:47], a[168:171], v[184:187], a[44:47]
ds_write_b32 v21, v20
v_accvgpr_read_b32 v32, a0
v_mfma_f32_16x16x32_bf16 a[44:47], a[172:175], v[188:191], a[44:47]
s_waitcnt lgkmcnt(0)
v_accvgpr_read_b32 v33, a1
v_accvgpr_read_b32 v34, a2
v_mfma_f32_16x16x32_bf16 a[48:51], a[176:179], v[128:131], a[48:51]
ds_read_b64_tr_b16 a[160:161], v7 offset:128
ds_read_b64_tr_b16 a[162:163], v7 offset:384
v_mfma_f32_16x16x32_bf16 a[48:51], a[180:183], v[132:135], a[48:51]
ds_read_b64_tr_b16 a[164:165], v7 offset:640
ds_read_b64_tr_b16 a[166:167], v7 offset:896
v_mfma_f32_16x16x32_bf16 a[48:51], a[184:187], v[136:139], a[48:51]
ds_read_b64_tr_b16 a[168:169], v7 offset:17024
ds_read_b64_tr_b16 a[170:171], v7 offset:17280
v_mfma_f32_16x16x32_bf16 a[48:51], a[188:191], v[140:143], a[48:51]
ds_read_b64_tr_b16 a[172:173], v7 offset:17536
ds_read_b64_tr_b16 a[174:175], v7 offset:17792
v_mfma_f32_16x16x32_bf16 a[52:55], a[176:179], v[144:147], a[52:55]
s_mov_b32 s45, 221312
buffer_load_dwordx4 v3, s[20:23], s45 offen lds
v_mfma_f32_16x16x32_bf16 a[52:55], a[180:183], v[148:151], a[52:55]
v_accvgpr_read_b32 v35, a3
v_mul_f32 v32, v32, v16
v_mfma_f32_16x16x32_bf16 a[52:55], a[184:187], v[152:155], a[52:55]
v_mul_f32 v33, v33, v16
v_mul_f32 v34, v34, v16
v_mfma_f32_16x16x32_bf16 a[52:55], a[188:191], v[156:159], a[52:55]
v_mul_f32 v35, v35, v16
v_cvt_pk_bf16_f32 v64, v32, v33
s_add_u32 m0, s40, 65536
v_mfma_f32_16x16x32_bf16 a[56:59], a[176:179], v[160:163], a[56:59]
s_mov_b32 s45, 258176
buffer_load_dwordx4 v3, s[20:23], s45 offen lds
v_mfma_f32_16x16x32_bf16 a[56:59], a[180:183], v[164:167], a[56:59]
v_cvt_pk_bf16_f32 v65, v34, v35
v_accvgpr_read_b32 v36, a8
v_mfma_f32_16x16x32_bf16 a[56:59], a[184:187], v[168:171], a[56:59]
v_accvgpr_read_b32 v37, a9
v_accvgpr_read_b32 v38, a10
v_mfma_f32_16x16x32_bf16 a[56:59], a[188:191], v[172:175], a[56:59]
v_accvgpr_read_b32 v39, a11
v_mul_f32 v36, v36, v18
s_add_u32 m0, s40, 73728
v_mfma_f32_16x16x32_bf16 a[60:63], a[176:179], v[176:179], a[60:63]
s_mov_b32 s45, 256
buffer_load_dwordx4 v3, s[20:23], s45 offen lds
v_mfma_f32_16x16x32_bf16 a[60:63], a[180:183], v[180:183], a[60:63]
v_mul_f32 v37, v37, v18
v_mul_f32 v38, v38, v18
v_mfma_f32_16x16x32_bf16 a[60:63], a[184:187], v[184:187], a[60:63]
v_mul_f32 v39, v39, v18
v_cvt_pk_bf16_f32 v80, v36, v37
v_mfma_f32_16x16x32_bf16 a[60:63], a[188:191], v[188:191], a[60:63]
s_waitcnt lgkmcnt(0)
v_cvt_pk_bf16_f32 v81, v38, v39
v_accvgpr_read_b32 v40, a4
v_mfma_f32_16x16x32_bf16 a[64:67], a[160:163], v[128:131], a[64:67]
ds_read_b64_tr_b16 a[176:177], v7 offset:160
ds_read_b64_tr_b16 a[178:179], v7 offset:416
v_mfma_f32_16x16x32_bf16 a[64:67], a[164:167], v[132:135], a[64:67]
ds_read_b64_tr_b16 a[180:181], v7 offset:672
ds_read_b64_tr_b16 a[182:183], v7 offset:928
v_mfma_f32_16x16x32_bf16 a[64:67], a[168:171], v[136:139], a[64:67]
ds_read_b64_tr_b16 a[184:185], v7 offset:17056
ds_read_b64_tr_b16 a[186:187], v7 offset:17312
v_mfma_f32_16x16x32_bf16 a[64:67], a[172:175], v[140:143], a[64:67]
ds_read_b64_tr_b16 a[188:189], v7 offset:17568
ds_read_b64_tr_b16 a[190:191], v7 offset:17824
s_add_u32 m0, s40, 77824
v_mfma_f32_16x16x32_bf16 a[68:71], a[160:163], v[144:147], a[68:71]
s_mov_b32 s45, 37120
buffer_load_dwordx4 v3, s[20:23], s45 offen lds
v_mfma_f32_16x16x32_bf16 a[68:71], a[164:167], v[148:151], a[68:71]
v_accvgpr_read_b32 v41, a5
v_accvgpr_read_b32 v42, a6
v_mfma_f32_16x16x32_bf16 a[68:71], a[168:171], v[152:155], a[68:71]
v_accvgpr_read_b32 v43, a7
v_mul_f32 v40, v40, v17
v_mfma_f32_16x16x32_bf16 a[68:71], a[172:175], v[156:159], a[68:71]
v_mul_f32 v41, v41, v17
v_mul_f32 v42, v42, v17
s_add_u32 m0, s40, 81920
v_mfma_f32_16x16x32_bf16 a[72:75], a[160:163], v[160:163], a[72:75]
s_mov_b32 s45, 73984
buffer_load_dwordx4 v3, s[20:23], s45 offen lds
v_mfma_f32_16x16x32_bf16 a[72:75], a[164:167], v[164:167], a[72:75]
v_mul_f32 v43, v43, v17
v_cvt_pk_bf16_f32 v96, v40, v41
v_mfma_f32_16x16x32_bf16 a[72:75], a[168:171], v[168:171], a[72:75]
v_cvt_pk_bf16_f32 v97, v42, v43
v_accvgpr_read_b32 v44, a12
v_mfma_f32_16x16x32_bf16 a[72:75], a[172:175], v[172:175], a[72:75]
v_accvgpr_read_b32 v45, a13
v_accvgpr_read_b32 v46, a14
s_add_u32 m0, s40, 86016
v_mfma_f32_16x16x32_bf16 a[76:79], a[160:163], v[176:179], a[76:79]
s_mov_b32 s45, 110848
buffer_load_dwordx4 v3, s[20:23], s45 offen lds
v_mfma_f32_16x16x32_bf16 a[76:79], a[164:167], v[180:183], a[76:79]
v_accvgpr_read_b32 v47, a15
v_mul_f32 v44, v44, v19
v_mfma_f32_16x16x32_bf16 a[76:79], a[168:171], v[184:187], a[76:79]
v_mul_f32 v45, v45, v19
v_mul_f32 v46, v46, v19
v_mfma_f32_16x16x32_bf16 a[76:79], a[172:175], v[188:191], a[76:79]
s_waitcnt lgkmcnt(0)
v_mul_f32 v47, v47, v19
v_cvt_pk_bf16_f32 v112, v44, v45
v_mfma_f32_16x16x32_bf16 a[80:83], a[176:179], v[128:131], a[80:83]
ds_read_b64_tr_b16 a[160:161], v7 offset:192
ds_read_b64_tr_b16 a[162:163], v7 offset:448
v_mfma_f32_16x16x32_bf16 a[80:83], a[180:183], v[132:135], a[80:83]
ds_read_b64_tr_b16 a[164:165], v7 offset:704
ds_read_b64_tr_b16 a[166:167], v7 offset:960
v_mfma_f32_16x16x32_bf16 a[80:83], a[184:187], v[136:139], a[80:83]
ds_read_b64_tr_b16 a[168:169], v7 offset:17088
ds_read_b64_tr_b16 a[170:171], v7 offset:17344
v_mfma_f32_16x16x32_bf16 a[80:83], a[188:191], v[140:143], a[80:83]
ds_read_b64_tr_b16 a[172:173], v7 offset:17600
ds_read_b64_tr_b16 a[174:175], v7 offset:17856
s_add_u32 m0, s40, 90112
v_mfma_f32_16x16x32_bf16 a[84:87], a[176:179], v[144:147], a[84:87]
s_mov_b32 s45, 147712
buffer_load_dwordx4 v3, s[20:23], s45 offen lds
v_mfma_f32_16x16x32_bf16 a[84:87], a[180:183], v[148:151], a[84:87]
v_cvt_pk_bf16_f32 v113, v46, v47
v_accvgpr_read_b32 v48, a16
v_mfma_f32_16x16x32_bf16 a[84:87], a[184:187], v[152:155], a[84:87]
v_accvgpr_read_b32 v49, a17
v_accvgpr_read_b32 v50, a18
v_mfma_f32_16x16x32_bf16 a[84:87], a[188:191], v[156:159], a[84:87]
v_accvgpr_read_b32 v51, a19
v_mul_f32 v48, v48, v16
s_add_u32 m0, s40, 94208
v_mfma_f32_16x16x32_bf16 a[88:91], a[176:179], v[160:163], a[88:91]
s_mov_b32 s45, 184576
buffer_load_dwordx4 v3, s[20:23], s45 offen lds
v_mfma_f32_16x16x32_bf16 a[88:91], a[180:183], v[164:167], a[88:91]
v_mul_f32 v49, v49, v16
v_mul_f32 v50, v50, v16
v_mfma_f32_16x16x32_bf16 a[88:91], a[184:187], v[168:171], a[88:91]
v_mul_f32 v51, v51, v16
v_cvt_pk_bf16_f32 v66, v48, v49
v_mfma_f32_16x16x32_bf16 a[88:91], a[188:191], v[172:175], a[88:91]
v_cvt_pk_bf16_f32 v67, v50, v51
v_accvgpr_read_b32 v52, a24
s_add_u32 m0, s40, 98304
v_mfma_f32_16x16x32_bf16 a[92:95], a[176:179], v[176:179], a[92:95]
s_mov_b32 s45, 221440
buffer_load_dwordx4 v3, s[20:23], s45 offen lds
v_mfma_f32_16x16x32_bf16 a[92:95], a[180:183], v[180:183], a[92:95]
v_accvgpr_read_b32 v53, a25
v_accvgpr_read_b32 v54, a26
v_mfma_f32_16x16x32_bf16 a[92:95], a[184:187], v[184:187], a[92:95]
v_accvgpr_read_b32 v55, a27
v_mul_f32 v52, v52, v18
v_mfma_f32_16x16x32_bf16 a[92:95], a[188:191], v[188:191], a[92:95]
s_waitcnt lgkmcnt(0)
v_mul_f32 v53, v53, v18
v_mul_f32 v54, v54, v18
v_mfma_f32_16x16x32_bf16 a[96:99], a[160:163], v[128:131], a[96:99]
ds_read_b64_tr_b16 a[176:177], v7 offset:224
ds_read_b64_tr_b16 a[178:179], v7 offset:480
v_mfma_f32_16x16x32_bf16 a[96:99], a[164:167], v[132:135], a[96:99]
ds_read_b64_tr_b16 a[180:181], v7 offset:736
ds_read_b64_tr_b16 a[182:183], v7 offset:992
v_mfma_f32_16x16x32_bf16 a[96:99], a[168:171], v[136:139], a[96:99]
ds_read_b64_tr_b16 a[184:185], v7 offset:17120
ds_read_b64_tr_b16 a[186:187], v7 offset:17376
v_mfma_f32_16x16x32_bf16 a[96:99], a[172:175], v[140:143], a[96:99]
ds_read_b64_tr_b16 a[188:189], v7 offset:17632
ds_read_b64_tr_b16 a[190:191], v7 offset:17888
s_add_u32 m0, s40, 102400
v_mfma_f32_16x16x32_bf16 a[100:103], a[160:163], v[144:147], a[100:103]
s_mov_b32 s45, 258304
buffer_load_dwordx4 v3, s[20:23], s45 offen lds
v_mfma_f32_16x16x32_bf16 a[100:103], a[164:167], v[148:151], a[100:103]
v_mul_f32 v55, v55, v18
v_cvt_pk_bf16_f32 v82, v52, v53
v_mfma_f32_16x16x32_bf16 a[100:103], a[168:171], v[152:155], a[100:103]
v_cvt_pk_bf16_f32 v83, v54, v55
v_accvgpr_read_b32 v56, a20
v_mfma_f32_16x16x32_bf16 a[100:103], a[172:175], v[156:159], a[100:103]
v_accvgpr_read_b32 v57, a21
v_accvgpr_read_b32 v58, a22
v_mfma_f32_16x16x32_bf16 a[104:107], a[160:163], v[160:163], a[104:107]
v_accvgpr_read_b32 v59, a23
v_mul_f32 v56, v56, v17
v_mfma_f32_16x16x32_bf16 a[104:107], a[164:167], v[164:167], a[104:107]
v_mul_f32 v57, v57, v17
v_mul_f32 v58, v58, v17
v_mfma_f32_16x16x32_bf16 a[104:107], a[168:171], v[168:171], a[104:107]
v_mul_f32 v59, v59, v17
v_cvt_pk_bf16_f32 v98, v56, v57
v_mfma_f32_16x16x32_bf16 a[104:107], a[172:175], v[172:175], a[104:107]
v_cvt_pk_bf16_f32 v99, v58, v59
v_accvgpr_read_b32 v60, a28
v_mfma_f32_16x16x32_bf16 a[108:111], a[160:163], v[176:179], a[108:111]
v_accvgpr_read_b32 v61, a29
v_accvgpr_read_b32 v62, a30
v_mfma_f32_16x16x32_bf16 a[108:111], a[164:167], v[180:183], a[108:111]
v_accvgpr_read_b32 v63, a31
v_mul_f32 v60, v60, v19
v_mfma_f32_16x16x32_bf16 a[108:111], a[168:171], v[184:187], a[108:111]
v_mul_f32 v61, v61, v19
v_mul_f32 v62, v62, v19
v_mfma_f32_16x16x32_bf16 a[108:111], a[172:175], v[188:191], a[108:111]
s_waitcnt lgkmcnt(0)
v_mul_f32 v63, v63, v19
v_cvt_pk_bf16_f32 v114, v60, v61
v_mfma_f32_16x16x32_bf16 a[112:115], a[176:179], v[128:131], a[112:115]
s_waitcnt vmcnt(17)
s_barrier
ds_read_b128 v[24:27], v28
ds_read_b64_tr_b16 a[128:129], v12 offset:0
v_mfma_f32_16x16x32_bf16 a[112:115], a[180:183], v[132:135], a[112:115]
ds_read_b64_tr_b16 a[130:131], v12 offset:2048
ds_read_b64_tr_b16 a[132:133], v12 offset:4096
v_mfma_f32_16x16x32_bf16 a[112:115], a[184:187], v[136:139], a[112:115]
ds_read_b64_tr_b16 a[134:135], v12 offset:6144
ds_read_b64_tr_b16 a[136:137], v12 offset:8192
v_mfma_f32_16x16x32_bf16 a[112:115], a[188:191], v[140:143], a[112:115]
ds_read_b64_tr_b16 a[138:139], v12 offset:10240
ds_read_b64_tr_b16 a[140:141], v12 offset:12288
v_mfma_f32_16x16x32_bf16 a[116:119], a[176:179], v[144:147], a[116:119]
ds_read_b64_tr_b16 a[142:143], v12 offset:14336
ds_read_b64_tr_b16 a[144:145], v12 offset:16384
v_mfma_f32_16x16x32_bf16 a[116:119], a[180:183], v[148:151], a[116:119]
ds_read_b64_tr_b16 a[146:147], v12 offset:18432
ds_read_b64_tr_b16 a[148:149], v12 offset:20480
v_mfma_f32_16x16x32_bf16 a[116:119], a[184:187], v[152:155], a[116:119]
ds_read_b64_tr_b16 a[150:151], v12 offset:22528
ds_read_b64_tr_b16 a[152:153], v12 offset:24576
v_mfma_f32_16x16x32_bf16 a[116:119], a[188:191], v[156:159], a[116:119]
ds_read_b64_tr_b16 a[154:155], v12 offset:26624
ds_read_b64_tr_b16 a[156:157], v12 offset:28672
v_mfma_f32_16x16x32_bf16 a[120:123], a[176:179], v[160:163], a[120:123]
ds_read_b64_tr_b16 a[158:159], v12 offset:30720
v_cvt_pk_bf16_f32 v115, v62, v63
v_mfma_f32_16x16x32_bf16 a[120:123], a[180:183], v[164:167], a[120:123]
v_accvgpr_read_b32 v32, a32
v_accvgpr_read_b32 v33, a33
v_mfma_f32_16x16x32_bf16 a[120:123], a[184:187], v[168:171], a[120:123]
v_accvgpr_read_b32 v34, a34
v_accvgpr_read_b32 v35, a35
v_mfma_f32_16x16x32_bf16 a[120:123], a[188:191], v[172:175], a[120:123]
v_mul_f32 v32, v32, v16
v_mul_f32 v33, v33, v16
v_mfma_f32_16x16x32_bf16 a[124:127], a[176:179], v[176:179], a[124:127]
v_mul_f32 v34, v34, v16
v_mul_f32 v35, v35, v16
v_mfma_f32_16x16x32_bf16 a[124:127], a[180:183], v[180:183], a[124:127]
v_cvt_pk_bf16_f32 v68, v32, v33
v_cvt_pk_bf16_f32 v69, v34, v35
v_mfma_f32_16x16x32_bf16 a[124:127], a[184:187], v[184:187], a[124:127]
v_accvgpr_read_b32 v36, a40
v_accvgpr_read_b32 v37, a41
v_mfma_f32_16x16x32_bf16 a[124:127], a[188:191], v[188:191], a[124:127]
s_waitcnt lgkmcnt(0)
v_accvgpr_read_b32 v38, a42
v_accvgpr_read_b32 v39, a43
v_or_b32 v24, v24, v25
v_or3_b32 v24, v24, v26, v27
s_nop 0
v_readfirstlane_b32 s38, v24
s_nop 1
s_cmp_gt_u32 s38, s47
s_cbranch_scc1 K1_fb
s_mov_b32 s8, s28
s_mov_b32 s9, s29
s_mov_b32 s10, 5308416
s_mov_b32 s11, 0x20000
s_mov_b32 s12, s30
s_mov_b32 s13, s31
s_mov_b32 s14, 5308416
s_mov_b32 s15, 0x20000
s_mov_b32 s16, s32
s_mov_b32 s17, s33
s_mov_b32 s18, 5308416
s_mov_b32 s19, 0x20000
s_lshl_b32 s6, s5, 4
s_add_u32 s6, s6, s4
s_mul_i32 s6, s6, 9216
s_lshl_b32 s7, s3, 8
s_add_u32 s60, s6, s7
s_lshr_b32 s7, s3, 1
s_lshl_b32 s7, s7, 6
s_and_b32 s38, s3, 1
s_lshl_b32 s38, s38, 4
s_add_u32 s7, s7, s38
s_add_u32 s46, s6, s7
s_lshl_b32 s7, s7, 1
s_add_u32 s61, s7, 65536
s_lshl2_add_u32 s6, s5, s3
s_lshl_b32 s6, s6, 7
s_lshr_b32 s38, s4, 3
s_add_u32 s6, s6, s38
s_lshl_b32 s6, s6, 5
s_and_b32 s7, s4, 7
s_lshl2_add_u32 s6, s7, s6
s_add_u32 s55, s6, 131068
s_lshr_b32 s6, s4, 2
s_lshl2_add_u32 s6, s5, s6
s_bfe_u32 s7, s4, 65544
s_lshl4_add_u32 s6, s6, s7
s_lshl_b32 s32, s6, 8
s_and_b32 s7, s3, 2
s_add_u32 s6, s38, s7
s_lshl2_add_u32 s6, s5, s6
s_bfe_u32 s7, s4, 65544
s_lshl4_add_u32 s6, s6, s7
s_lshl_b32 s33, s6, 8
s_mov_b32 s56, s34
s_mov_b32 s57, s35
s_mov_b32 s58, 2359296
s_mov_b32 s59, 0x20000
s_cmp_eq_u32 s3, 0
s_cselect_b32 s68, s55, 0x10000000
s_cmp_eq_u32 s68, 131068
s_cselect_b32 s69, 0, 0x10000000
s_mov_b32 s70, 131072
v_pk_mul_f32 v[36:37], v[36:37], v[18:19] op_sel:[0,0] op_sel_hi:[1,0]
v_pk_mul_f32 v[38:39], v[38:39], v[18:19] op_sel:[0,0] op_sel_hi:[1,0]
v_cvt_pk_bf16_f32 v84, v36, v37
v_cvt_pk_bf16_f32 v85, v38, v39
v_accvgpr_read_b32 v40, a36
v_accvgpr_read_b32 v41, a37
v_accvgpr_read_b32 v42, a38
v_accvgpr_read_b32 v43, a39
v_pk_mul_f32 v[40:41], v[40:41], v[16:17] op_sel:[0,1] op_sel_hi:[1,1]
v_pk_mul_f32 v[42:43], v[42:43], v[16:17] op_sel:[0,1] op_sel_hi:[1,1]
v_cvt_pk_bf16_f32 v100, v40, v41
v_cvt_pk_bf16_f32 v101, v42, v43
v_accvgpr_read_b32 v44, a44
v_accvgpr_read_b32 v45, a45
v_accvgpr_read_b32 v46, a46
v_accvgpr_read_b32 v47, a47
v_pk_mul_f32 v[44:45], v[44:45], v[18:19] op_sel:[0,1] op_sel_hi:[1,1]
v_pk_mul_f32 v[46:47], v[46:47], v[18:19] op_sel:[0,1] op_sel_hi:[1,1]
v_cvt_pk_bf16_f32 v116, v44, v45
v_cvt_pk_bf16_f32 v117, v46, v47
v_accvgpr_read_b32 v48, a48
v_accvgpr_read_b32 v49, a49
v_accvgpr_read_b32 v50, a50
v_accvgpr_read_b32 v51, a51
v_pk_mul_f32 v[48:49], v[48:49], v[16:17] op_sel:[0,0] op_sel_hi:[1,0]
v_pk_mul_f32 v[50:51], v[50:51], v[16:17] op_sel:[0,0] op_sel_hi:[1,0]
v_cvt_pk_bf16_f32 v70, v48, v49
v_cvt_pk_bf16_f32 v71, v50, v51
v_accvgpr_read_b32 v52, a56
v_accvgpr_read_b32 v53, a57
v_accvgpr_read_b32 v54, a58
v_accvgpr_read_b32 v55, a59
v_pk_mul_f32 v[52:53], v[52:53], v[18:19] op_sel:[0,0] op_sel_hi:[1,0]
v_pk_mul_f32 v[54:55], v[54:55], v[18:19] op_sel:[0,0] op_sel_hi:[1,0]
v_cvt_pk_bf16_f32 v86, v52, v53
v_cvt_pk_bf16_f32 v87, v54, v55
v_accvgpr_read_b32 v56, a52
v_accvgpr_read_b32 v57, a53
v_accvgpr_read_b32 v58, a54
v_accvgpr_read_b32 v59, a55
v_pk_mul_f32 v[56:57], v[56:57], v[16:17] op_sel:[0,1] op_sel_hi:[1,1]
v_pk_mul_f32 v[58:59], v[58:59], v[16:17] op_sel:[0,1] op_sel_hi:[1,1]
v_cvt_pk_bf16_f32 v102, v56, v57
v_cvt_pk_bf16_f32 v103, v58, v59
v_accvgpr_read_b32 v60, a60
v_accvgpr_read_b32 v61, a61
v_accvgpr_read_b32 v62, a62
v_accvgpr_read_b32 v63, a63
v_pk_mul_f32 v[60:61], v[60:61], v[18:19] op_sel:[0,1] op_sel_hi:[1,1]
v_pk_mul_f32 v[62:63], v[62:63], v[18:19] op_sel:[0,1] op_sel_hi:[1,1]
v_cvt_pk_bf16_f32 v118, v60, v61
v_cvt_pk_bf16_f32 v119, v62, v63
v_accvgpr_read_b32 v32, a64
v_accvgpr_read_b32 v33, a65
v_accvgpr_read_b32 v34, a66
v_accvgpr_read_b32 v35, a67
v_pk_mul_f32 v[32:33], v[32:33], v[16:17] op_sel:[0,0] op_sel_hi:[1,0]
v_pk_mul_f32 v[34:35], v[34:35], v[16:17] op_sel:[0,0] op_sel_hi:[1,0]
v_cvt_pk_bf16_f32 v72, v32, v33
v_cvt_pk_bf16_f32 v73, v34, v35
v_accvgpr_read_b32 v36, a72
v_accvgpr_read_b32 v37, a73
v_accvgpr_read_b32 v38, a74
v_accvgpr_read_b32 v39, a75
v_pk_mul_f32 v[36:37], v[36:37], v[18:19] op_sel:[0,0] op_sel_hi:[1,0]
v_pk_mul_f32 v[38:39], v[38:39], v[18:19] op_sel:[0,0] op_sel_hi:[1,0]
v_cvt_pk_bf16_f32 v88, v36, v37
v_cvt_pk_bf16_f32 v89, v38, v39
v_accvgpr_read_b32 v40, a68
v_accvgpr_read_b32 v41, a69
v_accvgpr_read_b32 v42, a70
v_accvgpr_read_b32 v43, a71
v_pk_mul_f32 v[40:41], v[40:41], v[16:17] op_sel:[0,1] op_sel_hi:[1,1]
v_pk_mul_f32 v[42:43], v[42:43], v[16:17] op_sel:[0,1] op_sel_hi:[1,1]
v_cvt_pk_bf16_f32 v104, v40, v41
v_cvt_pk_bf16_f32 v105, v42, v43
v_accvgpr_read_b32 v44, a76
v_accvgpr_read_b32 v45, a77
v_accvgpr_read_b32 v46, a78
v_accvgpr_read_b32 v47, a79
v_pk_mul_f32 v[44:45], v[44:45], v[18:19] op_sel:[0,1] op_sel_hi:[1,1]
v_pk_mul_f32 v[46:47], v[46:47], v[18:19] op_sel:[0,1] op_sel_hi:[1,1]
v_cvt_pk_bf16_f32 v120, v44, v45
v_cvt_pk_bf16_f32 v121, v46, v47
v_accvgpr_read_b32 v48, a80
v_accvgpr_read_b32 v49, a81
v_accvgpr_read_b32 v50, a82
v_accvgpr_read_b32 v51, a83
v_pk_mul_f32 v[48:49], v[48:49], v[16:17] op_sel:[0,0] op_sel_hi:[1,0]
v_pk_mul_f32 v[50:51], v[50:51], v[16:17] op_sel:[0,0] op_sel_hi:[1,0]
v_cvt_pk_bf16_f32 v74, v48, v49
v_cvt_pk_bf16_f32 v75, v50, v51
v_accvgpr_read_b32 v52, a88
v_accvgpr_read_b32 v53, a89
v_accvgpr_read_b32 v54, a90
v_accvgpr_read_b32 v55, a91
v_pk_mul_f32 v[52:53], v[52:53], v[18:19] op_sel:[0,0] op_sel_hi:[1,0]
v_pk_mul_f32 v[54:55], v[54:55], v[18:19] op_sel:[0,0] op_sel_hi:[1,0]
v_cvt_pk_bf16_f32 v90, v52, v53
v_cvt_pk_bf16_f32 v91, v54, v55
v_accvgpr_read_b32 v56, a84
v_accvgpr_read_b32 v57, a85
v_accvgpr_read_b32 v58, a86
v_accvgpr_read_b32 v59, a87
v_pk_mul_f32 v[56:57], v[56:57], v[16:17] op_sel:[0,1] op_sel_hi:[1,1]
v_pk_mul_f32 v[58:59], v[58:59], v[16:17] op_sel:[0,1] op_sel_hi:[1,1]
v_cvt_pk_bf16_f32 v106, v56, v57
v_cvt_pk_bf16_f32 v107, v58, v59
v_accvgpr_read_b32 v60, a92
v_accvgpr_read_b32 v61, a93
v_accvgpr_read_b32 v62, a94
v_accvgpr_read_b32 v63, a95
v_pk_mul_f32 v[60:61], v[60:61], v[18:19] op_sel:[0,1] op_sel_hi:[1,1]
v_pk_mul_f32 v[62:63], v[62:63], v[18:19] op_sel:[0,1] op_sel_hi:[1,1]
v_cvt_pk_bf16_f32 v122, v60, v61
v_cvt_pk_bf16_f32 v123, v62, v63
v_accvgpr_read_b32 v32, a96
v_accvgpr_read_b32 v33, a97
v_accvgpr_read_b32 v34, a98
v_accvgpr_read_b32 v35, a99
v_pk_mul_f32 v[32:33], v[32:33], v[16:17] op_sel:[0,0] op_sel_hi:[1,0]
v_pk_mul_f32 v[34:35], v[34:35], v[16:17] op_sel:[0,0] op_sel_hi:[1,0]
v_cvt_pk_bf16_f32 v76, v32, v33
v_cvt_pk_bf16_f32 v77, v34, v35
v_accvgpr_read_b32 v36, a104
v_accvgpr_read_b32 v37, a105
v_accvgpr_read_b32 v38, a106
v_accvgpr_read_b32 v39, a107
v_pk_mul_f32 v[36:37], v[36:37], v[18:19] op_sel:[0,0] op_sel_hi:[1,0]
v_pk_mul_f32 v[38:39], v[38:39], v[18:19] op_sel:[0,0] op_sel_hi:[1,0]
v_cvt_pk_bf16_f32 v92, v36, v37
v_cvt_pk_bf16_f32 v93, v38, v39
v_accvgpr_read_b32 v40, a100
v_accvgpr_read_b32 v41, a101
v_accvgpr_read_b32 v42, a102
v_accvgpr_read_b32 v43, a103
v_pk_mul_f32 v[40:41], v[40:41], v[16:17] op_sel:[0,1] op_sel_hi:[1,1]
v_pk_mul_f32 v[42:43], v[42:43], v[16:17] op_sel:[0,1] op_sel_hi:[1,1]
v_cvt_pk_bf16_f32 v108, v40, v41
v_cvt_pk_bf16_f32 v109, v42, v43
v_accvgpr_read_b32 v44, a108
v_accvgpr_read_b32 v45, a109
v_accvgpr_read_b32 v46, a110
v_accvgpr_read_b32 v47, a111
v_pk_mul_f32 v[44:45], v[44:45], v[18:19] op_sel:[0,1] op_sel_hi:[1,1]
v_pk_mul_f32 v[46:47], v[46:47], v[18:19] op_sel:[0,1] op_sel_hi:[1,1]
v_cvt_pk_bf16_f32 v124, v44, v45
v_cvt_pk_bf16_f32 v125, v46, v47
v_accvgpr_read_b32 v48, a112
v_accvgpr_read_b32 v49, a113
v_accvgpr_read_b32 v50, a114
v_accvgpr_read_b32 v51, a115
v_pk_mul_f32 v[48:49], v[48:49], v[16:17] op_sel:[0,0] op_sel_hi:[1,0]
v_pk_mul_f32 v[50:51], v[50:51], v[16:17] op_sel:[0,0] op_sel_hi:[1,0]
v_cvt_pk_bf16_f32 v78, v48, v49
v_cvt_pk_bf16_f32 v79, v50, v51
v_accvgpr_read_b32 v52, a120
v_accvgpr_read_b32 v53, a121
v_accvgpr_read_b32 v54, a122
v_accvgpr_read_b32 v55, a123
v_pk_mul_f32 v[52:53], v[52:53], v[18:19] op_sel:[0,0] op_sel_hi:[1,0]
v_pk_mul_f32 v[54:55], v[54:55], v[18:19] op_sel:[0,0] op_sel_hi:[1,0]
v_cvt_pk_bf16_f32 v94, v52, v53
v_cvt_pk_bf16_f32 v95, v54, v55
v_accvgpr_read_b32 v56, a116
v_accvgpr_read_b32 v57, a117
v_accvgpr_read_b32 v58, a118
v_accvgpr_read_b32 v59, a119
v_pk_mul_f32 v[56:57], v[56:57], v[16:17] op_sel:[0,1] op_sel_hi:[1,1]
v_pk_mul_f32 v[58:59], v[58:59], v[16:17] op_sel:[0,1] op_sel_hi:[1,1]
v_cvt_pk_bf16_f32 v110, v56, v57
v_cvt_pk_bf16_f32 v111, v58, v59
v_accvgpr_read_b32 v60, a124
v_accvgpr_read_b32 v61, a125
v_accvgpr_read_b32 v62, a126
v_accvgpr_read_b32 v63, a127
v_pk_mul_f32 v[60:61], v[60:61], v[18:19] op_sel:[0,1] op_sel_hi:[1,1]
v_pk_mul_f32 v[62:63], v[62:63], v[18:19] op_sel:[0,1] op_sel_hi:[1,1]
v_cvt_pk_bf16_f32 v126, v60, v61
v_cvt_pk_bf16_f32 v127, v62, v63
v_mfma_f32_16x16x32_bf16 v[16:19], a[128:131], v[64:67], 0
ds_read_b64_tr_b16 a[0:1], v13 offset:0
ds_read_b64_tr_b16 a[2:3], v13 offset:2048
v_mfma_f32_16x16x32_bf16 v[16:19], a[132:135], v[68:71], v[16:19]
v_add_u32 v12, 0xfffee000, v12
v_mfma_f32_16x16x32_bf16 v[16:19], a[136:139], v[72:75], v[16:19]
ds_read_b64_tr_b16 a[4:5], v13 offset:4096
ds_read_b64_tr_b16 a[6:7], v13 offset:6144
v_mfma_f32_16x16x32_bf16 v[16:19], a[140:143], v[76:79], v[16:19]
v_lshrrev_b32 v2, 3, v0
v_mul_u32_u24 v2, 8064, v2
v_mfma_f32_16x16x32_bf16 v[16:19], a[144:147], v[80:83], v[16:19]
ds_read_b64_tr_b16 a[8:9], v13 offset:8192
ds_read_b64_tr_b16 a[10:11], v13 offset:10240
v_mfma_f32_16x16x32_bf16 v[16:19], a[148:151], v[84:87], v[16:19]
v_add_u32 v2, v2, v3
v_lshrrev_b32 v4, 2, v0
v_mfma_f32_16x16x32_bf16 v[16:19], a[152:155], v[88:91], v[16:19]
ds_read_b64_tr_b16 a[12:13], v13 offset:12288
ds_read_b64_tr_b16 a[14:15], v13 offset:14336
v_mfma_f32_16x16x32_bf16 v[16:19], a[156:159], v[92:95], v[16:19]
v_mul_u32_u24 v4, 9216, v4
v_and_b32 v5, 48, v3
v_mfma_f32_16x16x32_bf16 v[20:23], a[128:131], v[96:99], 0
ds_read_b64_tr_b16 a[16:17], v13 offset:16384
ds_read_b64_tr_b16 a[18:19], v13 offset:18432
v_mfma_f32_16x16x32_bf16 v[20:23], a[132:135], v[100:103], v[20:23]
v_add_u32 v4, v4, v5
v_cmp_gt_u32 vcc, 1, v1
v_mfma_f32_16x16x32_bf16 v[20:23], a[136:139], v[104:107], v[20:23]
ds_read_b64_tr_b16 a[20:21], v13 offset:20480
ds_read_b64_tr_b16 a[22:23], v13 offset:22528
v_mfma_f32_16x16x32_bf16 v[20:23], a[140:143], v[108:111], v[20:23]
v_mov_b32 v0, 1073741824
v_lshlrev_b32 v60, 8, v1
v_mfma_f32_16x16x32_bf16 v[20:23], a[144:147], v[112:115], v[20:23]
ds_read_b64_tr_b16 a[24:25], v13 offset:24576
ds_read_b64_tr_b16 a[26:27], v13 offset:26624
v_mfma_f32_16x16x32_bf16 v[20:23], a[148:151], v[116:119], v[20:23]
v_or_b32 v60, 4, v60
v_cndmask_b32 v0, v0, v60, vcc
v_mfma_f32_16x16x32_bf16 v[20:23], a[152:155], v[120:123], v[20:23]
s_waitcnt vmcnt(16)
ds_read_b64_tr_b16 a[28:29], v13 offset:28672
ds_read_b64_tr_b16 a[30:31], v13 offset:30720
v_mfma_f32_16x16x32_bf16 v[20:23], a[156:159], v[124:127], v[20:23]
s_waitcnt lgkmcnt(6)
buffer_store_dword v0, v0, s[24:27], s68 offen offset:3584 sc1
v_mfma_f32_16x16x32_bf16 v[24:27], a[0:3], v[64:67], 0
ds_read_b64_tr_b16 a[128:129], v14 offset:0
ds_read_b64_tr_b16 a[130:131], v14 offset:2048
v_mfma_f32_16x16x32_bf16 v[24:27], a[4:7], v[68:71], v[24:27]
v_add_u32 v13, 0xfffee000, v13
v_lshrrev_b32 v236, 2, v1
v_mfma_f32_16x16x32_bf16 v[24:27], a[8:11], v[72:75], v[24:27]
ds_read_b64_tr_b16 a[132:133], v14 offset:4096
ds_read_b64_tr_b16 a[134:135], v14 offset:6144
v_mfma_f32_16x16x32_bf16 v[24:27], a[12:15], v[76:79], v[24:27]
v_cvt_pk_bf16_f32 v128, v16, v17
v_cvt_pk_bf16_f32 v129, v18, v19
v_mfma_f32_16x16x32_bf16 v[24:27], a[16:19], v[80:83], v[24:27]
s_waitcnt lgkmcnt(4)
ds_read_b64_tr_b16 a[136:137], v14 offset:8192
ds_read_b64_tr_b16 a[138:139], v14 offset:10240
v_mfma_f32_16x16x32_bf16 v[24:27], a[20:23], v[84:87], v[24:27]
v_cvt_pk_bf16_f32 v132, v20, v21
v_cvt_pk_bf16_f32 v133, v22, v23
v_mfma_f32_16x16x32_bf16 v[24:27], a[24:27], v[88:91], v[24:27]
ds_read_b64_tr_b16 a[140:141], v14 offset:12288
ds_read_b64_tr_b16 a[142:143], v14 offset:14336
v_mfma_f32_16x16x32_bf16 v[24:27], a[28:31], v[92:95], v[24:27]
v_and_b32 v237, 1, v1
v_lshlrev_b32 v237, 4, v237
v_mfma_f32_16x16x32_bf16 v[28:31], a[0:3], v[96:99], 0
ds_read_b64_tr_b16 a[144:145], v14 offset:16384
ds_read_b64_tr_b16 a[146:147], v14 offset:18432
v_mfma_f32_16x16x32_bf16 v[28:31], a[4:7], v[100:103], v[28:31]
v_lshl_add_u32 v236, v236, 14, v237
v_and_b32 v237, 2, v1
v_mfma_f32_16x16x32_bf16 v[28:31], a[8:11], v[104:107], v[28:31]
ds_read_b64_tr_b16 a[148:149], v14 offset:20480
ds_read_b64_tr_b16 a[150:151], v14 offset:22528
v_mfma_f32_16x16x32_bf16 v[28:31], a[12:15], v[108:111], v[28:31]
v_lshl_add_u32 v236, v237, 4, v236
v_mov_b32 v238, s72
v_mfma_f32_16x16x32_bf16 v[28:31], a[16:19], v[112:115], v[28:31]
ds_read_b64_tr_b16 a[152:153], v14 offset:24576
ds_read_b64_tr_b16 a[154:155], v14 offset:26624
v_mfma_f32_16x16x32_bf16 v[28:31], a[20:23], v[116:119], v[28:31]
v_mov_b32 v239, s73
v_mfma_f32_16x16x32_bf16 v[28:31], a[24:27], v[120:123], v[28:31]
ds_read_b64_tr_b16 a[156:157], v14 offset:28672
ds_read_b64_tr_b16 a[158:159], v14 offset:30720
v_mfma_f32_16x16x32_bf16 v[28:31], a[28:31], v[124:127], v[28:31]
s_waitcnt lgkmcnt(6)
v_mfma_f32_16x16x32_bf16 v[32:35], a[128:131], v[64:67], 0
ds_read_b64_tr_b16 a[0:1], v15 offset:0
ds_read_b64_tr_b16 a[2:3], v15 offset:2048
v_mfma_f32_16x16x32_bf16 v[32:35], a[132:135], v[68:71], v[32:35]
v_add_u32 v14, 0xfffee000, v14
s_add_u32 s51, s48, 0
v_mfma_f32_16x16x32_bf16 v[32:35], a[136:139], v[72:75], v[32:35]
ds_read_b64_tr_b16 a[4:5], v15 offset:4096
ds_read_b64_tr_b16 a[6:7], v15 offset:6144
v_mfma_f32_16x16x32_bf16 v[32:35], a[140:143], v[76:79], v[32:35]
v_cvt_pk_bf16_f32 v130, v24, v25
v_cvt_pk_bf16_f32 v131, v26, v27
v_mfma_f32_16x16x32_bf16 v[32:35], a[144:147], v[80:83], v[32:35]
s_waitcnt lgkmcnt(4)
ds_read_b64_tr_b16 a[8:9], v15 offset:8192
ds_read_b64_tr_b16 a[10:11], v15 offset:10240
v_mfma_f32_16x16x32_bf16 v[32:35], a[148:151], v[84:87], v[32:35]
v_cvt_pk_bf16_f32 v134, v28, v29
v_cvt_pk_bf16_f32 v135, v30, v31
v_mfma_f32_16x16x32_bf16 v[32:35], a[152:155], v[88:91], v[32:35]
ds_read_b64_tr_b16 a[12:13], v15 offset:12288
ds_read_b64_tr_b16 a[14:15], v15 offset:14336
v_mfma_f32_16x16x32_bf16 v[32:35], a[156:159], v[92:95], v[32:35]
buffer_store_dwordx4 v[128:131], v9, s[24:27], s51 offen sc1
v_mfma_f32_16x16x32_bf16 v[36:39], a[128:131], v[96:99], 0
ds_read_b64_tr_b16 a[16:17], v15 offset:16384
ds_read_b64_tr_b16 a[18:19], v15 offset:18432
v_mfma_f32_16x16x32_bf16 v[36:39], a[132:135], v[100:103], v[36:39]
s_add_u32 s51, s49, 0
buffer_store_dwordx4 v[132:135], v9, s[24:27], s51 offen sc1
v_mfma_f32_16x16x32_bf16 v[36:39], a[136:139], v[104:107], v[36:39]
ds_read_b64_tr_b16 a[20:21], v15 offset:20480
ds_read_b64_tr_b16 a[22:23], v15 offset:22528
v_mfma_f32_16x16x32_bf16 v[36:39], a[140:143], v[108:111], v[36:39]
v_and_b32 v11, 7, v1
v_and_b32 v60, 8, v1
v_mfma_f32_16x16x32_bf16 v[36:39], a[144:147], v[112:115], v[36:39]
ds_read_b64_tr_b16 a[24:25], v15 offset:24576
ds_read_b64_tr_b16 a[26:27], v15 offset:26624
v_mfma_f32_16x16x32_bf16 v[36:39], a[148:151], v[116:119], v[36:39]
v_lshlrev_b32 v11, 2, v11
v_lshl_add_u32 v11, v60, 2, v11
v_mfma_f32_16x16x32_bf16 v[36:39], a[152:155], v[120:123], v[36:39]
ds_read_b64_tr_b16 a[28:29], v15 offset:28672
ds_read_b64_tr_b16 a[30:31], v15 offset:30720
v_mfma_f32_16x16x32_bf16 v[36:39], a[156:159], v[124:127], v[36:39]
s_waitcnt lgkmcnt(6)
v_lshrrev_b32 v60, 4, v1
v_mul_u32_u24 v56, 2359296, v60
v_mfma_f32_16x16x32_bf16 v[40:43], a[0:3], v[64:67], 0
s_waitcnt vmcnt(11)
s_barrier
ds_read_b64_tr_b16 a[128:129], v12 offset:0
ds_read_b64_tr_b16 a[130:131], v12 offset:2048
v_mfma_f32_16x16x32_bf16 v[40:43], a[4:7], v[68:71], v[40:43]
v_add_u32 v15, 0xfffee000, v15
v_and_b32 v61, 15, v1
v_mfma_f32_16x16x32_bf16 v[40:43], a[8:11], v[72:75], v[40:43]
ds_read_b64_tr_b16 a[132:133], v12 offset:4096
ds_read_b64_tr_b16 a[134:135], v12 offset:6144
v_mfma_f32_16x16x32_bf16 v[40:43], a[12:15], v[76:79], v[40:43]
v_cvt_pk_bf16_f32 v136, v32, v33
v_cvt_pk_bf16_f32 v137, v34, v35
v_mfma_f32_16x16x32_bf16 v[40:43], a[16:19], v[80:83], v[40:43]
s_waitcnt lgkmcnt(4)
ds_read_b64_tr_b16 a[136:137], v12 offset:8192
ds_read_b64_tr_b16 a[138:139], v12 offset:10240
v_mfma_f32_16x16x32_bf16 v[40:43], a[20:23], v[84:87], v[40:43]
v_cvt_pk_bf16_f32 v140, v36, v37
v_cvt_pk_bf16_f32 v141, v38, v39
v_mfma_f32_16x16x32_bf16 v[40:43], a[24:27], v[88:91], v[40:43]
ds_read_b64_tr_b16 a[140:141], v12 offset:12288
ds_read_b64_tr_b16 a[142:143], v12 offset:14336
s_add_u32 m0, s40, 0
v_mfma_f32_16x16x32_bf16 v[40:43], a[28:31], v[92:95], v[40:43]
s_mov_b32 s45, 384
buffer_load_dwordx4 v3, s[20:23], s45 offen lds
v_mfma_f32_16x16x32_bf16 v[44:47], a[0:3], v[96:99], 0
ds_read_b64_tr_b16 a[144:145], v12 offset:16384
ds_read_b64_tr_b16 a[146:147], v12 offset:18432
v_mfma_f32_16x16x32_bf16 v[44:47], a[4:7], v[100:103], v[44:47]
v_lshl_add_u32 v56, v61, 4, v56
v_and_b32 v59, 8, v1
v_mfma_f32_16x16x32_bf16 v[44:47], a[8:11], v[104:107], v[44:47]
ds_read_b64_tr_b16 a[148:149], v12 offset:20480
ds_read_b64_tr_b16 a[150:151], v12 offset:22528
s_add_u32 m0, s40, 4096
v_mfma_f32_16x16x32_bf16 v[44:47], a[12:15], v[108:111], v[44:47]
s_mov_b32 s45, 37248
buffer_load_dwordx4 v3, s[20:23], s45 offen lds
v_mfma_f32_16x16x32_bf16 v[44:47], a[16:19], v[112:115], v[44:47]
ds_read_b64_tr_b16 a[152:153], v12 offset:24576
ds_read_b64_tr_b16 a[154:155], v12 offset:26624
v_mfma_f32_16x16x32_bf16 v[44:47], a[20:23], v[116:119], v[44:47]
v_lshlrev_b32 v59, 1, v59
v_and_b32 v60, 16, v1
v_mfma_f32_16x16x32_bf16 v[44:47], a[24:27], v[120:123], v[44:47]
ds_read_b64_tr_b16 a[156:157], v12 offset:28672
ds_read_b64_tr_b16 a[158:159], v12 offset:30720
s_add_u32 m0, s40, 8192
v_mfma_f32_16x16x32_bf16 v[44:47], a[28:31], v[124:127], v[44:47]
s_waitcnt lgkmcnt(6)
s_mov_b32 s45, 74112
buffer_load_dwordx4 v3, s[20:23], s45 offen lds
v_mfma_f32_16x16x32_bf16 v[16:19], a[128:131], v[64:67], 0
ds_read_b64_tr_b16 a[0:1], v13 offset:0
ds_read_b64_tr_b16 a[2:3], v13 offset:2048
v_mfma_f32_16x16x32_bf16 v[16:19], a[132:135], v[68:71], v[16:19]
v_add_u32 v12, 0x9000, v12
v_lshl_add_u32 v59, v60, 2, v59
v_mfma_f32_16x16x32_bf16 v[16:19], a[136:139], v[72:75], v[16:19]
ds_read_b64_tr_b16 a[4:5], v13 offset:4096
ds_read_b64_tr_b16 a[6:7], v13 offset:6144
v_mfma_f32_16x16x32_bf16 v[16:19], a[140:143], v[76:79], v[16:19]
v_cvt_pk_bf16_f32 v138, v40, v41
v_cvt_pk_bf16_f32 v139, v42, v43
v_mfma_f32_16x16x32_bf16 v[16:19], a[144:147], v[80:83], v[16:19]
s_waitcnt lgkmcnt(4)
ds_read_b64_tr_b16 a[8:9], v13 offset:8192
ds_read_b64_tr_b16 a[10:11], v13 offset:10240
v_mfma_f32_16x16x32_bf16 v[16:19], a[148:151], v[84:87], v[16:19]
v_cvt_pk_bf16_f32 v142, v44, v45
v_cvt_pk_bf16_f32 v143, v46, v47
v_mfma_f32_16x16x32_bf16 v[16:19], a[152:155], v[88:91], v[16:19]
ds_read_b64_tr_b16 a[12:13], v13 offset:12288
ds_read_b64_tr_b16 a[14:15], v13 offset:14336
v_mfma_f32_16x16x32_bf16 v[16:19], a[156:159], v[92:95], v[16:19]
s_add_u32 s51, s48, 512
buffer_store_dwordx4 v[136:139], v9, s[24:27], s51 offen sc1
v_mfma_f32_16x16x32_bf16 v[20:23], a[128:131], v[96:99], 0
ds_read_b64_tr_b16 a[16:17], v13 offset:16384
ds_read_b64_tr_b16 a[18:19], v13 offset:18432
v_mfma_f32_16x16x32_bf16 v[20:23], a[132:135], v[100:103], v[20:23]
s_add_u32 s51, s49, 512
buffer_store_dwordx4 v[140:143], v9, s[24:27], s51 offen sc1
v_mfma_f32_16x16x32_bf16 v[20:23], a[136:139], v[104:107], v[20:23]
ds_read_b64_tr_b16 a[20:21], v13 offset:20480
ds_read_b64_tr_b16 a[22:23], v13 offset:22528
s_add_u32 m0, s40, 12288
v_mfma_f32_16x16x32_bf16 v[20:23], a[140:143], v[108:111], v[20:23]
s_mov_b32 s45, 110976
buffer_load_dwordx4 v3, s[20:23], s45 offen lds
v_mfma_f32_16x16x32_bf16 v[20:23], a[144:147], v[112:115], v[20:23]
ds_read_b64_tr_b16 a[24:25], v13 offset:24576
ds_read_b64_tr_b16 a[26:27], v13 offset:26624
v_mfma_f32_16x16x32_bf16 v[20:23], a[148:151], v[116:119], v[20:23]
v_and_b32 v60, 32, v1
v_lshl_add_u32 v59, v60, 3, v59
v_mfma_f32_16x16x32_bf16 v[20:23], a[152:155], v[120:123], v[20:23]
ds_read_b64_tr_b16 a[28:29], v13 offset:28672
ds_read_b64_tr_b16 a[30:31], v13 offset:30720
s_add_u32 m0, s40, 16384
v_mfma_f32_16x16x32_bf16 v[20:23], a[156:159], v[124:127], v[20:23]
s_waitcnt lgkmcnt(6)
s_mov_b32 s45, 147840
buffer_load_dwordx4 v3, s[20:23], s45 offen lds
v_mfma_f32_16x16x32_bf16 v[24:27], a[0:3], v[64:67], 0
ds_read_b64_tr_b16 a[128:129], v14 offset:0
ds_read_b64_tr_b16 a[130:131], v14 offset:2048
v_mfma_f32_16x16x32_bf16 v[24:27], a[4:7], v[68:71], v[24:27]
v_add_u32 v13, 0x9000, v13
v_and_b32 v57, 7, v1
v_mfma_f32_16x16x32_bf16 v[24:27], a[8:11], v[72:75], v[24:27]
ds_read_b64_tr_b16 a[132:133], v14 offset:4096
ds_read_b64_tr_b16 a[134:135], v14 offset:6144
v_mfma_f32_16x16x32_bf16 v[24:27], a[12:15], v[76:79], v[24:27]
v_cvt_pk_bf16_f32 v144, v16, v17
v_cvt_pk_bf16_f32 v145, v18, v19
v_mfma_f32_16x16x32_bf16 v[24:27], a[16:19], v[80:83], v[24:27]
s_waitcnt lgkmcnt(4)
ds_read_b64_tr_b16 a[136:137], v14 offset:8192
ds_read_b64_tr_b16 a[138:139], v14 offset:10240
v_mfma_f32_16x16x32_bf16 v[24:27], a[20:23], v[84:87], v[24:27]
v_cvt_pk_bf16_f32 v148, v20, v21
v_cvt_pk_bf16_f32 v149, v22, v23
v_mfma_f32_16x16x32_bf16 v[24:27], a[24:27], v[88:91], v[24:27]
ds_read_b64_tr_b16 a[140:141], v14 offset:12288
ds_read_b64_tr_b16 a[142:143], v14 offset:14336
s_add_u32 m0, s40, 20480
v_mfma_f32_16x16x32_bf16 v[24:27], a[28:31], v[92:95], v[24:27]
s_mov_b32 s45, 184704
buffer_load_dwordx4 v3, s[20:23], s45 offen lds
v_mfma_f32_16x16x32_bf16 v[28:31], a[0:3], v[96:99], 0
ds_read_b64_tr_b16 a[144:145], v14 offset:16384
ds_read_b64_tr_b16 a[146:147], v14 offset:18432
v_mfma_f32_16x16x32_bf16 v[28:31], a[4:7], v[100:103], v[28:31]
v_mul_u32_u24 v57, 1152, v57
v_lshrrev_b32 v61, 1, v59
v_mfma_f32_16x16x32_bf16 v[28:31], a[8:11], v[104:107], v[28:31]
ds_read_b64_tr_b16 a[148:149], v14 offset:20480
ds_read_b64_tr_b16 a[150:151], v14 offset:22528
s_add_u32 m0, s40, 24576
v_mfma_f32_16x16x32_bf16 v[28:31], a[12:15], v[108:111], v[28:31]
s_mov_b32 s45, 221568
buffer_load_dwordx4 v3, s[20:23], s45 offen lds
v_mfma_f32_16x16x32_bf16 v[28:31], a[16:19], v[112:115], v[28:31]
ds_read_b64_tr_b16 a[152:153], v14 offset:24576
ds_read_b64_tr_b16 a[154:155], v14 offset:26624
v_mfma_f32_16x16x32_bf16 v[28:31], a[20:23], v[116:119], v[28:31]
v_add_u32 v57, v57, v61
v_lshl_add_u32 v58, v60, 25, v57
v_mfma_f32_16x16x32_bf16 v[28:31], a[24:27], v[120:123], v[28:31]
ds_read_b64_tr_b16 a[156:157], v14 offset:28672
ds_read_b64_tr_b16 a[158:159], v14 offset:30720
s_add_u32 m0, s40, 28672
v_mfma_f32_16x16x32_bf16 v[28:31], a[28:31], v[124:127], v[28:31]
s_waitcnt lgkmcnt(6)
s_mov_b32 s45, 258432
buffer_load_dwordx4 v3, s[20:23], s45 offen lds
v_mfma_f32_16x16x32_bf16 v[32:35], a[128:131], v[64:67], 0
ds_read_b64_tr_b16 a[0:1], v15 offset:0
ds_read_b64_tr_b16 a[2:3], v15 offset:2048
v_mfma_f32_16x16x32_bf16 v[32:35], a[132:135], v[68:71], v[32:35]
v_add_u32 v14, 0x9000, v14
v_and_b32 v60, 1, v1
v_mfma_f32_16x16x32_bf16 v[32:35], a[136:139], v[72:75], v[32:35]
ds_read_b64_tr_b16 a[4:5], v15 offset:4096
ds_read_b64_tr_b16 a[6:7], v15 offset:6144
v_mfma_f32_16x16x32_bf16 v[32:35], a[140:143], v[76:79], v[32:35]
v_cvt_pk_bf16_f32 v146, v24, v25
v_cvt_pk_bf16_f32 v147, v26, v27
v_mfma_f32_16x16x32_bf16 v[32:35], a[144:147], v[80:83], v[32:35]
s_waitcnt lgkmcnt(4)
ds_read_b64_tr_b16 a[8:9], v15 offset:8192
ds_read_b64_tr_b16 a[10:11], v15 offset:10240
v_mfma_f32_16x16x32_bf16 v[32:35], a[148:151], v[84:87], v[32:35]
v_cvt_pk_bf16_f32 v150, v28, v29
v_cvt_pk_bf16_f32 v151, v30, v31
v_mfma_f32_16x16x32_bf16 v[32:35], a[152:155], v[88:91], v[32:35]
ds_read_b64_tr_b16 a[12:13], v15 offset:12288
ds_read_b64_tr_b16 a[14:15], v15 offset:14336
v_mfma_f32_16x16x32_bf16 v[32:35], a[156:159], v[92:95], v[32:35]
s_add_u32 s51, s48, 1024
buffer_store_dwordx4 v[144:147], v9, s[24:27], s51 offen sc1
v_mfma_f32_16x16x32_bf16 v[36:39], a[128:131], v[96:99], 0
ds_read_b64_tr_b16 a[16:17], v15 offset:16384
ds_read_b64_tr_b16 a[18:19], v15 offset:18432
v_mfma_f32_16x16x32_bf16 v[36:39], a[132:135], v[100:103], v[36:39]
s_add_u32 s51, s49, 1024
buffer_store_dwordx4 v[148:151], v9, s[24:27], s51 offen sc1
v_mfma_f32_16x16x32_bf16 v[36:39], a[136:139], v[104:107], v[36:39]
ds_read_b64_tr_b16 a[20:21], v15 offset:20480
ds_read_b64_tr_b16 a[22:23], v15 offset:22528
v_mfma_f32_16x16x32_bf16 v[36:39], a[140:143], v[108:111], v[36:39]
v_lshlrev_b32 v60, 4, v60
v_mov_b32 v61, 0x3f80
v_mfma_f32_16x16x32_bf16 v[36:39], a[144:147], v[112:115], v[36:39]
ds_read_b64_tr_b16 a[24:25], v15 offset:24576
ds_read_b64_tr_b16 a[26:27], v15 offset:26624
v_mfma_f32_16x16x32_bf16 v[36:39], a[148:151], v[116:119], v[36:39]
v_lshlrev_b32 v60, v60, v61
v_bfe_u32 v61, v1, 1, 3
v_mfma_f32_16x16x32_bf16 v[36:39], a[152:155], v[120:123], v[36:39]
ds_read_b64_tr_b16 a[28:29], v15 offset:28672
ds_read_b64_tr_b16 a[30:31], v15 offset:30720
v_mfma_f32_16x16x32_bf16 v[36:39], a[156:159], v[124:127], v[36:39]
s_waitcnt lgkmcnt(6)
v_cmp_eq_u32 vcc, 0, v61
s_nop 1
v_cndmask_b32 v48, 0, v60, vcc
v_mfma_f32_16x16x32_bf16 v[40:43], a[0:3], v[64:67], 0
s_waitcnt vmcnt(15)
s_barrier
ds_read_b64_tr_b16 a[128:129], v12 offset:0
ds_read_b64_tr_b16 a[130:131], v12 offset:2048
v_mfma_f32_16x16x32_bf16 v[40:43], a[4:7], v[68:71], v[40:43]
v_add_u32 v15, 0x9000, v15
v_cmp_eq_u32 vcc, 1, v61
v_mfma_f32_16x16x32_bf16 v[40:43], a[8:11], v[72:75], v[40:43]
ds_read_b64_tr_b16 a[132:133], v12 offset:4096
ds_read_b64_tr_b16 a[134:135], v12 offset:6144
v_mfma_f32_16x16x32_bf16 v[40:43], a[12:15], v[76:79], v[40:43]
v_cvt_pk_bf16_f32 v152, v32, v33
v_cvt_pk_bf16_f32 v153, v34, v35
v_mfma_f32_16x16x32_bf16 v[40:43], a[16:19], v[80:83], v[40:43]
s_waitcnt lgkmcnt(4)
ds_read_b64_tr_b16 a[136:137], v12 offset:8192
ds_read_b64_tr_b16 a[138:139], v12 offset:10240
v_mfma_f32_16x16x32_bf16 v[40:43], a[20:23], v[84:87], v[40:43]
v_cvt_pk_bf16_f32 v156, v36, v37
v_cvt_pk_bf16_f32 v157, v38, v39
v_mfma_f32_16x16x32_bf16 v[40:43], a[24:27], v[88:91], v[40:43]
ds_read_b64_tr_b16 a[140:141], v12 offset:12288
ds_read_b64_tr_b16 a[142:143], v12 offset:14336
s_add_u32 m0, s40, 110592
v_mfma_f32_16x16x32_bf16 v[40:43], a[28:31], v[92:95], v[40:43]
s_mov_b32 s45, 512
buffer_load_dwordx4 v3, s[20:23], s45 offen lds
v_mfma_f32_16x16x32_bf16 v[44:47], a[0:3], v[96:99], 0
ds_read_b64_tr_b16 a[144:145], v12 offset:16384
ds_read_b64_tr_b16 a[146:147], v12 offset:18432
v_mfma_f32_16x16x32_bf16 v[44:47], a[4:7], v[100:103], v[44:47]
v_cndmask_b32 v49, 0, v60, vcc
v_cmp_eq_u32 vcc, 2, v61
v_mfma_f32_16x16x32_bf16 v[44:47], a[8:11], v[104:107], v[44:47]
ds_read_b64_tr_b16 a[148:149], v12 offset:20480
ds_read_b64_tr_b16 a[150:151], v12 offset:22528
s_add_u32 m0, s40, 114688
v_mfma_f32_16x16x32_bf16 v[44:47], a[12:15], v[108:111], v[44:47]
s_mov_b32 s45, 37376
buffer_load_dwordx4 v3, s[20:23], s45 offen lds
v_mfma_f32_16x16x32_bf16 v[44:47], a[16:19], v[112:115], v[44:47]
ds_read_b64_tr_b16 a[152:153], v12 offset:24576
ds_read_b64_tr_b16 a[154:155], v12 offset:26624
v_mfma_f32_16x16x32_bf16 v[44:47], a[20:23], v[116:119], v[44:47]
v_cndmask_b32 v50, 0, v60, vcc
v_cmp_eq_u32 vcc, 3, v61
v_mfma_f32_16x16x32_bf16 v[44:47], a[24:27], v[120:123], v[44:47]
ds_read_b64_tr_b16 a[156:157], v12 offset:28672
ds_read_b64_tr_b16 a[158:159], v12 offset:30720
s_add_u32 m0, s40, 118784
v_mfma_f32_16x16x32_bf16 v[44:47], a[28:31], v[124:127], v[44:47]
s_waitcnt lgkmcnt(6)
s_mov_b32 s45, 74240
buffer_load_dwordx4 v3, s[20:23], s45 offen lds
v_mfma_f32_16x16x32_bf16 v[16:19], a[128:131], v[64:67], 0
ds_read_b64_tr_b16 a[0:1], v13 offset:0
ds_read_b64_tr_b16 a[2:3], v13 offset:2048
v_mfma_f32_16x16x32_bf16 v[16:19], a[132:135], v[68:71], v[16:19]
v_add_u32 v12, 0xfffee000, v12
v_cndmask_b32 v51, 0, v60, vcc
v_mfma_f32_16x16x32_bf16 v[16:19], a[136:139], v[72:75], v[16:19]
ds_read_b64_tr_b16 a[4:5], v13 offset:4096
ds_read_b64_tr_b16 a[6:7], v13 offset:6144
v_mfma_f32_16x16x32_bf16 v[16:19], a[140:143], v[76:79], v[16:19]
v_cvt_pk_bf16_f32 v154, v40, v41
v_cvt_pk_bf16_f32 v155, v42, v43
v_mfma_f32_16x16x32_bf16 v[16:19], a[144:147], v[80:83], v[16:19]
s_waitcnt lgkmcnt(4)
ds_read_b64_tr_b16 a[8:9], v13 offset:8192
ds_read_b64_tr_b16 a[10:11], v13 offset:10240
v_mfma_f32_16x16x32_bf16 v[16:19], a[148:151], v[84:87], v[16:19]
v_cvt_pk_bf16_f32 v158, v44, v45
v_cvt_pk_bf16_f32 v159, v46, v47
v_mfma_f32_16x16x32_bf16 v[16:19], a[152:155], v[88:91], v[16:19]
ds_read_b64_tr_b16 a[12:13], v13 offset:12288
ds_read_b64_tr_b16 a[14:15], v13 offset:14336
v_mfma_f32_16x16x32_bf16 v[16:19], a[156:159], v[92:95], v[16:19]
s_add_u32 s51, s48, 1536
buffer_store_dwordx4 v[152:155], v9, s[24:27], s51 offen sc1
v_mfma_f32_16x16x32_bf16 v[20:23], a[128:131], v[96:99], 0
ds_read_b64_tr_b16 a[16:17], v13 offset:16384
ds_read_b64_tr_b16 a[18:19], v13 offset:18432
v_mfma_f32_16x16x32_bf16 v[20:23], a[132:135], v[100:103], v[20:23]
s_add_u32 s51, s49, 1536
buffer_store_dwordx4 v[156:159], v9, s[24:27], s51 offen sc1
v_mfma_f32_16x16x32_bf16 v[20:23], a[136:139], v[104:107], v[20:23]
ds_read_b64_tr_b16 a[20:21], v13 offset:20480
ds_read_b64_tr_b16 a[22:23], v13 offset:22528
s_add_u32 m0, s40, 122880
v_mfma_f32_16x16x32_bf16 v[20:23], a[140:143], v[108:111], v[20:23]
s_mov_b32 s45, 111104
buffer_load_dwordx4 v3, s[20:23], s45 offen lds
v_mfma_f32_16x16x32_bf16 v[20:23], a[144:147], v[112:115], v[20:23]
ds_read_b64_tr_b16 a[24:25], v13 offset:24576
ds_read_b64_tr_b16 a[26:27], v13 offset:26624
v_mfma_f32_16x16x32_bf16 v[20:23], a[148:151], v[116:119], v[20:23]
v_cmp_eq_u32 vcc, 4, v61
s_nop 1
v_cndmask_b32 v52, 0, v60, vcc
v_mfma_f32_16x16x32_bf16 v[20:23], a[152:155], v[120:123], v[20:23]
ds_read_b64_tr_b16 a[28:29], v13 offset:28672
ds_read_b64_tr_b16 a[30:31], v13 offset:30720
s_add_u32 m0, s40, 126976
v_mfma_f32_16x16x32_bf16 v[20:23], a[156:159], v[124:127], v[20:23]
s_waitcnt lgkmcnt(6)
s_mov_b32 s45, 147968
buffer_load_dwordx4 v3, s[20:23], s45 offen lds
v_mfma_f32_16x16x32_bf16 v[24:27], a[0:3], v[64:67], 0
ds_read_b64_tr_b16 a[128:129], v14 offset:0
ds_read_b64_tr_b16 a[130:131], v14 offset:2048
v_mfma_f32_16x16x32_bf16 v[24:27], a[4:7], v[68:71], v[24:27]
v_add_u32 v13, 0xfffee000, v13
v_cmp_eq_u32 vcc, 5, v61
v_mfma_f32_16x16x32_bf16 v[24:27], a[8:11], v[72:75], v[24:27]
ds_read_b64_tr_b16 a[132:133], v14 offset:4096
ds_read_b64_tr_b16 a[134:135], v14 offset:6144
v_mfma_f32_16x16x32_bf16 v[24:27], a[12:15], v[76:79], v[24:27]
v_cvt_pk_bf16_f32 v128, v16, v17
v_cvt_pk_bf16_f32 v129, v18, v19
v_mfma_f32_16x16x32_bf16 v[24:27], a[16:19], v[80:83], v[24:27]
s_waitcnt lgkmcnt(4)
ds_read_b64_tr_b16 a[136:137], v14 offset:8192
ds_read_b64_tr_b16 a[138:139], v14 offset:10240
v_mfma_f32_16x16x32_bf16 v[24:27], a[20:23], v[84:87], v[24:27]
v_cvt_pk_bf16_f32 v132, v20, v21
v_cvt_pk_bf16_f32 v133, v22, v23
v_mfma_f32_16x16x32_bf16 v[24:27], a[24:27], v[88:91], v[24:27]
ds_read_b64_tr_b16 a[140:141], v14 offset:12288
ds_read_b64_tr_b16 a[142:143], v14 offset:14336
s_add_u32 m0, s40, 131072
v_mfma_f32_16x16x32_bf16 v[24:27], a[28:31], v[92:95], v[24:27]
s_mov_b32 s45, 184832
buffer_load_dwordx4 v3, s[20:23], s45 offen lds
v_mfma_f32_16x16x32_bf16 v[28:31], a[0:3], v[96:99], 0
ds_read_b64_tr_b16 a[144:145], v14 offset:16384
ds_read_b64_tr_b16 a[146:147], v14 offset:18432
v_mfma_f32_16x16x32_bf16 v[28:31], a[4:7], v[100:103], v[28:31]
v_cndmask_b32 v53, 0, v60, vcc
v_cmp_eq_u32 vcc, 6, v61
v_mfma_f32_16x16x32_bf16 v[28:31], a[8:11], v[104:107], v[28:31]
ds_read_b64_tr_b16 a[148:149], v14 offset:20480
ds_read_b64_tr_b16 a[150:151], v14 offset:22528
s_add_u32 m0, s40, 135168
v_mfma_f32_16x16x32_bf16 v[28:31], a[12:15], v[108:111], v[28:31]
s_mov_b32 s45, 221696
buffer_load_dwordx4 v3, s[20:23], s45 offen lds
v_mfma_f32_16x16x32_bf16 v[28:31], a[16:19], v[112:115], v[28:31]
ds_read_b64_tr_b16 a[152:153], v14 offset:24576
ds_read_b64_tr_b16 a[154:155], v14 offset:26624
v_mfma_f32_16x16x32_bf16 v[28:31], a[20:23], v[116:119], v[28:31]
v_cndmask_b32 v54, 0, v60, vcc
v_cmp_eq_u32 vcc, 7, v61
v_mfma_f32_16x16x32_bf16 v[28:31], a[24:27], v[120:123], v[28:31]
ds_read_b64_tr_b16 a[156:157], v14 offset:28672
ds_read_b64_tr_b16 a[158:159], v14 offset:30720
s_add_u32 m0, s40, 139264
v_mfma_f32_16x16x32_bf16 v[28:31], a[28:31], v[124:127], v[28:31]
s_waitcnt lgkmcnt(6)
s_mov_b32 s45, 258560
buffer_load_dwordx4 v3, s[20:23], s45 offen lds
v_mfma_f32_16x16x32_bf16 v[32:35], a[128:131], v[64:67], 0
ds_read_b64_tr_b16 a[0:1], v15 offset:0
ds_read_b64_tr_b16 a[2:3], v15 offset:2048
v_mfma_f32_16x16x32_bf16 v[32:35], a[132:135], v[68:71], v[32:35]
v_add_u32 v14, 0xfffee000, v14
v_cndmask_b32 v55, 0, v60, vcc
v_mfma_f32_16x16x32_bf16 v[32:35], a[136:139], v[72:75], v[32:35]
ds_read_b64_tr_b16 a[4:5], v15 offset:4096
ds_read_b64_tr_b16 a[6:7], v15 offset:6144
v_mfma_f32_16x16x32_bf16 v[32:35], a[140:143], v[76:79], v[32:35]
v_cvt_pk_bf16_f32 v130, v24, v25
v_cvt_pk_bf16_f32 v131, v26, v27
v_mfma_f32_16x16x32_bf16 v[32:35], a[144:147], v[80:83], v[32:35]
s_waitcnt lgkmcnt(4)
ds_read_b64_tr_b16 a[8:9], v15 offset:8192
ds_read_b64_tr_b16 a[10:11], v15 offset:10240
v_mfma_f32_16x16x32_bf16 v[32:35], a[148:151], v[84:87], v[32:35]
v_cvt_pk_bf16_f32 v134, v28, v29
v_cvt_pk_bf16_f32 v135, v30, v31
v_mfma_f32_16x16x32_bf16 v[32:35], a[152:155], v[88:91], v[32:35]
ds_read_b64_tr_b16 a[12:13], v15 offset:12288
ds_read_b64_tr_b16 a[14:15], v15 offset:14336
v_mfma_f32_16x16x32_bf16 v[32:35], a[156:159], v[92:95], v[32:35]
s_add_u32 s51, s48, 2048
buffer_store_dwordx4 v[128:131], v9, s[24:27], s51 offen sc1
v_mfma_f32_16x16x32_bf16 v[36:39], a[128:131], v[96:99], 0
ds_read_b64_tr_b16 a[16:17], v15 offset:16384
ds_read_b64_tr_b16 a[18:19], v15 offset:18432
v_mfma_f32_16x16x32_bf16 v[36:39], a[132:135], v[100:103], v[36:39]
s_add_u32 s51, s49, 2048
buffer_store_dwordx4 v[132:135], v9, s[24:27], s51 offen sc1
v_mfma_f32_16x16x32_bf16 v[36:39], a[136:139], v[104:107], v[36:39]
ds_read_b64_tr_b16 a[20:21], v15 offset:20480
ds_read_b64_tr_b16 a[22:23], v15 offset:22528
v_mfma_f32_16x16x32_bf16 v[36:39], a[140:143], v[108:111], v[36:39]
buffer_load_dwordx2 v[160:161], v57, s[56:59], s46 offen offset:0
v_mfma_f32_16x16x32_bf16 v[36:39], a[144:147], v[112:115], v[36:39]
ds_read_b64_tr_b16 a[24:25], v15 offset:24576
ds_read_b64_tr_b16 a[26:27], v15 offset:26624
v_mfma_f32_16x16x32_bf16 v[36:39], a[148:151], v[116:119], v[36:39]
buffer_load_dwordx2 v[162:163], v57, s[56:59], s46 offen offset:256
v_mfma_f32_16x16x32_bf16 v[36:39], a[152:155], v[120:123], v[36:39]
ds_read_b64_tr_b16 a[28:29], v15 offset:28672
ds_read_b64_tr_b16 a[30:31], v15 offset:30720
v_mfma_f32_16x16x32_bf16 v[36:39], a[156:159], v[124:127], v[36:39]
s_waitcnt lgkmcnt(6)
buffer_load_dwordx2 v[164:165], v57, s[56:59], s46 offen offset:512
v_mfma_f32_16x16x32_bf16 v[40:43], a[0:3], v[64:67], 0
s_waitcnt vmcnt(17)
s_barrier
ds_read_b64_tr_b16 a[128:129], v12 offset:0
ds_read_b64_tr_b16 a[130:131], v12 offset:2048
v_mfma_f32_16x16x32_bf16 v[40:43], a[4:7], v[68:71], v[40:43]
v_add_u32 v15, 0xfffee000, v15
s_add_u32 m0, s40, 36864
v_mfma_f32_16x16x32_bf16 v[40:43], a[8:11], v[72:75], v[40:43]
ds_read_b64_tr_b16 a[132:133], v12 offset:4096
ds_read_b64_tr_b16 a[134:135], v12 offset:6144
v_mfma_f32_16x16x32_bf16 v[40:43], a[12:15], v[76:79], v[40:43]
v_cvt_pk_bf16_f32 v136, v32, v33
v_cvt_pk_bf16_f32 v137, v34, v35
v_mfma_f32_16x16x32_bf16 v[40:43], a[16:19], v[80:83], v[40:43]
s_waitcnt lgkmcnt(4)
ds_read_b64_tr_b16 a[136:137], v12 offset:8192
ds_read_b64_tr_b16 a[138:139], v12 offset:10240
v_mfma_f32_16x16x32_bf16 v[40:43], a[20:23], v[84:87], v[40:43]
v_cvt_pk_bf16_f32 v140, v36, v37
v_cvt_pk_bf16_f32 v141, v38, v39
v_mfma_f32_16x16x32_bf16 v[40:43], a[24:27], v[88:91], v[40:43]
ds_read_b64_tr_b16 a[140:141], v12 offset:12288
ds_read_b64_tr_b16 a[142:143], v12 offset:14336
v_mfma_f32_16x16x32_bf16 v[40:43], a[28:31], v[92:95], v[40:43]
s_mov_b32 s45, 640
buffer_load_dwordx4 v3, s[20:23], s45 offen lds
v_mfma_f32_16x16x32_bf16 v[44:47], a[0:3], v[96:99], 0
ds_read_b64_tr_b16 a[144:145], v12 offset:16384
ds_read_b64_tr_b16 a[146:147], v12 offset:18432
v_mfma_f32_16x16x32_bf16 v[44:47], a[4:7], v[100:103], v[44:47]
buffer_load_dwordx2 v[166:167], v57, s[56:59], s46 offen offset:768
v_mfma_f32_16x16x32_bf16 v[44:47], a[8:11], v[104:107], v[44:47]
ds_read_b64_tr_b16 a[148:149], v12 offset:20480
ds_read_b64_tr_b16 a[150:151], v12 offset:22528
s_add_u32 m0, s40, 40960
v_mfma_f32_16x16x32_bf16 v[44:47], a[12:15], v[108:111], v[44:47]
s_mov_b32 s45, 37504
buffer_load_dwordx4 v3, s[20:23], s45 offen lds
v_mfma_f32_16x16x32_bf16 v[44:47], a[16:19], v[112:115], v[44:47]
ds_read_b64_tr_b16 a[152:153], v12 offset:24576
ds_read_b64_tr_b16 a[154:155], v12 offset:26624
v_mfma_f32_16x16x32_bf16 v[44:47], a[20:23], v[116:119], v[44:47]
buffer_load_dwordx2 v[168:169], v58, s[56:59], s46 offen offset:1024
v_mfma_f32_16x16x32_bf16 v[44:47], a[24:27], v[120:123], v[44:47]
ds_read_b64_tr_b16 a[156:157], v12 offset:28672
ds_read_b64_tr_b16 a[158:159], v12 offset:30720
s_add_u32 m0, s40, 45056
v_mfma_f32_16x16x32_bf16 v[44:47], a[28:31], v[124:127], v[44:47]
s_waitcnt lgkmcnt(6)
s_mov_b32 s45, 74368
buffer_load_dwordx4 v3, s[20:23], s45 offen lds
v_mfma_f32_16x16x32_bf16 v[16:19], a[128:131], v[64:67], 0
ds_read_b64_tr_b16 a[0:1], v13 offset:0
ds_read_b64_tr_b16 a[2:3], v13 offset:2048
v_mfma_f32_16x16x32_bf16 v[16:19], a[132:135], v[68:71], v[16:19]
v_add_u32 v12, 0x1b000, v12
s_add_u32 s51, s48, 2560
v_mfma_f32_16x16x32_bf16 v[16:19], a[136:139], v[72:75], v[16:19]
ds_read_b64_tr_b16 a[4:5], v13 offset:4096
ds_read_b64_tr_b16 a[6:7], v13 offset:6144
v_mfma_f32_16x16x32_bf16 v[16:19], a[140:143], v[76:79], v[16:19]
v_cvt_pk_bf16_f32 v138, v40, v41
v_cvt_pk_bf16_f32 v139, v42, v43
v_mfma_f32_16x16x32_bf16 v[16:19], a[144:147], v[80:83], v[16:19]
s_waitcnt lgkmcnt(4)
ds_read_b64_tr_b16 a[8:9], v13 offset:8192
ds_read_b64_tr_b16 a[10:11], v13 offset:10240
v_mfma_f32_16x16x32_bf16 v[16:19], a[148:151], v[84:87], v[16:19]
v_cvt_pk_bf16_f32 v142, v44, v45
v_cvt_pk_bf16_f32 v143, v46, v47
v_mfma_f32_16x16x32_bf16 v[16:19], a[152:155], v[88:91], v[16:19]
ds_read_b64_tr_b16 a[12:13], v13 offset:12288
ds_read_b64_tr_b16 a[14:15], v13 offset:14336
v_mfma_f32_16x16x32_bf16 v[16:19], a[156:159], v[92:95], v[16:19]
buffer_store_dwordx4 v[136:139], v9, s[24:27], s51 offen sc1
v_mfma_f32_16x16x32_bf16 v[20:23], a[128:131], v[96:99], 0
ds_read_b64_tr_b16 a[16:17], v13 offset:16384
ds_read_b64_tr_b16 a[18:19], v13 offset:18432
v_mfma_f32_16x16x32_bf16 v[20:23], a[132:135], v[100:103], v[20:23]
s_add_u32 s51, s49, 2560
buffer_store_dwordx4 v[140:143], v9, s[24:27], s51 offen sc1
v_mfma_f32_16x16x32_bf16 v[20:23], a[136:139], v[104:107], v[20:23]
ds_read_b64_tr_b16 a[20:21], v13 offset:20480
ds_read_b64_tr_b16 a[22:23], v13 offset:22528
s_add_u32 m0, s40, 49152
v_mfma_f32_16x16x32_bf16 v[20:23], a[140:143], v[108:111], v[20:23]
s_mov_b32 s45, 111232
buffer_load_dwordx4 v3, s[20:23], s45 offen lds
v_mfma_f32_16x16x32_bf16 v[20:23], a[144:147], v[112:115], v[20:23]
ds_read_b64_tr_b16 a[24:25], v13 offset:24576
ds_read_b64_tr_b16 a[26:27], v13 offset:26624
v_mfma_f32_16x16x32_bf16 v[20:23], a[148:151], v[116:119], v[20:23]
s_add_u32 m0, s40, 53248
s_mov_b32 s45, 148096
v_mfma_f32_16x16x32_bf16 v[20:23], a[152:155], v[120:123], v[20:23]
ds_read_b64_tr_b16 a[28:29], v13 offset:28672
ds_read_b64_tr_b16 a[30:31], v13 offset:30720
v_mfma_f32_16x16x32_bf16 v[20:23], a[156:159], v[124:127], v[20:23]
s_waitcnt lgkmcnt(6)
buffer_load_dwordx4 v3, s[20:23], s45 offen lds
v_mfma_f32_16x16x32_bf16 v[24:27], a[0:3], v[64:67], 0
ds_read_b64_tr_b16 a[128:129], v14 offset:0
ds_read_b64_tr_b16 a[130:131], v14 offset:2048
v_mfma_f32_16x16x32_bf16 v[24:27], a[4:7], v[68:71], v[24:27]
v_add_u32 v13, 0x1b000, v13
s_add_u32 m0, s40, 57344
v_mfma_f32_16x16x32_bf16 v[24:27], a[8:11], v[72:75], v[24:27]
ds_read_b64_tr_b16 a[132:133], v14 offset:4096
ds_read_b64_tr_b16 a[134:135], v14 offset:6144
v_mfma_f32_16x16x32_bf16 v[24:27], a[12:15], v[76:79], v[24:27]
v_cvt_pk_bf16_f32 v144, v16, v17
v_cvt_pk_bf16_f32 v145, v18, v19
v_mfma_f32_16x16x32_bf16 v[24:27], a[16:19], v[80:83], v[24:27]
s_waitcnt lgkmcnt(4)
ds_read_b64_tr_b16 a[136:137], v14 offset:8192
ds_read_b64_tr_b16 a[138:139], v14 offset:10240
v_mfma_f32_16x16x32_bf16 v[24:27], a[20:23], v[84:87], v[24:27]
v_cvt_pk_bf16_f32 v148, v20, v21
v_cvt_pk_bf16_f32 v149, v22, v23
v_mfma_f32_16x16x32_bf16 v[24:27], a[24:27], v[88:91], v[24:27]
ds_read_b64_tr_b16 a[140:141], v14 offset:12288
ds_read_b64_tr_b16 a[142:143], v14 offset:14336
v_mfma_f32_16x16x32_bf16 v[24:27], a[28:31], v[92:95], v[24:27]
s_mov_b32 s45, 184960
buffer_load_dwordx4 v3, s[20:23], s45 offen lds
v_mfma_f32_16x16x32_bf16 v[28:31], a[0:3], v[96:99], 0
ds_read_b64_tr_b16 a[144:145], v14 offset:16384
ds_read_b64_tr_b16 a[146:147], v14 offset:18432
v_mfma_f32_16x16x32_bf16 v[28:31], a[4:7], v[100:103], v[28:31]
s_add_u32 m0, s40, 61440
s_mov_b32 s45, 221824
v_mfma_f32_16x16x32_bf16 v[28:31], a[8:11], v[104:107], v[28:31]
ds_read_b64_tr_b16 a[148:149], v14 offset:20480
ds_read_b64_tr_b16 a[150:151], v14 offset:22528
v_mfma_f32_16x16x32_bf16 v[28:31], a[12:15], v[108:111], v[28:31]
buffer_load_dwordx4 v3, s[20:23], s45 offen lds
v_mfma_f32_16x16x32_bf16 v[28:31], a[16:19], v[112:115], v[28:31]
ds_read_b64_tr_b16 a[152:153], v14 offset:24576
ds_read_b64_tr_b16 a[154:155], v14 offset:26624
v_mfma_f32_16x16x32_bf16 v[28:31], a[20:23], v[116:119], v[28:31]
s_add_u32 m0, s40, 65536
s_mov_b32 s45, 258688
v_mfma_f32_16x16x32_bf16 v[28:31], a[24:27], v[120:123], v[28:31]
ds_read_b64_tr_b16 a[156:157], v14 offset:28672
ds_read_b64_tr_b16 a[158:159], v14 offset:30720
v_mfma_f32_16x16x32_bf16 v[28:31], a[28:31], v[124:127], v[28:31]
s_waitcnt lgkmcnt(6)
buffer_load_dwordx4 v3, s[20:23], s45 offen lds
v_mfma_f32_16x16x32_bf16 v[32:35], a[128:131], v[64:67], 0
ds_read_b64_tr_b16 a[0:1], v15 offset:0
ds_read_b64_tr_b16 a[2:3], v15 offset:2048
v_mfma_f32_16x16x32_bf16 v[32:35], a[132:135], v[68:71], v[32:35]
v_add_u32 v14, 0x1b000, v14
s_add_u32 s51, s48, 3072
v_mfma_f32_16x16x32_bf16 v[32:35], a[136:139], v[72:75], v[32:35]
ds_read_b64_tr_b16 a[4:5], v15 offset:4096
ds_read_b64_tr_b16 a[6:7], v15 offset:6144
v_mfma_f32_16x16x32_bf16 v[32:35], a[140:143], v[76:79], v[32:35]
v_cvt_pk_bf16_f32 v146, v24, v25
v_cvt_pk_bf16_f32 v147, v26, v27
v_mfma_f32_16x16x32_bf16 v[32:35], a[144:147], v[80:83], v[32:35]
s_waitcnt lgkmcnt(4)
ds_read_b64_tr_b16 a[8:9], v15 offset:8192
ds_read_b64_tr_b16 a[10:11], v15 offset:10240
v_mfma_f32_16x16x32_bf16 v[32:35], a[148:151], v[84:87], v[32:35]
v_cvt_pk_bf16_f32 v150, v28, v29
v_cvt_pk_bf16_f32 v151, v30, v31
v_mfma_f32_16x16x32_bf16 v[32:35], a[152:155], v[88:91], v[32:35]
ds_read_b64_tr_b16 a[12:13], v15 offset:12288
ds_read_b64_tr_b16 a[14:15], v15 offset:14336
v_mfma_f32_16x16x32_bf16 v[32:35], a[156:159], v[92:95], v[32:35]
buffer_store_dwordx4 v[144:147], v9, s[24:27], s51 offen sc1
v_mfma_f32_16x16x32_bf16 v[36:39], a[128:131], v[96:99], 0
ds_read_b64_tr_b16 a[16:17], v15 offset:16384
ds_read_b64_tr_b16 a[18:19], v15 offset:18432
v_mfma_f32_16x16x32_bf16 v[36:39], a[132:135], v[100:103], v[36:39]
s_add_u32 s51, s49, 3072
buffer_store_dwordx4 v[148:151], v9, s[24:27], s51 offen sc1
v_mfma_f32_16x16x32_bf16 v[36:39], a[136:139], v[104:107], v[36:39]
ds_read_b64_tr_b16 a[20:21], v15 offset:20480
ds_read_b64_tr_b16 a[22:23], v15 offset:22528
v_mfma_f32_16x16x32_bf16 v[36:39], a[140:143], v[108:111], v[36:39]
v_mfma_f32_16x16x32_bf16 v[36:39], a[144:147], v[112:115], v[36:39]
ds_read_b64_tr_b16 a[24:25], v15 offset:24576
ds_read_b64_tr_b16 a[26:27], v15 offset:26624
v_mfma_f32_16x16x32_bf16 v[36:39], a[148:151], v[116:119], v[36:39]
v_mfma_f32_16x16x32_bf16 v[36:39], a[152:155], v[120:123], v[36:39]
ds_read_b64_tr_b16 a[28:29], v15 offset:28672
ds_read_b64_tr_b16 a[30:31], v15 offset:30720
v_mfma_f32_16x16x32_bf16 v[36:39], a[156:159], v[124:127], v[36:39]
s_waitcnt lgkmcnt(6)
s_mov_b32 s45, 768
v_mfma_f32_16x16x32_bf16 v[40:43], a[0:3], v[64:67], 0
s_waitcnt vmcnt(19)
s_barrier
ds_read_b64_tr_b16 a[128:129], v12 offset:0
ds_read_b64_tr_b16 a[130:131], v12 offset:2048
v_mfma_f32_16x16x32_bf16 v[40:43], a[4:7], v[68:71], v[40:43]
v_add_u32 v15, 0x1b000, v15
s_add_u32 m0, s40, 73728
v_mfma_f32_16x16x32_bf16 v[40:43], a[8:11], v[72:75], v[40:43]
ds_read_b64_tr_b16 a[132:133], v12 offset:4096
ds_read_b64_tr_b16 a[134:135], v12 offset:6144
v_mfma_f32_16x16x32_bf16 v[40:43], a[12:15], v[76:79], v[40:43]
v_cvt_pk_bf16_f32 v152, v32, v33
v_cvt_pk_bf16_f32 v153, v34, v35
v_mfma_f32_16x16x32_bf16 v[40:43], a[16:19], v[80:83], v[40:43]
s_waitcnt lgkmcnt(4)
ds_read_b64_tr_b16 a[136:137], v12 offset:8192
ds_read_b64_tr_b16 a[138:139], v12 offset:10240
v_mfma_f32_16x16x32_bf16 v[40:43], a[20:23], v[84:87], v[40:43]
v_cvt_pk_bf16_f32 v156, v36, v37
v_cvt_pk_bf16_f32 v157, v38, v39
v_mfma_f32_16x16x32_bf16 v[40:43], a[24:27], v[88:91], v[40:43]
ds_read_b64_tr_b16 a[140:141], v12 offset:12288
ds_read_b64_tr_b16 a[142:143], v12 offset:14336
v_mfma_f32_16x16x32_bf16 v[40:43], a[28:31], v[92:95], v[40:43]
buffer_load_dwordx4 v3, s[20:23], s45 offen lds
v_mfma_f32_16x16x32_bf16 v[44:47], a[0:3], v[96:99], 0
ds_read_b64_tr_b16 a[144:145], v12 offset:16384
ds_read_b64_tr_b16 a[146:147], v12 offset:18432
v_mfma_f32_16x16x32_bf16 v[44:47], a[4:7], v[100:103], v[44:47]
buffer_store_dword v0, v0, s[24:27], s55 offen offset:0 sc1
v_mfma_f32_16x16x32_bf16 v[44:47], a[8:11], v[104:107], v[44:47]
ds_read_b64_tr_b16 a[148:149], v12 offset:20480
ds_read_b64_tr_b16 a[150:151], v12 offset:22528
s_add_u32 m0, s40, 77824
v_mfma_f32_16x16x32_bf16 v[44:47], a[12:15], v[108:111], v[44:47]
s_mov_b32 s45, 37632
buffer_load_dwordx4 v3, s[20:23], s45 offen lds
v_mfma_f32_16x16x32_bf16 v[44:47], a[16:19], v[112:115], v[44:47]
ds_read_b64_tr_b16 a[152:153], v12 offset:24576
ds_read_b64_tr_b16 a[154:155], v12 offset:26624
v_mfma_f32_16x16x32_bf16 v[44:47], a[20:23], v[116:119], v[44:47]
s_add_u32 m0, s40, 81920
s_mov_b32 s45, 74496
v_mfma_f32_16x16x32_bf16 v[44:47], a[24:27], v[120:123], v[44:47]
ds_read_b64_tr_b16 a[156:157], v12 offset:28672
ds_read_b64_tr_b16 a[158:159], v12 offset:30720
v_mfma_f32_16x16x32_bf16 v[44:47], a[28:31], v[124:127], v[44:47]
s_waitcnt lgkmcnt(6)
buffer_load_dwordx4 v3, s[20:23], s45 offen lds
v_mfma_f32_16x16x32_bf16 v[16:19], a[128:131], v[64:67], 0
ds_read_b64_tr_b16 a[0:1], v13 offset:0
ds_read_b64_tr_b16 a[2:3], v13 offset:2048
v_mfma_f32_16x16x32_bf16 v[16:19], a[132:135], v[68:71], v[16:19]
v_add_u32 v12, 0xfffee000, v12
s_add_u32 s51, s48, 3584
v_mfma_f32_16x16x32_bf16 v[16:19], a[136:139], v[72:75], v[16:19]
ds_read_b64_tr_b16 a[4:5], v13 offset:4096
ds_read_b64_tr_b16 a[6:7], v13 offset:6144
v_mfma_f32_16x16x32_bf16 v[16:19], a[140:143], v[76:79], v[16:19]
v_cvt_pk_bf16_f32 v154, v40, v41
v_cvt_pk_bf16_f32 v155, v42, v43
v_mfma_f32_16x16x32_bf16 v[16:19], a[144:147], v[80:83], v[16:19]
s_waitcnt lgkmcnt(4)
ds_read_b64_tr_b16 a[8:9], v13 offset:8192
ds_read_b64_tr_b16 a[10:11], v13 offset:10240
v_mfma_f32_16x16x32_bf16 v[16:19], a[148:151], v[84:87], v[16:19]
v_cvt_pk_bf16_f32 v158, v44, v45
v_cvt_pk_bf16_f32 v159, v46, v47
v_mfma_f32_16x16x32_bf16 v[16:19], a[152:155], v[88:91], v[16:19]
ds_read_b64_tr_b16 a[12:13], v13 offset:12288
ds_read_b64_tr_b16 a[14:15], v13 offset:14336
v_mfma_f32_16x16x32_bf16 v[16:19], a[156:159], v[92:95], v[16:19]
buffer_store_dwordx4 v[152:155], v9, s[24:27], s51 offen sc1
v_mfma_f32_16x16x32_bf16 v[20:23], a[128:131], v[96:99], 0
ds_read_b64_tr_b16 a[16:17], v13 offset:16384
ds_read_b64_tr_b16 a[18:19], v13 offset:18432
v_mfma_f32_16x16x32_bf16 v[20:23], a[132:135], v[100:103], v[20:23]
s_add_u32 s51, s49, 3584
buffer_store_dwordx4 v[156:159], v9, s[24:27], s51 offen sc1
v_mfma_f32_16x16x32_bf16 v[20:23], a[136:139], v[104:107], v[20:23]
ds_read_b64_tr_b16 a[20:21], v13 offset:20480
ds_read_b64_tr_b16 a[22:23], v13 offset:22528
s_add_u32 m0, s40, 86016
v_mfma_f32_16x16x32_bf16 v[20:23], a[140:143], v[108:111], v[20:23]
s_mov_b32 s45, 111360
buffer_load_dwordx4 v3, s[20:23], s45 offen lds
v_mfma_f32_16x16x32_bf16 v[20:23], a[144:147], v[112:115], v[20:23]
ds_read_b64_tr_b16 a[24:25], v13 offset:24576
ds_read_b64_tr_b16 a[26:27], v13 offset:26624
v_mfma_f32_16x16x32_bf16 v[20:23], a[148:151], v[116:119], v[20:23]
s_add_u32 m0, s40, 90112
s_mov_b32 s45, 148224
v_mfma_f32_16x16x32_bf16 v[20:23], a[152:155], v[120:123], v[20:23]
ds_read_b64_tr_b16 a[28:29], v13 offset:28672
ds_read_b64_tr_b16 a[30:31], v13 offset:30720
v_mfma_f32_16x16x32_bf16 v[20:23], a[156:159], v[124:127], v[20:23]
s_waitcnt lgkmcnt(6)
buffer_load_dwordx4 v3, s[20:23], s45 offen lds
v_mfma_f32_16x16x32_bf16 v[24:27], a[0:3], v[64:67], 0
ds_read_b64_tr_b16 a[128:129], v14 offset:0
ds_read_b64_tr_b16 a[130:131], v14 offset:2048
v_mfma_f32_16x16x32_bf16 v[24:27], a[4:7], v[68:71], v[24:27]
v_add_u32 v13, 0xfffee000, v13
s_add_u32 m0, s40, 94208
v_mfma_f32_16x16x32_bf16 v[24:27], a[8:11], v[72:75], v[24:27]
ds_read_b64_tr_b16 a[132:133], v14 offset:4096
ds_read_b64_tr_b16 a[134:135], v14 offset:6144
v_mfma_f32_16x16x32_bf16 v[24:27], a[12:15], v[76:79], v[24:27]
v_cvt_pk_bf16_f32 v128, v16, v17
v_cvt_pk_bf16_f32 v129, v18, v19
v_mfma_f32_16x16x32_bf16 v[24:27], a[16:19], v[80:83], v[24:27]
s_waitcnt lgkmcnt(4)
ds_read_b64_tr_b16 a[136:137], v14 offset:8192
ds_read_b64_tr_b16 a[138:139], v14 offset:10240
v_mfma_f32_16x16x32_bf16 v[24:27], a[20:23], v[84:87], v[24:27]
v_cvt_pk_bf16_f32 v132, v20, v21
v_cvt_pk_bf16_f32 v133, v22, v23
v_mfma_f32_16x16x32_bf16 v[24:27], a[24:27], v[88:91], v[24:27]
ds_read_b64_tr_b16 a[140:141], v14 offset:12288
ds_read_b64_tr_b16 a[142:143], v14 offset:14336
v_mfma_f32_16x16x32_bf16 v[24:27], a[28:31], v[92:95], v[24:27]
s_mov_b32 s45, 185088
buffer_load_dwordx4 v3, s[20:23], s45 offen lds
v_mfma_f32_16x16x32_bf16 v[28:31], a[0:3], v[96:99], 0
ds_read_b64_tr_b16 a[144:145], v14 offset:16384
ds_read_b64_tr_b16 a[146:147], v14 offset:18432
v_mfma_f32_16x16x32_bf16 v[28:31], a[4:7], v[100:103], v[28:31]
buffer_load_dwordx4 v[232:235], v236, s[24:27], s70 offen offset:3584 sc1
v_mfma_f32_16x16x32_bf16 v[28:31], a[8:11], v[104:107], v[28:31]
ds_read_b64_tr_b16 a[148:149], v14 offset:20480
ds_read_b64_tr_b16 a[150:151], v14 offset:22528
s_add_u32 m0, s40, 98304
v_mfma_f32_16x16x32_bf16 v[28:31], a[12:15], v[108:111], v[28:31]
s_mov_b32 s45, 221952
buffer_load_dwordx4 v3, s[20:23], s45 offen lds
v_mfma_f32_16x16x32_bf16 v[28:31], a[16:19], v[112:115], v[28:31]
ds_read_b64_tr_b16 a[152:153], v14 offset:24576
ds_read_b64_tr_b16 a[154:155], v14 offset:26624
v_mfma_f32_16x16x32_bf16 v[28:31], a[20:23], v[116:119], v[28:31]
s_add_u32 m0, s40, 102400
s_mov_b32 s45, 258816
v_mfma_f32_16x16x32_bf16 v[28:31], a[24:27], v[120:123], v[28:31]
ds_read_b64_tr_b16 a[156:157], v14 offset:28672
ds_read_b64_tr_b16 a[158:159], v14 offset:30720
v_mfma_f32_16x16x32_bf16 v[28:31], a[28:31], v[124:127], v[28:31]
s_waitcnt lgkmcnt(6)
buffer_load_dwordx4 v3, s[20:23], s45 offen lds
v_mfma_f32_16x16x32_bf16 v[32:35], a[128:131], v[64:67], 0
ds_read_b64_tr_b16 a[0:1], v15 offset:0
ds_read_b64_tr_b16 a[2:3], v15 offset:2048
v_mfma_f32_16x16x32_bf16 v[32:35], a[132:135], v[68:71], v[32:35]
v_add_u32 v14, 0xfffee000, v14
s_add_u32 s51, s48, 4096
v_mfma_f32_16x16x32_bf16 v[32:35], a[136:139], v[72:75], v[32:35]
ds_read_b64_tr_b16 a[4:5], v15 offset:4096
ds_read_b64_tr_b16 a[6:7], v15 offset:6144
v_mfma_f32_16x16x32_bf16 v[32:35], a[140:143], v[76:79], v[32:35]
v_cvt_pk_bf16_f32 v130, v24, v25
v_cvt_pk_bf16_f32 v131, v26, v27
v_mfma_f32_16x16x32_bf16 v[32:35], a[144:147], v[80:83], v[32:35]
s_waitcnt lgkmcnt(4)
ds_read_b64_tr_b16 a[8:9], v15 offset:8192
ds_read_b64_tr_b16 a[10:11], v15 offset:10240
v_mfma_f32_16x16x32_bf16 v[32:35], a[148:151], v[84:87], v[32:35]
v_cvt_pk_bf16_f32 v134, v28, v29
v_cvt_pk_bf16_f32 v135, v30, v31
v_mfma_f32_16x16x32_bf16 v[32:35], a[152:155], v[88:91], v[32:35]
ds_read_b64_tr_b16 a[12:13], v15 offset:12288
ds_read_b64_tr_b16 a[14:15], v15 offset:14336
v_mfma_f32_16x16x32_bf16 v[32:35], a[156:159], v[92:95], v[32:35]
buffer_store_dwordx4 v[128:131], v9, s[24:27], s51 offen sc1
v_mfma_f32_16x16x32_bf16 v[36:39], a[128:131], v[96:99], 0
ds_read_b64_tr_b16 a[16:17], v15 offset:16384
ds_read_b64_tr_b16 a[18:19], v15 offset:18432
v_mfma_f32_16x16x32_bf16 v[36:39], a[132:135], v[100:103], v[36:39]
s_add_u32 s51, s49, 4096
buffer_store_dwordx4 v[132:135], v9, s[24:27], s51 offen sc1
v_mfma_f32_16x16x32_bf16 v[36:39], a[136:139], v[104:107], v[36:39]
ds_read_b64_tr_b16 a[20:21], v15 offset:20480
ds_read_b64_tr_b16 a[22:23], v15 offset:22528
v_mfma_f32_16x16x32_bf16 v[36:39], a[140:143], v[108:111], v[36:39]
v_mfma_f32_16x16x32_bf16 v[36:39], a[144:147], v[112:115], v[36:39]
ds_read_b64_tr_b16 a[24:25], v15 offset:24576
ds_read_b64_tr_b16 a[26:27], v15 offset:26624
v_mfma_f32_16x16x32_bf16 v[36:39], a[148:151], v[116:119], v[36:39]
v_mfma_f32_16x16x32_bf16 v[36:39], a[152:155], v[120:123], v[36:39]
ds_read_b64_tr_b16 a[28:29], v15 offset:28672
ds_read_b64_tr_b16 a[30:31], v15 offset:30720
v_mfma_f32_16x16x32_bf16 v[36:39], a[156:159], v[124:127], v[36:39]
s_waitcnt lgkmcnt(6)
s_mov_b32 s45, 896
v_mfma_f32_16x16x32_bf16 v[40:43], a[0:3], v[64:67], 0
s_waitcnt vmcnt(16)
s_barrier
ds_read_b64_tr_b16 a[128:129], v12 offset:0
ds_read_b64_tr_b16 a[130:131], v12 offset:2048
v_mfma_f32_16x16x32_bf16 v[40:43], a[4:7], v[68:71], v[40:43]
v_add_u32 v15, 0xfffee000, v15
s_add_u32 m0, s40, 0
v_mfma_f32_16x16x32_bf16 v[40:43], a[8:11], v[72:75], v[40:43]
ds_read_b64_tr_b16 a[132:133], v12 offset:4096
ds_read_b64_tr_b16 a[134:135], v12 offset:6144
v_mfma_f32_16x16x32_bf16 v[40:43], a[12:15], v[76:79], v[40:43]
v_cvt_pk_bf16_f32 v136, v32, v33
v_cvt_pk_bf16_f32 v137, v34, v35
v_mfma_f32_16x16x32_bf16 v[40:43], a[16:19], v[80:83], v[40:43]
s_waitcnt lgkmcnt(4)
ds_read_b64_tr_b16 a[136:137], v12 offset:8192
ds_read_b64_tr_b16 a[138:139], v12 offset:10240
v_mfma_f32_16x16x32_bf16 v[40:43], a[20:23], v[84:87], v[40:43]
v_cvt_pk_bf16_f32 v140, v36, v37
v_cvt_pk_bf16_f32 v141, v38, v39
v_mfma_f32_16x16x32_bf16 v[40:43], a[24:27], v[88:91], v[40:43]
ds_read_b64_tr_b16 a[140:141], v12 offset:12288
ds_read_b64_tr_b16 a[142:143], v12 offset:14336
v_mfma_f32_16x16x32_bf16 v[40:43], a[28:31], v[92:95], v[40:43]
buffer_load_dwordx4 v3, s[20:23], s45 offen lds
v_mfma_f32_16x16x32_bf16 v[44:47], a[0:3], v[96:99], 0
ds_read_b64_tr_b16 a[144:145], v12 offset:16384
ds_read_b64_tr_b16 a[146:147], v12 offset:18432
v_mfma_f32_16x16x32_bf16 v[44:47], a[4:7], v[100:103], v[44:47]
s_add_u32 m0, s40, 4096
s_mov_b32 s45, 37760
v_mfma_f32_16x16x32_bf16 v[44:47], a[8:11], v[104:107], v[44:47]
ds_read_b64_tr_b16 a[148:149], v12 offset:20480
ds_read_b64_tr_b16 a[150:151], v12 offset:22528
v_mfma_f32_16x16x32_bf16 v[44:47], a[12:15], v[108:111], v[44:47]
buffer_load_dwordx4 v3, s[20:23], s45 offen lds
v_mfma_f32_16x16x32_bf16 v[44:47], a[16:19], v[112:115], v[44:47]
ds_read_b64_tr_b16 a[152:153], v12 offset:24576
ds_read_b64_tr_b16 a[154:155], v12 offset:26624
v_mfma_f32_16x16x32_bf16 v[44:47], a[20:23], v[116:119], v[44:47]
s_add_u32 m0, s40, 8192
s_mov_b32 s45, 74624
v_mfma_f32_16x16x32_bf16 v[44:47], a[24:27], v[120:123], v[44:47]
ds_read_b64_tr_b16 a[156:157], v12 offset:28672
ds_read_b64_tr_b16 a[158:159], v12 offset:30720
v_mfma_f32_16x16x32_bf16 v[44:47], a[28:31], v[124:127], v[44:47]
s_waitcnt lgkmcnt(6)
buffer_load_dwordx4 v3, s[20:23], s45 offen lds
v_mfma_f32_16x16x32_bf16 v[16:19], a[128:131], v[64:67], 0
ds_read_b64_tr_b16 a[0:1], v13 offset:0
ds_read_b64_tr_b16 a[2:3], v13 offset:2048
v_mfma_f32_16x16x32_bf16 v[16:19], a[132:135], v[68:71], v[16:19]
v_add_u32 v12, 0x9000, v12
s_add_u32 s51, s48, 4608
v_mfma_f32_16x16x32_bf16 v[16:19], a[136:139], v[72:75], v[16:19]
ds_read_b64_tr_b16 a[4:5], v13 offset:4096
ds_read_b64_tr_b16 a[6:7], v13 offset:6144
v_mfma_f32_16x16x32_bf16 v[16:19], a[140:143], v[76:79], v[16:19]
v_cvt_pk_bf16_f32 v138, v40, v41
v_cvt_pk_bf16_f32 v139, v42, v43
v_mfma_f32_16x16x32_bf16 v[16:19], a[144:147], v[80:83], v[16:19]
s_waitcnt lgkmcnt(4)
ds_read_b64_tr_b16 a[8:9], v13 offset:8192
ds_read_b64_tr_b16 a[10:11], v13 offset:10240
v_mfma_f32_16x16x32_bf16 v[16:19], a[148:151], v[84:87], v[16:19]
v_cvt_pk_bf16_f32 v142, v44, v45
v_cvt_pk_bf16_f32 v143, v46, v47
v_mfma_f32_16x16x32_bf16 v[16:19], a[152:155], v[88:91], v[16:19]
ds_read_b64_tr_b16 a[12:13], v13 offset:12288
ds_read_b64_tr_b16 a[14:15], v13 offset:14336
v_mfma_f32_16x16x32_bf16 v[16:19], a[156:159], v[92:95], v[16:19]
buffer_store_dwordx4 v[136:139], v9, s[24:27], s51 offen sc1
v_mfma_f32_16x16x32_bf16 v[20:23], a[128:131], v[96:99], 0
ds_read_b64_tr_b16 a[16:17], v13 offset:16384
ds_read_b64_tr_b16 a[18:19], v13 offset:18432
v_mfma_f32_16x16x32_bf16 v[20:23], a[132:135], v[100:103], v[20:23]
s_add_u32 s51, s49, 4608
buffer_store_dwordx4 v[140:143], v9, s[24:27], s51 offen sc1
v_mfma_f32_16x16x32_bf16 v[20:23], a[136:139], v[104:107], v[20:23]
ds_read_b64_tr_b16 a[20:21], v13 offset:20480
ds_read_b64_tr_b16 a[22:23], v13 offset:22528
s_add_u32 m0, s40, 12288
v_mfma_f32_16x16x32_bf16 v[20:23], a[140:143], v[108:111], v[20:23]
s_mov_b32 s45, 111488
buffer_load_dwordx4 v3, s[20:23], s45 offen lds
v_mfma_f32_16x16x32_bf16 v[20:23], a[144:147], v[112:115], v[20:23]
ds_read_b64_tr_b16 a[24:25], v13 offset:24576
ds_read_b64_tr_b16 a[26:27], v13 offset:26624
v_mfma_f32_16x16x32_bf16 v[20:23], a[148:151], v[116:119], v[20:23]
s_add_u32 m0, s40, 16384
s_mov_b32 s45, 148352
v_mfma_f32_16x16x32_bf16 v[20:23], a[152:155], v[120:123], v[20:23]
ds_read_b64_tr_b16 a[28:29], v13 offset:28672
ds_read_b64_tr_b16 a[30:31], v13 offset:30720
v_mfma_f32_16x16x32_bf16 v[20:23], a[156:159], v[124:127], v[20:23]
s_waitcnt lgkmcnt(6)
buffer_load_dwordx4 v3, s[20:23], s45 offen lds
v_mfma_f32_16x16x32_bf16 v[24:27], a[0:3], v[64:67], 0
ds_read_b64_tr_b16 a[128:129], v14 offset:0
ds_read_b64_tr_b16 a[130:131], v14 offset:2048
v_mfma_f32_16x16x32_bf16 v[24:27], a[4:7], v[68:71], v[24:27]
s_waitcnt vmcnt(11)
v_add_u32 v13, 0x9000, v13
v_and_b32 v232, v232, v233
v_mfma_f32_16x16x32_bf16 v[24:27], a[8:11], v[72:75], v[24:27]
ds_read_b64_tr_b16 a[132:133], v14 offset:4096
ds_read_b64_tr_b16 a[134:135], v14 offset:6144
v_mfma_f32_16x16x32_bf16 v[24:27], a[12:15], v[76:79], v[24:27]
v_cvt_pk_bf16_f32 v144, v16, v17
v_cvt_pk_bf16_f32 v145, v18, v19
v_mfma_f32_16x16x32_bf16 v[24:27], a[16:19], v[80:83], v[24:27]
s_waitcnt lgkmcnt(4)
ds_read_b64_tr_b16 a[136:137], v14 offset:8192
ds_read_b64_tr_b16 a[138:139], v14 offset:10240
v_mfma_f32_16x16x32_bf16 v[24:27], a[20:23], v[84:87], v[24:27]
v_cvt_pk_bf16_f32 v148, v20, v21
v_cvt_pk_bf16_f32 v149, v22, v23
v_mfma_f32_16x16x32_bf16 v[24:27], a[24:27], v[88:91], v[24:27]
ds_read_b64_tr_b16 a[140:141], v14 offset:12288
ds_read_b64_tr_b16 a[142:143], v14 offset:14336
s_add_u32 m0, s40, 20480
v_mfma_f32_16x16x32_bf16 v[24:27], a[28:31], v[92:95], v[24:27]
s_mov_b32 s45, 185216
buffer_load_dwordx4 v3, s[20:23], s45 offen lds
v_mfma_f32_16x16x32_bf16 v[28:31], a[0:3], v[96:99], 0
ds_read_b64_tr_b16 a[144:145], v14 offset:16384
ds_read_b64_tr_b16 a[146:147], v14 offset:18432
v_mfma_f32_16x16x32_bf16 v[28:31], a[4:7], v[100:103], v[28:31]
v_and_b32 v234, v234, v235
v_and_b32 v232, v232, v234
v_mfma_f32_16x16x32_bf16 v[28:31], a[8:11], v[104:107], v[28:31]
ds_read_b64_tr_b16 a[148:149], v14 offset:20480
ds_read_b64_tr_b16 a[150:151], v14 offset:22528
s_add_u32 m0, s40, 24576
v_mfma_f32_16x16x32_bf16 v[28:31], a[12:15], v[108:111], v[28:31]
s_mov_b32 s45, 222080
buffer_load_dwordx4 v3, s[20:23], s45 offen lds
v_mfma_f32_16x16x32_bf16 v[28:31], a[16:19], v[112:115], v[28:31]
ds_read_b64_tr_b16 a[152:153], v14 offset:24576
ds_read_b64_tr_b16 a[154:155], v14 offset:26624
v_mfma_f32_16x16x32_bf16 v[28:31], a[20:23], v[116:119], v[28:31]
v_cmp_eq_u32 s[66:67], 0, v232
s_add_u32 m0, s40, 28672
v_mfma_f32_16x16x32_bf16 v[28:31], a[24:27], v[120:123], v[28:31]
ds_read_b64_tr_b16 a[156:157], v14 offset:28672
ds_read_b64_tr_b16 a[158:159], v14 offset:30720
v_mfma_f32_16x16x32_bf16 v[28:31], a[28:31], v[124:127], v[28:31]
s_waitcnt lgkmcnt(6)
s_mov_b32 s45, 258944
buffer_load_dwordx4 v3, s[20:23], s45 offen lds
v_mfma_f32_16x16x32_bf16 v[32:35], a[128:131], v[64:67], 0
s_cmp_lg_u64 s[66:67], 0
s_cbranch_scc1 K1_rdy0
K1_rdy1:
ds_read_b64_tr_b16 a[0:1], v15 offset:0
ds_read_b64_tr_b16 a[2:3], v15 offset:2048
v_mfma_f32_16x16x32_bf16 v[32:35], a[132:135], v[68:71], v[32:35]
v_add_u32 v14, 0x9000, v14
s_add_u32 s51, s48, 5120
v_mfma_f32_16x16x32_bf16 v[32:35], a[136:139], v[72:75], v[32:35]
ds_read_b64_tr_b16 a[4:5], v15 offset:4096
ds_read_b64_tr_b16 a[6:7], v15 offset:6144
v_mfma_f32_16x16x32_bf16 v[32:35], a[140:143], v[76:79], v[32:35]
v_cvt_pk_bf16_f32 v146, v24, v25
v_cvt_pk_bf16_f32 v147, v26, v27
v_mfma_f32_16x16x32_bf16 v[32:35], a[144:147], v[80:83], v[32:35]
s_waitcnt lgkmcnt(4)
ds_read_b64_tr_b16 a[8:9], v15 offset:8192
ds_read_b64_tr_b16 a[10:11], v15 offset:10240
v_mfma_f32_16x16x32_bf16 v[32:35], a[148:151], v[84:87], v[32:35]
v_cvt_pk_bf16_f32 v150, v28, v29
v_cvt_pk_bf16_f32 v151, v30, v31
v_mfma_f32_16x16x32_bf16 v[32:35], a[152:155], v[88:91], v[32:35]
ds_read_b64_tr_b16 a[12:13], v15 offset:12288
ds_read_b64_tr_b16 a[14:15], v15 offset:14336
v_mfma_f32_16x16x32_bf16 v[32:35], a[156:159], v[92:95], v[32:35]
buffer_store_dwordx4 v[144:147], v9, s[24:27], s51 offen sc1
v_mfma_f32_16x16x32_bf16 v[36:39], a[128:131], v[96:99], 0
ds_read_b64_tr_b16 a[16:17], v15 offset:16384
ds_read_b64_tr_b16 a[18:19], v15 offset:18432
v_mfma_f32_16x16x32_bf16 v[36:39], a[132:135], v[100:103], v[36:39]
s_add_u32 s51, s49, 5120
buffer_store_dwordx4 v[148:151], v9, s[24:27], s51 offen sc1
v_mfma_f32_16x16x32_bf16 v[36:39], a[136:139], v[104:107], v[36:39]
ds_read_b64_tr_b16 a[20:21], v15 offset:20480
ds_read_b64_tr_b16 a[22:23], v15 offset:22528
v_mfma_f32_16x16x32_bf16 v[36:39], a[140:143], v[108:111], v[36:39]
s_add_u32 s7, s32, 131072
buffer_load_dword v240, v11, s[24:27], s7 offen offset:0 sc1
v_mfma_f32_16x16x32_bf16 v[36:39], a[144:147], v[112:115], v[36:39]
ds_read_b64_tr_b16 a[24:25], v15 offset:24576
ds_read_b64_tr_b16 a[26:27], v15 offset:26624
v_mfma_f32_16x16x32_bf16 v[36:39], a[148:151], v[116:119], v[36:39]
buffer_store_dwordx2 v[238:239], v0, s[24:27], s69 offen offset:2044 sc1
v_mfma_f32_16x16x32_bf16 v[36:39], a[152:155], v[120:123], v[36:39]
ds_read_b64_tr_b16 a[28:29], v15 offset:28672
ds_read_b64_tr_b16 a[30:31], v15 offset:30720
v_mfma_f32_16x16x32_bf16 v[36:39], a[156:159], v[124:127], v[36:39]
s_waitcnt lgkmcnt(6)
s_mov_b32 s45, 1024
v_mfma_f32_16x16x32_bf16 v[40:43], a[0:3], v[64:67], 0
s_waitcnt vmcnt(16)
s_barrier
ds_read_b64_tr_b16 a[128:129], v12 offset:0
ds_read_b64_tr_b16 a[130:131], v12 offset:2048
v_mfma_f32_16x16x32_bf16 v[40:43], a[4:7], v[68:71], v[40:43]
v_add_u32 v15, 0x9000, v15
s_add_u32 m0, s40, 110592
v_mfma_f32_16x16x32_bf16 v[40:43], a[8:11], v[72:75], v[40:43]
ds_read_b64_tr_b16 a[132:133], v12 offset:4096
ds_read_b64_tr_b16 a[134:135], v12 offset:6144
v_mfma_f32_16x16x32_bf16 v[40:43], a[12:15], v[76:79], v[40:43]
v_cvt_pk_bf16_f32 v152, v32, v33
v_cvt_pk_bf16_f32 v153, v34, v35
v_mfma_f32_16x16x32_bf16 v[40:43], a[16:19], v[80:83], v[40:43]
s_waitcnt lgkmcnt(4)
ds_read_b64_tr_b16 a[136:137], v12 offset:8192
ds_read_b64_tr_b16 a[138:139], v12 offset:10240
v_mfma_f32_16x16x32_bf16 v[40:43], a[20:23], v[84:87], v[40:43]
v_cvt_pk_bf16_f32 v156, v36, v37
v_cvt_pk_bf16_f32 v157, v38, v39
v_mfma_f32_16x16x32_bf16 v[40:43], a[24:27], v[88:91], v[40:43]
ds_read_b64_tr_b16 a[140:141], v12 offset:12288
ds_read_b64_tr_b16 a[142:143], v12 offset:14336
v_mfma_f32_16x16x32_bf16 v[40:43], a[28:31], v[92:95], v[40:43]
buffer_load_dwordx4 v3, s[20:23], s45 offen lds
v_mfma_f32_16x16x32_bf16 v[44:47], a[0:3], v[96:99], 0
ds_read_b64_tr_b16 a[144:145], v12 offset:16384
ds_read_b64_tr_b16 a[146:147], v12 offset:18432
v_mfma_f32_16x16x32_bf16 v[44:47], a[4:7], v[100:103], v[44:47]
buffer_store_dword v0, v0, s[24:27], s55 offen offset:512 sc1
v_mfma_f32_16x16x32_bf16 v[44:47], a[8:11], v[104:107], v[44:47]
ds_read_b64_tr_b16 a[148:149], v12 offset:20480
ds_read_b64_tr_b16 a[150:151], v12 offset:22528
s_add_u32 m0, s40, 114688
v_mfma_f32_16x16x32_bf16 v[44:47], a[12:15], v[108:111], v[44:47]
s_mov_b32 s45, 37888
buffer_load_dwordx4 v3, s[20:23], s45 offen lds
v_mfma_f32_16x16x32_bf16 v[44:47], a[16:19], v[112:115], v[44:47]
ds_read_b64_tr_b16 a[152:153], v12 offset:24576
ds_read_b64_tr_b16 a[154:155], v12 offset:26624
v_mfma_f32_16x16x32_bf16 v[44:47], a[20:23], v[116:119], v[44:47]
s_add_u32 m0, s40, 118784
s_mov_b32 s45, 74752
v_mfma_f32_16x16x32_bf16 v[44:47], a[24:27], v[120:123], v[44:47]
ds_read_b64_tr_b16 a[156:157], v12 offset:28672
ds_read_b64_tr_b16 a[158:159], v12 offset:30720
v_mfma_f32_16x16x32_bf16 v[44:47], a[28:31], v[124:127], v[44:47]
s_waitcnt lgkmcnt(6)
buffer_load_dwordx4 v3, s[20:23], s45 offen lds
v_mfma_f32_16x16x32_bf16 v[16:19], a[128:131], v[64:67], 0
ds_read_b64_tr_b16 a[0:1], v13 offset:0
ds_read_b64_tr_b16 a[2:3], v13 offset:2048
v_mfma_f32_16x16x32_bf16 v[16:19], a[132:135], v[68:71], v[16:19]
s_waitcnt vmcnt(5)
v_add_u32 v12, 0xfffee000, v12
v_cmp_eq_u32 s[30:31], 0, v240
v_mfma_f32_16x16x32_bf16 v[16:19], a[136:139], v[72:75], v[16:19]
ds_read_b64_tr_b16 a[4:5], v13 offset:4096
ds_read_b64_tr_b16 a[6:7], v13 offset:6144
v_mfma_f32_16x16x32_bf16 v[16:19], a[140:143], v[76:79], v[16:19]
s_cmp_eq_u64 s[30:31], 0
s_cselect_b32 s28, s60, 0x10000000
v_cvt_pk_bf16_f32 v154, v40, v41
v_cvt_pk_bf16_f32 v155, v42, v43
v_mfma_f32_16x16x32_bf16 v[16:19], a[144:147], v[80:83], v[16:19]
s_waitcnt lgkmcnt(4)
ds_read_b64_tr_b16 a[8:9], v13 offset:8192
ds_read_b64_tr_b16 a[10:11], v13 offset:10240
v_mfma_f32_16x16x32_bf16 v[16:19], a[148:151], v[84:87], v[16:19]
v_cvt_pk_bf16_f32 v158, v44, v45
v_cvt_pk_bf16_f32 v159, v46, v47
v_mfma_f32_16x16x32_bf16 v[16:19], a[152:155], v[88:91], v[16:19]
ds_read_b64_tr_b16 a[12:13], v13 offset:12288
ds_read_b64_tr_b16 a[14:15], v13 offset:14336
v_mfma_f32_16x16x32_bf16 v[16:19], a[156:159], v[92:95], v[16:19]
s_add_u32 s51, s48, 5632
buffer_store_dwordx4 v[152:155], v9, s[24:27], s51 offen sc1
v_mfma_f32_16x16x32_bf16 v[20:23], a[128:131], v[96:99], 0
ds_read_b64_tr_b16 a[16:17], v13 offset:16384
ds_read_b64_tr_b16 a[18:19], v13 offset:18432
v_mfma_f32_16x16x32_bf16 v[20:23], a[132:135], v[100:103], v[20:23]
s_add_u32 s51, s49, 5632
buffer_store_dwordx4 v[156:159], v9, s[24:27], s51 offen sc1
v_mfma_f32_16x16x32_bf16 v[20:23], a[136:139], v[104:107], v[20:23]
ds_read_b64_tr_b16 a[20:21], v13 offset:20480
ds_read_b64_tr_b16 a[22:23], v13 offset:22528
s_add_u32 m0, s40, 122880
v_mfma_f32_16x16x32_bf16 v[20:23], a[140:143], v[108:111], v[20:23]
s_mov_b32 s45, 111616
buffer_load_dwordx4 v3, s[20:23], s45 offen lds
v_mfma_f32_16x16x32_bf16 v[20:23], a[144:147], v[112:115], v[20:23]
ds_read_b64_tr_b16 a[24:25], v13 offset:24576
ds_read_b64_tr_b16 a[26:27], v13 offset:26624
v_mfma_f32_16x16x32_bf16 v[20:23], a[148:151], v[116:119], v[20:23]
s_add_u32 s7, s28, 16777216
buffer_load_dwordx4 a[32:35], v56, s[24:27], s7 offen sc1
v_mfma_f32_16x16x32_bf16 v[20:23], a[152:155], v[120:123], v[20:23]
ds_read_b64_tr_b16 a[28:29], v13 offset:28672
ds_read_b64_tr_b16 a[30:31], v13 offset:30720
s_add_u32 m0, s40, 126976
v_mfma_f32_16x16x32_bf16 v[20:23], a[156:159], v[124:127], v[20:23]
s_waitcnt lgkmcnt(6)
s_mov_b32 s45, 148480
buffer_load_dwordx4 v3, s[20:23], s45 offen lds
v_mfma_f32_16x16x32_bf16 v[24:27], a[0:3], v[64:67], 0
ds_read_b64_tr_b16 a[128:129], v14 offset:0
ds_read_b64_tr_b16 a[130:131], v14 offset:2048
v_mfma_f32_16x16x32_bf16 v[24:27], a[4:7], v[68:71], v[24:27]
v_add_u32 v13, 0xfffee000, v13
v_mfma_f32_16x16x32_bf16 v[24:27], a[8:11], v[72:75], v[24:27]
s_and_b32 s6, s4, 1
s_mul_i32 s7, s4, 288
s_lshl_b32 s38, s6, 5
s_add_u32 s41, s7, s38
s_lshl_b32 s38, s6, 8
s_sub_u32 s42, s7, s38
s_add_u32 s42, s42, 256
s_mul_i32 s43, s41, 1152
s_mul_i32 s44, s42, 1152
s_lshl_b32 s41, s41, 1
s_lshl_b32 s42, s42, 1
s_mov_b32 s47, 0xc09d30fc
s_and_b32 s38, s3, 1
s_lshr_b32 s39, s3, 1
s_lshl_b32 s6, s5, 3
s_lshl_b32 s7, s38, 2
s_add_u32 s6, s6, s7
s_mul_i32 s54, s6, 18432
s_mul_i32 s6, s4, 2359296
s_add_u32 s50, s6, s54
s_lshl_b32 s6, s39, 9
s_add_u32 s50, s50, s6
s_add_u32 s50, s50, 67108864
s_mul_i32 s97, s3, 3072
s_mul_i32 s6, s3, 147456
s_add_u32 s41, s41, s6
s_mul_i32 s6, s3, 18432
s_add_u32 s43, s43, s6
s_add_u32 s44, s44, s6
s_sub_u32 s44, s44, 294912
s_cmp_eq_u32 s3, 3
s_cselect_b32 s98, s44, s43
s_cmp_ge_u32 s3, 2
s_cselect_b32 s99, s44, s43
s_mul_i32 s6, s39, 36864
s_add_u32 s54, s54, s6
ds_read_b64_tr_b16 a[132:133], v14 offset:4096
ds_read_b64_tr_b16 a[134:135], v14 offset:6144
v_mfma_f32_16x16x32_bf16 v[24:27], a[12:15], v[76:79], v[24:27]
v_cvt_pk_bf16_f32 v128, v16, v17
v_cvt_pk_bf16_f32 v129, v18, v19
v_mfma_f32_16x16x32_bf16 v[24:27], a[16:19], v[80:83], v[24:27]
s_waitcnt lgkmcnt(4)
ds_read_b64_tr_b16 a[136:137], v14 offset:8192
ds_read_b64_tr_b16 a[138:139], v14 offset:10240
v_mfma_f32_16x16x32_bf16 v[24:27], a[20:23], v[84:87], v[24:27]
v_cvt_pk_bf16_f32 v132, v20, v21
v_cvt_pk_bf16_f32 v133, v22, v23
v_mfma_f32_16x16x32_bf16 v[24:27], a[24:27], v[88:91], v[24:27]
ds_read_b64_tr_b16 a[140:141], v14 offset:12288
ds_read_b64_tr_b16 a[142:143], v14 offset:14336
s_add_u32 m0, s40, 131072
v_mfma_f32_16x16x32_bf16 v[24:27], a[28:31], v[92:95], v[24:27]
s_mov_b32 s45, 185344
buffer_load_dwordx4 v3, s[20:23], s45 offen lds
v_mfma_f32_16x16x32_bf16 v[28:31], a[0:3], v[96:99], 0
ds_read_b64_tr_b16 a[144:145], v14 offset:16384
ds_read_b64_tr_b16 a[146:147], v14 offset:18432
v_mfma_f32_16x16x32_bf16 v[28:31], a[4:7], v[100:103], v[28:31]
s_add_u32 s7, s28, 26214400
buffer_load_dwordx4 a[36:39], v56, s[24:27], s7 offen sc1
v_mfma_f32_16x16x32_bf16 v[28:31], a[8:11], v[104:107], v[28:31]
ds_read_b64_tr_b16 a[148:149], v14 offset:20480
ds_read_b64_tr_b16 a[150:151], v14 offset:22528
s_add_u32 m0, s40, 135168
v_mfma_f32_16x16x32_bf16 v[28:31], a[12:15], v[108:111], v[28:31]
s_mov_b32 s45, 222208
buffer_load_dwordx4 v3, s[20:23], s45 offen lds
v_mfma_f32_16x16x32_bf16 v[28:31], a[16:19], v[112:115], v[28:31]
ds_read_b64_tr_b16 a[152:153], v14 offset:24576
ds_read_b64_tr_b16 a[154:155], v14 offset:26624
v_mfma_f32_16x16x32_bf16 v[28:31], a[20:23], v[116:119], v[28:31]
s_add_u32 s7, s28, 35651584
buffer_load_dwordx4 a[40:43], v56, s[24:27], s7 offen sc1
v_mfma_f32_16x16x32_bf16 v[28:31], a[24:27], v[120:123], v[28:31]
ds_read_b64_tr_b16 a[156:157], v14 offset:28672
ds_read_b64_tr_b16 a[158:159], v14 offset:30720
s_add_u32 m0, s40, 139264
v_mfma_f32_16x16x32_bf16 v[28:31], a[28:31], v[124:127], v[28:31]
s_waitcnt lgkmcnt(6)
s_mov_b32 s45, 259072
buffer_load_dwordx4 v3, s[20:23], s45 offen lds
v_mfma_f32_16x16x32_bf16 v[32:35], a[128:131], v[64:67], 0
ds_read_b64_tr_b16 a[0:1], v15 offset:0
ds_read_b64_tr_b16 a[2:3], v15 offset:2048
v_mfma_f32_16x16x32_bf16 v[32:35], a[132:135], v[68:71], v[32:35]
v_add_u32 v14, 0xfffee000, v14
s_add_u32 s51, s48, 6144
v_mfma_f32_16x16x32_bf16 v[32:35], a[136:139], v[72:75], v[32:35]
ds_read_b64_tr_b16 a[4:5], v15 offset:4096
ds_read_b64_tr_b16 a[6:7], v15 offset:6144
v_mfma_f32_16x16x32_bf16 v[32:35], a[140:143], v[76:79], v[32:35]
v_cvt_pk_bf16_f32 v130, v24, v25
v_cvt_pk_bf16_f32 v131, v26, v27
v_mfma_f32_16x16x32_bf16 v[32:35], a[144:147], v[80:83], v[32:35]
s_waitcnt lgkmcnt(4)
ds_read_b64_tr_b16 a[8:9], v15 offset:8192
ds_read_b64_tr_b16 a[10:11], v15 offset:10240
v_mfma_f32_16x16x32_bf16 v[32:35], a[148:151], v[84:87], v[32:35]
v_cvt_pk_bf16_f32 v134, v28, v29
v_cvt_pk_bf16_f32 v135, v30, v31
v_mfma_f32_16x16x32_bf16 v[32:35], a[152:155], v[88:91], v[32:35]
ds_read_b64_tr_b16 a[12:13], v15 offset:12288
ds_read_b64_tr_b16 a[14:15], v15 offset:14336
v_mfma_f32_16x16x32_bf16 v[32:35], a[156:159], v[92:95], v[32:35]
buffer_store_dwordx4 v[128:131], v9, s[24:27], s51 offen sc1
v_mfma_f32_16x16x32_bf16 v[36:39], a[128:131], v[96:99], 0
ds_read_b64_tr_b16 a[16:17], v15 offset:16384
ds_read_b64_tr_b16 a[18:19], v15 offset:18432
v_mfma_f32_16x16x32_bf16 v[36:39], a[132:135], v[100:103], v[36:39]
s_add_u32 s51, s49, 6144
buffer_store_dwordx4 v[132:135], v9, s[24:27], s51 offen sc1
v_mfma_f32_16x16x32_bf16 v[36:39], a[136:139], v[104:107], v[36:39]
ds_read_b64_tr_b16 a[20:21], v15 offset:20480
ds_read_b64_tr_b16 a[22:23], v15 offset:22528
v_mfma_f32_16x16x32_bf16 v[36:39], a[140:143], v[108:111], v[36:39]
s_add_u32 s7, s28, 45088768
buffer_load_dwordx4 a[44:47], v56, s[24:27], s7 offen sc1
v_mfma_f32_16x16x32_bf16 v[36:39], a[144:147], v[112:115], v[36:39]
ds_read_b64_tr_b16 a[24:25], v15 offset:24576
ds_read_b64_tr_b16 a[26:27], v15 offset:26624
v_mfma_f32_16x16x32_bf16 v[36:39], a[148:151], v[116:119], v[36:39]
s_add_u32 s7, s28, 16778240
buffer_load_dwordx4 a[48:51], v56, s[24:27], s7 offen sc1
v_mfma_f32_16x16x32_bf16 v[36:39], a[152:155], v[120:123], v[36:39]
ds_read_b64_tr_b16 a[28:29], v15 offset:28672
ds_read_b64_tr_b16 a[30:31], v15 offset:30720
v_mfma_f32_16x16x32_bf16 v[36:39], a[156:159], v[124:127], v[36:39]
s_waitcnt lgkmcnt(6)
s_add_u32 s7, s28, 26215424
buffer_load_dwordx4 a[52:55], v56, s[24:27], s7 offen sc1
v_mfma_f32_16x16x32_bf16 v[40:43], a[0:3], v[64:67], 0
s_barrier
ds_read_b64_tr_b16 a[128:129], v12 offset:0
ds_read_b64_tr_b16 a[130:131], v12 offset:2048
v_mfma_f32_16x16x32_bf16 v[40:43], a[4:7], v[68:71], v[40:43]
v_add_u32 v15, 0xfffee000, v15
s_add_u32 s7, s28, 35652608
v_mfma_f32_16x16x32_bf16 v[40:43], a[8:11], v[72:75], v[40:43]
ds_read_b64_tr_b16 a[132:133], v12 offset:4096
ds_read_b64_tr_b16 a[134:135], v12 offset:6144
v_mfma_f32_16x16x32_bf16 v[40:43], a[12:15], v[76:79], v[40:43]
v_cvt_pk_bf16_f32 v136, v32, v33
v_cvt_pk_bf16_f32 v137, v34, v35
v_mfma_f32_16x16x32_bf16 v[40:43], a[16:19], v[80:83], v[40:43]
s_waitcnt lgkmcnt(4)
ds_read_b64_tr_b16 a[136:137], v12 offset:8192
ds_read_b64_tr_b16 a[138:139], v12 offset:10240
v_mfma_f32_16x16x32_bf16 v[40:43], a[20:23], v[84:87], v[40:43]
v_cvt_pk_bf16_f32 v140, v36, v37
v_cvt_pk_bf16_f32 v141, v38, v39
v_mfma_f32_16x16x32_bf16 v[40:43], a[24:27], v[88:91], v[40:43]
ds_read_b64_tr_b16 a[140:141], v12 offset:12288
ds_read_b64_tr_b16 a[142:143], v12 offset:14336
v_mfma_f32_16x16x32_bf16 v[40:43], a[28:31], v[92:95], v[40:43]
buffer_load_dwordx4 a[56:59], v56, s[24:27], s7 offen sc1
v_mfma_f32_16x16x32_bf16 v[44:47], a[0:3], v[96:99], 0
ds_read_b64_tr_b16 a[144:145], v12 offset:16384
ds_read_b64_tr_b16 a[146:147], v12 offset:18432
v_mfma_f32_16x16x32_bf16 v[44:47], a[4:7], v[100:103], v[44:47]
s_add_u32 s7, s28, 45089792
buffer_load_dwordx4 a[60:63], v56, s[24:27], s7 offen sc1
v_mfma_f32_16x16x32_bf16 v[44:47], a[8:11], v[104:107], v[44:47]
ds_read_b64_tr_b16 a[148:149], v12 offset:20480
ds_read_b64_tr_b16 a[150:151], v12 offset:22528
s_add_u32 m0, s97, 36864
v_mfma_f32_16x16x32_bf16 v[44:47], a[12:15], v[108:111], v[44:47]
s_add_u32 s45, s41, 0
buffer_load_dwordx4 v2, s[8:11], s45 offen offset:0 lds
v_mfma_f32_16x16x32_bf16 v[44:47], a[16:19], v[112:115], v[44:47]
ds_read_b64_tr_b16 a[152:153], v12 offset:24576
ds_read_b64_tr_b16 a[154:155], v12 offset:26624
s_add_u32 m0, s97, 36864
v_mfma_f32_16x16x32_bf16 v[44:47], a[20:23], v[116:119], v[44:47]
s_add_u32 s45, s41, 72704
buffer_load_dwordx4 v2, s[8:11], s45 offen offset:1024 lds
v_mfma_f32_16x16x32_bf16 v[44:47], a[24:27], v[120:123], v[44:47]
ds_read_b64_tr_b16 a[156:157], v12 offset:28672
ds_read_b64_tr_b16 a[158:159], v12 offset:30720
s_add_u32 m0, s97, 36864
v_mfma_f32_16x16x32_bf16 v[44:47], a[28:31], v[124:127], v[44:47]
s_waitcnt lgkmcnt(6)
s_add_u32 s45, s41, 145408
buffer_load_dwordx4 v2, s[8:11], s45 offen offset:2048 lds
v_mfma_f32_16x16x32_bf16 v[16:19], a[128:131], v[64:67], 0
ds_read_b64_tr_b16 a[0:1], v13 offset:0
ds_read_b64_tr_b16 a[2:3], v13 offset:2048
v_mfma_f32_16x16x32_bf16 v[16:19], a[132:135], v[68:71], v[16:19]
v_add_u32 v12, 0x1b000, v12
s_add_u32 s51, s48, 6656
v_mfma_f32_16x16x32_bf16 v[16:19], a[136:139], v[72:75], v[16:19]
ds_read_b64_tr_b16 a[4:5], v13 offset:4096
ds_read_b64_tr_b16 a[6:7], v13 offset:6144
v_mfma_f32_16x16x32_bf16 v[16:19], a[140:143], v[76:79], v[16:19]
v_cvt_pk_bf16_f32 v138, v40, v41
v_cvt_pk_bf16_f32 v139, v42, v43
v_mfma_f32_16x16x32_bf16 v[16:19], a[144:147], v[80:83], v[16:19]
s_waitcnt lgkmcnt(4)
ds_read_b64_tr_b16 a[8:9], v13 offset:8192
ds_read_b64_tr_b16 a[10:11], v13 offset:10240
v_mfma_f32_16x16x32_bf16 v[16:19], a[148:151], v[84:87], v[16:19]
v_cvt_pk_bf16_f32 v142, v44, v45
v_cvt_pk_bf16_f32 v143, v46, v47
v_mfma_f32_16x16x32_bf16 v[16:19], a[152:155], v[88:91], v[16:19]
ds_read_b64_tr_b16 a[12:13], v13 offset:12288
ds_read_b64_tr_b16 a[14:15], v13 offset:14336
v_mfma_f32_16x16x32_bf16 v[16:19], a[156:159], v[92:95], v[16:19]
buffer_store_dwordx4 v[136:139], v9, s[24:27], s51 offen sc1
v_mfma_f32_16x16x32_bf16 v[20:23], a[128:131], v[96:99], 0
ds_read_b64_tr_b16 a[16:17], v13 offset:16384
ds_read_b64_tr_b16 a[18:19], v13 offset:18432
v_mfma_f32_16x16x32_bf16 v[20:23], a[132:135], v[100:103], v[20:23]
s_add_u32 s51, s49, 6656
buffer_store_dwordx4 v[140:143], v9, s[24:27], s51 offen sc1
v_mfma_f32_16x16x32_bf16 v[20:23], a[136:139], v[104:107], v[20:23]
ds_read_b64_tr_b16 a[20:21], v13 offset:20480
ds_read_b64_tr_b16 a[22:23], v13 offset:22528
v_mfma_f32_16x16x32_bf16 v[20:23], a[140:143], v[108:111], v[20:23]
v_mfma_f32_16x16x32_bf16 v[20:23], a[144:147], v[112:115], v[20:23]
ds_read_b64_tr_b16 a[24:25], v13 offset:24576
ds_read_b64_tr_b16 a[26:27], v13 offset:26624
v_mfma_f32_16x16x32_bf16 v[20:23], a[148:151], v[116:119], v[20:23]
v_mfma_f32_16x16x32_bf16 v[20:23], a[152:155], v[120:123], v[20:23]
ds_read_b64_tr_b16 a[28:29], v13 offset:28672
ds_read_b64_tr_b16 a[30:31], v13 offset:30720
v_mfma_f32_16x16x32_bf16 v[20:23], a[156:159], v[124:127], v[20:23]
s_waitcnt lgkmcnt(6)
v_mfma_f32_16x16x32_bf16 v[24:27], a[0:3], v[64:67], 0
ds_read_b64_tr_b16 a[128:129], v14 offset:0
ds_read_b64_tr_b16 a[130:131], v14 offset:2048
v_mfma_f32_16x16x32_bf16 v[24:27], a[4:7], v[68:71], v[24:27]
v_add_u32 v13, 0x1b000, v13
s_add_u32 s7, s32, 131072
v_mfma_f32_16x16x32_bf16 v[24:27], a[8:11], v[72:75], v[24:27]
ds_read_b64_tr_b16 a[132:133], v14 offset:4096
ds_read_b64_tr_b16 a[134:135], v14 offset:6144
v_mfma_f32_16x16x32_bf16 v[24:27], a[12:15], v[76:79], v[24:27]
v_cvt_pk_bf16_f32 v144, v16, v17
v_cvt_pk_bf16_f32 v145, v18, v19
v_mfma_f32_16x16x32_bf16 v[24:27], a[16:19], v[80:83], v[24:27]
s_waitcnt lgkmcnt(4)
ds_read_b64_tr_b16 a[136:137], v14 offset:8192
ds_read_b64_tr_b16 a[138:139], v14 offset:10240
v_mfma_f32_16x16x32_bf16 v[24:27], a[20:23], v[84:87], v[24:27]
v_cvt_pk_bf16_f32 v148, v20, v21
v_cvt_pk_bf16_f32 v149, v22, v23
v_mfma_f32_16x16x32_bf16 v[24:27], a[24:27], v[88:91], v[24:27]
ds_read_b64_tr_b16 a[140:141], v14 offset:12288
ds_read_b64_tr_b16 a[142:143], v14 offset:14336
v_mfma_f32_16x16x32_bf16 v[24:27], a[28:31], v[92:95], v[24:27]
buffer_load_dword v241, v11, s[24:27], s7 offen offset:512 sc1
v_mfma_f32_16x16x32_bf16 v[28:31], a[0:3], v[96:99], 0
ds_read_b64_tr_b16 a[144:145], v14 offset:16384
ds_read_b64_tr_b16 a[146:147], v14 offset:18432
v_mfma_f32_16x16x32_bf16 v[28:31], a[4:7], v[100:103], v[28:31]
v_mfma_f32_16x16x32_bf16 v[28:31], a[8:11], v[104:107], v[28:31]
ds_read_b64_tr_b16 a[148:149], v14 offset:20480
ds_read_b64_tr_b16 a[150:151], v14 offset:22528
v_mfma_f32_16x16x32_bf16 v[28:31], a[12:15], v[108:111], v[28:31]
v_mfma_f32_16x16x32_bf16 v[28:31], a[16:19], v[112:115], v[28:31]
ds_read_b64_tr_b16 a[152:153], v14 offset:24576
ds_read_b64_tr_b16 a[154:155], v14 offset:26624
v_mfma_f32_16x16x32_bf16 v[28:31], a[20:23], v[116:119], v[28:31]
v_mfma_f32_16x16x32_bf16 v[28:31], a[24:27], v[120:123], v[28:31]
ds_read_b64_tr_b16 a[156:157], v14 offset:28672
ds_read_b64_tr_b16 a[158:159], v14 offset:30720
v_mfma_f32_16x16x32_bf16 v[28:31], a[28:31], v[124:127], v[28:31]
s_waitcnt lgkmcnt(6)
v_mfma_f32_16x16x32_bf16 v[32:35], a[128:131], v[64:67], 0
ds_read_b64_tr_b16 a[0:1], v15 offset:0
ds_read_b64_tr_b16 a[2:3], v15 offset:2048
v_mfma_f32_16x16x32_bf16 v[32:35], a[132:135], v[68:71], v[32:35]
v_add_u32 v14, 0x1b000, v14
s_add_u32 s51, s48, 7168
v_mfma_f32_16x16x32_bf16 v[32:35], a[136:139], v[72:75], v[32:35]
ds_read_b64_tr_b16 a[4:5], v15 offset:4096
ds_read_b64_tr_b16 a[6:7], v15 offset:6144
v_mfma_f32_16x16x32_bf16 v[32:35], a[140:143], v[76:79], v[32:35]
v_cvt_pk_bf16_f32 v146, v24, v25
v_cvt_pk_bf16_f32 v147, v26, v27
v_mfma_f32_16x16x32_bf16 v[32:35], a[144:147], v[80:83], v[32:35]
s_waitcnt lgkmcnt(4)
ds_read_b64_tr_b16 a[8:9], v15 offset:8192
ds_read_b64_tr_b16 a[10:11], v15 offset:10240
v_mfma_f32_16x16x32_bf16 v[32:35], a[148:151], v[84:87], v[32:35]
v_cvt_pk_bf16_f32 v150, v28, v29
v_cvt_pk_bf16_f32 v151, v30, v31
v_mfma_f32_16x16x32_bf16 v[32:35], a[152:155], v[88:91], v[32:35]
ds_read_b64_tr_b16 a[12:13], v15 offset:12288
ds_read_b64_tr_b16 a[14:15], v15 offset:14336
v_mfma_f32_16x16x32_bf16 v[32:35], a[156:159], v[92:95], v[32:35]
buffer_store_dwordx4 v[144:147], v9, s[24:27], s51 offen sc1
v_mfma_f32_16x16x32_bf16 v[36:39], a[128:131], v[96:99], 0
ds_read_b64_tr_b16 a[16:17], v15 offset:16384
ds_read_b64_tr_b16 a[18:19], v15 offset:18432
v_mfma_f32_16x16x32_bf16 v[36:39], a[132:135], v[100:103], v[36:39]
s_add_u32 s51, s49, 7168
buffer_store_dwordx4 v[148:151], v9, s[24:27], s51 offen sc1
v_mfma_f32_16x16x32_bf16 v[36:39], a[136:139], v[104:107], v[36:39]
ds_read_b64_tr_b16 a[20:21], v15 offset:20480
ds_read_b64_tr_b16 a[22:23], v15 offset:22528
v_mfma_f32_16x16x32_bf16 v[36:39], a[140:143], v[108:111], v[36:39]
v_mfma_f32_16x16x32_bf16 v[36:39], a[144:147], v[112:115], v[36:39]
ds_read_b64_tr_b16 a[24:25], v15 offset:24576
ds_read_b64_tr_b16 a[26:27], v15 offset:26624
v_mfma_f32_16x16x32_bf16 v[36:39], a[148:151], v[116:119], v[36:39]
v_mfma_f32_16x16x32_bf16 v[36:39], a[152:155], v[120:123], v[36:39]
ds_read_b64_tr_b16 a[28:29], v15 offset:28672
ds_read_b64_tr_b16 a[30:31], v15 offset:30720
v_mfma_f32_16x16x32_bf16 v[36:39], a[156:159], v[124:127], v[36:39]
s_waitcnt lgkmcnt(6)
v_mfma_f32_16x16x32_bf16 v[40:43], a[0:3], v[64:67], 0
s_waitcnt vmcnt(15)
s_barrier
ds_read_b64_tr_b16 a[128:129], v12 offset:0
ds_read_b64_tr_b16 a[130:131], v12 offset:2048
v_mfma_f32_16x16x32_bf16 v[40:43], a[4:7], v[68:71], v[40:43]
v_add_u32 v15, 0x1b000, v15
v_mfma_f32_16x16x32_bf16 v[40:43], a[8:11], v[72:75], v[40:43]
ds_read_b64_tr_b16 a[132:133], v12 offset:4096
ds_read_b64_tr_b16 a[134:135], v12 offset:6144
v_mfma_f32_16x16x32_bf16 v[40:43], a[12:15], v[76:79], v[40:43]
v_cvt_pk_bf16_f32 v152, v32, v33
v_cvt_pk_bf16_f32 v153, v34, v35
v_mfma_f32_16x16x32_bf16 v[40:43], a[16:19], v[80:83], v[40:43]
s_waitcnt lgkmcnt(4)
ds_read_b64_tr_b16 a[136:137], v12 offset:8192
ds_read_b64_tr_b16 a[138:139], v12 offset:10240
v_mfma_f32_16x16x32_bf16 v[40:43], a[20:23], v[84:87], v[40:43]
v_cvt_pk_bf16_f32 v156, v36, v37
v_cvt_pk_bf16_f32 v157, v38, v39
v_mfma_f32_16x16x32_bf16 v[40:43], a[24:27], v[88:91], v[40:43]
ds_read_b64_tr_b16 a[140:141], v12 offset:12288
ds_read_b64_tr_b16 a[142:143], v12 offset:14336
v_mfma_f32_16x16x32_bf16 v[40:43], a[28:31], v[92:95], v[40:43]
buffer_store_dword v0, v0, s[24:27], s55 offen offset:1024 sc1
v_mfma_f32_16x16x32_bf16 v[44:47], a[0:3], v[96:99], 0
ds_read_b64_tr_b16 a[144:145], v12 offset:16384
ds_read_b64_tr_b16 a[146:147], v12 offset:18432
v_mfma_f32_16x16x32_bf16 v[44:47], a[4:7], v[100:103], v[44:47]
v_mfma_f32_16x16x32_bf16 v[44:47], a[8:11], v[104:107], v[44:47]
ds_read_b64_tr_b16 a[148:149], v12 offset:20480
ds_read_b64_tr_b16 a[150:151], v12 offset:22528
v_mfma_f32_16x16x32_bf16 v[44:47], a[12:15], v[108:111], v[44:47]
v_mfma_f32_16x16x32_bf16 v[44:47], a[16:19], v[112:115], v[44:47]
ds_read_b64_tr_b16 a[152:153], v12 offset:24576
ds_read_b64_tr_b16 a[154:155], v12 offset:26624
v_mfma_f32_16x16x32_bf16 v[44:47], a[20:23], v[116:119], v[44:47]
v_mfma_f32_16x16x32_bf16 v[44:47], a[24:27], v[120:123], v[44:47]
ds_read_b64_tr_b16 a[156:157], v12 offset:28672
ds_read_b64_tr_b16 a[158:159], v12 offset:30720
v_mfma_f32_16x16x32_bf16 v[44:47], a[28:31], v[124:127], v[44:47]
s_waitcnt lgkmcnt(6)
v_mfma_f32_16x16x32_bf16 v[16:19], a[128:131], v[64:67], 0
ds_read_b64_tr_b16 a[0:1], v13 offset:0
ds_read_b64_tr_b16 a[2:3], v13 offset:2048
v_mfma_f32_16x16x32_bf16 v[16:19], a[132:135], v[68:71], v[16:19]
s_waitcnt vmcnt(3)
v_cmp_eq_u32 s[30:31], 0, v241
v_mfma_f32_16x16x32_bf16 v[16:19], a[136:139], v[72:75], v[16:19]
ds_read_b64_tr_b16 a[4:5], v13 offset:4096
ds_read_b64_tr_b16 a[6:7], v13 offset:6144
v_mfma_f32_16x16x32_bf16 v[16:19], a[140:143], v[76:79], v[16:19]
s_cmp_eq_u64 s[30:31], 0
s_cselect_b32 s29, s60, 0x10000000
v_cvt_pk_bf16_f32 v154, v40, v41
v_cvt_pk_bf16_f32 v155, v42, v43
v_mfma_f32_16x16x32_bf16 v[16:19], a[144:147], v[80:83], v[16:19]
s_waitcnt lgkmcnt(4)
ds_read_b64_tr_b16 a[8:9], v13 offset:8192
ds_read_b64_tr_b16 a[10:11], v13 offset:10240
v_mfma_f32_16x16x32_bf16 v[16:19], a[148:151], v[84:87], v[16:19]
v_cvt_pk_bf16_f32 v158, v44, v45
v_cvt_pk_bf16_f32 v159, v46, v47
v_mfma_f32_16x16x32_bf16 v[16:19], a[152:155], v[88:91], v[16:19]
ds_read_b64_tr_b16 a[12:13], v13 offset:12288
ds_read_b64_tr_b16 a[14:15], v13 offset:14336
v_mfma_f32_16x16x32_bf16 v[16:19], a[156:159], v[92:95], v[16:19]
s_add_u32 s51, s48, 7680
buffer_store_dwordx4 v[152:155], v9, s[24:27], s51 offen sc1
v_mfma_f32_16x16x32_bf16 v[20:23], a[128:131], v[96:99], 0
ds_read_b64_tr_b16 a[16:17], v13 offset:16384
ds_read_b64_tr_b16 a[18:19], v13 offset:18432
v_mfma_f32_16x16x32_bf16 v[20:23], a[132:135], v[100:103], v[20:23]
s_add_u32 s51, s49, 7680
buffer_store_dwordx4 v[156:159], v9, s[24:27], s51 offen sc1
v_mfma_f32_16x16x32_bf16 v[20:23], a[136:139], v[104:107], v[20:23]
ds_read_b64_tr_b16 a[20:21], v13 offset:20480
ds_read_b64_tr_b16 a[22:23], v13 offset:22528
v_mfma_f32_16x16x32_bf16 v[20:23], a[140:143], v[108:111], v[20:23]
s_add_u32 s7, s29, 16779264
buffer_load_dwordx4 a[64:67], v56, s[24:27], s7 offen sc1
v_mfma_f32_16x16x32_bf16 v[20:23], a[144:147], v[112:115], v[20:23]
ds_read_b64_tr_b16 a[24:25], v13 offset:24576
ds_read_b64_tr_b16 a[26:27], v13 offset:26624
v_mfma_f32_16x16x32_bf16 v[20:23], a[148:151], v[116:119], v[20:23]
s_add_u32 s7, s29, 26216448
buffer_load_dwordx4 a[68:71], v56, s[24:27], s7 offen sc1
v_mfma_f32_16x16x32_bf16 v[20:23], a[152:155], v[120:123], v[20:23]
ds_read_b64_tr_b16 a[28:29], v13 offset:28672
ds_read_b64_tr_b16 a[30:31], v13 offset:30720
v_mfma_f32_16x16x32_bf16 v[20:23], a[156:159], v[124:127], v[20:23]
s_waitcnt lgkmcnt(6)
s_add_u32 s7, s29, 35653632
buffer_load_dwordx4 a[72:75], v56, s[24:27], s7 offen sc1
v_mfma_f32_16x16x32_bf16 v[24:27], a[0:3], v[64:67], 0
ds_read_b64_tr_b16 a[128:129], v14 offset:0
ds_read_b64_tr_b16 a[130:131], v14 offset:2048
v_mfma_f32_16x16x32_bf16 v[24:27], a[4:7], v[68:71], v[24:27]
s_add_u32 s7, s29, 45090816
buffer_load_dwordx4 a[76:79], v56, s[24:27], s7 offen sc1
v_mfma_f32_16x16x32_bf16 v[24:27], a[8:11], v[72:75], v[24:27]
ds_read_b64_tr_b16 a[132:133], v14 offset:4096
ds_read_b64_tr_b16 a[134:135], v14 offset:6144
v_mfma_f32_16x16x32_bf16 v[24:27], a[12:15], v[76:79], v[24:27]
v_cvt_pk_bf16_f32 v128, v16, v17
v_cvt_pk_bf16_f32 v129, v18, v19
v_mfma_f32_16x16x32_bf16 v[24:27], a[16:19], v[80:83], v[24:27]
s_waitcnt lgkmcnt(4)
ds_read_b64_tr_b16 a[136:137], v14 offset:8192
ds_read_b64_tr_b16 a[138:139], v14 offset:10240
v_mfma_f32_16x16x32_bf16 v[24:27], a[20:23], v[84:87], v[24:27]
v_cvt_pk_bf16_f32 v132, v20, v21
v_cvt_pk_bf16_f32 v133, v22, v23
v_mfma_f32_16x16x32_bf16 v[24:27], a[24:27], v[88:91], v[24:27]
ds_read_b64_tr_b16 a[140:141], v14 offset:12288
ds_read_b64_tr_b16 a[142:143], v14 offset:14336
v_mfma_f32_16x16x32_bf16 v[24:27], a[28:31], v[92:95], v[24:27]
s_add_u32 s7, s29, 16780288
buffer_load_dwordx4 a[80:83], v56, s[24:27], s7 offen sc1
v_mfma_f32_16x16x32_bf16 v[28:31], a[0:3], v[96:99], 0
ds_read_b64_tr_b16 a[144:145], v14 offset:16384
ds_read_b64_tr_b16 a[146:147], v14 offset:18432
v_mfma_f32_16x16x32_bf16 v[28:31], a[4:7], v[100:103], v[28:31]
s_add_u32 s7, s29, 26217472
buffer_load_dwordx4 a[84:87], v56, s[24:27], s7 offen sc1
v_mfma_f32_16x16x32_bf16 v[28:31], a[8:11], v[104:107], v[28:31]
ds_read_b64_tr_b16 a[148:149], v14 offset:20480
ds_read_b64_tr_b16 a[150:151], v14 offset:22528
v_mfma_f32_16x16x32_bf16 v[28:31], a[12:15], v[108:111], v[28:31]
s_add_u32 s7, s29, 35654656
buffer_load_dwordx4 a[88:91], v56, s[24:27], s7 offen sc1
v_mfma_f32_16x16x32_bf16 v[28:31], a[16:19], v[112:115], v[28:31]
ds_read_b64_tr_b16 a[152:153], v14 offset:24576
ds_read_b64_tr_b16 a[154:155], v14 offset:26624
v_mfma_f32_16x16x32_bf16 v[28:31], a[20:23], v[116:119], v[28:31]
s_add_u32 s7, s29, 45091840
buffer_load_dwordx4 a[92:95], v56, s[24:27], s7 offen sc1
v_mfma_f32_16x16x32_bf16 v[28:31], a[24:27], v[120:123], v[28:31]
ds_read_b64_tr_b16 a[156:157], v14 offset:28672
ds_read_b64_tr_b16 a[158:159], v14 offset:30720
v_mfma_f32_16x16x32_bf16 v[28:31], a[28:31], v[124:127], v[28:31]
s_waitcnt lgkmcnt(6)
v_mfma_f32_16x16x32_bf16 v[32:35], a[128:131], v[64:67], 0
ds_read_b64_tr_b16 a[0:1], v15 offset:0
ds_read_b64_tr_b16 a[2:3], v15 offset:2048
v_mfma_f32_16x16x32_bf16 v[32:35], a[132:135], v[68:71], v[32:35]
s_add_u32 s51, s48, 8192
v_mfma_f32_16x16x32_bf16 v[32:35], a[136:139], v[72:75], v[32:35]
ds_read_b64_tr_b16 a[4:5], v15 offset:4096
ds_read_b64_tr_b16 a[6:7], v15 offset:6144
v_mfma_f32_16x16x32_bf16 v[32:35], a[140:143], v[76:79], v[32:35]
v_cvt_pk_bf16_f32 v130, v24, v25
v_cvt_pk_bf16_f32 v131, v26, v27
v_mfma_f32_16x16x32_bf16 v[32:35], a[144:147], v[80:83], v[32:35]
s_waitcnt lgkmcnt(4)
ds_read_b64_tr_b16 a[8:9], v15 offset:8192
ds_read_b64_tr_b16 a[10:11], v15 offset:10240
v_mfma_f32_16x16x32_bf16 v[32:35], a[148:151], v[84:87], v[32:35]
v_cvt_pk_bf16_f32 v134, v28, v29
v_cvt_pk_bf16_f32 v135, v30, v31
v_mfma_f32_16x16x32_bf16 v[32:35], a[152:155], v[88:91], v[32:35]
ds_read_b64_tr_b16 a[12:13], v15 offset:12288
ds_read_b64_tr_b16 a[14:15], v15 offset:14336
v_mfma_f32_16x16x32_bf16 v[32:35], a[156:159], v[92:95], v[32:35]
buffer_store_dwordx4 v[128:131], v9, s[24:27], s51 offen sc1
v_mfma_f32_16x16x32_bf16 v[36:39], a[128:131], v[96:99], 0
ds_read_b64_tr_b16 a[16:17], v15 offset:16384
ds_read_b64_tr_b16 a[18:19], v15 offset:18432
v_mfma_f32_16x16x32_bf16 v[36:39], a[132:135], v[100:103], v[36:39]
s_add_u32 s51, s49, 8192
buffer_store_dwordx4 v[132:135], v9, s[24:27], s51 offen sc1
v_mfma_f32_16x16x32_bf16 v[36:39], a[136:139], v[104:107], v[36:39]
ds_read_b64_tr_b16 a[20:21], v15 offset:20480
ds_read_b64_tr_b16 a[22:23], v15 offset:22528
v_mfma_f32_16x16x32_bf16 v[36:39], a[140:143], v[108:111], v[36:39]
v_mfma_f32_16x16x32_bf16 v[36:39], a[144:147], v[112:115], v[36:39]
ds_read_b64_tr_b16 a[24:25], v15 offset:24576
ds_read_b64_tr_b16 a[26:27], v15 offset:26624
v_mfma_f32_16x16x32_bf16 v[36:39], a[148:151], v[116:119], v[36:39]
v_mfma_f32_16x16x32_bf16 v[36:39], a[152:155], v[120:123], v[36:39]
ds_read_b64_tr_b16 a[28:29], v15 offset:28672
ds_read_b64_tr_b16 a[30:31], v15 offset:30720
v_mfma_f32_16x16x32_bf16 v[36:39], a[156:159], v[124:127], v[36:39]
s_waitcnt lgkmcnt(6)
v_mfma_f32_16x16x32_bf16 v[40:43], a[0:3], v[64:67], 0
v_mfma_f32_16x16x32_bf16 v[40:43], a[4:7], v[68:71], v[40:43]
v_mfma_f32_16x16x32_bf16 v[40:43], a[8:11], v[72:75], v[40:43]
v_mfma_f32_16x16x32_bf16 v[40:43], a[12:15], v[76:79], v[40:43]
v_cvt_pk_bf16_f32 v136, v32, v33
v_cvt_pk_bf16_f32 v137, v34, v35
v_mfma_f32_16x16x32_bf16 v[40:43], a[16:19], v[80:83], v[40:43]
s_waitcnt lgkmcnt(0)
v_cvt_pk_bf16_f32 v140, v36, v37
v_cvt_pk_bf16_f32 v141, v38, v39
v_mfma_f32_16x16x32_bf16 v[40:43], a[20:23], v[84:87], v[40:43]
v_mfma_f32_16x16x32_bf16 v[40:43], a[24:27], v[88:91], v[40:43]
v_mfma_f32_16x16x32_bf16 v[40:43], a[28:31], v[92:95], v[40:43]
v_mfma_f32_16x16x32_bf16 v[44:47], a[0:3], v[96:99], 0
v_mfma_f32_16x16x32_bf16 v[44:47], a[4:7], v[100:103], v[44:47]
v_mfma_f32_16x16x32_bf16 v[44:47], a[8:11], v[104:107], v[44:47]
v_mfma_f32_16x16x32_bf16 v[44:47], a[12:15], v[108:111], v[44:47]
v_mfma_f32_16x16x32_bf16 v[44:47], a[16:19], v[112:115], v[44:47]
v_mfma_f32_16x16x32_bf16 v[44:47], a[20:23], v[116:119], v[44:47]
v_mfma_f32_16x16x32_bf16 v[44:47], a[24:27], v[120:123], v[44:47]
v_mfma_f32_16x16x32_bf16 v[44:47], a[28:31], v[124:127], v[44:47]
v_cvt_pk_bf16_f32 v138, v40, v41
v_cvt_pk_bf16_f32 v139, v42, v43
s_nop 5
v_cvt_pk_bf16_f32 v142, v44, v45
v_cvt_pk_bf16_f32 v143, v46, v47
s_add_u32 s51, s48, 8704
buffer_store_dwordx4 v[136:139], v9, s[24:27], s51 offen sc1
s_add_u32 s51, s49, 8704
buffer_store_dwordx4 v[140:143], v9, s[24:27], s51 offen sc1
s_waitcnt vmcnt(12)
buffer_store_dword v0, v0, s[24:27], s55 offen offset:1536 sc1
s_cmp_eq_u32 s28, s60
s_cbranch_scc0 K1_m00
K1_r00:
s_cmp_eq_u32 s29, s60
s_cbranch_scc0 K1_m01
K1_r01:
s_add_u32 s38, s32, 1024
s_mov_b32 s39, 0x20000
s_and_b32 s6, s3, 3
s_cbranch_scc1 K1_poll1d
K1_poll1:
s_load_dwordx16 s[64:79], s[52:53], s38 glc
s_waitcnt lgkmcnt(0)
s_and_b64 s[64:65], s[64:65], s[72:73]
s_and_b64 s[66:67], s[66:67], s[74:75]
s_and_b64 s[68:69], s[68:69], s[76:77]
s_and_b64 s[70:71], s[70:71], s[78:79]
s_and_b64 s[64:65], s[64:65], s[68:69]
s_and_b64 s[66:67], s[66:67], s[70:71]
s_and_b64 s[64:65], s[64:65], s[66:67]
s_and_b32 s64, s64, s65
s_cbranch_scc1 K1_poll1d
s_sub_u32 s39, s39, 1
s_cbranch_scc0 K1_poll1
K1_poll1d:
s_barrier
s_add_u32 s7, s60, 16781312
buffer_load_dwordx4 a[96:99], v56, s[24:27], s7 offen sc1
s_add_u32 s7, s60, 26218496
buffer_load_dwordx4 a[100:103], v56, s[24:27], s7 offen sc1
s_add_u32 s7, s60, 35655680
buffer_load_dwordx4 a[104:107], v56, s[24:27], s7 offen sc1
s_add_u32 s7, s60, 45092864
buffer_load_dwordx4 a[108:111], v56, s[24:27], s7 offen sc1
s_add_u32 s7, s60, 16782336
buffer_load_dwordx4 a[112:115], v56, s[24:27], s7 offen sc1
s_add_u32 s7, s60, 26219520
buffer_load_dwordx4 a[116:119], v56, s[24:27], s7 offen sc1
s_add_u32 s7, s60, 35656704
buffer_load_dwordx4 a[120:123], v56, s[24:27], s7 offen sc1
s_add_u32 s7, s60, 45093888
buffer_load_dwordx4 a[124:127], v56, s[24:27], s7 offen sc1
s_waitcnt vmcnt(9)
buffer_store_dword v0, v0, s[24:27], s55 offen offset:2048 sc1
s_add_u32 s7, s61, 4608
buffer_load_dwordx4 v[172:175], v59, s[24:27], s7 offen offset:0 sc1
s_add_u32 s7, s61, 4608
buffer_load_dwordx4 v[176:179], v59, s[24:27], s7 offen offset:512 sc1
s_add_u32 s7, s61, 4608
buffer_load_dwordx4 v[180:183], v59, s[24:27], s7 offen offset:1024 sc1
s_add_u32 s7, s61, 4608
buffer_load_dwordx4 v[184:187], v59, s[24:27], s7 offen offset:1536 sc1
s_add_u32 s7, s61, 4608
buffer_load_dwordx4 v[188:191], v59, s[24:27], s7 offen offset:2048 sc1
s_add_u32 s7, s61, 9216
buffer_load_dwordx4 v[192:195], v59, s[24:27], s7 offen offset:0 sc1
s_add_u32 s7, s61, 9216
buffer_load_dwordx4 v[196:199], v59, s[24:27], s7 offen offset:512 sc1
s_add_u32 s7, s61, 9216
buffer_load_dwordx4 v[200:203], v59, s[24:27], s7 offen offset:1024 sc1
s_add_u32 s7, s61, 9216
buffer_load_dwordx4 v[204:207], v59, s[24:27], s7 offen offset:1536 sc1
s_add_u32 s7, s61, 9216
buffer_load_dwordx4 v[208:211], v59, s[24:27], s7 offen offset:2048 sc1
s_add_u32 s7, s61, 6912
buffer_load_dwordx4 v[212:215], v59, s[24:27], s7 offen offset:0 sc1
s_add_u32 s7, s61, 6912
buffer_load_dwordx4 v[216:219], v59, s[24:27], s7 offen offset:512 sc1
s_add_u32 s7, s61, 6912
buffer_load_dwordx4 v[220:223], v59, s[24:27], s7 offen offset:1024 sc1
s_add_u32 s7, s61, 6912
buffer_load_dwordx4 v[224:227], v59, s[24:27], s7 offen offset:1536 sc1
s_add_u32 s7, s61, 6912
buffer_load_dwordx4 v[228:231], v59, s[24:27], s7 offen offset:2048 sc1
s_and_b32 s38, s3, 1
s_lshr_b32 s39, s3, 1
v_lshlrev_b32 v8, 4, v1
v_lshrrev_b32 v19, 4, v1
s_mul_i32 s6, s38, 110592
v_add_u32 v7, s6, v8
s_lshl_b32 s6, s39, 12
v_add_u32 v6, s6, v7
v_lshrrev_b32 v26, 2, v1
v_and_b32 v27, 3, v1
v_lshlrev_b32 v25, 7, v26
v_lshl_add_u32 v25, v27, 3, v25
v_add_u32 v25, 36864, v25
v_bfe_u32 v24, v1, 3, 2
s_lshl_b32 s6, s39, 1
v_xor_b32 v23, s6, v24
v_xor_b32 v23, 0, v23
v_lshl_add_u32 v10, v23, 5, v25
v_add_u32 v11, 36864, v10
v_xor_b32 v23, s6, v24
v_xor_b32 v23, 1, v23
v_lshl_add_u32 v12, v23, 5, v25
v_add_u32 v13, 36864, v12
v_lshlrev_b32 v25, 6, v26
v_lshl_add_u32 v25, v27, 3, v25
v_add_u32 v25, 36864, v25
v_and_b32 v23, 1, v19
v_xor_b32 v23, s39, v23
v_lshl_add_u32 v14, v23, 5, v25
v_add_u32 v15, 36864, v14
s_lshl_b32 s6, s39, 3
v_add_u32 v5, s6, v7
s_mov_b32 s20, s62
s_mov_b32 s21, s63
s_mov_b32 s22, 2359296
s_mov_b32 s23, 0x20000
v_lshlrev_b32 v64, 16, v160
v_and_b32 v65, 0xffff0000, v160
v_lshlrev_b32 v66, 16, v161
v_and_b32 v67, 0xffff0000, v161
v_lshlrev_b32 v68, 16, v162
v_and_b32 v69, 0xffff0000, v162
v_lshlrev_b32 v70, 16, v163
v_and_b32 v71, 0xffff0000, v163
v_lshlrev_b32 v72, 16, v164
v_and_b32 v73, 0xffff0000, v164
v_lshlrev_b32 v74, 16, v165
v_and_b32 v75, 0xffff0000, v165
v_lshlrev_b32 v76, 16, v166
v_and_b32 v77, 0xffff0000, v166
v_lshlrev_b32 v78, 16, v167
v_and_b32 v79, 0xffff0000, v167
v_lshlrev_b32 v80, 16, v168
v_and_b32 v81, 0xffff0000, v168
v_lshlrev_b32 v82, 16, v169
v_and_b32 v83, 0xffff0000, v169
v_and_b32 v100, 7, v1
v_lshlrev_b32 v110, 4, v100
v_lshl_add_u32 v114, v100, 5, 0
v_add_u32 v114, 159744, v114
s_lshl_b32 s6, s3, 3
v_add_u32 v113, s6, v114
v_and_b32 v100, 8, v1
v_lshl_add_u32 v110, v100, 5, v110
v_and_b32 v100, 16, v1
v_lshl_add_u32 v110, v100, 8, v110
v_and_b32 v100, 32, v1
v_lshl_add_u32 v110, v100, 6, v110
v_cmp_eq_u32 vcc, 0, v100
v_and_b32 v100, 48, v1
v_lshl_add_u32 v111, v100, 25, v110
v_cndmask_b32 v115, 0, 1.0, vcc
s_add_u32 s6, s40, 147456
v_add_u32 v112, s6, v8
s_lshl_b32 s6, s5, 3
s_lshr_b32 s7, s4, 1
s_add_u32 s6, s6, s7
s_mul_i32 s48, s6, 18432
s_and_b32 s6, s4, 1
s_lshl_b32 s6, s6, 7
s_add_u32 s48, s48, s6
s_lshl_b32 s6, s3, 9
s_add_u32 s48, s48, s6
v_lshrrev_b32 v100, 2, v1
v_and_b32 v116, 3, v1
v_lshl_add_u32 v116, v100, 4, v116
v_and_b32 v100, 48, v1
v_lshl_add_u32 v116, v116, 8, 4
v_lshl_add_u32 v116, v100, 25, v116
s_cmp_eq_u32 s3, 0
s_cselect_b32 s49, s55, 0x10000000
s_add_u32 s38, s32, 1536
s_mov_b32 s39, 0x20000
s_and_b32 s6, s3, 3
s_cbranch_scc1 K1_poll2d
K1_poll2:
s_load_dwordx16 s[64:79], s[52:53], s38 glc
s_waitcnt lgkmcnt(0)
s_and_b64 s[64:65], s[64:65], s[72:73]
s_and_b64 s[66:67], s[66:67], s[74:75]
s_and_b64 s[68:69], s[68:69], s[76:77]
s_and_b64 s[70:71], s[70:71], s[78:79]
s_and_b64 s[64:65], s[64:65], s[68:69]
s_and_b64 s[66:67], s[66:67], s[70:71]
s_and_b64 s[64:65], s[64:65], s[66:67]
s_and_b32 s64, s64, s65
s_cbranch_scc1 K1_poll2d
s_sub_u32 s39, s39, 1
s_cbranch_scc0 K1_poll2
K1_poll2d:
s_barrier
s_add_u32 s7, s60, 16783360
buffer_load_dwordx4 a[160:163], v56, s[24:27], s7 offen sc1
s_add_u32 s7, s60, 26220544
buffer_load_dwordx4 a[164:167], v56, s[24:27], s7 offen sc1
s_add_u32 s7, s60, 35657728
buffer_load_dwordx4 a[168:171], v56, s[24:27], s7 offen sc1
s_add_u32 s7, s60, 45094912
buffer_load_dwordx4 a[172:175], v56, s[24:27], s7 offen sc1
s_add_u32 s7, s60, 16784384
buffer_load_dwordx4 a[176:179], v56, s[24:27], s7 offen sc1
s_add_u32 s7, s60, 26221568
buffer_load_dwordx4 a[180:183], v56, s[24:27], s7 offen sc1
s_add_u32 s7, s60, 35658752
buffer_load_dwordx4 a[184:187], v56, s[24:27], s7 offen sc1
s_add_u32 s7, s60, 45095936
buffer_load_dwordx4 a[188:191], v56, s[24:27], s7 offen sc1
s_add_u32 s38, s32, 2048
s_mov_b32 s39, 0x20000
s_and_b32 s6, s3, 3
s_cbranch_scc1 K1_poll3d
K1_poll3:
s_load_dwordx16 s[64:79], s[52:53], s38 glc
s_waitcnt lgkmcnt(0)
s_and_b64 s[64:65], s[64:65], s[72:73]
s_and_b64 s[66:67], s[66:67], s[74:75]
s_and_b64 s[68:69], s[68:69], s[76:77]
s_and_b64 s[70:71], s[70:71], s[78:79]
s_and_b64 s[64:65], s[64:65], s[68:69]
s_and_b64 s[66:67], s[66:67], s[70:71]
s_and_b64 s[64:65], s[64:65], s[66:67]
s_and_b32 s64, s64, s65
s_cbranch_scc1 K1_poll3d
s_sub_u32 s39, s39, 1
s_cbranch_scc0 K1_poll3
K1_poll3d:
s_barrier
s_add_u32 s7, s60, 16785408
buffer_load_dwordx4 a[192:195], v56, s[24:27], s7 offen sc1
s_add_u32 s7, s60, 26222592
buffer_load_dwordx4 a[196:199], v56, s[24:27], s7 offen sc1
s_add_u32 s7, s60, 35659776
buffer_load_dwordx4 a[200:203], v56, s[24:27], s7 offen sc1
s_add_u32 s7, s60, 45096960
buffer_load_dwordx4 a[204:207], v56, s[24:27], s7 offen sc1
s_waitcnt vmcnt(28)
v_mfma_f32_16x16x32_bf16 v[232:235], v[48:51], a[32:35], 0
v_mfma_f32_16x16x32_bf16 v[232:235], v[48:51], a[36:39], v[232:235]
v_mfma_f32_16x16x32_bf16 v[232:235], v[48:51], a[40:43], v[232:235]
v_mfma_f32_16x16x32_bf16 v[232:235], v[48:51], a[44:47], v[232:235]
v_mfma_f32_16x16x32_bf16 v[232:235], v[52:55], a[48:51], v[232:235]
v_mfma_f32_16x16x32_bf16 v[232:235], v[52:55], a[52:55], v[232:235]
v_mfma_f32_16x16x32_bf16 v[232:235], v[52:55], a[56:59], v[232:235]
v_mfma_f32_16x16x32_bf16 v[232:235], v[52:55], a[60:63], v[232:235]
v_mfma_f32_16x16x32_bf16 v[236:239], v[48:51], a[64:67], 0
v_mfma_f32_16x16x32_bf16 v[236:239], v[48:51], a[68:71], v[236:239]
v_mfma_f32_16x16x32_bf16 v[236:239], v[48:51], a[72:75], v[236:239]
v_mfma_f32_16x16x32_bf16 v[236:239], v[48:51], a[76:79], v[236:239]
v_mfma_f32_16x16x32_bf16 v[236:239], v[52:55], a[80:83], v[236:239]
v_mfma_f32_16x16x32_bf16 v[236:239], v[52:55], a[84:87], v[236:239]
v_mfma_f32_16x16x32_bf16 v[236:239], v[52:55], a[88:91], v[236:239]
v_mfma_f32_16x16x32_bf16 v[236:239], v[52:55], a[92:95], v[236:239]
v_mfma_f32_16x16x32_bf16 v[240:243], v[48:51], a[96:99], 0
v_mfma_f32_16x16x32_bf16 v[240:243], v[48:51], a[100:103], v[240:243]
v_mfma_f32_16x16x32_bf16 v[240:243], v[48:51], a[104:107], v[240:243]
v_mfma_f32_16x16x32_bf16 v[240:243], v[48:51], a[108:111], v[240:243]
v_mfma_f32_16x16x32_bf16 v[240:243], v[52:55], a[112:115], v[240:243]
v_mfma_f32_16x16x32_bf16 v[240:243], v[52:55], a[116:119], v[240:243]
v_mfma_f32_16x16x32_bf16 v[240:243], v[52:55], a[120:123], v[240:243]
v_mfma_f32_16x16x32_bf16 v[240:243], v[52:55], a[124:127], v[240:243]
s_waitcnt vmcnt(11)
v_pk_fma_f32 v[64:65], v[232:233], v[172:173], v[64:65]
v_pk_fma_f32 v[66:67], v[234:235], v[174:175], v[66:67]
v_cvt_pk_bf16_f32 v88, v64, v65
v_cvt_pk_bf16_f32 v89, v66, v67
v_lshlrev_b32 v64, 16, v88
v_and_b32 v65, 0xffff0000, v88
v_lshlrev_b32 v66, 16, v89
v_and_b32 v67, 0xffff0000, v89
v_pk_add_f32 v[100:101], v[64:65], v[66:67]
v_pk_fma_f32 v[68:69], v[236:237], v[176:177], v[68:69]
v_pk_fma_f32 v[70:71], v[238:239], v[178:179], v[70:71]
v_cvt_pk_bf16_f32 v90, v68, v69
v_cvt_pk_bf16_f32 v91, v70, v71
v_lshlrev_b32 v68, 16, v90
v_and_b32 v69, 0xffff0000, v90
v_lshlrev_b32 v70, 16, v91
v_and_b32 v71, 0xffff0000, v91
v_pk_add_f32 v[100:101], v[100:101], v[68:69]
v_pk_add_f32 v[100:101], v[100:101], v[70:71]
v_pk_fma_f32 v[72:73], v[240:241], v[180:181], v[72:73]
v_pk_fma_f32 v[74:75], v[242:243], v[182:183], v[74:75]
v_cvt_pk_bf16_f32 v92, v72, v73
v_cvt_pk_bf16_f32 v93, v74, v75
v_lshlrev_b32 v72, 16, v92
v_and_b32 v73, 0xffff0000, v92
v_lshlrev_b32 v74, 16, v93
v_and_b32 v75, 0xffff0000, v93
v_pk_add_f32 v[100:101], v[100:101], v[72:73]
v_pk_add_f32 v[100:101], v[100:101], v[74:75]
ds_write_b128 v112, v[88:91]
v_mfma_f32_16x16x32_bf16 v[244:247], v[48:51], a[160:163], 0
s_waitcnt vmcnt(10)
v_mfma_f32_16x16x32_bf16 v[244:247], v[48:51], a[164:167], v[244:247]
s_waitcnt vmcnt(9)
v_mfma_f32_16x16x32_bf16 v[244:247], v[48:51], a[168:171], v[244:247]
s_waitcnt vmcnt(8)
v_mfma_f32_16x16x32_bf16 v[244:247], v[48:51], a[172:175], v[244:247]
s_waitcnt vmcnt(7)
v_mfma_f32_16x16x32_bf16 v[244:247], v[52:55], a[176:179], v[244:247]
s_waitcnt vmcnt(6)
v_mfma_f32_16x16x32_bf16 v[244:247], v[52:55], a[180:183], v[244:247]
s_waitcnt vmcnt(5)
v_mfma_f32_16x16x32_bf16 v[244:247], v[52:55], a[184:187], v[244:247]
s_waitcnt vmcnt(4)
v_mfma_f32_16x16x32_bf16 v[244:247], v[52:55], a[188:191], v[244:247]
s_waitcnt vmcnt(3)
s_nop 6
v_pk_fma_f32 v[76:77], v[244:245], v[184:185], v[76:77]
v_pk_fma_f32 v[78:79], v[246:247], v[186:187], v[78:79]
v_cvt_pk_bf16_f32 v94, v76, v77
v_cvt_pk_bf16_f32 v95, v78, v79
v_lshlrev_b32 v76, 16, v94
v_and_b32 v77, 0xffff0000, v94
v_lshlrev_b32 v78, 16, v95
v_and_b32 v79, 0xffff0000, v95
v_pk_add_f32 v[100:101], v[100:101], v[76:77]
v_pk_add_f32 v[100:101], v[100:101], v[78:79]
v_mfma_f32_16x16x32_bf16 v[248:251], v[48:51], a[192:195], 0
s_waitcnt vmcnt(2)
v_mfma_f32_16x16x32_bf16 v[248:251], v[48:51], a[196:199], v[248:251]
s_waitcnt vmcnt(1)
v_mfma_f32_16x16x32_bf16 v[248:251], v[48:51], a[200:203], v[248:251]
s_waitcnt vmcnt(0)
v_mfma_f32_16x16x32_bf16 v[248:251], v[48:51], a[204:207], v[248:251]
s_nop 7
v_pk_fma_f32 v[80:81], v[248:249], v[188:189], v[80:81]
v_pk_fma_f32 v[82:83], v[250:251], v[190:191], v[82:83]
v_cvt_pk_bf16_f32 v96, v80, v81
v_cvt_pk_bf16_f32 v97, v82, v83
v_lshlrev_b32 v80, 16, v96
v_and_b32 v81, 0xffff0000, v96
v_lshlrev_b32 v82, 16, v97
v_and_b32 v83, 0xffff0000, v97
v_pk_add_f32 v[100:101], v[100:101], v[80:81]
v_pk_add_f32 v[100:101], v[100:101], v[82:83]
v_add_f32 v100, v100, v101
s_nop 1
v_add_f32_dpp v100, v100, v100 row_ror:8 row_mask:0xf bank_mask:0xf
v_mov_b32 v101, v100
s_nop 1
v_permlane16_swap_b32 v100, v101
v_add_f32 v100, v100, v101
v_mov_b32 v101, v100
s_nop 1
v_permlane32_swap_b32 v100, v101
v_add_f32 v100, v100, v101
ds_write_b128 v112, v[92:95] offset:4096
ds_write_b64 v112, v[96:97] offset:8192
v_mul_f32 v100, 0x3be38e39, v100
v_mul_f32 v102, v100, v115
v_pk_add_f32 v[64:65], v[64:65], v[100:101] op_sel_hi:[1,0] neg_lo:[0,1] neg_hi:[0,1]
v_pk_add_f32 v[66:67], v[66:67], v[100:101] op_sel_hi:[1,0] neg_lo:[0,1] neg_hi:[0,1]
v_pk_add_f32 v[68:69], v[68:69], v[100:101] op_sel_hi:[1,0] neg_lo:[0,1] neg_hi:[0,1]
v_pk_add_f32 v[70:71], v[70:71], v[100:101] op_sel_hi:[1,0] neg_lo:[0,1] neg_hi:[0,1]
v_pk_add_f32 v[72:73], v[72:73], v[100:101] op_sel_hi:[1,0] neg_lo:[0,1] neg_hi:[0,1]
v_pk_add_f32 v[74:75], v[74:75], v[100:101] op_sel_hi:[1,0] neg_lo:[0,1] neg_hi:[0,1]
v_pk_add_f32 v[76:77], v[76:77], v[100:101] op_sel_hi:[1,0] neg_lo:[0,1] neg_hi:[0,1]
v_pk_add_f32 v[78:79], v[78:79], v[100:101] op_sel_hi:[1,0] neg_lo:[0,1] neg_hi:[0,1]
v_pk_add_f32 v[80:81], v[80:81], v[102:103] op_sel_hi:[1,0] neg_lo:[0,1] neg_hi:[0,1]
v_pk_add_f32 v[82:83], v[82:83], v[102:103] op_sel_hi:[1,0] neg_lo:[0,1] neg_hi:[0,1]
v_pk_mul_f32 v[102:103], v[64:65], v[64:65]
v_pk_mul_f32 v[104:105], v[66:67], v[66:67]
v_pk_fma_f32 v[102:103], v[68:69], v[68:69], v[102:103]
v_pk_fma_f32 v[104:105], v[70:71], v[70:71], v[104:105]
v_pk_fma_f32 v[102:103], v[72:73], v[72:73], v[102:103]
v_pk_fma_f32 v[104:105], v[74:75], v[74:75], v[104:105]
v_pk_fma_f32 v[102:103], v[76:77], v[76:77], v[102:103]
v_pk_fma_f32 v[104:105], v[78:79], v[78:79], v[104:105]
v_pk_fma_f32 v[102:103], v[80:81], v[80:81], v[102:103]
v_pk_fma_f32 v[104:105], v[82:83], v[82:83], v[104:105]
v_pk_add_f32 v[102:103], v[102:103], v[104:105]
v_add_f32 v101, v102, v103
s_nop 1
v_add_f32_dpp v101, v101, v101 row_ror:8 row_mask:0xf bank_mask:0xf
v_mov_b32 v102, v101
s_nop 1
v_permlane16_swap_b32 v101, v102
v_add_f32 v101, v101, v102
v_mov_b32 v102, v101
s_nop 1
v_permlane32_swap_b32 v101, v102
v_add_f32 v101, v101, v102
ds_write_b64 v113, v[100:101]
s_waitcnt lgkmcnt(0)
s_barrier
ds_read_b128 v[120:123], v114
ds_read_b128 v[124:127], v114 offset:16
s_waitcnt lgkmcnt(1)
v_pk_add_f32 v[102:103], v[120:121], v[122:123]
s_waitcnt lgkmcnt(0)
v_pk_add_f32 v[104:105], v[124:125], v[126:127]
v_pk_add_f32 v[102:103], v[102:103], v[104:105]
v_mul_f32 v102, 0.25, v102
v_sub_f32 v120, v120, v102
v_sub_f32 v122, v122, v102
v_sub_f32 v124, v124, v102
v_sub_f32 v126, v126, v102
v_mul_f32 v104, v120, v120
v_fmac_f32 v104, v122, v122
v_fmac_f32 v104, v124, v124
v_fmac_f32 v104, v126, v126
v_fmac_f32 v103, 0x43100000, v104
v_mov_b32 v104, 0x3727c5ac
v_fmac_f32 v104, 0x3ae38e39, v103
v_rsq_f32 v104, v104
v_sub_f32 v100, v100, v102
v_mul_f32 v100, v100, v104
v_pk_fma_f32 v[64:65], v[64:65], v[104:105], v[100:101] op_sel_hi:[1,0,0]
v_pk_fma_f32 v[64:65], v[64:65], v[192:193], v[212:213]
v_pk_fma_f32 v[66:67], v[66:67], v[104:105], v[100:101] op_sel_hi:[1,0,0]
v_pk_fma_f32 v[66:67], v[66:67], v[194:195], v[214:215]
v_cvt_pk_bf16_f32 v120, v64, v65
v_cvt_pk_bf16_f32 v121, v66, v67
v_pk_fma_f32 v[68:69], v[68:69], v[104:105], v[100:101] op_sel_hi:[1,0,0]
v_pk_fma_f32 v[68:69], v[68:69], v[196:197], v[216:217]
v_pk_fma_f32 v[70:71], v[70:71], v[104:105], v[100:101] op_sel_hi:[1,0,0]
v_pk_fma_f32 v[70:71], v[70:71], v[198:199], v[218:219]
v_cvt_pk_bf16_f32 v122, v68, v69
v_cvt_pk_bf16_f32 v123, v70, v71
s_nop 0
v_permlane16_swap_b32 v120, v122
v_permlane16_swap_b32 v121, v123
s_add_u32 s7, s48, 7340032
buffer_store_dwordx4 v[120:123], v110, s[24:27], s7 offen sc1
v_pk_fma_f32 v[72:73], v[72:73], v[104:105], v[100:101] op_sel_hi:[1,0,0]
v_pk_fma_f32 v[72:73], v[72:73], v[200:201], v[220:221]
v_pk_fma_f32 v[74:75], v[74:75], v[104:105], v[100:101] op_sel_hi:[1,0,0]
v_pk_fma_f32 v[74:75], v[74:75], v[202:203], v[222:223]
v_cvt_pk_bf16_f32 v124, v72, v73
v_cvt_pk_bf16_f32 v125, v74, v75
v_pk_fma_f32 v[76:77], v[76:77], v[104:105], v[100:101] op_sel_hi:[1,0,0]
v_pk_fma_f32 v[76:77], v[76:77], v[204:205], v[224:225]
v_pk_fma_f32 v[78:79], v[78:79], v[104:105], v[100:101] op_sel_hi:[1,0,0]
v_pk_fma_f32 v[78:79], v[78:79], v[206:207], v[226:227]
v_cvt_pk_bf16_f32 v126, v76, v77
v_cvt_pk_bf16_f32 v127, v78, v79
s_nop 0
v_permlane16_swap_b32 v124, v126
v_permlane16_swap_b32 v125, v127
s_add_u32 s7, s48, 7348224
buffer_store_dwordx4 v[124:127], v110, s[24:27], s7 offen sc1
v_pk_fma_f32 v[80:81], v[80:81], v[104:105], v[100:101] op_sel_hi:[1,0,0]
v_pk_fma_f32 v[80:81], v[80:81], v[208:209], v[228:229]
v_pk_fma_f32 v[82:83], v[82:83], v[104:105], v[100:101] op_sel_hi:[1,0,0]
v_pk_fma_f32 v[82:83], v[82:83], v[210:211], v[230:231]
v_cvt_pk_bf16_f32 v128, v80, v81
v_cvt_pk_bf16_f32 v129, v82, v83
s_nop 0
v_permlane16_swap_b32 v128, v130
v_permlane16_swap_b32 v129, v131
s_add_u32 s7, s48, 7356416
buffer_store_dwordx4 v[128:131], v111, s[24:27], s7 offen sc1
s_waitcnt vmcnt(0)
s_barrier
buffer_store_dword v116, v116, s[24:27], s49 offen offset:2560 sc1
s_add_u32 m0, s97, 49152
s_add_u32 s45, s41, 0
buffer_load_dwordx4 v2, s[12:15], s45 offen offset:0 lds
s_add_u32 m0, s97, 49152
s_add_u32 s45, s41, 72704
buffer_load_dwordx4 v2, s[12:15], s45 offen offset:1024 lds
s_add_u32 m0, s97, 49152
s_add_u32 s45, s41, 145408
buffer_load_dwordx4 v2, s[12:15], s45 offen offset:2048 lds
s_add_u32 m0, s97, 61440
s_add_u32 s45, s41, 884736
buffer_load_dwordx4 v2, s[8:11], s45 offen offset:0 lds
s_add_u32 m0, s97, 61440
s_add_u32 s45, s41, 957440
buffer_load_dwordx4 v2, s[8:11], s45 offen offset:1024 lds
s_add_u32 m0, s97, 61440
s_add_u32 s45, s41, 1030144
buffer_load_dwordx4 v2, s[8:11], s45 offen offset:2048 lds
s_add_u32 m0, s97, 73728
s_add_u32 s45, s41, 884736
buffer_load_dwordx4 v2, s[12:15], s45 offen offset:0 lds
s_add_u32 m0, s97, 73728
s_add_u32 s45, s41, 957440
buffer_load_dwordx4 v2, s[12:15], s45 offen offset:1024 lds
s_add_u32 m0, s97, 73728
s_add_u32 s45, s41, 1030144
buffer_load_dwordx4 v2, s[12:15], s45 offen offset:2048 lds
s_add_u32 m0, s97, 86016
s_add_u32 s45, s41, 1769472
buffer_load_dwordx4 v2, s[8:11], s45 offen offset:0 lds
s_add_u32 m0, s97, 86016
s_add_u32 s45, s41, 1842176
buffer_load_dwordx4 v2, s[8:11], s45 offen offset:1024 lds
s_add_u32 m0, s97, 86016
s_add_u32 s45, s41, 1914880
buffer_load_dwordx4 v2, s[8:11], s45 offen offset:2048 lds
s_add_u32 m0, s97, 98304
s_add_u32 s45, s41, 1769472
buffer_load_dwordx4 v2, s[12:15], s45 offen offset:0 lds
s_add_u32 m0, s97, 98304
s_add_u32 s45, s41, 1842176
buffer_load_dwordx4 v2, s[12:15], s45 offen offset:1024 lds
s_add_u32 m0, s97, 98304
s_add_u32 s45, s41, 1914880
buffer_load_dwordx4 v2, s[12:15], s45 offen offset:2048 lds
s_and_b32 s6, s3, 1
s_mul_i32 s6, s6, 110592
s_lshr_b32 s7, s3, 1
s_lshl_b32 s7, s7, 11
s_add_u32 s48, s6, s7
s_and_b32 s38, s3, 1
s_and_b32 s39, s4, 3
s_lshl3_add_u32 s38, s39, s38
s_lshl_b32 s38, s38, 5
s_and_b32 s39, s32, 0xfffff000
s_add_u32 s38, s38, s39
s_add_u32 s38, s38, 2560
s_mov_b32 s39, 0x20000
K1_poll4:
s_load_dwordx8 s[64:71], s[52:53], s38 glc
s_waitcnt lgkmcnt(0)
s_and_b64 s[64:65], s[64:65], s[68:69]
s_and_b64 s[66:67], s[66:67], s[70:71]
s_and_b64 s[64:65], s[64:65], s[66:67]
s_and_b32 s64, s64, s65
s_cbranch_scc1 K1_poll4d
s_sub_u32 s39, s39, 1
s_cbranch_scc0 K1_poll4
K1_poll4d:
s_add_u32 m0, s48, 0
s_add_u32 s45, s54, 7340032
buffer_load_dwordx4 v8, s[24:27], s45 offen sc1 lds
s_add_u32 m0, s48, 1024
s_add_u32 s45, s54, 7358464
buffer_load_dwordx4 v8, s[24:27], s45 offen sc1 lds
s_add_u32 m0, s48, 4096
s_add_u32 s45, s54, 7341056
buffer_load_dwordx4 v8, s[24:27], s45 offen sc1 lds
s_add_u32 m0, s48, 5120
s_add_u32 s45, s54, 7359488
buffer_load_dwordx4 v8, s[24:27], s45 offen sc1 lds
s_add_u32 m0, s48, 8192
s_add_u32 s45, s54, 7342080
buffer_load_dwordx4 v8, s[24:27], s45 offen sc1 lds
s_add_u32 m0, s48, 9216
s_add_u32 s45, s54, 7360512
buffer_load_dwordx4 v8, s[24:27], s45 offen sc1 lds
s_add_u32 m0, s48, 12288
s_add_u32 s45, s54, 7343104
buffer_load_dwordx4 v8, s[24:27], s45 offen sc1 lds
s_add_u32 m0, s48, 13312
s_add_u32 s45, s54, 7361536
buffer_load_dwordx4 v8, s[24:27], s45 offen sc1 lds
s_add_u32 m0, s48, 16384
s_add_u32 s45, s54, 7344128
buffer_load_dwordx4 v8, s[24:27], s45 offen sc1 lds
s_add_u32 m0, s48, 17408
s_add_u32 s45, s54, 7362560
buffer_load_dwordx4 v8, s[24:27], s45 offen sc1 lds
s_add_u32 m0, s48, 20480
s_add_u32 s45, s54, 7345152
buffer_load_dwordx4 v8, s[24:27], s45 offen sc1 lds
s_add_u32 m0, s48, 21504
s_add_u32 s45, s54, 7363584
buffer_load_dwordx4 v8, s[24:27], s45 offen sc1 lds
s_add_u32 m0, s48, 24576
s_add_u32 s45, s54, 7346176
buffer_load_dwordx4 v8, s[24:27], s45 offen sc1 lds
s_add_u32 m0, s48, 25600
s_add_u32 s45, s54, 7364608
buffer_load_dwordx4 v8, s[24:27], s45 offen sc1 lds
s_add_u32 m0, s48, 28672
s_add_u32 s45, s54, 7347200
buffer_load_dwordx4 v8, s[24:27], s45 offen sc1 lds
s_add_u32 m0, s48, 29696
s_add_u32 s45, s54, 7365632
buffer_load_dwordx4 v8, s[24:27], s45 offen sc1 lds
s_add_u32 m0, s48, 32768
s_add_u32 s45, s54, 7348224
buffer_load_dwordx4 v8, s[24:27], s45 offen sc1 lds
s_add_u32 m0, s48, 33792
s_add_u32 s45, s54, 7366656
buffer_load_dwordx4 v8, s[24:27], s45 offen sc1 lds
ds_read_b64_tr_b16 v[16:17], v10 offset:0
ds_read_b64_tr_b16 v[18:19], v10 offset:2048
ds_read_b64_tr_b16 v[20:21], v10 offset:4096
ds_read_b64_tr_b16 v[22:23], v10 offset:6144
ds_read_b64_tr_b16 v[24:25], v10 offset:8192
ds_read_b64_tr_b16 v[26:27], v10 offset:10240
s_waitcnt vmcnt(12)
s_barrier
ds_read_b128 a[0:3], v7 offset:0
ds_read_b128 a[16:19], v7 offset:4096
ds_read_b128 a[32:35], v7 offset:8192
ds_read_b128 a[4:7], v7 offset:1024
ds_read_b128 a[20:23], v7 offset:5120
ds_read_b128 a[36:39], v7 offset:9216
ds_read_b128 a[8:11], v7 offset:2048
ds_read_b128 a[24:27], v7 offset:6144
ds_read_b128 a[40:43], v7 offset:10240
ds_read_b128 a[12:15], v7 offset:3072
ds_read_b128 a[28:31], v7 offset:7168
ds_read_b128 a[44:47], v7 offset:11264
s_waitcnt lgkmcnt(11)
v_mfma_f32_16x16x32_bf16 v[64:67], v[16:19], a[0:3], 0
s_waitcnt lgkmcnt(10)
ds_read_b64_tr_b16 v[28:29], v12 offset:0
v_add_u32 v254, 72704, v2
v_mfma_f32_16x16x32_bf16 v[64:67], v[20:23], a[16:19], v[64:67]
s_waitcnt lgkmcnt(10)
ds_read_b64_tr_b16 v[30:31], v12 offset:2048
v_add_u32 v255, 145408, v2
v_mfma_f32_16x16x32_bf16 v[64:67], v[24:27], a[32:35], v[64:67]
s_waitcnt lgkmcnt(10)
ds_read_b64_tr_b16 v[32:33], v12 offset:4096
v_mfma_f32_16x16x32_bf16 v[68:71], v[16:19], a[4:7], 0
s_waitcnt lgkmcnt(10)
ds_read_b64_tr_b16 v[34:35], v12 offset:6144
v_mfma_f32_16x16x32_bf16 v[68:71], v[20:23], a[20:23], v[68:71]
s_waitcnt lgkmcnt(10)
ds_read_b64_tr_b16 v[36:37], v12 offset:8192
v_mfma_f32_16x16x32_bf16 v[68:71], v[24:27], a[36:39], v[68:71]
s_waitcnt lgkmcnt(5)
ds_read_b64_tr_b16 v[38:39], v12 offset:10240
v_mfma_f32_16x16x32_bf16 v[72:75], v[16:19], a[8:11], 0
v_mfma_f32_16x16x32_bf16 v[72:75], v[20:23], a[24:27], v[72:75]
v_mfma_f32_16x16x32_bf16 v[72:75], v[24:27], a[40:43], v[72:75]
v_mfma_f32_16x16x32_bf16 v[76:79], v[16:19], a[12:15], 0
v_mfma_f32_16x16x32_bf16 v[76:79], v[20:23], a[28:31], v[76:79]
s_add_u32 s45, s41, 2654208
v_mfma_f32_16x16x32_bf16 v[76:79], v[24:27], a[44:47], v[76:79]
s_waitcnt lgkmcnt(0)
s_waitcnt vmcnt(6)
s_barrier
s_add_u32 m0, s97, 36864
v_mfma_f32_16x16x32_bf16 v[80:83], v[28:31], a[0:3], 0
ds_read_b64_tr_b16 v[16:17], v10 offset:12288
ds_read_b128 a[48:51], v7 offset:12288
v_mfma_f32_16x16x32_bf16 v[80:83], v[32:35], a[16:19], v[80:83]
ds_read_b64_tr_b16 v[18:19], v10 offset:14336
ds_read_b128 a[64:67], v7 offset:16384
v_mfma_f32_16x16x32_bf16 v[80:83], v[36:39], a[32:35], v[80:83]
ds_read_b64_tr_b16 v[20:21], v10 offset:16384
ds_read_b128 a[80:83], v7 offset:20480
v_mfma_f32_16x16x32_bf16 v[84:87], v[28:31], a[4:7], 0
ds_read_b64_tr_b16 v[22:23], v10 offset:18432
ds_read_b128 a[52:55], v7 offset:13312
v_mfma_f32_16x16x32_bf16 v[84:87], v[32:35], a[20:23], v[84:87]
ds_read_b64_tr_b16 v[24:25], v10 offset:20480
ds_read_b128 a[68:71], v7 offset:17408
v_mfma_f32_16x16x32_bf16 v[84:87], v[36:39], a[36:39], v[84:87]
ds_read_b64_tr_b16 v[26:27], v10 offset:22528
ds_read_b128 a[84:87], v7 offset:21504
v_mfma_f32_16x16x32_bf16 v[88:91], v[28:31], a[8:11], 0
buffer_load_dwordx4 v2, s[8:11], s45 offen offset:0 lds
s_add_u32 m0, s48, 0
v_mfma_f32_16x16x32_bf16 v[88:91], v[32:35], a[24:27], v[88:91]
s_add_u32 s45, s54, 7349248
buffer_load_dwordx4 v8, s[24:27], s45 offen sc1 lds
s_add_u32 m0, s97, 36864
v_mfma_f32_16x16x32_bf16 v[88:91], v[36:39], a[40:43], v[88:91]
s_add_u32 s45, s41, 2726912
buffer_load_dwordx4 v2, s[8:11], s45 offen offset:1024 lds
s_add_u32 m0, s48, 1024
v_mfma_f32_16x16x32_bf16 v[92:95], v[28:31], a[12:15], 0
s_add_u32 s45, s54, 7367680
buffer_load_dwordx4 v8, s[24:27], s45 offen sc1 lds
s_add_u32 m0, s97, 36864
v_mfma_f32_16x16x32_bf16 v[92:95], v[32:35], a[28:31], v[92:95]
s_add_u32 s45, s41, 2799616
buffer_load_dwordx4 v2, s[8:11], s45 offen offset:2048 lds
s_add_u32 m0, s48, 4096
v_mfma_f32_16x16x32_bf16 v[92:95], v[36:39], a[44:47], v[92:95]
s_waitcnt lgkmcnt(0)
s_add_u32 s45, s54, 7350272
buffer_load_dwordx4 v8, s[24:27], s45 offen sc1 lds
v_mfma_f32_16x16x32_bf16 v[192:195], v[16:19], a[0:3], 0
ds_read_b64_tr_b16 v[28:29], v12 offset:12288
ds_read_b128 a[56:59], v7 offset:14336
v_mfma_f32_16x16x32_bf16 v[192:195], v[20:23], a[16:19], v[192:195]
ds_read_b64_tr_b16 v[30:31], v12 offset:14336
ds_read_b128 a[72:75], v7 offset:18432
v_mfma_f32_16x16x32_bf16 v[192:195], v[24:27], a[32:35], v[192:195]
ds_read_b64_tr_b16 v[32:33], v12 offset:16384
ds_read_b128 a[88:91], v7 offset:22528
v_mfma_f32_16x16x32_bf16 v[196:199], v[16:19], a[4:7], 0
ds_read_b64_tr_b16 v[34:35], v12 offset:18432
ds_read_b128 a[60:63], v7 offset:15360
v_mfma_f32_16x16x32_bf16 v[196:199], v[20:23], a[20:23], v[196:199]
ds_read_b64_tr_b16 v[36:37], v12 offset:20480
ds_read_b128 a[76:79], v7 offset:19456
v_mfma_f32_16x16x32_bf16 v[196:199], v[24:27], a[36:39], v[196:199]
ds_read_b64_tr_b16 v[38:39], v12 offset:22528
ds_read_b128 a[92:95], v7 offset:23552
s_add_u32 m0, s48, 5120
v_mfma_f32_16x16x32_bf16 v[200:203], v[16:19], a[8:11], 0
s_add_u32 s45, s54, 7368704
buffer_load_dwordx4 v8, s[24:27], s45 offen sc1 lds
s_add_u32 m0, s48, 8192
v_mfma_f32_16x16x32_bf16 v[200:203], v[20:23], a[24:27], v[200:203]
s_add_u32 s45, s54, 7351296
buffer_load_dwordx4 v8, s[24:27], s45 offen sc1 lds
s_add_u32 m0, s48, 9216
v_mfma_f32_16x16x32_bf16 v[200:203], v[24:27], a[40:43], v[200:203]
s_add_u32 s45, s54, 7369728
buffer_load_dwordx4 v8, s[24:27], s45 offen sc1 lds
v_mfma_f32_16x16x32_bf16 v[204:207], v[16:19], a[12:15], 0
v_mfma_f32_16x16x32_bf16 v[204:207], v[20:23], a[28:31], v[204:207]
s_add_u32 s45, s41, 2654208
v_mfma_f32_16x16x32_bf16 v[204:207], v[24:27], a[44:47], v[204:207]
s_waitcnt lgkmcnt(0)
s_waitcnt vmcnt(9)
s_barrier
s_add_u32 m0, s97, 49152
v_mfma_f32_16x16x32_bf16 v[208:211], v[28:31], a[0:3], 0
ds_read_b64_tr_b16 v[16:17], v10 offset:24576
ds_read_b128 a[96:99], v7 offset:24576
v_mfma_f32_16x16x32_bf16 v[208:211], v[32:35], a[16:19], v[208:211]
ds_read_b64_tr_b16 v[18:19], v10 offset:26624
ds_read_b128 a[112:115], v7 offset:28672
v_mfma_f32_16x16x32_bf16 v[208:211], v[36:39], a[32:35], v[208:211]
ds_read_b64_tr_b16 v[20:21], v10 offset:28672
ds_read_b128 a[128:131], v7 offset:32768
v_mfma_f32_16x16x32_bf16 v[212:215], v[28:31], a[4:7], 0
ds_read_b64_tr_b16 v[22:23], v10 offset:30720
ds_read_b128 a[100:103], v7 offset:25600
v_mfma_f32_16x16x32_bf16 v[212:215], v[32:35], a[20:23], v[212:215]
ds_read_b64_tr_b16 v[24:25], v10 offset:32768
ds_read_b128 a[116:119], v7 offset:29696
v_mfma_f32_16x16x32_bf16 v[212:215], v[36:39], a[36:39], v[212:215]
ds_read_b64_tr_b16 v[26:27], v10 offset:34816
ds_read_b128 a[132:135], v7 offset:33792
v_mfma_f32_16x16x32_bf16 v[216:219], v[28:31], a[8:11], 0
buffer_load_dwordx4 v2, s[12:15], s45 offen offset:0 lds
s_add_u32 m0, s48, 12288
v_mfma_f32_16x16x32_bf16 v[216:219], v[32:35], a[24:27], v[216:219]
s_add_u32 s45, s54, 7352320
buffer_load_dwordx4 v8, s[24:27], s45 offen sc1 lds
s_add_u32 m0, s97, 49152
v_mfma_f32_16x16x32_bf16 v[216:219], v[36:39], a[40:43], v[216:219]
s_add_u32 s45, s41, 2726912
buffer_load_dwordx4 v2, s[12:15], s45 offen offset:1024 lds
s_add_u32 m0, s48, 13312
v_mfma_f32_16x16x32_bf16 v[220:223], v[28:31], a[12:15], 0
s_add_u32 s45, s54, 7370752
buffer_load_dwordx4 v8, s[24:27], s45 offen sc1 lds
s_add_u32 m0, s97, 49152
v_mfma_f32_16x16x32_bf16 v[220:223], v[32:35], a[28:31], v[220:223]
s_add_u32 s45, s41, 2799616
buffer_load_dwordx4 v2, s[12:15], s45 offen offset:2048 lds
s_add_u32 m0, s48, 16384
v_mfma_f32_16x16x32_bf16 v[220:223], v[36:39], a[44:47], v[220:223]
s_waitcnt lgkmcnt(0)
s_add_u32 s45, s54, 7353344
buffer_load_dwordx4 v8, s[24:27], s45 offen sc1 lds
v_mfma_f32_16x16x32_bf16 v[64:67], v[16:19], a[48:51], v[64:67]
ds_read_b64_tr_b16 v[28:29], v12 offset:24576
ds_read_b128 a[104:107], v7 offset:26624
v_mfma_f32_16x16x32_bf16 v[64:67], v[20:23], a[64:67], v[64:67]
ds_read_b64_tr_b16 v[30:31], v12 offset:26624
ds_read_b128 a[120:123], v7 offset:30720
v_mfma_f32_16x16x32_bf16 v[64:67], v[24:27], a[80:83], v[64:67]
ds_read_b64_tr_b16 v[32:33], v12 offset:28672
ds_read_b128 a[136:139], v7 offset:34816
v_mfma_f32_16x16x32_bf16 v[68:71], v[16:19], a[52:55], v[68:71]
ds_read_b64_tr_b16 v[34:35], v12 offset:30720
ds_read_b128 a[108:111], v7 offset:27648
v_mfma_f32_16x16x32_bf16 v[68:71], v[20:23], a[68:71], v[68:71]
ds_read_b64_tr_b16 v[36:37], v12 offset:32768
ds_read_b128 a[124:127], v7 offset:31744
v_mfma_f32_16x16x32_bf16 v[68:71], v[24:27], a[84:87], v[68:71]
ds_read_b64_tr_b16 v[38:39], v12 offset:34816
ds_read_b128 a[140:143], v7 offset:35840
s_add_u32 m0, s48, 17408
v_mfma_f32_16x16x32_bf16 v[72:75], v[16:19], a[56:59], v[72:75]
s_add_u32 s45, s54, 7371776
buffer_load_dwordx4 v8, s[24:27], s45 offen sc1 lds
s_add_u32 m0, s48, 20480
v_mfma_f32_16x16x32_bf16 v[72:75], v[20:23], a[72:75], v[72:75]
s_add_u32 s45, s54, 7354368
buffer_load_dwordx4 v8, s[24:27], s45 offen sc1 lds
s_add_u32 m0, s48, 21504
v_mfma_f32_16x16x32_bf16 v[72:75], v[24:27], a[88:91], v[72:75]
s_add_u32 s45, s54, 7372800
buffer_load_dwordx4 v8, s[24:27], s45 offen sc1 lds
v_mfma_f32_16x16x32_bf16 v[76:79], v[16:19], a[60:63], v[76:79]
v_mfma_f32_16x16x32_bf16 v[76:79], v[20:23], a[76:79], v[76:79]
v_mfma_f32_16x16x32_bf16 v[76:79], v[24:27], a[92:95], v[76:79]
s_waitcnt lgkmcnt(0)
s_barrier
v_mfma_f32_16x16x32_bf16 v[80:83], v[28:31], a[48:51], v[80:83]
ds_read_b64_tr_b16 v[16:17], v11 offset:0
v_mfma_f32_16x16x32_bf16 v[80:83], v[32:35], a[64:67], v[80:83]
ds_read_b64_tr_b16 v[18:19], v11 offset:2048
v_mfma_f32_16x16x32_bf16 v[80:83], v[36:39], a[80:83], v[80:83]
ds_read_b64_tr_b16 v[20:21], v11 offset:4096
v_mfma_f32_16x16x32_bf16 v[84:87], v[28:31], a[52:55], v[84:87]
ds_read_b64_tr_b16 v[22:23], v11 offset:6144
v_mfma_f32_16x16x32_bf16 v[84:87], v[32:35], a[68:71], v[84:87]
ds_read_b64_tr_b16 v[24:25], v11 offset:8192
s_add_u32 s45, s41, 3538944
v_mfma_f32_16x16x32_bf16 v[84:87], v[36:39], a[84:87], v[84:87]
ds_read_b64_tr_b16 v[26:27], v11 offset:10240
s_add_u32 m0, s97, 61440
v_mfma_f32_16x16x32_bf16 v[88:91], v[28:31], a[56:59], v[88:91]
buffer_load_dwordx4 v2, s[8:11], s45 offen offset:0 lds
s_add_u32 m0, s48, 24576
v_mfma_f32_16x16x32_bf16 v[88:91], v[32:35], a[72:75], v[88:91]
s_add_u32 s45, s54, 7355392
buffer_load_dwordx4 v8, s[24:27], s45 offen sc1 lds
s_add_u32 m0, s97, 61440
v_mfma_f32_16x16x32_bf16 v[88:91], v[36:39], a[88:91], v[88:91]
s_add_u32 s45, s41, 3611648
buffer_load_dwordx4 v2, s[8:11], s45 offen offset:1024 lds
s_add_u32 m0, s48, 25600
v_mfma_f32_16x16x32_bf16 v[92:95], v[28:31], a[60:63], v[92:95]
s_add_u32 s45, s54, 7373824
buffer_load_dwordx4 v8, s[24:27], s45 offen sc1 lds
s_add_u32 m0, s97, 61440
v_mfma_f32_16x16x32_bf16 v[92:95], v[32:35], a[76:79], v[92:95]
s_add_u32 s45, s41, 3684352
buffer_load_dwordx4 v2, s[8:11], s45 offen offset:2048 lds
s_add_u32 m0, s48, 28672
v_mfma_f32_16x16x32_bf16 v[92:95], v[36:39], a[92:95], v[92:95]
s_waitcnt lgkmcnt(0)
s_add_u32 s45, s54, 7356416
buffer_load_dwordx4 v8, s[24:27], s45 offen sc1 lds
v_mfma_f32_16x16x32_bf16 v[192:195], v[16:19], a[48:51], v[192:195]
ds_read_b64_tr_b16 v[28:29], v13 offset:0
v_mfma_f32_16x16x32_bf16 v[192:195], v[20:23], a[64:67], v[192:195]
ds_read_b64_tr_b16 v[30:31], v13 offset:2048
v_mfma_f32_16x16x32_bf16 v[192:195], v[24:27], a[80:83], v[192:195]
ds_read_b64_tr_b16 v[32:33], v13 offset:4096
v_mfma_f32_16x16x32_bf16 v[196:199], v[16:19], a[52:55], v[196:199]
ds_read_b64_tr_b16 v[34:35], v13 offset:6144
v_mfma_f32_16x16x32_bf16 v[196:199], v[20:23], a[68:71], v[196:199]
ds_read_b64_tr_b16 v[36:37], v13 offset:8192
s_add_u32 s45, s54, 7374848
v_mfma_f32_16x16x32_bf16 v[196:199], v[24:27], a[84:87], v[196:199]
ds_read_b64_tr_b16 v[38:39], v13 offset:10240
s_add_u32 m0, s48, 29696
v_mfma_f32_16x16x32_bf16 v[200:203], v[16:19], a[56:59], v[200:203]
buffer_load_dwordx4 v8, s[24:27], s45 offen sc1 lds
s_add_u32 m0, s48, 32768
v_mfma_f32_16x16x32_bf16 v[200:203], v[20:23], a[72:75], v[200:203]
s_add_u32 s45, s54, 7357440
buffer_load_dwordx4 v8, s[24:27], s45 offen sc1 lds
s_add_u32 m0, s48, 33792
v_mfma_f32_16x16x32_bf16 v[200:203], v[24:27], a[88:91], v[200:203]
s_add_u32 s45, s54, 7375872
buffer_load_dwordx4 v8, s[24:27], s45 offen sc1 lds
v_mfma_f32_16x16x32_bf16 v[204:207], v[16:19], a[60:63], v[204:207]
v_mfma_f32_16x16x32_bf16 v[204:207], v[20:23], a[76:79], v[204:207]
v_mfma_f32_16x16x32_bf16 v[204:207], v[24:27], a[92:95], v[204:207]
s_waitcnt lgkmcnt(0)
s_barrier
v_mfma_f32_16x16x32_bf16 v[208:211], v[28:31], a[48:51], v[208:211]
ds_read_b64_tr_b16 v[16:17], v11 offset:12288
v_mfma_f32_16x16x32_bf16 v[208:211], v[32:35], a[64:67], v[208:211]
ds_read_b64_tr_b16 v[18:19], v11 offset:14336
v_mfma_f32_16x16x32_bf16 v[208:211], v[36:39], a[80:83], v[208:211]
ds_read_b64_tr_b16 v[20:21], v11 offset:16384
v_mfma_f32_16x16x32_bf16 v[212:215], v[28:31], a[52:55], v[212:215]
ds_read_b64_tr_b16 v[22:23], v11 offset:18432
v_mfma_f32_16x16x32_bf16 v[212:215], v[32:35], a[68:71], v[212:215]
ds_read_b64_tr_b16 v[24:25], v11 offset:20480
s_add_u32 s45, s41, 3538944
v_mfma_f32_16x16x32_bf16 v[212:215], v[36:39], a[84:87], v[212:215]
ds_read_b64_tr_b16 v[26:27], v11 offset:22528
s_add_u32 m0, s97, 73728
v_mfma_f32_16x16x32_bf16 v[216:219], v[28:31], a[56:59], v[216:219]
buffer_load_dwordx4 v2, s[12:15], s45 offen offset:0 lds
v_mfma_f32_16x16x32_bf16 v[216:219], v[32:35], a[72:75], v[216:219]
s_add_u32 m0, s97, 73728
s_add_u32 s45, s41, 3611648
v_mfma_f32_16x16x32_bf16 v[216:219], v[36:39], a[88:91], v[216:219]
buffer_load_dwordx4 v2, s[12:15], s45 offen offset:1024 lds
v_mfma_f32_16x16x32_bf16 v[220:223], v[28:31], a[60:63], v[220:223]
s_add_u32 m0, s97, 73728
s_add_u32 s45, s41, 3684352
v_mfma_f32_16x16x32_bf16 v[220:223], v[32:35], a[76:79], v[220:223]
buffer_load_dwordx4 v2, s[12:15], s45 offen offset:2048 lds
v_mfma_f32_16x16x32_bf16 v[220:223], v[36:39], a[92:95], v[220:223]
s_waitcnt lgkmcnt(0)
v_mfma_f32_16x16x32_bf16 v[64:67], v[16:19], a[96:99], v[64:67]
ds_read_b64_tr_b16 v[28:29], v13 offset:12288
v_mfma_f32_16x16x32_bf16 v[64:67], v[20:23], a[112:115], v[64:67]
ds_read_b64_tr_b16 v[30:31], v13 offset:14336
v_mfma_f32_16x16x32_bf16 v[64:67], v[24:27], a[128:131], v[64:67]
ds_read_b64_tr_b16 v[32:33], v13 offset:16384
v_mfma_f32_16x16x32_bf16 v[68:71], v[16:19], a[100:103], v[68:71]
ds_read_b64_tr_b16 v[34:35], v13 offset:18432
v_mfma_f32_16x16x32_bf16 v[68:71], v[20:23], a[116:119], v[68:71]
ds_read_b64_tr_b16 v[36:37], v13 offset:20480
v_mfma_f32_16x16x32_bf16 v[68:71], v[24:27], a[132:135], v[68:71]
ds_read_b64_tr_b16 v[38:39], v13 offset:22528
v_mfma_f32_16x16x32_bf16 v[72:75], v[16:19], a[104:107], v[72:75]
v_mfma_f32_16x16x32_bf16 v[72:75], v[20:23], a[120:123], v[72:75]
v_mfma_f32_16x16x32_bf16 v[72:75], v[24:27], a[136:139], v[72:75]
v_mfma_f32_16x16x32_bf16 v[76:79], v[16:19], a[108:111], v[76:79]
v_mfma_f32_16x16x32_bf16 v[76:79], v[20:23], a[124:127], v[76:79]
s_add_u32 s45, s41, 4423680
v_mfma_f32_16x16x32_bf16 v[76:79], v[24:27], a[140:143], v[76:79]
s_waitcnt lgkmcnt(0)
s_waitcnt vmcnt(21)
s_barrier
s_add_u32 m0, s97, 86016
v_mfma_f32_16x16x32_bf16 v[80:83], v[28:31], a[96:99], v[80:83]
ds_read_b64_tr_b16 v[16:17], v11 offset:24576
ds_read_b128 a[144:147], v7 offset:0
v_mfma_f32_16x16x32_bf16 v[80:83], v[32:35], a[112:115], v[80:83]
ds_read_b64_tr_b16 v[18:19], v11 offset:26624
ds_read_b128 a[160:163], v7 offset:4096
v_mfma_f32_16x16x32_bf16 v[80:83], v[36:39], a[128:131], v[80:83]
ds_read_b64_tr_b16 v[20:21], v11 offset:28672
ds_read_b128 a[176:179], v7 offset:8192
v_mfma_f32_16x16x32_bf16 v[84:87], v[28:31], a[100:103], v[84:87]
ds_read_b64_tr_b16 v[22:23], v11 offset:30720
ds_read_b128 a[148:151], v7 offset:1024
v_mfma_f32_16x16x32_bf16 v[84:87], v[32:35], a[116:119], v[84:87]
ds_read_b64_tr_b16 v[24:25], v11 offset:32768
ds_read_b128 a[164:167], v7 offset:5120
v_mfma_f32_16x16x32_bf16 v[84:87], v[36:39], a[132:135], v[84:87]
ds_read_b64_tr_b16 v[26:27], v11 offset:34816
ds_read_b128 a[180:183], v7 offset:9216
v_mfma_f32_16x16x32_bf16 v[88:91], v[28:31], a[104:107], v[88:91]
buffer_load_dwordx4 v2, s[8:11], s45 offen offset:0 lds
v_mfma_f32_16x16x32_bf16 v[88:91], v[32:35], a[120:123], v[88:91]
v_mfma_f32_16x16x32_bf16 v[88:91], v[36:39], a[136:139], v[88:91]
buffer_load_dwordx4 v254, s[8:11], s45 offen offset:1024 lds
v_mfma_f32_16x16x32_bf16 v[92:95], v[28:31], a[108:111], v[92:95]
v_mfma_f32_16x16x32_bf16 v[92:95], v[32:35], a[124:127], v[92:95]
buffer_load_dwordx4 v255, s[8:11], s45 offen offset:2048 lds
v_mfma_f32_16x16x32_bf16 v[92:95], v[36:39], a[140:143], v[92:95]
s_waitcnt lgkmcnt(0)
v_mfma_f32_16x16x32_bf16 v[192:195], v[16:19], a[96:99], v[192:195]
ds_read_b64_tr_b16 v[28:29], v13 offset:24576
ds_read_b128 a[152:155], v7 offset:2048
v_mfma_f32_16x16x32_bf16 v[192:195], v[20:23], a[112:115], v[192:195]
ds_read_b64_tr_b16 v[30:31], v13 offset:26624
ds_read_b128 a[168:171], v7 offset:6144
v_mfma_f32_16x16x32_bf16 v[192:195], v[24:27], a[128:131], v[192:195]
ds_read_b64_tr_b16 v[32:33], v13 offset:28672
ds_read_b128 a[184:187], v7 offset:10240
v_mfma_f32_16x16x32_bf16 v[196:199], v[16:19], a[100:103], v[196:199]
ds_read_b64_tr_b16 v[34:35], v13 offset:30720
ds_read_b128 a[156:159], v7 offset:3072
v_mfma_f32_16x16x32_bf16 v[196:199], v[20:23], a[116:119], v[196:199]
ds_read_b64_tr_b16 v[36:37], v13 offset:32768
ds_read_b128 a[172:175], v7 offset:7168
v_mfma_f32_16x16x32_bf16 v[196:199], v[24:27], a[132:135], v[196:199]
ds_read_b64_tr_b16 v[38:39], v13 offset:34816
ds_read_b128 a[188:191], v7 offset:11264
v_mfma_f32_16x16x32_bf16 v[200:203], v[16:19], a[104:107], v[200:203]
v_mfma_f32_16x16x32_bf16 v[200:203], v[20:23], a[120:123], v[200:203]
v_mfma_f32_16x16x32_bf16 v[200:203], v[24:27], a[136:139], v[200:203]
v_mfma_f32_16x16x32_bf16 v[204:207], v[16:19], a[108:111], v[204:207]
v_mfma_f32_16x16x32_bf16 v[204:207], v[20:23], a[124:127], v[204:207]
v_mfma_f32_16x16x32_bf16 v[204:207], v[24:27], a[140:143], v[204:207]
s_waitcnt lgkmcnt(0)
s_barrier
v_mfma_f32_16x16x32_bf16 v[208:211], v[28:31], a[96:99], v[208:211]
ds_read_b64_tr_b16 v[16:17], v10 offset:0
v_mfma_f32_16x16x32_bf16 v[208:211], v[32:35], a[112:115], v[208:211]
ds_read_b64_tr_b16 v[18:19], v10 offset:2048
v_mfma_f32_16x16x32_bf16 v[208:211], v[36:39], a[128:131], v[208:211]
ds_read_b64_tr_b16 v[20:21], v10 offset:4096
v_mfma_f32_16x16x32_bf16 v[212:215], v[28:31], a[100:103], v[212:215]
ds_read_b64_tr_b16 v[22:23], v10 offset:6144
v_mfma_f32_16x16x32_bf16 v[212:215], v[32:35], a[116:119], v[212:215]
ds_read_b64_tr_b16 v[24:25], v10 offset:8192
s_add_u32 s45, s41, 4423680
v_mfma_f32_16x16x32_bf16 v[212:215], v[36:39], a[132:135], v[212:215]
ds_read_b64_tr_b16 v[26:27], v10 offset:10240
s_add_u32 m0, s97, 98304
v_mfma_f32_16x16x32_bf16 v[216:219], v[28:31], a[104:107], v[216:219]
buffer_load_dwordx4 v2, s[12:15], s45 offen offset:0 lds
v_mfma_f32_16x16x32_bf16 v[216:219], v[32:35], a[120:123], v[216:219]
v_mfma_f32_16x16x32_bf16 v[216:219], v[36:39], a[136:139], v[216:219]
buffer_load_dwordx4 v254, s[12:15], s45 offen offset:1024 lds
v_mfma_f32_16x16x32_bf16 v[220:223], v[28:31], a[108:111], v[220:223]
v_mfma_f32_16x16x32_bf16 v[220:223], v[32:35], a[124:127], v[220:223]
buffer_load_dwordx4 v255, s[12:15], s45 offen offset:2048 lds
v_mfma_f32_16x16x32_bf16 v[220:223], v[36:39], a[140:143], v[220:223]
s_waitcnt lgkmcnt(0)
v_mfma_f32_16x16x32_bf16 v[64:67], v[16:19], a[144:147], v[64:67]
ds_read_b64_tr_b16 v[28:29], v12 offset:0
v_mfma_f32_16x16x32_bf16 v[64:67], v[20:23], a[160:163], v[64:67]
ds_read_b64_tr_b16 v[30:31], v12 offset:2048
v_mfma_f32_16x16x32_bf16 v[64:67], v[24:27], a[176:179], v[64:67]
ds_read_b64_tr_b16 v[32:33], v12 offset:4096
v_mfma_f32_16x16x32_bf16 v[68:71], v[16:19], a[148:151], v[68:71]
ds_read_b64_tr_b16 v[34:35], v12 offset:6144
v_mfma_f32_16x16x32_bf16 v[68:71], v[20:23], a[164:167], v[68:71]
ds_read_b64_tr_b16 v[36:37], v12 offset:8192
v_mfma_f32_16x16x32_bf16 v[68:71], v[24:27], a[180:183], v[68:71]
ds_read_b64_tr_b16 v[38:39], v12 offset:10240
v_mfma_f32_16x16x32_bf16 v[72:75], v[16:19], a[152:155], v[72:75]
v_mfma_f32_16x16x32_bf16 v[72:75], v[20:23], a[168:171], v[72:75]
v_mfma_f32_16x16x32_bf16 v[72:75], v[24:27], a[184:187], v[72:75]
v_mfma_f32_16x16x32_bf16 v[76:79], v[16:19], a[156:159], v[76:79]
v_mfma_f32_16x16x32_bf16 v[76:79], v[20:23], a[172:175], v[76:79]
s_add_u32 s45, s41, 128
v_mfma_f32_16x16x32_bf16 v[76:79], v[24:27], a[188:191], v[76:79]
s_waitcnt lgkmcnt(0)
s_waitcnt vmcnt(22)
s_waitcnt vmcnt(18)
s_barrier
s_add_u32 m0, s97, 36864
v_mfma_f32_16x16x32_bf16 v[80:83], v[28:31], a[144:147], v[80:83]
ds_read_b64_tr_b16 v[16:17], v10 offset:12288
ds_read_b128 a[192:195], v7 offset:12288
v_mfma_f32_16x16x32_bf16 v[80:83], v[32:35], a[160:163], v[80:83]
ds_read_b64_tr_b16 v[18:19], v10 offset:14336
ds_read_b128 a[208:211], v7 offset:16384
v_mfma_f32_16x16x32_bf16 v[80:83], v[36:39], a[176:179], v[80:83]
ds_read_b64_tr_b16 v[20:21], v10 offset:16384
ds_read_b128 a[224:227], v7 offset:20480
v_mfma_f32_16x16x32_bf16 v[84:87], v[28:31], a[148:151], v[84:87]
ds_read_b64_tr_b16 v[22:23], v10 offset:18432
ds_read_b128 a[196:199], v7 offset:13312
v_mfma_f32_16x16x32_bf16 v[84:87], v[32:35], a[164:167], v[84:87]
ds_read_b64_tr_b16 v[24:25], v10 offset:20480
ds_read_b128 a[212:215], v7 offset:17408
v_mfma_f32_16x16x32_bf16 v[84:87], v[36:39], a[180:183], v[84:87]
ds_read_b64_tr_b16 v[26:27], v10 offset:22528
ds_read_b128 a[228:231], v7 offset:21504
v_mfma_f32_16x16x32_bf16 v[88:91], v[28:31], a[152:155], v[88:91]
buffer_load_dwordx4 v2, s[8:11], s45 offen offset:0 lds
v_mfma_f32_16x16x32_bf16 v[88:91], v[32:35], a[168:171], v[88:91]
v_mfma_f32_16x16x32_bf16 v[88:91], v[36:39], a[184:187], v[88:91]
buffer_load_dwordx4 v254, s[8:11], s45 offen offset:1024 lds
v_mfma_f32_16x16x32_bf16 v[92:95], v[28:31], a[156:159], v[92:95]
v_mfma_f32_16x16x32_bf16 v[92:95], v[32:35], a[172:175], v[92:95]
buffer_load_dwordx4 v255, s[8:11], s45 offen offset:2048 lds
v_mfma_f32_16x16x32_bf16 v[92:95], v[36:39], a[188:191], v[92:95]
s_waitcnt lgkmcnt(0)
v_mfma_f32_16x16x32_bf16 v[192:195], v[16:19], a[144:147], v[192:195]
ds_read_b64_tr_b16 v[28:29], v12 offset:12288
ds_read_b128 a[200:203], v7 offset:14336
v_mfma_f32_16x16x32_bf16 v[192:195], v[20:23], a[160:163], v[192:195]
ds_read_b64_tr_b16 v[30:31], v12 offset:14336
ds_read_b128 a[216:219], v7 offset:18432
v_mfma_f32_16x16x32_bf16 v[192:195], v[24:27], a[176:179], v[192:195]
ds_read_b64_tr_b16 v[32:33], v12 offset:16384
ds_read_b128 a[232:235], v7 offset:22528
v_mfma_f32_16x16x32_bf16 v[196:199], v[16:19], a[148:151], v[196:199]
ds_read_b64_tr_b16 v[34:35], v12 offset:18432
ds_read_b128 a[204:207], v7 offset:15360
v_mfma_f32_16x16x32_bf16 v[196:199], v[20:23], a[164:167], v[196:199]
ds_read_b64_tr_b16 v[36:37], v12 offset:20480
ds_read_b128 a[220:223], v7 offset:19456
v_mfma_f32_16x16x32_bf16 v[196:199], v[24:27], a[180:183], v[196:199]
ds_read_b64_tr_b16 v[38:39], v12 offset:22528
ds_read_b128 a[236:239], v7 offset:23552
v_mfma_f32_16x16x32_bf16 v[200:203], v[16:19], a[152:155], v[200:203]
v_mfma_f32_16x16x32_bf16 v[200:203], v[20:23], a[168:171], v[200:203]
v_mfma_f32_16x16x32_bf16 v[200:203], v[24:27], a[184:187], v[200:203]
v_mfma_f32_16x16x32_bf16 v[204:207], v[16:19], a[156:159], v[204:207]
v_mfma_f32_16x16x32_bf16 v[204:207], v[20:23], a[172:175], v[204:207]
v_mfma_f32_16x16x32_bf16 v[204:207], v[24:27], a[188:191], v[204:207]
s_waitcnt lgkmcnt(0)
s_waitcnt vmcnt(16)
s_barrier
v_mfma_f32_16x16x32_bf16 v[208:211], v[28:31], a[144:147], v[208:211]
ds_read_b64_tr_b16 v[16:17], v10 offset:24576
v_mfma_f32_16x16x32_bf16 v[208:211], v[32:35], a[160:163], v[208:211]
ds_read_b64_tr_b16 v[18:19], v10 offset:26624
v_mfma_f32_16x16x32_bf16 v[208:211], v[36:39], a[176:179], v[208:211]
ds_read_b64_tr_b16 v[20:21], v10 offset:28672
v_mfma_f32_16x16x32_bf16 v[212:215], v[28:31], a[148:151], v[212:215]
ds_read_b64_tr_b16 v[22:23], v10 offset:30720
v_mfma_f32_16x16x32_bf16 v[212:215], v[32:35], a[164:167], v[212:215]
ds_read_b64_tr_b16 v[24:25], v10 offset:32768
s_add_u32 s45, s41, 884864
v_mfma_f32_16x16x32_bf16 v[212:215], v[36:39], a[180:183], v[212:215]
ds_read_b64_tr_b16 v[26:27], v10 offset:34816
s_add_u32 m0, s97, 49152
v_mfma_f32_16x16x32_bf16 v[216:219], v[28:31], a[152:155], v[216:219]
buffer_load_dwordx4 v2, s[8:11], s45 offen offset:0 lds
v_mfma_f32_16x16x32_bf16 v[216:219], v[32:35], a[168:171], v[216:219]
v_mfma_f32_16x16x32_bf16 v[216:219], v[36:39], a[184:187], v[216:219]
buffer_load_dwordx4 v254, s[8:11], s45 offen offset:1024 lds
v_mfma_f32_16x16x32_bf16 v[220:223], v[28:31], a[156:159], v[220:223]
v_mfma_f32_16x16x32_bf16 v[220:223], v[32:35], a[172:175], v[220:223]
buffer_load_dwordx4 v255, s[8:11], s45 offen offset:2048 lds
v_mfma_f32_16x16x32_bf16 v[220:223], v[36:39], a[188:191], v[220:223]
s_waitcnt lgkmcnt(0)
v_mfma_f32_16x16x32_bf16 v[64:67], v[16:19], a[192:195], v[64:67]
ds_read_b64_tr_b16 v[28:29], v12 offset:24576
v_mfma_f32_16x16x32_bf16 v[64:67], v[20:23], a[208:211], v[64:67]
ds_read_b64_tr_b16 v[30:31], v12 offset:26624
v_mfma_f32_16x16x32_bf16 v[64:67], v[24:27], a[224:227], v[64:67]
ds_read_b64_tr_b16 v[32:33], v12 offset:28672
v_mfma_f32_16x16x32_bf16 v[68:71], v[16:19], a[196:199], v[68:71]
ds_read_b64_tr_b16 v[34:35], v12 offset:30720
v_mfma_f32_16x16x32_bf16 v[68:71], v[20:23], a[212:215], v[68:71]
ds_read_b64_tr_b16 v[36:37], v12 offset:32768
v_mfma_f32_16x16x32_bf16 v[68:71], v[24:27], a[228:231], v[68:71]
ds_read_b64_tr_b16 v[38:39], v12 offset:34816
v_mfma_f32_16x16x32_bf16 v[72:75], v[16:19], a[200:203], v[72:75]
v_mfma_f32_16x16x32_bf16 v[72:75], v[20:23], a[216:219], v[72:75]
v_mfma_f32_16x16x32_bf16 v[72:75], v[24:27], a[232:235], v[72:75]
v_mfma_f32_16x16x32_bf16 v[76:79], v[16:19], a[204:207], v[76:79]
v_mfma_f32_16x16x32_bf16 v[76:79], v[20:23], a[220:223], v[76:79]
s_add_u32 s45, s41, 1769600
v_mfma_f32_16x16x32_bf16 v[76:79], v[24:27], a[236:239], v[76:79]
s_waitcnt lgkmcnt(0)
s_waitcnt vmcnt(12)
s_barrier
s_add_u32 m0, s97, 61440
v_mfma_f32_16x16x32_bf16 v[80:83], v[28:31], a[192:195], v[80:83]
ds_read_b64_tr_b16 v[16:17], v11 offset:0
ds_read_b128 a[240:243], v7 offset:24576
v_mfma_f32_16x16x32_bf16 v[80:83], v[32:35], a[208:211], v[80:83]
ds_read_b64_tr_b16 v[18:19], v11 offset:2048
ds_read_b128 v[160:163], v7 offset:28672
v_mfma_f32_16x16x32_bf16 v[80:83], v[36:39], a[224:227], v[80:83]
ds_read_b64_tr_b16 v[20:21], v11 offset:4096
ds_read_b128 v[176:179], v7 offset:32768
v_mfma_f32_16x16x32_bf16 v[84:87], v[28:31], a[196:199], v[84:87]
ds_read_b64_tr_b16 v[22:23], v11 offset:6144
ds_read_b128 a[244:247], v7 offset:25600
v_mfma_f32_16x16x32_bf16 v[84:87], v[32:35], a[212:215], v[84:87]
ds_read_b64_tr_b16 v[24:25], v11 offset:8192
ds_read_b128 v[164:167], v7 offset:29696
v_mfma_f32_16x16x32_bf16 v[84:87], v[36:39], a[228:231], v[84:87]
ds_read_b64_tr_b16 v[26:27], v11 offset:10240
ds_read_b128 v[180:183], v7 offset:33792
v_mfma_f32_16x16x32_bf16 v[88:91], v[28:31], a[200:203], v[88:91]
buffer_load_dwordx4 v2, s[8:11], s45 offen offset:0 lds
v_mfma_f32_16x16x32_bf16 v[88:91], v[32:35], a[216:219], v[88:91]
v_mfma_f32_16x16x32_bf16 v[88:91], v[36:39], a[232:235], v[88:91]
buffer_load_dwordx4 v254, s[8:11], s45 offen offset:1024 lds
v_mfma_f32_16x16x32_bf16 v[92:95], v[28:31], a[204:207], v[92:95]
v_mfma_f32_16x16x32_bf16 v[92:95], v[32:35], a[220:223], v[92:95]
buffer_load_dwordx4 v255, s[8:11], s45 offen offset:2048 lds
v_mfma_f32_16x16x32_bf16 v[92:95], v[36:39], a[236:239], v[92:95]
s_waitcnt lgkmcnt(0)
v_mfma_f32_16x16x32_bf16 v[192:195], v[16:19], a[192:195], v[192:195]
ds_read_b64_tr_b16 v[28:29], v13 offset:0
ds_read_b128 a[248:251], v7 offset:26624
v_mfma_f32_16x16x32_bf16 v[192:195], v[20:23], a[208:211], v[192:195]
ds_read_b64_tr_b16 v[30:31], v13 offset:2048
ds_read_b128 v[168:171], v7 offset:30720
v_mfma_f32_16x16x32_bf16 v[192:195], v[24:27], a[224:227], v[192:195]
ds_read_b64_tr_b16 v[32:33], v13 offset:4096
ds_read_b128 v[184:187], v7 offset:34816
v_mfma_f32_16x16x32_bf16 v[196:199], v[16:19], a[196:199], v[196:199]
ds_read_b64_tr_b16 v[34:35], v13 offset:6144
ds_read_b128 a[252:255], v7 offset:27648
v_mfma_f32_16x16x32_bf16 v[196:199], v[20:23], a[212:215], v[196:199]
ds_read_b64_tr_b16 v[36:37], v13 offset:8192
ds_read_b128 v[172:175], v7 offset:31744
v_mfma_f32_16x16x32_bf16 v[196:199], v[24:27], a[228:231], v[196:199]
ds_read_b64_tr_b16 v[38:39], v13 offset:10240
ds_read_b128 v[188:191], v7 offset:35840
v_mfma_f32_16x16x32_bf16 v[200:203], v[16:19], a[200:203], v[200:203]
v_mfma_f32_16x16x32_bf16 v[200:203], v[20:23], a[216:219], v[200:203]
v_mfma_f32_16x16x32_bf16 v[200:203], v[24:27], a[232:235], v[200:203]
v_mfma_f32_16x16x32_bf16 v[204:207], v[16:19], a[204:207], v[204:207]
v_mfma_f32_16x16x32_bf16 v[204:207], v[20:23], a[220:223], v[204:207]
v_mfma_f32_16x16x32_bf16 v[204:207], v[24:27], a[236:239], v[204:207]
s_waitcnt lgkmcnt(0)
s_waitcnt vmcnt(12)
s_barrier
v_mfma_f32_16x16x32_bf16 v[208:211], v[28:31], a[192:195], v[208:211]
ds_read_b64_tr_b16 v[16:17], v11 offset:12288
v_mfma_f32_16x16x32_bf16 v[208:211], v[32:35], a[208:211], v[208:211]
ds_read_b64_tr_b16 v[18:19], v11 offset:14336
v_mfma_f32_16x16x32_bf16 v[208:211], v[36:39], a[224:227], v[208:211]
ds_read_b64_tr_b16 v[20:21], v11 offset:16384
v_mfma_f32_16x16x32_bf16 v[212:215], v[28:31], a[196:199], v[212:215]
ds_read_b64_tr_b16 v[22:23], v11 offset:18432
v_mfma_f32_16x16x32_bf16 v[212:215], v[32:35], a[212:215], v[212:215]
ds_read_b64_tr_b16 v[24:25], v11 offset:20480
s_add_u32 s45, s41, 2654336
v_mfma_f32_16x16x32_bf16 v[212:215], v[36:39], a[228:231], v[212:215]
ds_read_b64_tr_b16 v[26:27], v11 offset:22528
s_add_u32 m0, s97, 73728
v_mfma_f32_16x16x32_bf16 v[216:219], v[28:31], a[200:203], v[216:219]
buffer_load_dwordx4 v2, s[8:11], s45 offen offset:0 lds
v_mfma_f32_16x16x32_bf16 v[216:219], v[32:35], a[216:219], v[216:219]
v_mfma_f32_16x16x32_bf16 v[216:219], v[36:39], a[232:235], v[216:219]
buffer_load_dwordx4 v254, s[8:11], s45 offen offset:1024 lds
v_mfma_f32_16x16x32_bf16 v[220:223], v[28:31], a[204:207], v[220:223]
v_mfma_f32_16x16x32_bf16 v[220:223], v[32:35], a[220:223], v[220:223]
buffer_load_dwordx4 v255, s[8:11], s45 offen offset:2048 lds
v_mfma_f32_16x16x32_bf16 v[220:223], v[36:39], a[236:239], v[220:223]
s_waitcnt lgkmcnt(0)
v_mfma_f32_16x16x32_bf16 v[64:67], v[16:19], a[240:243], v[64:67]
ds_read_b64_tr_b16 v[28:29], v13 offset:12288
v_mfma_f32_16x16x32_bf16 v[64:67], v[20:23], v[160:163], v[64:67]
ds_read_b64_tr_b16 v[30:31], v13 offset:14336
v_mfma_f32_16x16x32_bf16 v[64:67], v[24:27], v[176:179], v[64:67]
ds_read_b64_tr_b16 v[32:33], v13 offset:16384
v_mfma_f32_16x16x32_bf16 v[68:71], v[16:19], a[244:247], v[68:71]
ds_read_b64_tr_b16 v[34:35], v13 offset:18432
v_mfma_f32_16x16x32_bf16 v[68:71], v[20:23], v[164:167], v[68:71]
ds_read_b64_tr_b16 v[36:37], v13 offset:20480
v_mfma_f32_16x16x32_bf16 v[68:71], v[24:27], v[180:183], v[68:71]
ds_read_b64_tr_b16 v[38:39], v13 offset:22528
v_mfma_f32_16x16x32_bf16 v[72:75], v[16:19], a[248:251], v[72:75]
v_mfma_f32_16x16x32_bf16 v[72:75], v[20:23], v[168:171], v[72:75]
v_mfma_f32_16x16x32_bf16 v[72:75], v[24:27], v[184:187], v[72:75]
v_mfma_f32_16x16x32_bf16 v[76:79], v[16:19], a[252:255], v[76:79]
v_mfma_f32_16x16x32_bf16 v[76:79], v[20:23], v[172:175], v[76:79]
v_mfma_f32_16x16x32_bf16 v[76:79], v[24:27], v[188:191], v[76:79]
s_waitcnt lgkmcnt(0)
s_waitcnt vmcnt(12)
s_barrier
v_mfma_f32_16x16x32_bf16 v[80:83], v[28:31], a[240:243], v[80:83]
ds_read_b64_tr_b16 v[16:17], v11 offset:24576
v_mfma_f32_16x16x32_bf16 v[80:83], v[32:35], v[160:163], v[80:83]
ds_read_b64_tr_b16 v[18:19], v11 offset:26624
v_mfma_f32_16x16x32_bf16 v[80:83], v[36:39], v[176:179], v[80:83]
ds_read_b64_tr_b16 v[20:21], v11 offset:28672
v_mfma_f32_16x16x32_bf16 v[84:87], v[28:31], a[244:247], v[84:87]
ds_read_b64_tr_b16 v[22:23], v11 offset:30720
v_mfma_f32_16x16x32_bf16 v[84:87], v[32:35], v[164:167], v[84:87]
ds_read_b64_tr_b16 v[24:25], v11 offset:32768
s_add_u32 s45, s41, 3539072
v_mfma_f32_16x16x32_bf16 v[84:87], v[36:39], v[180:183], v[84:87]
ds_read_b64_tr_b16 v[26:27], v11 offset:34816
s_add_u32 m0, s97, 86016
v_mfma_f32_16x16x32_bf16 v[88:91], v[28:31], a[248:251], v[88:91]
buffer_load_dwordx4 v2, s[8:11], s45 offen offset:0 lds
v_mfma_f32_16x16x32_bf16 v[88:91], v[32:35], v[168:171], v[88:91]
v_mfma_f32_16x16x32_bf16 v[88:91], v[36:39], v[184:187], v[88:91]
buffer_load_dwordx4 v254, s[8:11], s45 offen offset:1024 lds
v_mfma_f32_16x16x32_bf16 v[92:95], v[28:31], a[252:255], v[92:95]
v_mfma_f32_16x16x32_bf16 v[92:95], v[32:35], v[172:175], v[92:95]
buffer_load_dwordx4 v255, s[8:11], s45 offen offset:2048 lds
v_mfma_f32_16x16x32_bf16 v[92:95], v[36:39], v[188:191], v[92:95]
s_waitcnt lgkmcnt(0)
v_mfma_f32_16x16x32_bf16 v[192:195], v[16:19], a[240:243], v[192:195]
ds_read_b64_tr_b16 v[28:29], v13 offset:24576
v_mfma_f32_16x16x32_bf16 v[192:195], v[20:23], v[160:163], v[192:195]
ds_read_b64_tr_b16 v[30:31], v13 offset:26624
v_mfma_f32_16x16x32_bf16 v[192:195], v[24:27], v[176:179], v[192:195]
ds_read_b64_tr_b16 v[32:33], v13 offset:28672
v_mfma_f32_16x16x32_bf16 v[196:199], v[16:19], a[244:247], v[196:199]
ds_read_b64_tr_b16 v[34:35], v13 offset:30720
v_fma_f32 v40, -v64, v64, s47
v_mfma_f32_16x16x32_bf16 v[196:199], v[20:23], v[164:167], v[196:199]
ds_read_b64_tr_b16 v[36:37], v13 offset:32768
v_mul_f32 v40, v40, v64
v_mfma_f32_16x16x32_bf16 v[196:199], v[24:27], v[180:183], v[196:199]
ds_read_b64_tr_b16 v[38:39], v13 offset:34816
v_fma_f32 v41, -v65, v65, s47
v_mfma_f32_16x16x32_bf16 v[200:203], v[16:19], a[248:251], v[200:203]
v_exp_f32 v40, v40
v_mfma_f32_16x16x32_bf16 v[200:203], v[20:23], v[168:171], v[200:203]
v_add_f32 v40, 1.0, v40
v_mul_f32 v41, v41, v65
v_mfma_f32_16x16x32_bf16 v[200:203], v[24:27], v[184:187], v[200:203]
v_rcp_f32 v40, v40
v_mfma_f32_16x16x32_bf16 v[204:207], v[16:19], a[252:255], v[204:207]
v_exp_f32 v41, v41
v_mfma_f32_16x16x32_bf16 v[204:207], v[20:23], v[172:175], v[204:207]
v_mul_f32 v64, v64, v40
v_add_f32 v41, 1.0, v41
v_mfma_f32_16x16x32_bf16 v[204:207], v[24:27], v[188:191], v[204:207]
s_waitcnt lgkmcnt(0)
s_waitcnt vmcnt(9)
s_barrier
v_rcp_f32 v41, v41
v_mfma_f32_16x16x32_bf16 v[208:211], v[28:31], a[240:243], v[208:211]
ds_read_b64_tr_b16 v[16:17], v10 offset:0
v_mul_f32 v65, v65, v41
v_mfma_f32_16x16x32_bf16 v[208:211], v[32:35], v[160:163], v[208:211]
ds_read_b64_tr_b16 v[18:19], v10 offset:2048
v_fma_f32 v42, -v66, v66, s47
v_mfma_f32_16x16x32_bf16 v[208:211], v[36:39], v[176:179], v[208:211]
ds_read_b64_tr_b16 v[20:21], v10 offset:4096
v_mul_f32 v42, v42, v66
v_mfma_f32_16x16x32_bf16 v[212:215], v[28:31], a[244:247], v[212:215]
ds_read_b64_tr_b16 v[22:23], v10 offset:6144
v_fma_f32 v43, -v67, v67, s47
v_mfma_f32_16x16x32_bf16 v[212:215], v[32:35], v[164:167], v[212:215]
ds_read_b64_tr_b16 v[24:25], v10 offset:8192
v_mul_f32 v43, v43, v67
v_mfma_f32_16x16x32_bf16 v[212:215], v[36:39], v[180:183], v[212:215]
ds_read_b64_tr_b16 v[26:27], v10 offset:10240
v_fma_f32 v44, -v80, v80, s47
v_mfma_f32_16x16x32_bf16 v[216:219], v[28:31], a[248:251], v[216:219]
v_exp_f32 v42, v42
v_mfma_f32_16x16x32_bf16 v[216:219], v[32:35], v[168:171], v[216:219]
v_exp_f32 v43, v43
v_mfma_f32_16x16x32_bf16 v[216:219], v[36:39], v[184:187], v[216:219]
v_add_f32 v42, 1.0, v42
v_add_f32 v43, 1.0, v43
v_mfma_f32_16x16x32_bf16 v[220:223], v[28:31], a[252:255], v[220:223]
v_rcp_f32 v42, v42
v_mfma_f32_16x16x32_bf16 v[220:223], v[32:35], v[172:175], v[220:223]
v_rcp_f32 v43, v43
v_mfma_f32_16x16x32_bf16 v[220:223], v[36:39], v[188:191], v[220:223]
s_waitcnt lgkmcnt(0)
v_mul_f32 v66, v66, v42
v_mul_f32 v67, v67, v43
v_mfma_f32_16x16x32_bf16 v[96:99], v[16:19], a[0:3], 0
ds_read_b64_tr_b16 v[28:29], v12 offset:0
v_mul_f32 v44, v44, v80
v_mfma_f32_16x16x32_bf16 v[96:99], v[20:23], a[16:19], v[96:99]
ds_read_b64_tr_b16 v[30:31], v12 offset:2048
v_fma_f32 v45, -v81, v81, s47
v_mfma_f32_16x16x32_bf16 v[96:99], v[24:27], a[32:35], v[96:99]
ds_read_b64_tr_b16 v[32:33], v12 offset:4096
v_mul_f32 v45, v45, v81
v_mfma_f32_16x16x32_bf16 v[100:103], v[16:19], a[4:7], 0
ds_read_b64_tr_b16 v[34:35], v12 offset:6144
v_mul_f32 v64, v64, v192
v_mfma_f32_16x16x32_bf16 v[100:103], v[20:23], a[20:23], v[100:103]
ds_read_b64_tr_b16 v[36:37], v12 offset:8192
v_mul_f32 v65, v65, v193
v_mfma_f32_16x16x32_bf16 v[100:103], v[24:27], a[36:39], v[100:103]
ds_read_b64_tr_b16 v[38:39], v12 offset:10240
v_mul_f32 v66, v66, v194
v_mfma_f32_16x16x32_bf16 v[104:107], v[16:19], a[8:11], 0
v_exp_f32 v44, v44
v_mfma_f32_16x16x32_bf16 v[104:107], v[20:23], a[24:27], v[104:107]
v_exp_f32 v45, v45
v_mfma_f32_16x16x32_bf16 v[104:107], v[24:27], a[40:43], v[104:107]
v_mul_f32 v67, v67, v195
v_cvt_pk_bf16_f32 v48, v64, v65
v_mfma_f32_16x16x32_bf16 v[108:111], v[16:19], a[12:15], 0
v_cvt_pk_bf16_f32 v49, v66, v67
v_add_f32 v44, 1.0, v44
v_mfma_f32_16x16x32_bf16 v[108:111], v[20:23], a[28:31], v[108:111]
v_rcp_f32 v44, v44
v_mfma_f32_16x16x32_bf16 v[108:111], v[24:27], a[44:47], v[108:111]
s_waitcnt lgkmcnt(0)
v_mul_f32 v80, v80, v44
v_mul_f32 v80, v80, v208
v_mfma_f32_16x16x32_bf16 v[112:115], v[28:31], a[0:3], 0
ds_read_b64_tr_b16 v[16:17], v10 offset:12288
v_add_f32 v45, 1.0, v45
v_mfma_f32_16x16x32_bf16 v[112:115], v[32:35], a[16:19], v[112:115]
ds_read_b64_tr_b16 v[18:19], v10 offset:14336
v_fma_f32 v46, -v82, v82, s47
s_add_u32 m0, s97, 98304
v_mfma_f32_16x16x32_bf16 v[112:115], v[36:39], a[32:35], v[112:115]
s_add_u32 s45, s41, 4423808
buffer_load_dwordx4 v2, s[8:11], s45 offen offset:0 lds
v_mfma_f32_16x16x32_bf16 v[116:119], v[28:31], a[4:7], 0
ds_read_b64_tr_b16 v[20:21], v10 offset:16384
v_mul_f32 v46, v46, v82
v_mfma_f32_16x16x32_bf16 v[116:119], v[32:35], a[20:23], v[116:119]
ds_read_b64_tr_b16 v[22:23], v10 offset:18432
v_fma_f32 v47, -v83, v83, s47
v_mfma_f32_16x16x32_bf16 v[116:119], v[36:39], a[36:39], v[116:119]
ds_read_b64_tr_b16 v[24:25], v10 offset:20480
v_mul_f32 v47, v47, v83
v_mfma_f32_16x16x32_bf16 v[120:123], v[28:31], a[8:11], 0
ds_read_b64_tr_b16 v[26:27], v10 offset:22528
v_fma_f32 v240, -v68, v68, s47
v_mfma_f32_16x16x32_bf16 v[120:123], v[32:35], a[24:27], v[120:123]
v_rcp_f32 v45, v45
v_mfma_f32_16x16x32_bf16 v[120:123], v[36:39], a[40:43], v[120:123]
v_exp_f32 v46, v46
v_mfma_f32_16x16x32_bf16 v[124:127], v[28:31], a[12:15], 0
v_exp_f32 v47, v47
v_mfma_f32_16x16x32_bf16 v[124:127], v[32:35], a[28:31], v[124:127]
buffer_load_dwordx4 v254, s[8:11], s45 offen offset:1024 lds
v_mfma_f32_16x16x32_bf16 v[124:127], v[36:39], a[44:47], v[124:127]
s_waitcnt lgkmcnt(1)
v_mul_f32 v81, v81, v45
v_mul_f32 v81, v81, v209
v_mfma_f32_16x16x32_bf16 v[96:99], v[16:19], a[48:51], v[96:99]
ds_read_b64_tr_b16 v[28:29], v12 offset:12288
v_add_f32 v46, 1.0, v46
v_mfma_f32_16x16x32_bf16 v[96:99], v[20:23], a[64:67], v[96:99]
s_waitcnt lgkmcnt(1)
ds_read_b64_tr_b16 v[30:31], v12 offset:14336
v_add_f32 v47, 1.0, v47
v_mfma_f32_16x16x32_bf16 v[96:99], v[24:27], a[80:83], v[96:99]
ds_read_b64_tr_b16 v[32:33], v12 offset:16384
v_cvt_pk_bf16_f32 v50, v80, v81
v_mfma_f32_16x16x32_bf16 v[100:103], v[16:19], a[52:55], v[100:103]
ds_read_b64_tr_b16 v[34:35], v12 offset:18432
v_mul_f32 v240, v240, v68
v_mfma_f32_16x16x32_bf16 v[100:103], v[20:23], a[68:71], v[100:103]
ds_read_b64_tr_b16 v[36:37], v12 offset:20480
v_fma_f32 v241, -v69, v69, s47
v_mfma_f32_16x16x32_bf16 v[100:103], v[24:27], a[84:87], v[100:103]
ds_read_b64_tr_b16 v[38:39], v12 offset:22528
v_mul_f32 v241, v241, v69
v_mfma_f32_16x16x32_bf16 v[104:107], v[16:19], a[56:59], v[104:107]
buffer_load_dwordx4 v255, s[8:11], s45 offen offset:2048 lds
v_mfma_f32_16x16x32_bf16 v[104:107], v[20:23], a[72:75], v[104:107]
v_rcp_f32 v46, v46
v_mfma_f32_16x16x32_bf16 v[104:107], v[24:27], a[88:91], v[104:107]
v_rcp_f32 v47, v47
v_mfma_f32_16x16x32_bf16 v[108:111], v[16:19], a[60:63], v[108:111]
v_exp_f32 v240, v240
v_mfma_f32_16x16x32_bf16 v[108:111], v[20:23], a[76:79], v[108:111]
v_exp_f32 v241, v241
v_mfma_f32_16x16x32_bf16 v[108:111], v[24:27], a[92:95], v[108:111]
s_waitcnt lgkmcnt(0)
s_waitcnt vmcnt(6)
s_barrier
v_mul_f32 v82, v82, v46
v_mul_f32 v82, v82, v210
v_mfma_f32_16x16x32_bf16 v[112:115], v[28:31], a[48:51], v[112:115]
ds_read_b64_tr_b16 v[16:17], v10 offset:24576
v_mul_f32 v83, v83, v47
v_mfma_f32_16x16x32_bf16 v[112:115], v[32:35], a[64:67], v[112:115]
ds_read_b64_tr_b16 v[18:19], v10 offset:26624
v_mul_f32 v83, v83, v211
s_add_u32 m0, s97, 36864
v_mfma_f32_16x16x32_bf16 v[112:115], v[36:39], a[80:83], v[112:115]
s_add_u32 s45, s41, 128
buffer_load_dwordx4 v2, s[12:15], s45 offen offset:0 lds
v_mfma_f32_16x16x32_bf16 v[116:119], v[28:31], a[52:55], v[116:119]
ds_read_b64_tr_b16 v[20:21], v10 offset:28672
v_cvt_pk_bf16_f32 v51, v82, v83
v_mfma_f32_16x16x32_bf16 v[116:119], v[32:35], a[68:71], v[116:119]
ds_read_b64_tr_b16 v[22:23], v10 offset:30720
ds_write_b128 v6, v[48:51] offset:0
v_mfma_f32_16x16x32_bf16 v[116:119], v[36:39], a[84:87], v[116:119]
ds_read_b64_tr_b16 v[24:25], v10 offset:32768
v_add_f32 v240, 1.0, v240
v_mfma_f32_16x16x32_bf16 v[120:123], v[28:31], a[56:59], v[120:123]
ds_read_b64_tr_b16 v[26:27], v10 offset:34816
v_add_f32 v241, 1.0, v241
v_mfma_f32_16x16x32_bf16 v[120:123], v[32:35], a[72:75], v[120:123]
v_rcp_f32 v240, v240
v_mfma_f32_16x16x32_bf16 v[120:123], v[36:39], a[88:91], v[120:123]
v_rcp_f32 v241, v241
v_mfma_f32_16x16x32_bf16 v[124:127], v[28:31], a[60:63], v[124:127]
v_mul_f32 v68, v68, v240
v_mul_f32 v68, v68, v196
v_mfma_f32_16x16x32_bf16 v[124:127], v[32:35], a[76:79], v[124:127]
buffer_load_dwordx4 v254, s[12:15], s45 offen offset:1024 lds
v_mfma_f32_16x16x32_bf16 v[124:127], v[36:39], a[92:95], v[124:127]
s_waitcnt lgkmcnt(1)
v_mul_f32 v69, v69, v241
v_mul_f32 v69, v69, v197
v_mfma_f32_16x16x32_bf16 v[96:99], v[16:19], a[96:99], v[96:99]
ds_read_b64_tr_b16 v[28:29], v12 offset:24576
v_fma_f32 v242, -v70, v70, s47
v_mfma_f32_16x16x32_bf16 v[96:99], v[20:23], a[112:115], v[96:99]
s_waitcnt lgkmcnt(1)
ds_read_b64_tr_b16 v[30:31], v12 offset:26624
v_mul_f32 v242, v242, v70
v_mfma_f32_16x16x32_bf16 v[96:99], v[24:27], a[128:131], v[96:99]
ds_read_b64_tr_b16 v[32:33], v12 offset:28672
v_fma_f32 v243, -v71, v71, s47
v_mfma_f32_16x16x32_bf16 v[100:103], v[16:19], a[100:103], v[100:103]
ds_read_b64_tr_b16 v[34:35], v12 offset:30720
v_mul_f32 v243, v243, v71
v_mfma_f32_16x16x32_bf16 v[100:103], v[20:23], a[116:119], v[100:103]
ds_read_b64_tr_b16 v[36:37], v12 offset:32768
v_cvt_pk_bf16_f32 v52, v68, v69
v_mfma_f32_16x16x32_bf16 v[100:103], v[24:27], a[132:135], v[100:103]
ds_read_b64_tr_b16 v[38:39], v12 offset:34816
v_fma_f32 v244, -v84, v84, s47
v_mfma_f32_16x16x32_bf16 v[104:107], v[16:19], a[104:107], v[104:107]
buffer_load_dwordx4 v255, s[12:15], s45 offen offset:2048 lds
v_mfma_f32_16x16x32_bf16 v[104:107], v[20:23], a[120:123], v[104:107]
v_exp_f32 v242, v242
v_mfma_f32_16x16x32_bf16 v[104:107], v[24:27], a[136:139], v[104:107]
v_exp_f32 v243, v243
v_mfma_f32_16x16x32_bf16 v[108:111], v[16:19], a[108:111], v[108:111]
v_add_f32 v242, 1.0, v242
v_add_f32 v243, 1.0, v243
v_mfma_f32_16x16x32_bf16 v[108:111], v[20:23], a[124:127], v[108:111]
v_rcp_f32 v242, v242
v_mfma_f32_16x16x32_bf16 v[108:111], v[24:27], a[140:143], v[108:111]
s_waitcnt lgkmcnt(0)
v_rcp_f32 v243, v243
v_mfma_f32_16x16x32_bf16 v[112:115], v[28:31], a[96:99], v[112:115]
ds_read_b64_tr_b16 v[16:17], v11 offset:0
v_mul_f32 v70, v70, v242
v_mfma_f32_16x16x32_bf16 v[112:115], v[32:35], a[112:115], v[112:115]
ds_read_b64_tr_b16 v[18:19], v11 offset:2048
v_mul_f32 v70, v70, v198
s_add_u32 m0, s97, 49152
v_mfma_f32_16x16x32_bf16 v[112:115], v[36:39], a[128:131], v[112:115]
s_add_u32 s45, s41, 884864
buffer_load_dwordx4 v2, s[12:15], s45 offen offset:0 lds
v_mfma_f32_16x16x32_bf16 v[116:119], v[28:31], a[100:103], v[116:119]
ds_read_b64_tr_b16 v[20:21], v11 offset:4096
v_mul_f32 v71, v71, v243
v_mfma_f32_16x16x32_bf16 v[116:119], v[32:35], a[116:119], v[116:119]
ds_read_b64_tr_b16 v[22:23], v11 offset:6144
v_mul_f32 v71, v71, v199
v_mfma_f32_16x16x32_bf16 v[116:119], v[36:39], a[132:135], v[116:119]
ds_read_b64_tr_b16 v[24:25], v11 offset:8192
v_cvt_pk_bf16_f32 v53, v70, v71
v_mfma_f32_16x16x32_bf16 v[120:123], v[28:31], a[104:107], v[120:123]
ds_read_b64_tr_b16 v[26:27], v11 offset:10240
v_mul_f32 v244, v244, v84
v_mfma_f32_16x16x32_bf16 v[120:123], v[32:35], a[120:123], v[120:123]
v_exp_f32 v244, v244
v_mfma_f32_16x16x32_bf16 v[120:123], v[36:39], a[136:139], v[120:123]
v_add_f32 v244, 1.0, v244
v_fma_f32 v245, -v85, v85, s47
v_mfma_f32_16x16x32_bf16 v[124:127], v[28:31], a[108:111], v[124:127]
v_rcp_f32 v244, v244
v_mfma_f32_16x16x32_bf16 v[124:127], v[32:35], a[124:127], v[124:127]
buffer_load_dwordx4 v254, s[12:15], s45 offen offset:1024 lds
v_mfma_f32_16x16x32_bf16 v[124:127], v[36:39], a[140:143], v[124:127]
s_waitcnt lgkmcnt(1)
v_mul_f32 v84, v84, v244
v_mul_f32 v84, v84, v212
v_mfma_f32_16x16x32_bf16 v[96:99], v[16:19], a[144:147], v[96:99]
ds_read_b64_tr_b16 v[28:29], v13 offset:0
v_mul_f32 v245, v245, v85
v_mfma_f32_16x16x32_bf16 v[96:99], v[20:23], a[160:163], v[96:99]
s_waitcnt lgkmcnt(1)
ds_read_b64_tr_b16 v[30:31], v13 offset:2048
v_fma_f32 v246, -v86, v86, s47
v_mfma_f32_16x16x32_bf16 v[96:99], v[24:27], a[176:179], v[96:99]
ds_read_b64_tr_b16 v[32:33], v13 offset:4096
v_mul_f32 v246, v246, v86
v_mfma_f32_16x16x32_bf16 v[100:103], v[16:19], a[148:151], v[100:103]
ds_read_b64_tr_b16 v[34:35], v13 offset:6144
v_fma_f32 v247, -v87, v87, s47
v_mfma_f32_16x16x32_bf16 v[100:103], v[20:23], a[164:167], v[100:103]
ds_read_b64_tr_b16 v[36:37], v13 offset:8192
v_mul_f32 v247, v247, v87
v_mfma_f32_16x16x32_bf16 v[100:103], v[24:27], a[180:183], v[100:103]
ds_read_b64_tr_b16 v[38:39], v13 offset:10240
v_fma_f32 v248, -v72, v72, s47
v_mfma_f32_16x16x32_bf16 v[104:107], v[16:19], a[152:155], v[104:107]
buffer_load_dwordx4 v255, s[12:15], s45 offen offset:2048 lds
v_mfma_f32_16x16x32_bf16 v[104:107], v[20:23], a[168:171], v[104:107]
v_exp_f32 v245, v245
v_mfma_f32_16x16x32_bf16 v[104:107], v[24:27], a[184:187], v[104:107]
v_exp_f32 v246, v246
v_mfma_f32_16x16x32_bf16 v[108:111], v[16:19], a[156:159], v[108:111]
v_exp_f32 v247, v247
v_mfma_f32_16x16x32_bf16 v[108:111], v[20:23], a[172:175], v[108:111]
v_add_f32 v245, 1.0, v245
v_add_f32 v246, 1.0, v246
v_mfma_f32_16x16x32_bf16 v[108:111], v[24:27], a[188:191], v[108:111]
s_waitcnt lgkmcnt(0)
s_waitcnt vmcnt(6)
s_barrier
v_rcp_f32 v245, v245
v_mfma_f32_16x16x32_bf16 v[112:115], v[28:31], a[144:147], v[112:115]
ds_read_b64_tr_b16 v[16:17], v11 offset:12288
v_mul_f32 v85, v85, v245
v_mfma_f32_16x16x32_bf16 v[112:115], v[32:35], a[160:163], v[112:115]
ds_read_b64_tr_b16 v[18:19], v11 offset:14336
v_mul_f32 v85, v85, v213
s_add_u32 m0, s97, 61440
v_mfma_f32_16x16x32_bf16 v[112:115], v[36:39], a[176:179], v[112:115]
s_add_u32 s45, s41, 1769600
buffer_load_dwordx4 v2, s[12:15], s45 offen offset:0 lds
v_mfma_f32_16x16x32_bf16 v[116:119], v[28:31], a[148:151], v[116:119]
ds_read_b64_tr_b16 v[20:21], v11 offset:16384
v_add_f32 v247, 1.0, v247
v_mfma_f32_16x16x32_bf16 v[116:119], v[32:35], a[164:167], v[116:119]
ds_read_b64_tr_b16 v[22:23], v11 offset:18432
v_cvt_pk_bf16_f32 v54, v84, v85
v_mfma_f32_16x16x32_bf16 v[116:119], v[36:39], a[180:183], v[116:119]
ds_read_b64_tr_b16 v[24:25], v11 offset:20480
v_mul_f32 v248, v248, v72
v_mfma_f32_16x16x32_bf16 v[120:123], v[28:31], a[152:155], v[120:123]
ds_read_b64_tr_b16 v[26:27], v11 offset:22528
v_fma_f32 v249, -v73, v73, s47
v_mfma_f32_16x16x32_bf16 v[120:123], v[32:35], a[168:171], v[120:123]
v_rcp_f32 v246, v246
v_mfma_f32_16x16x32_bf16 v[120:123], v[36:39], a[184:187], v[120:123]
v_rcp_f32 v247, v247
v_mfma_f32_16x16x32_bf16 v[124:127], v[28:31], a[156:159], v[124:127]
v_exp_f32 v248, v248
v_mfma_f32_16x16x32_bf16 v[124:127], v[32:35], a[172:175], v[124:127]
buffer_load_dwordx4 v254, s[12:15], s45 offen offset:1024 lds
v_mfma_f32_16x16x32_bf16 v[124:127], v[36:39], a[188:191], v[124:127]
s_waitcnt lgkmcnt(1)
v_mul_f32 v86, v86, v246
v_mul_f32 v86, v86, v214
v_mfma_f32_16x16x32_bf16 v[96:99], v[16:19], a[192:195], v[96:99]
ds_read_b64_tr_b16 v[28:29], v13 offset:12288
v_mul_f32 v87, v87, v247
v_mfma_f32_16x16x32_bf16 v[96:99], v[20:23], a[208:211], v[96:99]
s_waitcnt lgkmcnt(1)
ds_read_b64_tr_b16 v[30:31], v13 offset:14336
v_mul_f32 v87, v87, v215
v_mfma_f32_16x16x32_bf16 v[96:99], v[24:27], a[224:227], v[96:99]
ds_read_b64_tr_b16 v[32:33], v13 offset:16384
v_cvt_pk_bf16_f32 v55, v86, v87
v_mfma_f32_16x16x32_bf16 v[100:103], v[16:19], a[196:199], v[100:103]
ds_read_b64_tr_b16 v[34:35], v13 offset:18432
ds_write_b128 v6, v[52:55] offset:1024
v_mfma_f32_16x16x32_bf16 v[100:103], v[20:23], a[212:215], v[100:103]
ds_read_b64_tr_b16 v[36:37], v13 offset:20480
v_add_f32 v248, 1.0, v248
v_mfma_f32_16x16x32_bf16 v[100:103], v[24:27], a[228:231], v[100:103]
ds_read_b64_tr_b16 v[38:39], v13 offset:22528
v_mul_f32 v249, v249, v73
v_mfma_f32_16x16x32_bf16 v[104:107], v[16:19], a[200:203], v[104:107]
buffer_load_dwordx4 v255, s[12:15], s45 offen offset:2048 lds
v_mfma_f32_16x16x32_bf16 v[104:107], v[20:23], a[216:219], v[104:107]
v_rcp_f32 v248, v248
v_mfma_f32_16x16x32_bf16 v[104:107], v[24:27], a[232:235], v[104:107]
v_exp_f32 v249, v249
v_mfma_f32_16x16x32_bf16 v[108:111], v[16:19], a[204:207], v[108:111]
v_mul_f32 v72, v72, v248
v_mul_f32 v72, v72, v200
v_mfma_f32_16x16x32_bf16 v[108:111], v[20:23], a[220:223], v[108:111]
v_add_f32 v249, 1.0, v249
v_fma_f32 v250, -v74, v74, s47
v_mfma_f32_16x16x32_bf16 v[108:111], v[24:27], a[236:239], v[108:111]
s_waitcnt lgkmcnt(0)
v_rcp_f32 v249, v249
v_mfma_f32_16x16x32_bf16 v[112:115], v[28:31], a[192:195], v[112:115]
ds_read_b64_tr_b16 v[16:17], v11 offset:24576
v_mul_f32 v73, v73, v249
v_mfma_f32_16x16x32_bf16 v[112:115], v[32:35], a[208:211], v[112:115]
ds_read_b64_tr_b16 v[18:19], v11 offset:26624
v_mul_f32 v73, v73, v201
s_add_u32 m0, s97, 73728
v_mfma_f32_16x16x32_bf16 v[112:115], v[36:39], a[224:227], v[112:115]
s_add_u32 s45, s41, 2654336
buffer_load_dwordx4 v2, s[12:15], s45 offen offset:0 lds
v_mfma_f32_16x16x32_bf16 v[116:119], v[28:31], a[196:199], v[116:119]
ds_read_b64_tr_b16 v[20:21], v11 offset:28672
v_mul_f32 v250, v250, v74
v_mfma_f32_16x16x32_bf16 v[116:119], v[32:35], a[212:215], v[116:119]
ds_read_b64_tr_b16 v[22:23], v11 offset:30720
v_fma_f32 v251, -v75, v75, s47
v_mfma_f32_16x16x32_bf16 v[116:119], v[36:39], a[228:231], v[116:119]
ds_read_b64_tr_b16 v[24:25], v11 offset:32768
v_mul_f32 v251, v251, v75
v_mfma_f32_16x16x32_bf16 v[120:123], v[28:31], a[200:203], v[120:123]
ds_read_b64_tr_b16 v[26:27], v11 offset:34816
v_cvt_pk_bf16_f32 v56, v72, v73
v_mfma_f32_16x16x32_bf16 v[120:123], v[32:35], a[216:219], v[120:123]
v_exp_f32 v250, v250
v_mfma_f32_16x16x32_bf16 v[120:123], v[36:39], a[232:235], v[120:123]
v_exp_f32 v251, v251
v_mfma_f32_16x16x32_bf16 v[124:127], v[28:31], a[204:207], v[124:127]
v_add_f32 v250, 1.0, v250
v_add_f32 v251, 1.0, v251
v_mfma_f32_16x16x32_bf16 v[124:127], v[32:35], a[220:223], v[124:127]
buffer_load_dwordx4 v254, s[12:15], s45 offen offset:1024 lds
v_mfma_f32_16x16x32_bf16 v[124:127], v[36:39], a[236:239], v[124:127]
s_waitcnt lgkmcnt(1)
v_rcp_f32 v250, v250
v_mfma_f32_16x16x32_bf16 v[96:99], v[16:19], a[240:243], v[96:99]
ds_read_b64_tr_b16 v[28:29], v13 offset:24576
v_mul_f32 v74, v74, v250
v_mfma_f32_16x16x32_bf16 v[96:99], v[20:23], v[160:163], v[96:99]
s_waitcnt lgkmcnt(1)
ds_read_b64_tr_b16 v[30:31], v13 offset:26624
v_mul_f32 v74, v74, v202
v_mfma_f32_16x16x32_bf16 v[96:99], v[24:27], v[176:179], v[96:99]
ds_read_b64_tr_b16 v[32:33], v13 offset:28672
v_fma_f32 v252, -v88, v88, s47
v_mfma_f32_16x16x32_bf16 v[100:103], v[16:19], a[244:247], v[100:103]
ds_read_b64_tr_b16 v[34:35], v13 offset:30720
v_mul_f32 v252, v252, v88
v_mfma_f32_16x16x32_bf16 v[100:103], v[20:23], v[164:167], v[100:103]
ds_read_b64_tr_b16 v[36:37], v13 offset:32768
v_fma_f32 v253, -v89, v89, s47
v_mfma_f32_16x16x32_bf16 v[100:103], v[24:27], v[180:183], v[100:103]
ds_read_b64_tr_b16 v[38:39], v13 offset:34816
v_mul_f32 v253, v253, v89
v_mfma_f32_16x16x32_bf16 v[104:107], v[16:19], a[248:251], v[104:107]
buffer_load_dwordx4 v255, s[12:15], s45 offen offset:2048 lds
v_mfma_f32_16x16x32_bf16 v[104:107], v[20:23], v[168:171], v[104:107]
v_rcp_f32 v251, v251
v_mfma_f32_16x16x32_bf16 v[104:107], v[24:27], v[184:187], v[104:107]
v_exp_f32 v252, v252
v_mfma_f32_16x16x32_bf16 v[108:111], v[16:19], a[252:255], v[108:111]
v_exp_f32 v253, v253
v_mfma_f32_16x16x32_bf16 v[108:111], v[20:23], v[172:175], v[108:111]
v_mul_f32 v75, v75, v251
v_mul_f32 v75, v75, v203
v_mfma_f32_16x16x32_bf16 v[108:111], v[24:27], v[188:191], v[108:111]
s_waitcnt lgkmcnt(0)
s_waitcnt vmcnt(6)
s_barrier
v_cvt_pk_bf16_f32 v57, v74, v75
v_add_f32 v252, 1.0, v252
v_mfma_f32_16x16x32_bf16 v[112:115], v[28:31], a[240:243], v[112:115]
ds_read_b64_tr_b16 v[16:17], v10 offset:0
v_add_f32 v253, 1.0, v253
v_mfma_f32_16x16x32_bf16 v[112:115], v[32:35], v[160:163], v[112:115]
ds_read_b64_tr_b16 v[18:19], v10 offset:2048
v_fma_f32 v40, -v90, v90, s47
s_add_u32 m0, s97, 86016
v_mfma_f32_16x16x32_bf16 v[112:115], v[36:39], v[176:179], v[112:115]
s_add_u32 s45, s41, 3539072
buffer_load_dwordx4 v2, s[12:15], s45 offen offset:0 lds
v_mfma_f32_16x16x32_bf16 v[116:119], v[28:31], a[244:247], v[116:119]
ds_read_b64_tr_b16 v[20:21], v10 offset:4096
v_mul_f32 v40, v40, v90
v_mfma_f32_16x16x32_bf16 v[116:119], v[32:35], v[164:167], v[116:119]
ds_read_b64_tr_b16 v[22:23], v10 offset:6144
v_fma_f32 v41, -v91, v91, s47
v_mfma_f32_16x16x32_bf16 v[116:119], v[36:39], v[180:183], v[116:119]
ds_read_b64_tr_b16 v[24:25], v10 offset:8192
v_mul_f32 v41, v41, v91
v_mfma_f32_16x16x32_bf16 v[120:123], v[28:31], a[248:251], v[120:123]
ds_read_b64_tr_b16 v[26:27], v10 offset:10240
v_fma_f32 v42, -v76, v76, s47
v_mfma_f32_16x16x32_bf16 v[120:123], v[32:35], v[168:171], v[120:123]
v_rcp_f32 v252, v252
v_mfma_f32_16x16x32_bf16 v[120:123], v[36:39], v[184:187], v[120:123]
v_rcp_f32 v253, v253
v_mfma_f32_16x16x32_bf16 v[124:127], v[28:31], a[252:255], v[124:127]
v_exp_f32 v40, v40
v_mfma_f32_16x16x32_bf16 v[124:127], v[32:35], v[172:175], v[124:127]
buffer_load_dwordx4 v254, s[12:15], s45 offen offset:1024 lds
v_mfma_f32_16x16x32_bf16 v[124:127], v[36:39], v[188:191], v[124:127]
s_waitcnt lgkmcnt(1)
v_exp_f32 v41, v41
v_mfma_f32_16x16x32_bf16 v[128:131], v[16:19], a[0:3], 0
ds_read_b64_tr_b16 v[28:29], v12 offset:0
v_mul_f32 v88, v88, v252
v_mfma_f32_16x16x32_bf16 v[128:131], v[20:23], a[16:19], v[128:131]
s_waitcnt lgkmcnt(1)
ds_read_b64_tr_b16 v[30:31], v12 offset:2048
v_mul_f32 v88, v88, v216
v_mfma_f32_16x16x32_bf16 v[128:131], v[24:27], a[32:35], v[128:131]
ds_read_b64_tr_b16 v[32:33], v12 offset:4096
v_mul_f32 v89, v89, v253
v_mfma_f32_16x16x32_bf16 v[132:135], v[16:19], a[4:7], 0
ds_read_b64_tr_b16 v[34:35], v12 offset:6144
v_mul_f32 v89, v89, v217
v_mfma_f32_16x16x32_bf16 v[132:135], v[20:23], a[20:23], v[132:135]
ds_read_b64_tr_b16 v[36:37], v12 offset:8192
v_add_f32 v40, 1.0, v40
v_mfma_f32_16x16x32_bf16 v[132:135], v[24:27], a[36:39], v[132:135]
ds_read_b64_tr_b16 v[38:39], v12 offset:10240
v_add_f32 v41, 1.0, v41
v_mfma_f32_16x16x32_bf16 v[136:139], v[16:19], a[8:11], 0
buffer_load_dwordx4 v255, s[12:15], s45 offen offset:2048 lds
v_mfma_f32_16x16x32_bf16 v[136:139], v[20:23], a[24:27], v[136:139]
v_rcp_f32 v40, v40
v_mfma_f32_16x16x32_bf16 v[136:139], v[24:27], a[40:43], v[136:139]
v_rcp_f32 v41, v41
v_mfma_f32_16x16x32_bf16 v[140:143], v[16:19], a[12:15], 0
v_mul_f32 v90, v90, v40
v_mul_f32 v90, v90, v218
v_mfma_f32_16x16x32_bf16 v[140:143], v[20:23], a[28:31], v[140:143]
v_mul_f32 v91, v91, v41
v_mul_f32 v91, v91, v219
v_mfma_f32_16x16x32_bf16 v[140:143], v[24:27], a[44:47], v[140:143]
s_waitcnt lgkmcnt(0)
v_cvt_pk_bf16_f32 v58, v88, v89
v_cvt_pk_bf16_f32 v59, v90, v91
v_mfma_f32_16x16x32_bf16 v[144:147], v[28:31], a[0:3], 0
ds_read_b64_tr_b16 v[16:17], v10 offset:12288
ds_write_b128 v6, v[56:59] offset:2048
v_mfma_f32_16x16x32_bf16 v[144:147], v[32:35], a[16:19], v[144:147]
ds_read_b64_tr_b16 v[18:19], v10 offset:14336
v_mul_f32 v42, v42, v76
s_add_u32 m0, s97, 98304
v_mfma_f32_16x16x32_bf16 v[144:147], v[36:39], a[32:35], v[144:147]
s_add_u32 s45, s41, 4423808
buffer_load_dwordx4 v2, s[12:15], s45 offen offset:0 lds
v_mfma_f32_16x16x32_bf16 v[148:151], v[28:31], a[4:7], 0
ds_read_b64_tr_b16 v[20:21], v10 offset:16384
v_fma_f32 v43, -v77, v77, s47
v_mfma_f32_16x16x32_bf16 v[148:151], v[32:35], a[20:23], v[148:151]
ds_read_b64_tr_b16 v[22:23], v10 offset:18432
v_mul_f32 v43, v43, v77
v_mfma_f32_16x16x32_bf16 v[148:151], v[36:39], a[36:39], v[148:151]
ds_read_b64_tr_b16 v[24:25], v10 offset:20480
v_fma_f32 v44, -v78, v78, s47
v_mfma_f32_16x16x32_bf16 v[152:155], v[28:31], a[8:11], 0
ds_read_b64_tr_b16 v[26:27], v10 offset:22528
v_mul_f32 v44, v44, v78
v_mfma_f32_16x16x32_bf16 v[152:155], v[32:35], a[24:27], v[152:155]
v_exp_f32 v42, v42
v_mfma_f32_16x16x32_bf16 v[152:155], v[36:39], a[40:43], v[152:155]
v_exp_f32 v43, v43
v_mfma_f32_16x16x32_bf16 v[156:159], v[28:31], a[12:15], 0
v_exp_f32 v44, v44
v_mfma_f32_16x16x32_bf16 v[156:159], v[32:35], a[28:31], v[156:159]
buffer_load_dwordx4 v254, s[12:15], s45 offen offset:1024 lds
v_mfma_f32_16x16x32_bf16 v[156:159], v[36:39], a[44:47], v[156:159]
s_waitcnt lgkmcnt(1)
v_add_f32 v42, 1.0, v42
v_add_f32 v43, 1.0, v43
v_mfma_f32_16x16x32_bf16 v[128:131], v[16:19], a[48:51], v[128:131]
ds_read_b64_tr_b16 v[28:29], v12 offset:12288
v_add_f32 v44, 1.0, v44
v_mfma_f32_16x16x32_bf16 v[128:131], v[20:23], a[64:67], v[128:131]
s_waitcnt lgkmcnt(1)
ds_read_b64_tr_b16 v[30:31], v12 offset:14336
v_fma_f32 v45, -v79, v79, s47
v_mfma_f32_16x16x32_bf16 v[128:131], v[24:27], a[80:83], v[128:131]
ds_read_b64_tr_b16 v[32:33], v12 offset:16384
v_mul_f32 v45, v45, v79
v_mfma_f32_16x16x32_bf16 v[132:135], v[16:19], a[52:55], v[132:135]
ds_read_b64_tr_b16 v[34:35], v12 offset:18432
v_fma_f32 v46, -v92, v92, s47
v_mfma_f32_16x16x32_bf16 v[132:135], v[20:23], a[68:71], v[132:135]
ds_read_b64_tr_b16 v[36:37], v12 offset:20480
v_mul_f32 v46, v46, v92
v_mfma_f32_16x16x32_bf16 v[132:135], v[24:27], a[84:87], v[132:135]
ds_read_b64_tr_b16 v[38:39], v12 offset:22528
v_fma_f32 v47, -v93, v93, s47
v_mfma_f32_16x16x32_bf16 v[136:139], v[16:19], a[56:59], v[136:139]
buffer_load_dwordx4 v255, s[12:15], s45 offen offset:2048 lds
v_mfma_f32_16x16x32_bf16 v[136:139], v[20:23], a[72:75], v[136:139]
v_rcp_f32 v42, v42
v_mfma_f32_16x16x32_bf16 v[136:139], v[24:27], a[88:91], v[136:139]
v_rcp_f32 v43, v43
v_mfma_f32_16x16x32_bf16 v[140:143], v[16:19], a[60:63], v[140:143]
v_rcp_f32 v44, v44
v_mfma_f32_16x16x32_bf16 v[140:143], v[20:23], a[76:79], v[140:143]
v_exp_f32 v45, v45
v_mfma_f32_16x16x32_bf16 v[140:143], v[24:27], a[92:95], v[140:143]
s_waitcnt lgkmcnt(0)
s_waitcnt vmcnt(6)
s_barrier
v_exp_f32 v46, v46
v_mfma_f32_16x16x32_bf16 v[144:147], v[28:31], a[48:51], v[144:147]
ds_read_b64_tr_b16 v[16:17], v10 offset:24576
v_mul_f32 v76, v76, v42
v_mfma_f32_16x16x32_bf16 v[144:147], v[32:35], a[64:67], v[144:147]
ds_read_b64_tr_b16 v[18:19], v10 offset:26624
v_mul_f32 v76, v76, v204
s_add_u32 m0, s97, 36864
v_mfma_f32_16x16x32_bf16 v[144:147], v[36:39], a[80:83], v[144:147]
s_add_u32 s45, s41, 256
buffer_load_dwordx4 v2, s[8:11], s45 offen offset:0 lds
v_mfma_f32_16x16x32_bf16 v[148:151], v[28:31], a[52:55], v[148:151]
ds_read_b64_tr_b16 v[20:21], v10 offset:28672
v_mul_f32 v77, v77, v43
v_mfma_f32_16x16x32_bf16 v[148:151], v[32:35], a[68:71], v[148:151]
ds_read_b64_tr_b16 v[22:23], v10 offset:30720
v_mul_f32 v77, v77, v205
v_mfma_f32_16x16x32_bf16 v[148:151], v[36:39], a[84:87], v[148:151]
ds_read_b64_tr_b16 v[24:25], v10 offset:32768
v_mul_f32 v78, v78, v44
v_mfma_f32_16x16x32_bf16 v[152:155], v[28:31], a[56:59], v[152:155]
ds_read_b64_tr_b16 v[26:27], v10 offset:34816
v_mul_f32 v78, v78, v206
v_mfma_f32_16x16x32_bf16 v[152:155], v[32:35], a[72:75], v[152:155]
v_add_f32 v45, 1.0, v45
v_cvt_pk_bf16_f32 v60, v76, v77
v_mfma_f32_16x16x32_bf16 v[152:155], v[36:39], a[88:91], v[152:155]
v_rcp_f32 v45, v45
v_mfma_f32_16x16x32_bf16 v[156:159], v[28:31], a[60:63], v[156:159]
v_mul_f32 v79, v79, v45
v_mul_f32 v79, v79, v207
v_mfma_f32_16x16x32_bf16 v[156:159], v[32:35], a[76:79], v[156:159]
buffer_load_dwordx4 v254, s[8:11], s45 offen offset:1024 lds
v_mfma_f32_16x16x32_bf16 v[156:159], v[36:39], a[92:95], v[156:159]
s_waitcnt lgkmcnt(1)
v_cvt_pk_bf16_f32 v61, v78, v79
v_add_f32 v46, 1.0, v46
v_mfma_f32_16x16x32_bf16 v[128:131], v[16:19], a[96:99], v[128:131]
ds_read_b64_tr_b16 v[28:29], v12 offset:24576
v_mul_f32 v47, v47, v93
v_mfma_f32_16x16x32_bf16 v[128:131], v[20:23], a[112:115], v[128:131]
s_waitcnt lgkmcnt(1)
ds_read_b64_tr_b16 v[30:31], v12 offset:26624
v_fma_f32 v240, -v94, v94, s47
v_mfma_f32_16x16x32_bf16 v[128:131], v[24:27], a[128:131], v[128:131]
ds_read_b64_tr_b16 v[32:33], v12 offset:28672
v_mul_f32 v240, v240, v94
v_mfma_f32_16x16x32_bf16 v[132:135], v[16:19], a[100:103], v[132:135]
ds_read_b64_tr_b16 v[34:35], v12 offset:30720
v_fma_f32 v241, -v95, v95, s47
v_mfma_f32_16x16x32_bf16 v[132:135], v[20:23], a[116:119], v[132:135]
ds_read_b64_tr_b16 v[36:37], v12 offset:32768
v_mul_f32 v241, v241, v95
v_mfma_f32_16x16x32_bf16 v[132:135], v[24:27], a[132:135], v[132:135]
ds_read_b64_tr_b16 v[38:39], v12 offset:34816
v_fma_f32 v242, -v96, v96, s47
v_mfma_f32_16x16x32_bf16 v[136:139], v[16:19], a[104:107], v[136:139]
buffer_load_dwordx4 v255, s[8:11], s45 offen offset:2048 lds
v_mfma_f32_16x16x32_bf16 v[136:139], v[20:23], a[120:123], v[136:139]
v_rcp_f32 v46, v46
v_mfma_f32_16x16x32_bf16 v[136:139], v[24:27], a[136:139], v[136:139]
v_exp_f32 v47, v47
v_mfma_f32_16x16x32_bf16 v[140:143], v[16:19], a[108:111], v[140:143]
v_exp_f32 v240, v240
v_mfma_f32_16x16x32_bf16 v[140:143], v[20:23], a[124:127], v[140:143]
v_exp_f32 v241, v241
v_mfma_f32_16x16x32_bf16 v[140:143], v[24:27], a[140:143], v[140:143]
s_waitcnt lgkmcnt(0)
v_mul_f32 v92, v92, v46
v_mul_f32 v92, v92, v220
v_mfma_f32_16x16x32_bf16 v[144:147], v[28:31], a[96:99], v[144:147]
ds_read_b64_tr_b16 v[16:17], v11 offset:0
v_add_f32 v47, 1.0, v47
v_mfma_f32_16x16x32_bf16 v[144:147], v[32:35], a[112:115], v[144:147]
ds_read_b64_tr_b16 v[18:19], v11 offset:2048
v_add_f32 v240, 1.0, v240
s_add_u32 m0, s97, 49152
v_mfma_f32_16x16x32_bf16 v[144:147], v[36:39], a[128:131], v[144:147]
s_add_u32 s45, s41, 884992
buffer_load_dwordx4 v2, s[8:11], s45 offen offset:0 lds
v_mfma_f32_16x16x32_bf16 v[148:151], v[28:31], a[100:103], v[148:151]
ds_read_b64_tr_b16 v[20:21], v11 offset:4096
v_add_f32 v241, 1.0, v241
v_mfma_f32_16x16x32_bf16 v[148:151], v[32:35], a[116:119], v[148:151]
ds_read_b64_tr_b16 v[22:23], v11 offset:6144
v_mul_f32 v242, v242, v96
v_mfma_f32_16x16x32_bf16 v[148:151], v[36:39], a[132:135], v[148:151]
ds_read_b64_tr_b16 v[24:25], v11 offset:8192
v_fma_f32 v243, -v97, v97, s47
v_mfma_f32_16x16x32_bf16 v[152:155], v[28:31], a[104:107], v[152:155]
ds_read_b64_tr_b16 v[26:27], v11 offset:10240
v_mul_f32 v243, v243, v97
v_mfma_f32_16x16x32_bf16 v[152:155], v[32:35], a[120:123], v[152:155]
v_rcp_f32 v47, v47
v_mfma_f32_16x16x32_bf16 v[152:155], v[36:39], a[136:139], v[152:155]
v_rcp_f32 v240, v240
v_mfma_f32_16x16x32_bf16 v[156:159], v[28:31], a[108:111], v[156:159]
v_rcp_f32 v241, v241
v_mfma_f32_16x16x32_bf16 v[156:159], v[32:35], a[124:127], v[156:159]
buffer_load_dwordx4 v254, s[8:11], s45 offen offset:1024 lds
v_mfma_f32_16x16x32_bf16 v[156:159], v[36:39], a[140:143], v[156:159]
s_waitcnt lgkmcnt(1)
v_exp_f32 v242, v242
v_mfma_f32_16x16x32_bf16 v[128:131], v[16:19], a[144:147], v[128:131]
ds_read_b64_tr_b16 v[28:29], v13 offset:0
v_mul_f32 v93, v93, v47
v_mfma_f32_16x16x32_bf16 v[128:131], v[20:23], a[160:163], v[128:131]
s_waitcnt lgkmcnt(1)
ds_read_b64_tr_b16 v[30:31], v13 offset:2048
v_mul_f32 v93, v93, v221
v_mfma_f32_16x16x32_bf16 v[128:131], v[24:27], a[176:179], v[128:131]
ds_read_b64_tr_b16 v[32:33], v13 offset:4096
v_mul_f32 v94, v94, v240
v_mfma_f32_16x16x32_bf16 v[132:135], v[16:19], a[148:151], v[132:135]
ds_read_b64_tr_b16 v[34:35], v13 offset:6144
v_mul_f32 v94, v94, v222
v_mfma_f32_16x16x32_bf16 v[132:135], v[20:23], a[164:167], v[132:135]
ds_read_b64_tr_b16 v[36:37], v13 offset:8192
v_mul_f32 v95, v95, v241
v_mfma_f32_16x16x32_bf16 v[132:135], v[24:27], a[180:183], v[132:135]
ds_read_b64_tr_b16 v[38:39], v13 offset:10240
v_mul_f32 v95, v95, v223
v_mfma_f32_16x16x32_bf16 v[136:139], v[16:19], a[152:155], v[136:139]
buffer_load_dwordx4 v255, s[8:11], s45 offen offset:2048 lds
v_mfma_f32_16x16x32_bf16 v[136:139], v[20:23], a[168:171], v[136:139]
v_exp_f32 v243, v243
v_mfma_f32_16x16x32_bf16 v[136:139], v[24:27], a[184:187], v[136:139]
v_cvt_pk_bf16_f32 v62, v92, v93
v_cvt_pk_bf16_f32 v63, v94, v95
v_mfma_f32_16x16x32_bf16 v[140:143], v[16:19], a[156:159], v[140:143]
ds_write_b128 v6, v[60:63] offset:3072
v_add_f32 v242, 1.0, v242
v_mfma_f32_16x16x32_bf16 v[140:143], v[20:23], a[172:175], v[140:143]
v_rcp_f32 v242, v242
v_mfma_f32_16x16x32_bf16 v[140:143], v[24:27], a[188:191], v[140:143]
s_waitcnt lgkmcnt(0)
s_waitcnt vmcnt(6)
s_barrier
v_mul_f32 v96, v96, v242
v_add_f32 v243, 1.0, v243
v_mfma_f32_16x16x32_bf16 v[144:147], v[28:31], a[144:147], v[144:147]
ds_read_b64_tr_b16 v[16:17], v11 offset:12288
v_fma_f32 v244, -v98, v98, s47
v_mfma_f32_16x16x32_bf16 v[144:147], v[32:35], a[160:163], v[144:147]
ds_read_b64_tr_b16 v[18:19], v11 offset:14336
v_mul_f32 v244, v244, v98
s_add_u32 m0, s97, 61440
v_mfma_f32_16x16x32_bf16 v[144:147], v[36:39], a[176:179], v[144:147]
s_add_u32 s45, s41, 1769728
buffer_load_dwordx4 v2, s[8:11], s45 offen offset:0 lds
v_mfma_f32_16x16x32_bf16 v[148:151], v[28:31], a[148:151], v[148:151]
ds_read_b64_tr_b16 v[20:21], v11 offset:16384
v_fma_f32 v245, -v99, v99, s47
v_mfma_f32_16x16x32_bf16 v[148:151], v[32:35], a[164:167], v[148:151]
ds_read_b64_tr_b16 v[22:23], v11 offset:18432
v_mul_f32 v245, v245, v99
v_mfma_f32_16x16x32_bf16 v[148:151], v[36:39], a[180:183], v[148:151]
ds_read_b64_tr_b16 v[24:25], v11 offset:20480
v_fma_f32 v246, -v112, v112, s47
v_mfma_f32_16x16x32_bf16 v[152:155], v[28:31], a[152:155], v[152:155]
ds_read_b64_tr_b16 v[26:27], v11 offset:22528
v_mul_f32 v246, v246, v112
v_mfma_f32_16x16x32_bf16 v[152:155], v[32:35], a[168:171], v[152:155]
v_rcp_f32 v243, v243
v_mfma_f32_16x16x32_bf16 v[152:155], v[36:39], a[184:187], v[152:155]
v_exp_f32 v244, v244
v_mfma_f32_16x16x32_bf16 v[156:159], v[28:31], a[156:159], v[156:159]
v_exp_f32 v245, v245
v_mfma_f32_16x16x32_bf16 v[156:159], v[32:35], a[172:175], v[156:159]
buffer_load_dwordx4 v254, s[8:11], s45 offen offset:1024 lds
v_mfma_f32_16x16x32_bf16 v[156:159], v[36:39], a[188:191], v[156:159]
s_waitcnt lgkmcnt(1)
v_exp_f32 v246, v246
v_mfma_f32_16x16x32_bf16 v[128:131], v[16:19], a[192:195], v[128:131]
ds_read_b64_tr_b16 v[28:29], v13 offset:12288
v_mul_f32 v97, v97, v243
v_mfma_f32_16x16x32_bf16 v[128:131], v[20:23], a[208:211], v[128:131]
s_waitcnt lgkmcnt(1)
ds_read_b64_tr_b16 v[30:31], v13 offset:14336
v_add_f32 v244, 1.0, v244
v_mfma_f32_16x16x32_bf16 v[128:131], v[24:27], a[224:227], v[128:131]
ds_read_b64_tr_b16 v[32:33], v13 offset:16384
v_add_f32 v245, 1.0, v245
v_mfma_f32_16x16x32_bf16 v[132:135], v[16:19], a[196:199], v[132:135]
ds_read_b64_tr_b16 v[34:35], v13 offset:18432
v_add_f32 v246, 1.0, v246
v_mfma_f32_16x16x32_bf16 v[132:135], v[20:23], a[212:215], v[132:135]
ds_read_b64_tr_b16 v[36:37], v13 offset:20480
v_fma_f32 v247, -v113, v113, s47
v_mfma_f32_16x16x32_bf16 v[132:135], v[24:27], a[228:231], v[132:135]
ds_read_b64_tr_b16 v[38:39], v13 offset:22528
v_mul_f32 v247, v247, v113
v_mfma_f32_16x16x32_bf16 v[136:139], v[16:19], a[200:203], v[136:139]
buffer_load_dwordx4 v255, s[8:11], s45 offen offset:2048 lds
v_mfma_f32_16x16x32_bf16 v[136:139], v[20:23], a[216:219], v[136:139]
v_rcp_f32 v244, v244
v_mfma_f32_16x16x32_bf16 v[136:139], v[24:27], a[232:235], v[136:139]
v_rcp_f32 v245, v245
v_mfma_f32_16x16x32_bf16 v[140:143], v[16:19], a[204:207], v[140:143]
v_rcp_f32 v246, v246
v_mfma_f32_16x16x32_bf16 v[140:143], v[20:23], a[220:223], v[140:143]
v_exp_f32 v247, v247
v_mfma_f32_16x16x32_bf16 v[140:143], v[24:27], a[236:239], v[140:143]
s_waitcnt lgkmcnt(0)
v_mul_f32 v98, v98, v244
v_mul_f32 v99, v99, v245
v_mfma_f32_16x16x32_bf16 v[144:147], v[28:31], a[192:195], v[144:147]
ds_read_b64_tr_b16 v[16:17], v11 offset:24576
v_mul_f32 v112, v112, v246
v_mfma_f32_16x16x32_bf16 v[144:147], v[32:35], a[208:211], v[144:147]
ds_read_b64_tr_b16 v[18:19], v11 offset:26624
v_add_f32 v247, 1.0, v247
s_add_u32 m0, s97, 73728
v_mfma_f32_16x16x32_bf16 v[144:147], v[36:39], a[224:227], v[144:147]
s_add_u32 s45, s41, 2654464
buffer_load_dwordx4 v2, s[8:11], s45 offen offset:0 lds
v_mfma_f32_16x16x32_bf16 v[148:151], v[28:31], a[196:199], v[148:151]
ds_read_b64_tr_b16 v[20:21], v11 offset:28672
v_fma_f32 v248, -v114, v114, s47
v_mfma_f32_16x16x32_bf16 v[148:151], v[32:35], a[212:215], v[148:151]
ds_read_b64_tr_b16 v[22:23], v11 offset:30720
v_mul_f32 v248, v248, v114
v_mfma_f32_16x16x32_bf16 v[148:151], v[36:39], a[228:231], v[148:151]
ds_read_b64_tr_b16 v[24:25], v11 offset:32768
v_fma_f32 v249, -v115, v115, s47
v_mfma_f32_16x16x32_bf16 v[152:155], v[28:31], a[200:203], v[152:155]
ds_read_b64_tr_b16 v[26:27], v11 offset:34816
v_mul_f32 v249, v249, v115
v_mfma_f32_16x16x32_bf16 v[152:155], v[32:35], a[216:219], v[152:155]
v_rcp_f32 v247, v247
v_mfma_f32_16x16x32_bf16 v[152:155], v[36:39], a[232:235], v[152:155]
v_exp_f32 v248, v248
v_mfma_f32_16x16x32_bf16 v[156:159], v[28:31], a[204:207], v[156:159]
v_exp_f32 v249, v249
v_mfma_f32_16x16x32_bf16 v[156:159], v[32:35], a[220:223], v[156:159]
buffer_load_dwordx4 v254, s[8:11], s45 offen offset:1024 lds
v_mfma_f32_16x16x32_bf16 v[156:159], v[36:39], a[236:239], v[156:159]
s_waitcnt lgkmcnt(1)
v_mul_f32 v113, v113, v247
v_add_f32 v248, 1.0, v248
v_mfma_f32_16x16x32_bf16 v[128:131], v[16:19], a[240:243], v[128:131]
ds_read_b64_tr_b16 v[28:29], v13 offset:24576
v_add_f32 v249, 1.0, v249
v_mfma_f32_16x16x32_bf16 v[128:131], v[20:23], v[160:163], v[128:131]
s_waitcnt lgkmcnt(1)
ds_read_b64_tr_b16 v[30:31], v13 offset:26624
v_fma_f32 v250, -v100, v100, s47
v_mfma_f32_16x16x32_bf16 v[128:131], v[24:27], v[176:179], v[128:131]
ds_read_b64_tr_b16 v[32:33], v13 offset:28672
v_mul_f32 v250, v250, v100
v_mfma_f32_16x16x32_bf16 v[132:135], v[16:19], a[244:247], v[132:135]
ds_read_b64_tr_b16 v[34:35], v13 offset:30720
v_fma_f32 v251, -v101, v101, s47
v_mfma_f32_16x16x32_bf16 v[132:135], v[20:23], v[164:167], v[132:135]
ds_read_b64_tr_b16 v[36:37], v13 offset:32768
v_mul_f32 v251, v251, v101
v_mfma_f32_16x16x32_bf16 v[132:135], v[24:27], v[180:183], v[132:135]
ds_read_b64_tr_b16 v[38:39], v13 offset:34816
v_fma_f32 v252, -v102, v102, s47
v_mfma_f32_16x16x32_bf16 v[136:139], v[16:19], a[248:251], v[136:139]
buffer_load_dwordx4 v255, s[8:11], s45 offen offset:2048 lds
v_mfma_f32_16x16x32_bf16 v[136:139], v[20:23], v[168:171], v[136:139]
v_rcp_f32 v248, v248
v_mfma_f32_16x16x32_bf16 v[136:139], v[24:27], v[184:187], v[136:139]
v_rcp_f32 v249, v249
v_mfma_f32_16x16x32_bf16 v[140:143], v[16:19], a[252:255], v[140:143]
v_exp_f32 v250, v250
v_mfma_f32_16x16x32_bf16 v[140:143], v[20:23], v[172:175], v[140:143]
v_exp_f32 v251, v251
v_mfma_f32_16x16x32_bf16 v[140:143], v[24:27], v[188:191], v[140:143]
s_waitcnt lgkmcnt(0)
s_waitcnt vmcnt(6)
s_barrier
v_mul_f32 v114, v114, v248
v_mul_f32 v115, v115, v249
v_mfma_f32_16x16x32_bf16 v[144:147], v[28:31], a[240:243], v[144:147]
ds_read_b64_tr_b16 v[16:17], v10 offset:0
v_add_f32 v250, 1.0, v250
v_mfma_f32_16x16x32_bf16 v[144:147], v[32:35], v[160:163], v[144:147]
ds_read_b64_tr_b16 v[18:19], v10 offset:2048
v_add_f32 v251, 1.0, v251
s_add_u32 m0, s97, 86016
v_mfma_f32_16x16x32_bf16 v[144:147], v[36:39], v[176:179], v[144:147]
s_add_u32 s45, s41, 3539200
buffer_load_dwordx4 v2, s[8:11], s45 offen offset:0 lds
v_mfma_f32_16x16x32_bf16 v[148:151], v[28:31], a[244:247], v[148:151]
ds_read_b64_tr_b16 v[20:21], v10 offset:4096
v_mul_f32 v252, v252, v102
v_mfma_f32_16x16x32_bf16 v[148:151], v[32:35], v[164:167], v[148:151]
ds_read_b64_tr_b16 v[22:23], v10 offset:6144
v_fma_f32 v253, -v103, v103, s47
v_mfma_f32_16x16x32_bf16 v[148:151], v[36:39], v[180:183], v[148:151]
ds_read_b64_tr_b16 v[24:25], v10 offset:8192
v_mul_f32 v253, v253, v103
v_mfma_f32_16x16x32_bf16 v[152:155], v[28:31], a[248:251], v[152:155]
ds_read_b64_tr_b16 v[26:27], v10 offset:10240
v_fma_f32 v40, -v116, v116, s47
v_mfma_f32_16x16x32_bf16 v[152:155], v[32:35], v[168:171], v[152:155]
v_rcp_f32 v250, v250
v_mfma_f32_16x16x32_bf16 v[152:155], v[36:39], v[184:187], v[152:155]
v_rcp_f32 v251, v251
v_mfma_f32_16x16x32_bf16 v[156:159], v[28:31], a[252:255], v[156:159]
v_exp_f32 v252, v252
v_mfma_f32_16x16x32_bf16 v[156:159], v[32:35], v[172:175], v[156:159]
buffer_load_dwordx4 v254, s[8:11], s45 offen offset:1024 lds
v_mfma_f32_16x16x32_bf16 v[156:159], v[36:39], v[188:191], v[156:159]
s_waitcnt lgkmcnt(1)
v_exp_f32 v253, v253
v_mfma_f32_16x16x32_bf16 v[64:67], v[16:19], a[0:3], 0
ds_read_b64_tr_b16 v[28:29], v12 offset:0
v_mul_f32 v100, v100, v250
v_mfma_f32_16x16x32_bf16 v[64:67], v[20:23], a[16:19], v[64:67]
s_waitcnt lgkmcnt(1)
ds_read_b64_tr_b16 v[30:31], v12 offset:2048
v_mul_f32 v101, v101, v251
v_mfma_f32_16x16x32_bf16 v[64:67], v[24:27], a[32:35], v[64:67]
ds_read_b64_tr_b16 v[32:33], v12 offset:4096
v_add_f32 v252, 1.0, v252
v_mfma_f32_16x16x32_bf16 v[68:71], v[16:19], a[4:7], 0
ds_read_b64_tr_b16 v[34:35], v12 offset:6144
v_mul_f32 v96, v96, v128
v_mfma_f32_16x16x32_bf16 v[68:71], v[20:23], a[20:23], v[68:71]
ds_read_b64_tr_b16 v[36:37], v12 offset:8192
v_mul_f32 v97, v97, v129
v_mfma_f32_16x16x32_bf16 v[68:71], v[24:27], a[36:39], v[68:71]
ds_read_b64_tr_b16 v[38:39], v12 offset:10240
v_mul_f32 v98, v98, v130
v_mfma_f32_16x16x32_bf16 v[72:75], v[16:19], a[8:11], 0
buffer_load_dwordx4 v255, s[8:11], s45 offen offset:2048 lds
v_mfma_f32_16x16x32_bf16 v[72:75], v[20:23], a[24:27], v[72:75]
v_rcp_f32 v252, v252
v_mfma_f32_16x16x32_bf16 v[72:75], v[24:27], a[40:43], v[72:75]
v_mul_f32 v99, v99, v131
v_cvt_pk_bf16_f32 v48, v96, v97
v_mfma_f32_16x16x32_bf16 v[76:79], v[16:19], a[12:15], 0
v_cvt_pk_bf16_f32 v49, v98, v99
v_mul_f32 v112, v112, v144
v_mfma_f32_16x16x32_bf16 v[76:79], v[20:23], a[28:31], v[76:79]
v_mul_f32 v113, v113, v145
v_mul_f32 v114, v114, v146
v_mfma_f32_16x16x32_bf16 v[76:79], v[24:27], a[44:47], v[76:79]
s_waitcnt lgkmcnt(0)
v_mul_f32 v115, v115, v147
v_cvt_pk_bf16_f32 v50, v112, v113
v_mfma_f32_16x16x32_bf16 v[80:83], v[28:31], a[0:3], 0
ds_read_b64_tr_b16 v[16:17], v10 offset:12288
v_cvt_pk_bf16_f32 v51, v114, v115
v_mfma_f32_16x16x32_bf16 v[80:83], v[32:35], a[16:19], v[80:83]
ds_read_b64_tr_b16 v[18:19], v10 offset:14336
ds_write_b128 v6, v[48:51] offset:8192
s_add_u32 m0, s97, 98304
v_mfma_f32_16x16x32_bf16 v[80:83], v[36:39], a[32:35], v[80:83]
s_add_u32 s45, s41, 4423936
buffer_load_dwordx4 v2, s[8:11], s45 offen offset:0 lds
v_mfma_f32_16x16x32_bf16 v[84:87], v[28:31], a[4:7], 0
ds_read_b64_tr_b16 v[20:21], v10 offset:16384
v_mul_f32 v100, v100, v132
v_mfma_f32_16x16x32_bf16 v[84:87], v[32:35], a[20:23], v[84:87]
ds_read_b64_tr_b16 v[22:23], v10 offset:18432
v_mul_f32 v101, v101, v133
v_mfma_f32_16x16x32_bf16 v[84:87], v[36:39], a[36:39], v[84:87]
ds_read_b64_tr_b16 v[24:25], v10 offset:20480
v_mul_f32 v102, v102, v252
v_mfma_f32_16x16x32_bf16 v[88:91], v[28:31], a[8:11], 0
ds_read_b64_tr_b16 v[26:27], v10 offset:22528
v_mul_f32 v102, v102, v134
v_mfma_f32_16x16x32_bf16 v[88:91], v[32:35], a[24:27], v[88:91]
v_add_f32 v253, 1.0, v253
v_cvt_pk_bf16_f32 v52, v100, v101
v_mfma_f32_16x16x32_bf16 v[88:91], v[36:39], a[40:43], v[88:91]
v_rcp_f32 v253, v253
v_mfma_f32_16x16x32_bf16 v[92:95], v[28:31], a[12:15], 0
v_mul_f32 v103, v103, v253
v_mul_f32 v103, v103, v135
v_mfma_f32_16x16x32_bf16 v[92:95], v[32:35], a[28:31], v[92:95]
buffer_load_dwordx4 v254, s[8:11], s45 offen offset:1024 lds
v_mfma_f32_16x16x32_bf16 v[92:95], v[36:39], a[44:47], v[92:95]
s_waitcnt lgkmcnt(1)
v_cvt_pk_bf16_f32 v53, v102, v103
v_mul_f32 v40, v40, v116
v_mfma_f32_16x16x32_bf16 v[64:67], v[16:19], a[48:51], v[64:67]
ds_read_b64_tr_b16 v[28:29], v12 offset:12288
v_fma_f32 v41, -v117, v117, s47
v_mfma_f32_16x16x32_bf16 v[64:67], v[20:23], a[64:67], v[64:67]
s_waitcnt lgkmcnt(1)
ds_read_b64_tr_b16 v[30:31], v12 offset:14336
v_mul_f32 v41, v41, v117
v_mfma_f32_16x16x32_bf16 v[64:67], v[24:27], a[80:83], v[64:67]
ds_read_b64_tr_b16 v[32:33], v12 offset:16384
v_fma_f32 v42, -v118, v118, s47
v_mfma_f32_16x16x32_bf16 v[68:71], v[16:19], a[52:55], v[68:71]
ds_read_b64_tr_b16 v[34:35], v12 offset:18432
v_mul_f32 v42, v42, v118
v_mfma_f32_16x16x32_bf16 v[68:71], v[20:23], a[68:71], v[68:71]
ds_read_b64_tr_b16 v[36:37], v12 offset:20480
v_fma_f32 v43, -v119, v119, s47
v_mfma_f32_16x16x32_bf16 v[68:71], v[24:27], a[84:87], v[68:71]
ds_read_b64_tr_b16 v[38:39], v12 offset:22528
v_mul_f32 v43, v43, v119
v_mfma_f32_16x16x32_bf16 v[72:75], v[16:19], a[56:59], v[72:75]
buffer_load_dwordx4 v255, s[8:11], s45 offen offset:2048 lds
v_mfma_f32_16x16x32_bf16 v[72:75], v[20:23], a[72:75], v[72:75]
v_exp_f32 v40, v40
v_mfma_f32_16x16x32_bf16 v[72:75], v[24:27], a[88:91], v[72:75]
v_exp_f32 v41, v41
v_mfma_f32_16x16x32_bf16 v[76:79], v[16:19], a[60:63], v[76:79]
v_exp_f32 v42, v42
v_mfma_f32_16x16x32_bf16 v[76:79], v[20:23], a[76:79], v[76:79]
v_exp_f32 v43, v43
v_mfma_f32_16x16x32_bf16 v[76:79], v[24:27], a[92:95], v[76:79]
s_waitcnt lgkmcnt(0)
s_waitcnt vmcnt(6)
s_barrier
v_add_f32 v40, 1.0, v40
v_add_f32 v41, 1.0, v41
v_mfma_f32_16x16x32_bf16 v[80:83], v[28:31], a[48:51], v[80:83]
ds_read_b64_tr_b16 v[16:17], v10 offset:24576
v_add_f32 v42, 1.0, v42
v_mfma_f32_16x16x32_bf16 v[80:83], v[32:35], a[64:67], v[80:83]
ds_read_b64_tr_b16 v[18:19], v10 offset:26624
v_add_f32 v43, 1.0, v43
s_add_u32 m0, s97, 36864
v_mfma_f32_16x16x32_bf16 v[80:83], v[36:39], a[80:83], v[80:83]
s_add_u32 s45, s41, 256
buffer_load_dwordx4 v2, s[12:15], s45 offen offset:0 lds
v_mfma_f32_16x16x32_bf16 v[84:87], v[28:31], a[52:55], v[84:87]
ds_read_b64_tr_b16 v[20:21], v10 offset:28672
v_fma_f32 v44, -v104, v104, s47
v_mfma_f32_16x16x32_bf16 v[84:87], v[32:35], a[68:71], v[84:87]
ds_read_b64_tr_b16 v[22:23], v10 offset:30720
v_mul_f32 v44, v44, v104
v_mfma_f32_16x16x32_bf16 v[84:87], v[36:39], a[84:87], v[84:87]
ds_read_b64_tr_b16 v[24:25], v10 offset:32768
v_fma_f32 v45, -v105, v105, s47
v_mfma_f32_16x16x32_bf16 v[88:91], v[28:31], a[56:59], v[88:91]
ds_read_b64_tr_b16 v[26:27], v10 offset:34816
v_mul_f32 v45, v45, v105
v_mfma_f32_16x16x32_bf16 v[88:91], v[32:35], a[72:75], v[88:91]
v_rcp_f32 v40, v40
v_mfma_f32_16x16x32_bf16 v[88:91], v[36:39], a[88:91], v[88:91]
v_rcp_f32 v41, v41
v_mfma_f32_16x16x32_bf16 v[92:95], v[28:31], a[60:63], v[92:95]
v_rcp_f32 v42, v42
v_mfma_f32_16x16x32_bf16 v[92:95], v[32:35], a[76:79], v[92:95]
buffer_load_dwordx4 v254, s[12:15], s45 offen offset:1024 lds
v_mfma_f32_16x16x32_bf16 v[92:95], v[36:39], a[92:95], v[92:95]
s_waitcnt lgkmcnt(1)
v_rcp_f32 v43, v43
v_mfma_f32_16x16x32_bf16 v[64:67], v[16:19], a[96:99], v[64:67]
ds_read_b64_tr_b16 v[28:29], v12 offset:24576
v_mul_f32 v116, v116, v40
v_mfma_f32_16x16x32_bf16 v[64:67], v[20:23], a[112:115], v[64:67]
s_waitcnt lgkmcnt(1)
ds_read_b64_tr_b16 v[30:31], v12 offset:26624
v_mul_f32 v116, v116, v148
v_mfma_f32_16x16x32_bf16 v[64:67], v[24:27], a[128:131], v[64:67]
ds_read_b64_tr_b16 v[32:33], v12 offset:28672
v_mul_f32 v117, v117, v41
v_mfma_f32_16x16x32_bf16 v[68:71], v[16:19], a[100:103], v[68:71]
ds_read_b64_tr_b16 v[34:35], v12 offset:30720
v_mul_f32 v117, v117, v149
v_mfma_f32_16x16x32_bf16 v[68:71], v[20:23], a[116:119], v[68:71]
ds_read_b64_tr_b16 v[36:37], v12 offset:32768
v_mul_f32 v118, v118, v42
v_mfma_f32_16x16x32_bf16 v[68:71], v[24:27], a[132:135], v[68:71]
ds_read_b64_tr_b16 v[38:39], v12 offset:34816
v_mul_f32 v118, v118, v150
v_mfma_f32_16x16x32_bf16 v[72:75], v[16:19], a[104:107], v[72:75]
buffer_load_dwordx4 v255, s[12:15], s45 offen offset:2048 lds
v_mfma_f32_16x16x32_bf16 v[72:75], v[20:23], a[120:123], v[72:75]
v_exp_f32 v44, v44
v_mfma_f32_16x16x32_bf16 v[72:75], v[24:27], a[136:139], v[72:75]
v_exp_f32 v45, v45
v_mfma_f32_16x16x32_bf16 v[76:79], v[16:19], a[108:111], v[76:79]
v_mul_f32 v119, v119, v43
v_mul_f32 v119, v119, v151
v_mfma_f32_16x16x32_bf16 v[76:79], v[20:23], a[124:127], v[76:79]
v_cvt_pk_bf16_f32 v54, v116, v117
v_cvt_pk_bf16_f32 v55, v118, v119
v_mfma_f32_16x16x32_bf16 v[76:79], v[24:27], a[140:143], v[76:79]
s_waitcnt lgkmcnt(0)
ds_write_b128 v6, v[52:55] offset:9216
v_add_f32 v44, 1.0, v44
v_mfma_f32_16x16x32_bf16 v[80:83], v[28:31], a[96:99], v[80:83]
ds_read_b64_tr_b16 v[16:17], v11 offset:0
v_add_f32 v45, 1.0, v45
v_mfma_f32_16x16x32_bf16 v[80:83], v[32:35], a[112:115], v[80:83]
ds_read_b64_tr_b16 v[18:19], v11 offset:2048
v_fma_f32 v46, -v106, v106, s47
s_add_u32 m0, s97, 49152
v_mfma_f32_16x16x32_bf16 v[80:83], v[36:39], a[128:131], v[80:83]
s_add_u32 s45, s41, 884992
buffer_load_dwordx4 v2, s[12:15], s45 offen offset:0 lds
v_mfma_f32_16x16x32_bf16 v[84:87], v[28:31], a[100:103], v[84:87]
ds_read_b64_tr_b16 v[20:21], v11 offset:4096
v_mul_f32 v46, v46, v106
v_mfma_f32_16x16x32_bf16 v[84:87], v[32:35], a[116:119], v[84:87]
ds_read_b64_tr_b16 v[22:23], v11 offset:6144
v_fma_f32 v47, -v107, v107, s47
v_mfma_f32_16x16x32_bf16 v[84:87], v[36:39], a[132:135], v[84:87]
ds_read_b64_tr_b16 v[24:25], v11 offset:8192
v_mul_f32 v47, v47, v107
v_mfma_f32_16x16x32_bf16 v[88:91], v[28:31], a[104:107], v[88:91]
ds_read_b64_tr_b16 v[26:27], v11 offset:10240
v_fma_f32 v240, -v120, v120, s47
v_mfma_f32_16x16x32_bf16 v[88:91], v[32:35], a[120:123], v[88:91]
v_rcp_f32 v44, v44
v_mfma_f32_16x16x32_bf16 v[88:91], v[36:39], a[136:139], v[88:91]
v_rcp_f32 v45, v45
v_mfma_f32_16x16x32_bf16 v[92:95], v[28:31], a[108:111], v[92:95]
v_exp_f32 v46, v46
v_mfma_f32_16x16x32_bf16 v[92:95], v[32:35], a[124:127], v[92:95]
buffer_load_dwordx4 v254, s[12:15], s45 offen offset:1024 lds
v_mfma_f32_16x16x32_bf16 v[92:95], v[36:39], a[140:143], v[92:95]
s_waitcnt lgkmcnt(1)
v_exp_f32 v47, v47
v_mfma_f32_16x16x32_bf16 v[64:67], v[16:19], a[144:147], v[64:67]
ds_read_b64_tr_b16 v[28:29], v13 offset:0
v_mul_f32 v104, v104, v44
v_mfma_f32_16x16x32_bf16 v[64:67], v[20:23], a[160:163], v[64:67]
s_waitcnt lgkmcnt(1)
ds_read_b64_tr_b16 v[30:31], v13 offset:2048
v_mul_f32 v104, v104, v136
v_mfma_f32_16x16x32_bf16 v[64:67], v[24:27], a[176:179], v[64:67]
ds_read_b64_tr_b16 v[32:33], v13 offset:4096
v_mul_f32 v105, v105, v45
v_mfma_f32_16x16x32_bf16 v[68:71], v[16:19], a[148:151], v[68:71]
ds_read_b64_tr_b16 v[34:35], v13 offset:6144
v_mul_f32 v105, v105, v137
v_mfma_f32_16x16x32_bf16 v[68:71], v[20:23], a[164:167], v[68:71]
ds_read_b64_tr_b16 v[36:37], v13 offset:8192
v_add_f32 v46, 1.0, v46
v_mfma_f32_16x16x32_bf16 v[68:71], v[24:27], a[180:183], v[68:71]
ds_read_b64_tr_b16 v[38:39], v13 offset:10240
v_add_f32 v47, 1.0, v47
v_mfma_f32_16x16x32_bf16 v[72:75], v[16:19], a[152:155], v[72:75]
buffer_load_dwordx4 v255, s[12:15], s45 offen offset:2048 lds
v_mfma_f32_16x16x32_bf16 v[72:75], v[20:23], a[168:171], v[72:75]
v_rcp_f32 v46, v46
v_mfma_f32_16x16x32_bf16 v[72:75], v[24:27], a[184:187], v[72:75]
v_rcp_f32 v47, v47
v_mfma_f32_16x16x32_bf16 v[76:79], v[16:19], a[156:159], v[76:79]
v_mul_f32 v106, v106, v46
v_mul_f32 v106, v106, v138
v_mfma_f32_16x16x32_bf16 v[76:79], v[20:23], a[172:175], v[76:79]
v_mul_f32 v107, v107, v47
v_mul_f32 v107, v107, v139
v_mfma_f32_16x16x32_bf16 v[76:79], v[24:27], a[188:191], v[76:79]
s_waitcnt lgkmcnt(0)
s_waitcnt vmcnt(6)
s_barrier
v_cvt_pk_bf16_f32 v56, v104, v105
v_cvt_pk_bf16_f32 v57, v106, v107
v_mfma_f32_16x16x32_bf16 v[80:83], v[28:31], a[144:147], v[80:83]
ds_read_b64_tr_b16 v[16:17], v11 offset:12288
v_mul_f32 v240, v240, v120
v_mfma_f32_16x16x32_bf16 v[80:83], v[32:35], a[160:163], v[80:83]
ds_read_b64_tr_b16 v[18:19], v11 offset:14336
v_fma_f32 v241, -v121, v121, s47
s_add_u32 m0, s97, 61440
v_mfma_f32_16x16x32_bf16 v[80:83], v[36:39], a[176:179], v[80:83]
s_add_u32 s45, s41, 1769728
buffer_load_dwordx4 v2, s[12:15], s45 offen offset:0 lds
v_mfma_f32_16x16x32_bf16 v[84:87], v[28:31], a[148:151], v[84:87]
ds_read_b64_tr_b16 v[20:21], v11 offset:16384
v_mul_f32 v241, v241, v121
v_mfma_f32_16x16x32_bf16 v[84:87], v[32:35], a[164:167], v[84:87]
ds_read_b64_tr_b16 v[22:23], v11 offset:18432
v_fma_f32 v242, -v122, v122, s47
v_mfma_f32_16x16x32_bf16 v[84:87], v[36:39], a[180:183], v[84:87]
ds_read_b64_tr_b16 v[24:25], v11 offset:20480
v_mul_f32 v242, v242, v122
v_mfma_f32_16x16x32_bf16 v[88:91], v[28:31], a[152:155], v[88:91]
ds_read_b64_tr_b16 v[26:27], v11 offset:22528
v_fma_f32 v243, -v123, v123, s47
v_mfma_f32_16x16x32_bf16 v[88:91], v[32:35], a[168:171], v[88:91]
v_exp_f32 v240, v240
v_mfma_f32_16x16x32_bf16 v[88:91], v[36:39], a[184:187], v[88:91]
v_exp_f32 v241, v241
v_mfma_f32_16x16x32_bf16 v[92:95], v[28:31], a[156:159], v[92:95]
v_exp_f32 v242, v242
v_mfma_f32_16x16x32_bf16 v[92:95], v[32:35], a[172:175], v[92:95]
buffer_load_dwordx4 v254, s[12:15], s45 offen offset:1024 lds
v_mfma_f32_16x16x32_bf16 v[92:95], v[36:39], a[188:191], v[92:95]
s_waitcnt lgkmcnt(1)
v_add_f32 v240, 1.0, v240
v_add_f32 v241, 1.0, v241
v_mfma_f32_16x16x32_bf16 v[64:67], v[16:19], a[192:195], v[64:67]
ds_read_b64_tr_b16 v[28:29], v13 offset:12288
v_add_f32 v242, 1.0, v242
v_mfma_f32_16x16x32_bf16 v[64:67], v[20:23], a[208:211], v[64:67]
s_waitcnt lgkmcnt(1)
ds_read_b64_tr_b16 v[30:31], v13 offset:14336
v_mul_f32 v243, v243, v123
v_mfma_f32_16x16x32_bf16 v[64:67], v[24:27], a[224:227], v[64:67]
ds_read_b64_tr_b16 v[32:33], v13 offset:16384
v_fma_f32 v244, -v108, v108, s47
v_mfma_f32_16x16x32_bf16 v[68:71], v[16:19], a[196:199], v[68:71]
ds_read_b64_tr_b16 v[34:35], v13 offset:18432
v_mul_f32 v244, v244, v108
v_mfma_f32_16x16x32_bf16 v[68:71], v[20:23], a[212:215], v[68:71]
ds_read_b64_tr_b16 v[36:37], v13 offset:20480
v_fma_f32 v245, -v109, v109, s47
v_mfma_f32_16x16x32_bf16 v[68:71], v[24:27], a[228:231], v[68:71]
ds_read_b64_tr_b16 v[38:39], v13 offset:22528
v_mul_f32 v245, v245, v109
v_mfma_f32_16x16x32_bf16 v[72:75], v[16:19], a[200:203], v[72:75]
buffer_load_dwordx4 v255, s[12:15], s45 offen offset:2048 lds
v_mfma_f32_16x16x32_bf16 v[72:75], v[20:23], a[216:219], v[72:75]
v_rcp_f32 v240, v240
v_mfma_f32_16x16x32_bf16 v[72:75], v[24:27], a[232:235], v[72:75]
v_rcp_f32 v241, v241
v_mfma_f32_16x16x32_bf16 v[76:79], v[16:19], a[204:207], v[76:79]
v_rcp_f32 v242, v242
v_mfma_f32_16x16x32_bf16 v[76:79], v[20:23], a[220:223], v[76:79]
v_exp_f32 v243, v243
v_mfma_f32_16x16x32_bf16 v[76:79], v[24:27], a[236:239], v[76:79]
s_waitcnt lgkmcnt(0)
v_exp_f32 v244, v244
v_mfma_f32_16x16x32_bf16 v[80:83], v[28:31], a[192:195], v[80:83]
ds_read_b64_tr_b16 v[16:17], v11 offset:24576
v_mul_f32 v120, v120, v240
v_mfma_f32_16x16x32_bf16 v[80:83], v[32:35], a[208:211], v[80:83]
ds_read_b64_tr_b16 v[18:19], v11 offset:26624
v_mul_f32 v120, v120, v152
s_add_u32 m0, s97, 73728
v_mfma_f32_16x16x32_bf16 v[80:83], v[36:39], a[224:227], v[80:83]
s_add_u32 s45, s41, 2654464
buffer_load_dwordx4 v2, s[12:15], s45 offen offset:0 lds
v_mfma_f32_16x16x32_bf16 v[84:87], v[28:31], a[196:199], v[84:87]
ds_read_b64_tr_b16 v[20:21], v11 offset:28672
v_mul_f32 v121, v121, v241
v_mfma_f32_16x16x32_bf16 v[84:87], v[32:35], a[212:215], v[84:87]
ds_read_b64_tr_b16 v[22:23], v11 offset:30720
v_mul_f32 v121, v121, v153
v_mfma_f32_16x16x32_bf16 v[84:87], v[36:39], a[228:231], v[84:87]
ds_read_b64_tr_b16 v[24:25], v11 offset:32768
v_mul_f32 v122, v122, v242
v_mfma_f32_16x16x32_bf16 v[88:91], v[28:31], a[200:203], v[88:91]
ds_read_b64_tr_b16 v[26:27], v11 offset:34816
v_mul_f32 v122, v122, v154
v_mfma_f32_16x16x32_bf16 v[88:91], v[32:35], a[216:219], v[88:91]
v_exp_f32 v245, v245
v_mfma_f32_16x16x32_bf16 v[88:91], v[36:39], a[232:235], v[88:91]
v_add_f32 v243, 1.0, v243
v_cvt_pk_bf16_f32 v58, v120, v121
v_mfma_f32_16x16x32_bf16 v[92:95], v[28:31], a[204:207], v[92:95]
v_rcp_f32 v243, v243
v_mfma_f32_16x16x32_bf16 v[92:95], v[32:35], a[220:223], v[92:95]
buffer_load_dwordx4 v254, s[12:15], s45 offen offset:1024 lds
v_mfma_f32_16x16x32_bf16 v[92:95], v[36:39], a[236:239], v[92:95]
s_waitcnt lgkmcnt(1)
v_mul_f32 v123, v123, v243
v_mul_f32 v123, v123, v155
v_mfma_f32_16x16x32_bf16 v[64:67], v[16:19], a[240:243], v[64:67]
ds_read_b64_tr_b16 v[28:29], v13 offset:24576
v_cvt_pk_bf16_f32 v59, v122, v123
v_mfma_f32_16x16x32_bf16 v[64:67], v[20:23], v[160:163], v[64:67]
s_waitcnt lgkmcnt(1)
ds_read_b64_tr_b16 v[30:31], v13 offset:26624
ds_write_b128 v6, v[56:59] offset:10240
v_mfma_f32_16x16x32_bf16 v[64:67], v[24:27], v[176:179], v[64:67]
ds_read_b64_tr_b16 v[32:33], v13 offset:28672
v_add_f32 v244, 1.0, v244
v_mfma_f32_16x16x32_bf16 v[68:71], v[16:19], a[244:247], v[68:71]
ds_read_b64_tr_b16 v[34:35], v13 offset:30720
v_add_f32 v245, 1.0, v245
v_mfma_f32_16x16x32_bf16 v[68:71], v[20:23], v[164:167], v[68:71]
ds_read_b64_tr_b16 v[36:37], v13 offset:32768
v_fma_f32 v246, -v110, v110, s47
v_mfma_f32_16x16x32_bf16 v[68:71], v[24:27], v[180:183], v[68:71]
ds_read_b64_tr_b16 v[38:39], v13 offset:34816
v_mul_f32 v246, v246, v110
v_mfma_f32_16x16x32_bf16 v[72:75], v[16:19], a[248:251], v[72:75]
buffer_load_dwordx4 v255, s[12:15], s45 offen offset:2048 lds
v_mfma_f32_16x16x32_bf16 v[72:75], v[20:23], v[168:171], v[72:75]
v_rcp_f32 v244, v244
v_mfma_f32_16x16x32_bf16 v[72:75], v[24:27], v[184:187], v[72:75]
v_rcp_f32 v245, v245
v_mfma_f32_16x16x32_bf16 v[76:79], v[16:19], a[252:255], v[76:79]
v_exp_f32 v246, v246
v_mfma_f32_16x16x32_bf16 v[76:79], v[20:23], v[172:175], v[76:79]
v_mul_f32 v108, v108, v244
v_mul_f32 v108, v108, v140
v_mfma_f32_16x16x32_bf16 v[76:79], v[24:27], v[188:191], v[76:79]
s_waitcnt lgkmcnt(0)
s_waitcnt vmcnt(6)
s_barrier
v_mul_f32 v109, v109, v245
v_mul_f32 v109, v109, v141
v_mfma_f32_16x16x32_bf16 v[80:83], v[28:31], a[240:243], v[80:83]
ds_read_b64_tr_b16 v[16:17], v10 offset:0
v_add_f32 v246, 1.0, v246
v_mfma_f32_16x16x32_bf16 v[80:83], v[32:35], v[160:163], v[80:83]
ds_read_b64_tr_b16 v[18:19], v10 offset:2048
v_fma_f32 v247, -v111, v111, s47
s_add_u32 m0, s97, 86016
v_mfma_f32_16x16x32_bf16 v[80:83], v[36:39], v[176:179], v[80:83]
s_add_u32 s45, s41, 3539200
buffer_load_dwordx4 v2, s[12:15], s45 offen offset:0 lds
v_mfma_f32_16x16x32_bf16 v[84:87], v[28:31], a[244:247], v[84:87]
ds_read_b64_tr_b16 v[20:21], v10 offset:4096
v_mul_f32 v247, v247, v111
v_mfma_f32_16x16x32_bf16 v[84:87], v[32:35], v[164:167], v[84:87]
ds_read_b64_tr_b16 v[22:23], v10 offset:6144
v_cvt_pk_bf16_f32 v60, v108, v109
v_mfma_f32_16x16x32_bf16 v[84:87], v[36:39], v[180:183], v[84:87]
ds_read_b64_tr_b16 v[24:25], v10 offset:8192
v_fma_f32 v248, -v124, v124, s47
v_mfma_f32_16x16x32_bf16 v[88:91], v[28:31], a[248:251], v[88:91]
ds_read_b64_tr_b16 v[26:27], v10 offset:10240
v_mul_f32 v248, v248, v124
v_mfma_f32_16x16x32_bf16 v[88:91], v[32:35], v[168:171], v[88:91]
v_rcp_f32 v246, v246
v_mfma_f32_16x16x32_bf16 v[88:91], v[36:39], v[184:187], v[88:91]
v_exp_f32 v247, v247
v_mfma_f32_16x16x32_bf16 v[92:95], v[28:31], a[252:255], v[92:95]
v_exp_f32 v248, v248
v_mfma_f32_16x16x32_bf16 v[92:95], v[32:35], v[172:175], v[92:95]
buffer_load_dwordx4 v254, s[12:15], s45 offen offset:1024 lds
v_mfma_f32_16x16x32_bf16 v[92:95], v[36:39], v[188:191], v[92:95]
s_waitcnt lgkmcnt(1)
v_mul_f32 v110, v110, v246
v_mul_f32 v110, v110, v142
v_mfma_f32_16x16x32_bf16 v[192:195], v[16:19], a[0:3], 0
ds_read_b64_tr_b16 v[28:29], v12 offset:0
v_add_f32 v247, 1.0, v247
v_mfma_f32_16x16x32_bf16 v[192:195], v[20:23], a[16:19], v[192:195]
s_waitcnt lgkmcnt(1)
ds_read_b64_tr_b16 v[30:31], v12 offset:2048
v_add_f32 v248, 1.0, v248
v_mfma_f32_16x16x32_bf16 v[192:195], v[24:27], a[32:35], v[192:195]
ds_read_b64_tr_b16 v[32:33], v12 offset:4096
v_fma_f32 v249, -v125, v125, s47
v_mfma_f32_16x16x32_bf16 v[196:199], v[16:19], a[4:7], 0
ds_read_b64_tr_b16 v[34:35], v12 offset:6144
v_mul_f32 v249, v249, v125
v_mfma_f32_16x16x32_bf16 v[196:199], v[20:23], a[20:23], v[196:199]
ds_read_b64_tr_b16 v[36:37], v12 offset:8192
v_fma_f32 v250, -v126, v126, s47
v_mfma_f32_16x16x32_bf16 v[196:199], v[24:27], a[36:39], v[196:199]
ds_read_b64_tr_b16 v[38:39], v12 offset:10240
v_mul_f32 v250, v250, v126
v_mfma_f32_16x16x32_bf16 v[200:203], v[16:19], a[8:11], 0
buffer_load_dwordx4 v255, s[12:15], s45 offen offset:2048 lds
v_mfma_f32_16x16x32_bf16 v[200:203], v[20:23], a[24:27], v[200:203]
v_rcp_f32 v247, v247
v_mfma_f32_16x16x32_bf16 v[200:203], v[24:27], a[40:43], v[200:203]
v_rcp_f32 v248, v248
v_mfma_f32_16x16x32_bf16 v[204:207], v[16:19], a[12:15], 0
v_exp_f32 v249, v249
v_mfma_f32_16x16x32_bf16 v[204:207], v[20:23], a[28:31], v[204:207]
v_exp_f32 v250, v250
v_mfma_f32_16x16x32_bf16 v[204:207], v[24:27], a[44:47], v[204:207]
s_waitcnt lgkmcnt(0)
v_mul_f32 v111, v111, v247
v_mul_f32 v111, v111, v143
v_mfma_f32_16x16x32_bf16 v[208:211], v[28:31], a[0:3], 0
ds_read_b64_tr_b16 v[16:17], v10 offset:12288
v_cvt_pk_bf16_f32 v61, v110, v111
v_mfma_f32_16x16x32_bf16 v[208:211], v[32:35], a[16:19], v[208:211]
ds_read_b64_tr_b16 v[18:19], v10 offset:14336
v_mul_f32 v124, v124, v248
s_add_u32 m0, s97, 98304
v_mfma_f32_16x16x32_bf16 v[208:211], v[36:39], a[32:35], v[208:211]
s_add_u32 s45, s41, 4423936
buffer_load_dwordx4 v2, s[12:15], s45 offen offset:0 lds
v_mfma_f32_16x16x32_bf16 v[212:215], v[28:31], a[4:7], 0
ds_read_b64_tr_b16 v[20:21], v10 offset:16384
v_mul_f32 v124, v124, v156
v_mfma_f32_16x16x32_bf16 v[212:215], v[32:35], a[20:23], v[212:215]
ds_read_b64_tr_b16 v[22:23], v10 offset:18432
v_add_f32 v249, 1.0, v249
v_mfma_f32_16x16x32_bf16 v[212:215], v[36:39], a[36:39], v[212:215]
ds_read_b64_tr_b16 v[24:25], v10 offset:20480
v_add_f32 v250, 1.0, v250
v_mfma_f32_16x16x32_bf16 v[216:219], v[28:31], a[8:11], 0
ds_read_b64_tr_b16 v[26:27], v10 offset:22528
v_fma_f32 v251, -v127, v127, s47
v_mfma_f32_16x16x32_bf16 v[216:219], v[32:35], a[24:27], v[216:219]
v_rcp_f32 v249, v249
v_mfma_f32_16x16x32_bf16 v[216:219], v[36:39], a[40:43], v[216:219]
v_rcp_f32 v250, v250
v_mfma_f32_16x16x32_bf16 v[220:223], v[28:31], a[12:15], 0
v_mul_f32 v125, v125, v249
v_mul_f32 v125, v125, v157
v_mfma_f32_16x16x32_bf16 v[220:223], v[32:35], a[28:31], v[220:223]
buffer_load_dwordx4 v254, s[12:15], s45 offen offset:1024 lds
v_mfma_f32_16x16x32_bf16 v[220:223], v[36:39], a[44:47], v[220:223]
s_waitcnt lgkmcnt(1)
v_mul_f32 v126, v126, v250
v_mul_f32 v126, v126, v158
v_mfma_f32_16x16x32_bf16 v[192:195], v[16:19], a[48:51], v[192:195]
ds_read_b64_tr_b16 v[28:29], v12 offset:12288
v_mul_f32 v251, v251, v127
v_mfma_f32_16x16x32_bf16 v[192:195], v[20:23], a[64:67], v[192:195]
s_waitcnt lgkmcnt(1)
ds_read_b64_tr_b16 v[30:31], v12 offset:14336
v_cvt_pk_bf16_f32 v62, v124, v125
v_mfma_f32_16x16x32_bf16 v[192:195], v[24:27], a[80:83], v[192:195]
ds_read_b64_tr_b16 v[32:33], v12 offset:16384
v_fma_f32 v252, -v64, v64, s47
v_mfma_f32_16x16x32_bf16 v[196:199], v[16:19], a[52:55], v[196:199]
ds_read_b64_tr_b16 v[34:35], v12 offset:18432
v_mul_f32 v252, v252, v64
v_mfma_f32_16x16x32_bf16 v[196:199], v[20:23], a[68:71], v[196:199]
ds_read_b64_tr_b16 v[36:37], v12 offset:20480
v_fma_f32 v253, -v65, v65, s47
v_mfma_f32_16x16x32_bf16 v[196:199], v[24:27], a[84:87], v[196:199]
ds_read_b64_tr_b16 v[38:39], v12 offset:22528
v_mul_f32 v253, v253, v65
v_mfma_f32_16x16x32_bf16 v[200:203], v[16:19], a[56:59], v[200:203]
buffer_load_dwordx4 v255, s[12:15], s45 offen offset:2048 lds
v_mfma_f32_16x16x32_bf16 v[200:203], v[20:23], a[72:75], v[200:203]
v_exp_f32 v251, v251
v_mfma_f32_16x16x32_bf16 v[200:203], v[24:27], a[88:91], v[200:203]
v_exp_f32 v252, v252
v_mfma_f32_16x16x32_bf16 v[204:207], v[16:19], a[60:63], v[204:207]
v_exp_f32 v253, v253
v_mfma_f32_16x16x32_bf16 v[204:207], v[20:23], a[76:79], v[204:207]
v_add_f32 v251, 1.0, v251
v_add_f32 v252, 1.0, v252
v_mfma_f32_16x16x32_bf16 v[204:207], v[24:27], a[92:95], v[204:207]
s_waitcnt lgkmcnt(0)
s_waitcnt vmcnt(6)
s_barrier
v_rcp_f32 v251, v251
v_mfma_f32_16x16x32_bf16 v[208:211], v[28:31], a[48:51], v[208:211]
ds_read_b64_tr_b16 v[16:17], v10 offset:24576
v_mul_f32 v127, v127, v251
v_mfma_f32_16x16x32_bf16 v[208:211], v[32:35], a[64:67], v[208:211]
ds_read_b64_tr_b16 v[18:19], v10 offset:26624
v_mul_f32 v127, v127, v159
s_add_u32 m0, s97, 36864
v_mfma_f32_16x16x32_bf16 v[208:211], v[36:39], a[80:83], v[208:211]
s_add_u32 s45, s41, 384
buffer_load_dwordx4 v2, s[8:11], s45 offen offset:0 lds
v_mfma_f32_16x16x32_bf16 v[212:215], v[28:31], a[52:55], v[212:215]
ds_read_b64_tr_b16 v[20:21], v10 offset:28672
v_cvt_pk_bf16_f32 v63, v126, v127
v_mfma_f32_16x16x32_bf16 v[212:215], v[32:35], a[68:71], v[212:215]
ds_read_b64_tr_b16 v[22:23], v10 offset:30720
ds_write_b128 v6, v[60:63] offset:11264
v_mfma_f32_16x16x32_bf16 v[212:215], v[36:39], a[84:87], v[212:215]
ds_read_b64_tr_b16 v[24:25], v10 offset:32768
v_add_f32 v253, 1.0, v253
v_mfma_f32_16x16x32_bf16 v[216:219], v[28:31], a[56:59], v[216:219]
ds_read_b64_tr_b16 v[26:27], v10 offset:34816
v_fma_f32 v40, -v66, v66, s47
v_mfma_f32_16x16x32_bf16 v[216:219], v[32:35], a[72:75], v[216:219]
v_rcp_f32 v252, v252
v_mfma_f32_16x16x32_bf16 v[216:219], v[36:39], a[88:91], v[216:219]
v_rcp_f32 v253, v253
v_mfma_f32_16x16x32_bf16 v[220:223], v[28:31], a[60:63], v[220:223]
v_mul_f32 v64, v64, v252
v_mul_f32 v65, v65, v253
v_mfma_f32_16x16x32_bf16 v[220:223], v[32:35], a[76:79], v[220:223]
buffer_load_dwordx4 v254, s[8:11], s45 offen offset:1024 lds
v_mfma_f32_16x16x32_bf16 v[220:223], v[36:39], a[92:95], v[220:223]
s_waitcnt lgkmcnt(1)
v_mul_f32 v40, v40, v66
v_fma_f32 v41, -v67, v67, s47
v_mfma_f32_16x16x32_bf16 v[192:195], v[16:19], a[96:99], v[192:195]
ds_read_b64_tr_b16 v[28:29], v12 offset:24576
v_mul_f32 v41, v41, v67
v_mfma_f32_16x16x32_bf16 v[192:195], v[20:23], a[112:115], v[192:195]
s_waitcnt lgkmcnt(1)
ds_read_b64_tr_b16 v[30:31], v12 offset:26624
v_fma_f32 v42, -v80, v80, s47
v_mfma_f32_16x16x32_bf16 v[192:195], v[24:27], a[128:131], v[192:195]
ds_read_b64_tr_b16 v[32:33], v12 offset:28672
v_mul_f32 v42, v42, v80
v_mfma_f32_16x16x32_bf16 v[196:199], v[16:19], a[100:103], v[196:199]
ds_read_b64_tr_b16 v[34:35], v12 offset:30720
v_fma_f32 v43, -v81, v81, s47
v_mfma_f32_16x16x32_bf16 v[196:199], v[20:23], a[116:119], v[196:199]
ds_read_b64_tr_b16 v[36:37], v12 offset:32768
v_mul_f32 v43, v43, v81
v_mfma_f32_16x16x32_bf16 v[196:199], v[24:27], a[132:135], v[196:199]
ds_read_b64_tr_b16 v[38:39], v12 offset:34816
v_fma_f32 v44, -v82, v82, s47
v_mfma_f32_16x16x32_bf16 v[200:203], v[16:19], a[104:107], v[200:203]
buffer_load_dwordx4 v255, s[8:11], s45 offen offset:2048 lds
v_mfma_f32_16x16x32_bf16 v[200:203], v[20:23], a[120:123], v[200:203]
v_exp_f32 v40, v40
v_mfma_f32_16x16x32_bf16 v[200:203], v[24:27], a[136:139], v[200:203]
v_exp_f32 v41, v41
v_mfma_f32_16x16x32_bf16 v[204:207], v[16:19], a[108:111], v[204:207]
v_exp_f32 v42, v42
v_mfma_f32_16x16x32_bf16 v[204:207], v[20:23], a[124:127], v[204:207]
v_exp_f32 v43, v43
v_mfma_f32_16x16x32_bf16 v[204:207], v[24:27], a[140:143], v[204:207]
s_waitcnt lgkmcnt(0)
v_add_f32 v40, 1.0, v40
v_add_f32 v41, 1.0, v41
v_mfma_f32_16x16x32_bf16 v[208:211], v[28:31], a[96:99], v[208:211]
ds_read_b64_tr_b16 v[16:17], v11 offset:0
v_add_f32 v42, 1.0, v42
v_mfma_f32_16x16x32_bf16 v[208:211], v[32:35], a[112:115], v[208:211]
ds_read_b64_tr_b16 v[18:19], v11 offset:2048
v_add_f32 v43, 1.0, v43
s_add_u32 m0, s97, 49152
v_mfma_f32_16x16x32_bf16 v[208:211], v[36:39], a[128:131], v[208:211]
s_add_u32 s45, s41, 885120
buffer_load_dwordx4 v2, s[8:11], s45 offen offset:0 lds
v_mfma_f32_16x16x32_bf16 v[212:215], v[28:31], a[100:103], v[212:215]
ds_read_b64_tr_b16 v[20:21], v11 offset:4096
v_mul_f32 v44, v44, v82
v_mfma_f32_16x16x32_bf16 v[212:215], v[32:35], a[116:119], v[212:215]
ds_read_b64_tr_b16 v[22:23], v11 offset:6144
v_fma_f32 v45, -v83, v83, s47
v_mfma_f32_16x16x32_bf16 v[212:215], v[36:39], a[132:135], v[212:215]
ds_read_b64_tr_b16 v[24:25], v11 offset:8192
v_mul_f32 v45, v45, v83
v_mfma_f32_16x16x32_bf16 v[216:219], v[28:31], a[104:107], v[216:219]
ds_read_b64_tr_b16 v[26:27], v11 offset:10240
v_fma_f32 v46, -v68, v68, s47
v_mfma_f32_16x16x32_bf16 v[216:219], v[32:35], a[120:123], v[216:219]
v_rcp_f32 v40, v40
v_mfma_f32_16x16x32_bf16 v[216:219], v[36:39], a[136:139], v[216:219]
v_rcp_f32 v41, v41
v_mfma_f32_16x16x32_bf16 v[220:223], v[28:31], a[108:111], v[220:223]
v_rcp_f32 v42, v42
v_mfma_f32_16x16x32_bf16 v[220:223], v[32:35], a[124:127], v[220:223]
buffer_load_dwordx4 v254, s[8:11], s45 offen offset:1024 lds
v_mfma_f32_16x16x32_bf16 v[220:223], v[36:39], a[140:143], v[220:223]
s_waitcnt lgkmcnt(1)
v_rcp_f32 v43, v43
v_mfma_f32_16x16x32_bf16 v[192:195], v[16:19], a[144:147], v[192:195]
ds_read_b64_tr_b16 v[28:29], v13 offset:0
v_mul_f32 v66, v66, v40
v_mfma_f32_16x16x32_bf16 v[192:195], v[20:23], a[160:163], v[192:195]
s_waitcnt lgkmcnt(1)
ds_read_b64_tr_b16 v[30:31], v13 offset:2048
v_mul_f32 v67, v67, v41
v_mfma_f32_16x16x32_bf16 v[192:195], v[24:27], a[176:179], v[192:195]
ds_read_b64_tr_b16 v[32:33], v13 offset:4096
v_mul_f32 v80, v80, v42
v_mfma_f32_16x16x32_bf16 v[196:199], v[16:19], a[148:151], v[196:199]
ds_read_b64_tr_b16 v[34:35], v13 offset:6144
v_mul_f32 v81, v81, v43
v_mfma_f32_16x16x32_bf16 v[196:199], v[20:23], a[164:167], v[196:199]
ds_read_b64_tr_b16 v[36:37], v13 offset:8192
v_mul_f32 v46, v46, v68
v_mfma_f32_16x16x32_bf16 v[196:199], v[24:27], a[180:183], v[196:199]
ds_read_b64_tr_b16 v[38:39], v13 offset:10240
v_fma_f32 v47, -v69, v69, s47
v_mfma_f32_16x16x32_bf16 v[200:203], v[16:19], a[152:155], v[200:203]
buffer_load_dwordx4 v255, s[8:11], s45 offen offset:2048 lds
v_mfma_f32_16x16x32_bf16 v[200:203], v[20:23], a[168:171], v[200:203]
v_exp_f32 v44, v44
v_mfma_f32_16x16x32_bf16 v[200:203], v[24:27], a[184:187], v[200:203]
v_exp_f32 v45, v45
v_mfma_f32_16x16x32_bf16 v[204:207], v[16:19], a[156:159], v[204:207]
v_exp_f32 v46, v46
v_mfma_f32_16x16x32_bf16 v[204:207], v[20:23], a[172:175], v[204:207]
v_add_f32 v44, 1.0, v44
v_add_f32 v45, 1.0, v45
v_mfma_f32_16x16x32_bf16 v[204:207], v[24:27], a[188:191], v[204:207]
s_waitcnt lgkmcnt(0)
s_waitcnt vmcnt(6)
s_barrier
v_rcp_f32 v44, v44
v_mfma_f32_16x16x32_bf16 v[208:211], v[28:31], a[144:147], v[208:211]
ds_read_b64_tr_b16 v[16:17], v11 offset:12288
v_mul_f32 v82, v82, v44
v_mfma_f32_16x16x32_bf16 v[208:211], v[32:35], a[160:163], v[208:211]
ds_read_b64_tr_b16 v[18:19], v11 offset:14336
v_add_f32 v46, 1.0, v46
s_add_u32 m0, s97, 61440
v_mfma_f32_16x16x32_bf16 v[208:211], v[36:39], a[176:179], v[208:211]
s_add_u32 s45, s41, 1769856
buffer_load_dwordx4 v2, s[8:11], s45 offen offset:0 lds
v_mfma_f32_16x16x32_bf16 v[212:215], v[28:31], a[148:151], v[212:215]
ds_read_b64_tr_b16 v[20:21], v11 offset:16384
v_mul_f32 v47, v47, v69
v_mfma_f32_16x16x32_bf16 v[212:215], v[32:35], a[164:167], v[212:215]
ds_read_b64_tr_b16 v[22:23], v11 offset:18432
v_fma_f32 v240, -v70, v70, s47
v_mfma_f32_16x16x32_bf16 v[212:215], v[36:39], a[180:183], v[212:215]
ds_read_b64_tr_b16 v[24:25], v11 offset:20480
v_mul_f32 v240, v240, v70
v_mfma_f32_16x16x32_bf16 v[216:219], v[28:31], a[152:155], v[216:219]
ds_read_b64_tr_b16 v[26:27], v11 offset:22528
v_fma_f32 v241, -v71, v71, s47
v_mfma_f32_16x16x32_bf16 v[216:219], v[32:35], a[168:171], v[216:219]
v_rcp_f32 v45, v45
v_mfma_f32_16x16x32_bf16 v[216:219], v[36:39], a[184:187], v[216:219]
v_rcp_f32 v46, v46
v_mfma_f32_16x16x32_bf16 v[220:223], v[28:31], a[156:159], v[220:223]
v_exp_f32 v47, v47
v_mfma_f32_16x16x32_bf16 v[220:223], v[32:35], a[172:175], v[220:223]
buffer_load_dwordx4 v254, s[8:11], s45 offen offset:1024 lds
v_mfma_f32_16x16x32_bf16 v[220:223], v[36:39], a[188:191], v[220:223]
s_waitcnt lgkmcnt(1)
v_exp_f32 v240, v240
v_mfma_f32_16x16x32_bf16 v[192:195], v[16:19], a[192:195], v[192:195]
ds_read_b64_tr_b16 v[28:29], v13 offset:12288
v_mul_f32 v83, v83, v45
v_mfma_f32_16x16x32_bf16 v[192:195], v[20:23], a[208:211], v[192:195]
s_waitcnt lgkmcnt(1)
ds_read_b64_tr_b16 v[30:31], v13 offset:14336
v_mul_f32 v68, v68, v46
v_mfma_f32_16x16x32_bf16 v[192:195], v[24:27], a[224:227], v[192:195]
ds_read_b64_tr_b16 v[32:33], v13 offset:16384
v_add_f32 v47, 1.0, v47
v_mfma_f32_16x16x32_bf16 v[196:199], v[16:19], a[196:199], v[196:199]
ds_read_b64_tr_b16 v[34:35], v13 offset:18432
v_add_f32 v240, 1.0, v240
v_mfma_f32_16x16x32_bf16 v[196:199], v[20:23], a[212:215], v[196:199]
ds_read_b64_tr_b16 v[36:37], v13 offset:20480
v_mul_f32 v241, v241, v71
v_mfma_f32_16x16x32_bf16 v[196:199], v[24:27], a[228:231], v[196:199]
ds_read_b64_tr_b16 v[38:39], v13 offset:22528
v_fma_f32 v242, -v84, v84, s47
v_mfma_f32_16x16x32_bf16 v[200:203], v[16:19], a[200:203], v[200:203]
buffer_load_dwordx4 v255, s[8:11], s45 offen offset:2048 lds
v_mfma_f32_16x16x32_bf16 v[200:203], v[20:23], a[216:219], v[200:203]
v_rcp_f32 v47, v47
v_mfma_f32_16x16x32_bf16 v[200:203], v[24:27], a[232:235], v[200:203]
v_rcp_f32 v240, v240
v_mfma_f32_16x16x32_bf16 v[204:207], v[16:19], a[204:207], v[204:207]
v_exp_f32 v241, v241
v_mfma_f32_16x16x32_bf16 v[204:207], v[20:23], a[220:223], v[204:207]
v_mul_f32 v69, v69, v47
v_mul_f32 v70, v70, v240
v_mfma_f32_16x16x32_bf16 v[204:207], v[24:27], a[236:239], v[204:207]
s_waitcnt lgkmcnt(0)
v_add_f32 v241, 1.0, v241
v_mul_f32 v242, v242, v84
v_mfma_f32_16x16x32_bf16 v[208:211], v[28:31], a[192:195], v[208:211]
ds_read_b64_tr_b16 v[16:17], v11 offset:24576
v_fma_f32 v243, -v85, v85, s47
v_mfma_f32_16x16x32_bf16 v[208:211], v[32:35], a[208:211], v[208:211]
ds_read_b64_tr_b16 v[18:19], v11 offset:26624
v_mul_f32 v243, v243, v85
s_add_u32 m0, s97, 73728
v_mfma_f32_16x16x32_bf16 v[208:211], v[36:39], a[224:227], v[208:211]
s_add_u32 s45, s41, 2654592
buffer_load_dwordx4 v2, s[8:11], s45 offen offset:0 lds
v_mfma_f32_16x16x32_bf16 v[212:215], v[28:31], a[196:199], v[212:215]
ds_read_b64_tr_b16 v[20:21], v11 offset:28672
v_fma_f32 v244, -v86, v86, s47
v_mfma_f32_16x16x32_bf16 v[212:215], v[32:35], a[212:215], v[212:215]
ds_read_b64_tr_b16 v[22:23], v11 offset:30720
v_mul_f32 v244, v244, v86
v_mfma_f32_16x16x32_bf16 v[212:215], v[36:39], a[228:231], v[212:215]
ds_read_b64_tr_b16 v[24:25], v11 offset:32768
v_fma_f32 v245, -v87, v87, s47
v_mfma_f32_16x16x32_bf16 v[216:219], v[28:31], a[200:203], v[216:219]
ds_read_b64_tr_b16 v[26:27], v11 offset:34816
v_mul_f32 v245, v245, v87
v_mfma_f32_16x16x32_bf16 v[216:219], v[32:35], a[216:219], v[216:219]
v_rcp_f32 v241, v241
v_mfma_f32_16x16x32_bf16 v[216:219], v[36:39], a[232:235], v[216:219]
v_exp_f32 v242, v242
v_mfma_f32_16x16x32_bf16 v[220:223], v[28:31], a[204:207], v[220:223]
v_exp_f32 v243, v243
v_mfma_f32_16x16x32_bf16 v[220:223], v[32:35], a[220:223], v[220:223]
buffer_load_dwordx4 v254, s[8:11], s45 offen offset:1024 lds
v_mfma_f32_16x16x32_bf16 v[220:223], v[36:39], a[236:239], v[220:223]
s_waitcnt lgkmcnt(1)
v_exp_f32 v244, v244
v_mfma_f32_16x16x32_bf16 v[192:195], v[16:19], a[240:243], v[192:195]
ds_read_b64_tr_b16 v[28:29], v13 offset:24576
v_mul_f32 v71, v71, v241
v_mfma_f32_16x16x32_bf16 v[192:195], v[20:23], v[160:163], v[192:195]
s_waitcnt lgkmcnt(1)
ds_read_b64_tr_b16 v[30:31], v13 offset:26624
v_add_f32 v242, 1.0, v242
v_mfma_f32_16x16x32_bf16 v[192:195], v[24:27], v[176:179], v[192:195]
ds_read_b64_tr_b16 v[32:33], v13 offset:28672
v_add_f32 v243, 1.0, v243
v_mfma_f32_16x16x32_bf16 v[196:199], v[16:19], a[244:247], v[196:199]
ds_read_b64_tr_b16 v[34:35], v13 offset:30720
v_add_f32 v244, 1.0, v244
v_mfma_f32_16x16x32_bf16 v[196:199], v[20:23], v[164:167], v[196:199]
ds_read_b64_tr_b16 v[36:37], v13 offset:32768
v_fma_f32 v246, -v72, v72, s47
v_mfma_f32_16x16x32_bf16 v[196:199], v[24:27], v[180:183], v[196:199]
ds_read_b64_tr_b16 v[38:39], v13 offset:34816
v_mul_f32 v246, v246, v72
v_mfma_f32_16x16x32_bf16 v[200:203], v[16:19], a[248:251], v[200:203]
buffer_load_dwordx4 v255, s[8:11], s45 offen offset:2048 lds
v_mfma_f32_16x16x32_bf16 v[200:203], v[20:23], v[168:171], v[200:203]
v_rcp_f32 v242, v242
v_mfma_f32_16x16x32_bf16 v[200:203], v[24:27], v[184:187], v[200:203]
v_rcp_f32 v243, v243
v_mfma_f32_16x16x32_bf16 v[204:207], v[16:19], a[252:255], v[204:207]
v_rcp_f32 v244, v244
v_mfma_f32_16x16x32_bf16 v[204:207], v[20:23], v[172:175], v[204:207]
v_exp_f32 v245, v245
v_mfma_f32_16x16x32_bf16 v[204:207], v[24:27], v[188:191], v[204:207]
s_waitcnt lgkmcnt(0)
s_waitcnt vmcnt(6)
s_barrier
v_exp_f32 v246, v246
v_mfma_f32_16x16x32_bf16 v[208:211], v[28:31], a[240:243], v[208:211]
ds_read_b64_tr_b16 v[16:17], v10 offset:0
v_mul_f32 v84, v84, v242
v_mfma_f32_16x16x32_bf16 v[208:211], v[32:35], v[160:163], v[208:211]
ds_read_b64_tr_b16 v[18:19], v10 offset:2048
v_mul_f32 v85, v85, v243
s_add_u32 m0, s97, 86016
v_mfma_f32_16x16x32_bf16 v[208:211], v[36:39], v[176:179], v[208:211]
s_add_u32 s45, s41, 3539328
buffer_load_dwordx4 v2, s[8:11], s45 offen offset:0 lds
v_mfma_f32_16x16x32_bf16 v[212:215], v[28:31], a[244:247], v[212:215]
ds_read_b64_tr_b16 v[20:21], v10 offset:4096
v_mul_f32 v86, v86, v244
v_mfma_f32_16x16x32_bf16 v[212:215], v[32:35], v[164:167], v[212:215]
ds_read_b64_tr_b16 v[22:23], v10 offset:6144
v_add_f32 v245, 1.0, v245
v_mfma_f32_16x16x32_bf16 v[212:215], v[36:39], v[180:183], v[212:215]
ds_read_b64_tr_b16 v[24:25], v10 offset:8192
v_add_f32 v246, 1.0, v246
v_mfma_f32_16x16x32_bf16 v[216:219], v[28:31], a[248:251], v[216:219]
ds_read_b64_tr_b16 v[26:27], v10 offset:10240
v_fma_f32 v247, -v73, v73, s47
v_mfma_f32_16x16x32_bf16 v[216:219], v[32:35], v[168:171], v[216:219]
v_rcp_f32 v245, v245
v_mfma_f32_16x16x32_bf16 v[216:219], v[36:39], v[184:187], v[216:219]
v_rcp_f32 v246, v246
v_mfma_f32_16x16x32_bf16 v[220:223], v[28:31], a[252:255], v[220:223]
v_mul_f32 v87, v87, v245
v_mul_f32 v72, v72, v246
v_mfma_f32_16x16x32_bf16 v[220:223], v[32:35], v[172:175], v[220:223]
buffer_load_dwordx4 v254, s[8:11], s45 offen offset:1024 lds
v_mfma_f32_16x16x32_bf16 v[220:223], v[36:39], v[188:191], v[220:223]
s_waitcnt lgkmcnt(1)
v_mul_f32 v247, v247, v73
v_fma_f32 v248, -v74, v74, s47
v_mfma_f32_16x16x32_bf16 v[96:99], v[16:19], a[0:3], 0
ds_read_b64_tr_b16 v[28:29], v12 offset:0
v_mul_f32 v248, v248, v74
v_mfma_f32_16x16x32_bf16 v[96:99], v[20:23], a[16:19], v[96:99]
s_waitcnt lgkmcnt(1)
ds_read_b64_tr_b16 v[30:31], v12 offset:2048
v_fma_f32 v249, -v75, v75, s47
v_mfma_f32_16x16x32_bf16 v[96:99], v[24:27], a[32:35], v[96:99]
ds_read_b64_tr_b16 v[32:33], v12 offset:4096
v_mul_f32 v249, v249, v75
v_mfma_f32_16x16x32_bf16 v[100:103], v[16:19], a[4:7], 0
ds_read_b64_tr_b16 v[34:35], v12 offset:6144
v_mul_f32 v64, v64, v192
v_mfma_f32_16x16x32_bf16 v[100:103], v[20:23], a[20:23], v[100:103]
ds_read_b64_tr_b16 v[36:37], v12 offset:8192
v_mul_f32 v65, v65, v193
v_mfma_f32_16x16x32_bf16 v[100:103], v[24:27], a[36:39], v[100:103]
ds_read_b64_tr_b16 v[38:39], v12 offset:10240
v_mul_f32 v66, v66, v194
v_mfma_f32_16x16x32_bf16 v[104:107], v[16:19], a[8:11], 0
buffer_load_dwordx4 v255, s[8:11], s45 offen offset:2048 lds
v_mfma_f32_16x16x32_bf16 v[104:107], v[20:23], a[24:27], v[104:107]
v_exp_f32 v247, v247
v_mfma_f32_16x16x32_bf16 v[104:107], v[24:27], a[40:43], v[104:107]
v_exp_f32 v248, v248
v_mfma_f32_16x16x32_bf16 v[108:111], v[16:19], a[12:15], 0
v_exp_f32 v249, v249
v_mfma_f32_16x16x32_bf16 v[108:111], v[20:23], a[28:31], v[108:111]
v_mul_f32 v67, v67, v195
v_cvt_pk_bf16_f32 v48, v64, v65
v_mfma_f32_16x16x32_bf16 v[108:111], v[24:27], a[44:47], v[108:111]
s_waitcnt lgkmcnt(0)
v_cvt_pk_bf16_f32 v49, v66, v67
v_mul_f32 v80, v80, v208
v_mfma_f32_16x16x32_bf16 v[112:115], v[28:31], a[0:3], 0
ds_read_b64_tr_b16 v[16:17], v10 offset:12288
v_mul_f32 v81, v81, v209
v_mfma_f32_16x16x32_bf16 v[112:115], v[32:35], a[16:19], v[112:115]
ds_read_b64_tr_b16 v[18:19], v10 offset:14336
v_mul_f32 v82, v82, v210
s_add_u32 m0, s97, 98304
v_mfma_f32_16x16x32_bf16 v[112:115], v[36:39], a[32:35], v[112:115]
s_add_u32 s45, s41, 4424064
buffer_load_dwordx4 v2, s[8:11], s45 offen offset:0 lds
v_mfma_f32_16x16x32_bf16 v[116:119], v[28:31], a[4:7], 0
ds_read_b64_tr_b16 v[20:21], v10 offset:16384
v_mul_f32 v83, v83, v211
v_mfma_f32_16x16x32_bf16 v[116:119], v[32:35], a[20:23], v[116:119]
ds_read_b64_tr_b16 v[22:23], v10 offset:18432
v_cvt_pk_bf16_f32 v50, v80, v81
v_mfma_f32_16x16x32_bf16 v[116:119], v[36:39], a[36:39], v[116:119]
ds_read_b64_tr_b16 v[24:25], v10 offset:20480
v_cvt_pk_bf16_f32 v51, v82, v83
v_mfma_f32_16x16x32_bf16 v[120:123], v[28:31], a[8:11], 0
ds_read_b64_tr_b16 v[26:27], v10 offset:22528
ds_write_b128 v6, v[48:51] offset:16384
v_mfma_f32_16x16x32_bf16 v[120:123], v[32:35], a[24:27], v[120:123]
v_mul_f32 v68, v68, v196
v_mul_f32 v69, v69, v197
v_mfma_f32_16x16x32_bf16 v[120:123], v[36:39], a[40:43], v[120:123]
v_mul_f32 v70, v70, v198
v_mul_f32 v71, v71, v199
v_mfma_f32_16x16x32_bf16 v[124:127], v[28:31], a[12:15], 0
v_cvt_pk_bf16_f32 v52, v68, v69
v_cvt_pk_bf16_f32 v53, v70, v71
v_mfma_f32_16x16x32_bf16 v[124:127], v[32:35], a[28:31], v[124:127]
buffer_load_dwordx4 v254, s[8:11], s45 offen offset:1024 lds
v_mfma_f32_16x16x32_bf16 v[124:127], v[36:39], a[44:47], v[124:127]
s_waitcnt lgkmcnt(2)
v_mul_f32 v84, v84, v212
v_mul_f32 v85, v85, v213
v_mfma_f32_16x16x32_bf16 v[96:99], v[16:19], a[48:51], v[96:99]
ds_read_b64_tr_b16 v[28:29], v12 offset:12288
v_mul_f32 v86, v86, v214
v_mfma_f32_16x16x32_bf16 v[96:99], v[20:23], a[64:67], v[96:99]
s_waitcnt lgkmcnt(1)
ds_read_b64_tr_b16 v[30:31], v12 offset:14336
v_mul_f32 v87, v87, v215
v_mfma_f32_16x16x32_bf16 v[96:99], v[24:27], a[80:83], v[96:99]
ds_read_b64_tr_b16 v[32:33], v12 offset:16384
v_cvt_pk_bf16_f32 v54, v84, v85
v_mfma_f32_16x16x32_bf16 v[100:103], v[16:19], a[52:55], v[100:103]
ds_read_b64_tr_b16 v[34:35], v12 offset:18432
v_cvt_pk_bf16_f32 v55, v86, v87
v_mfma_f32_16x16x32_bf16 v[100:103], v[20:23], a[68:71], v[100:103]
ds_read_b64_tr_b16 v[36:37], v12 offset:20480
ds_write_b128 v6, v[52:55] offset:17408
v_mfma_f32_16x16x32_bf16 v[100:103], v[24:27], a[84:87], v[100:103]
ds_read_b64_tr_b16 v[38:39], v12 offset:22528
v_mul_f32 v72, v72, v200
v_mfma_f32_16x16x32_bf16 v[104:107], v[16:19], a[56:59], v[104:107]
buffer_load_dwordx4 v255, s[8:11], s45 offen offset:2048 lds
v_mfma_f32_16x16x32_bf16 v[104:107], v[20:23], a[72:75], v[104:107]
v_add_f32 v247, 1.0, v247
v_add_f32 v248, 1.0, v248
v_mfma_f32_16x16x32_bf16 v[104:107], v[24:27], a[88:91], v[104:107]
v_rcp_f32 v247, v247
v_mfma_f32_16x16x32_bf16 v[108:111], v[16:19], a[60:63], v[108:111]
v_rcp_f32 v248, v248
v_mfma_f32_16x16x32_bf16 v[108:111], v[20:23], a[76:79], v[108:111]
v_mul_f32 v73, v73, v247
v_mul_f32 v73, v73, v201
v_mfma_f32_16x16x32_bf16 v[108:111], v[24:27], a[92:95], v[108:111]
s_waitcnt lgkmcnt(0)
s_waitcnt vmcnt(6)
s_barrier
v_mul_f32 v74, v74, v248
v_mul_f32 v74, v74, v202
v_mfma_f32_16x16x32_bf16 v[112:115], v[28:31], a[48:51], v[112:115]
ds_read_b64_tr_b16 v[16:17], v10 offset:24576
v_add_f32 v249, 1.0, v249
v_mfma_f32_16x16x32_bf16 v[112:115], v[32:35], a[64:67], v[112:115]
ds_read_b64_tr_b16 v[18:19], v10 offset:26624
v_cvt_pk_bf16_f32 v56, v72, v73
s_add_u32 m0, s97, 36864
v_mfma_f32_16x16x32_bf16 v[112:115], v[36:39], a[80:83], v[112:115]
s_add_u32 s45, s41, 384
buffer_load_dwordx4 v2, s[12:15], s45 offen offset:0 lds
v_mfma_f32_16x16x32_bf16 v[116:119], v[28:31], a[52:55], v[116:119]
ds_read_b64_tr_b16 v[20:21], v10 offset:28672
v_fma_f32 v250, -v88, v88, s47
v_mfma_f32_16x16x32_bf16 v[116:119], v[32:35], a[68:71], v[116:119]
ds_read_b64_tr_b16 v[22:23], v10 offset:30720
v_mul_f32 v250, v250, v88
v_mfma_f32_16x16x32_bf16 v[116:119], v[36:39], a[84:87], v[116:119]
ds_read_b64_tr_b16 v[24:25], v10 offset:32768
v_fma_f32 v251, -v89, v89, s47
v_mfma_f32_16x16x32_bf16 v[120:123], v[28:31], a[56:59], v[120:123]
ds_read_b64_tr_b16 v[26:27], v10 offset:34816
v_mul_f32 v251, v251, v89
v_mfma_f32_16x16x32_bf16 v[120:123], v[32:35], a[72:75], v[120:123]
v_rcp_f32 v249, v249
v_mfma_f32_16x16x32_bf16 v[120:123], v[36:39], a[88:91], v[120:123]
v_exp_f32 v250, v250
v_mfma_f32_16x16x32_bf16 v[124:127], v[28:31], a[60:63], v[124:127]
v_exp_f32 v251, v251
v_mfma_f32_16x16x32_bf16 v[124:127], v[32:35], a[76:79], v[124:127]
buffer_load_dwordx4 v254, s[12:15], s45 offen offset:1024 lds
v_mfma_f32_16x16x32_bf16 v[124:127], v[36:39], a[92:95], v[124:127]
s_waitcnt lgkmcnt(1)
v_mul_f32 v75, v75, v249
v_mul_f32 v75, v75, v203
v_mfma_f32_16x16x32_bf16 v[96:99], v[16:19], a[96:99], v[96:99]
ds_read_b64_tr_b16 v[28:29], v12 offset:24576
v_cvt_pk_bf16_f32 v57, v74, v75
v_mfma_f32_16x16x32_bf16 v[96:99], v[20:23], a[112:115], v[96:99]
s_waitcnt lgkmcnt(1)
ds_read_b64_tr_b16 v[30:31], v12 offset:26624
v_add_f32 v250, 1.0, v250
v_mfma_f32_16x16x32_bf16 v[96:99], v[24:27], a[128:131], v[96:99]
ds_read_b64_tr_b16 v[32:33], v12 offset:28672
v_add_f32 v251, 1.0, v251
v_mfma_f32_16x16x32_bf16 v[100:103], v[16:19], a[100:103], v[100:103]
ds_read_b64_tr_b16 v[34:35], v12 offset:30720
v_fma_f32 v252, -v90, v90, s47
v_mfma_f32_16x16x32_bf16 v[100:103], v[20:23], a[116:119], v[100:103]
ds_read_b64_tr_b16 v[36:37], v12 offset:32768
v_mul_f32 v252, v252, v90
v_mfma_f32_16x16x32_bf16 v[100:103], v[24:27], a[132:135], v[100:103]
ds_read_b64_tr_b16 v[38:39], v12 offset:34816
v_fma_f32 v253, -v91, v91, s47
v_mfma_f32_16x16x32_bf16 v[104:107], v[16:19], a[104:107], v[104:107]
buffer_load_dwordx4 v255, s[12:15], s45 offen offset:2048 lds
v_mfma_f32_16x16x32_bf16 v[104:107], v[20:23], a[120:123], v[104:107]
v_rcp_f32 v250, v250
v_mfma_f32_16x16x32_bf16 v[104:107], v[24:27], a[136:139], v[104:107]
v_rcp_f32 v251, v251
v_mfma_f32_16x16x32_bf16 v[108:111], v[16:19], a[108:111], v[108:111]
v_exp_f32 v252, v252
v_mfma_f32_16x16x32_bf16 v[108:111], v[20:23], a[124:127], v[108:111]
v_mul_f32 v88, v88, v250
v_mul_f32 v88, v88, v216
v_mfma_f32_16x16x32_bf16 v[108:111], v[24:27], a[140:143], v[108:111]
s_waitcnt lgkmcnt(0)
v_mul_f32 v89, v89, v251
v_mul_f32 v89, v89, v217
v_mfma_f32_16x16x32_bf16 v[112:115], v[28:31], a[96:99], v[112:115]
ds_read_b64_tr_b16 v[16:17], v11 offset:0
v_add_f32 v252, 1.0, v252
v_mfma_f32_16x16x32_bf16 v[112:115], v[32:35], a[112:115], v[112:115]
ds_read_b64_tr_b16 v[18:19], v11 offset:2048
v_mul_f32 v253, v253, v91
s_add_u32 m0, s97, 49152
v_mfma_f32_16x16x32_bf16 v[112:115], v[36:39], a[128:131], v[112:115]
s_add_u32 s45, s41, 885120
buffer_load_dwordx4 v2, s[12:15], s45 offen offset:0 lds
v_mfma_f32_16x16x32_bf16 v[116:119], v[28:31], a[100:103], v[116:119]
ds_read_b64_tr_b16 v[20:21], v11 offset:4096
v_cvt_pk_bf16_f32 v58, v88, v89
v_mfma_f32_16x16x32_bf16 v[116:119], v[32:35], a[116:119], v[116:119]
ds_read_b64_tr_b16 v[22:23], v11 offset:6144
v_fma_f32 v40, -v76, v76, s47
v_mfma_f32_16x16x32_bf16 v[116:119], v[36:39], a[132:135], v[116:119]
ds_read_b64_tr_b16 v[24:25], v11 offset:8192
v_mul_f32 v40, v40, v76
v_mfma_f32_16x16x32_bf16 v[120:123], v[28:31], a[104:107], v[120:123]
ds_read_b64_tr_b16 v[26:27], v11 offset:10240
v_fma_f32 v41, -v77, v77, s47
v_mfma_f32_16x16x32_bf16 v[120:123], v[32:35], a[120:123], v[120:123]
v_rcp_f32 v252, v252
v_mfma_f32_16x16x32_bf16 v[120:123], v[36:39], a[136:139], v[120:123]
v_exp_f32 v253, v253
v_mfma_f32_16x16x32_bf16 v[124:127], v[28:31], a[108:111], v[124:127]
v_exp_f32 v40, v40
v_mfma_f32_16x16x32_bf16 v[124:127], v[32:35], a[124:127], v[124:127]
buffer_load_dwordx4 v254, s[12:15], s45 offen offset:1024 lds
v_mfma_f32_16x16x32_bf16 v[124:127], v[36:39], a[140:143], v[124:127]
s_waitcnt lgkmcnt(1)
v_mul_f32 v90, v90, v252
v_mul_f32 v90, v90, v218
v_mfma_f32_16x16x32_bf16 v[96:99], v[16:19], a[144:147], v[96:99]
ds_read_b64_tr_b16 v[28:29], v13 offset:0
v_add_f32 v253, 1.0, v253
v_mfma_f32_16x16x32_bf16 v[96:99], v[20:23], a[160:163], v[96:99]
s_waitcnt lgkmcnt(1)
ds_read_b64_tr_b16 v[30:31], v13 offset:2048
v_add_f32 v40, 1.0, v40
v_mfma_f32_16x16x32_bf16 v[96:99], v[24:27], a[176:179], v[96:99]
ds_read_b64_tr_b16 v[32:33], v13 offset:4096
v_mul_f32 v41, v41, v77
v_mfma_f32_16x16x32_bf16 v[100:103], v[16:19], a[148:151], v[100:103]
ds_read_b64_tr_b16 v[34:35], v13 offset:6144
v_fma_f32 v42, -v78, v78, s47
v_mfma_f32_16x16x32_bf16 v[100:103], v[20:23], a[164:167], v[100:103]
ds_read_b64_tr_b16 v[36:37], v13 offset:8192
v_mul_f32 v42, v42, v78
v_mfma_f32_16x16x32_bf16 v[100:103], v[24:27], a[180:183], v[100:103]
ds_read_b64_tr_b16 v[38:39], v13 offset:10240
v_fma_f32 v43, -v79, v79, s47
v_mfma_f32_16x16x32_bf16 v[104:107], v[16:19], a[152:155], v[104:107]
buffer_load_dwordx4 v255, s[12:15], s45 offen offset:2048 lds
v_mfma_f32_16x16x32_bf16 v[104:107], v[20:23], a[168:171], v[104:107]
v_rcp_f32 v253, v253
v_mfma_f32_16x16x32_bf16 v[104:107], v[24:27], a[184:187], v[104:107]
v_rcp_f32 v40, v40
v_mfma_f32_16x16x32_bf16 v[108:111], v[16:19], a[156:159], v[108:111]
v_exp_f32 v41, v41
v_mfma_f32_16x16x32_bf16 v[108:111], v[20:23], a[172:175], v[108:111]
v_exp_f32 v42, v42
v_mfma_f32_16x16x32_bf16 v[108:111], v[24:27], a[188:191], v[108:111]
s_waitcnt lgkmcnt(0)
s_waitcnt vmcnt(6)
s_barrier
v_mul_f32 v91, v91, v253
v_mul_f32 v91, v91, v219
v_mfma_f32_16x16x32_bf16 v[112:115], v[28:31], a[144:147], v[112:115]
ds_read_b64_tr_b16 v[16:17], v11 offset:12288
v_cvt_pk_bf16_f32 v59, v90, v91
v_mfma_f32_16x16x32_bf16 v[112:115], v[32:35], a[160:163], v[112:115]
ds_read_b64_tr_b16 v[18:19], v11 offset:14336
ds_write_b128 v6, v[56:59] offset:18432
s_add_u32 m0, s97, 61440
v_mfma_f32_16x16x32_bf16 v[112:115], v[36:39], a[176:179], v[112:115]
s_add_u32 s45, s41, 1769856
buffer_load_dwordx4 v2, s[12:15], s45 offen offset:0 lds
v_mfma_f32_16x16x32_bf16 v[116:119], v[28:31], a[148:151], v[116:119]
ds_read_b64_tr_b16 v[20:21], v11 offset:16384
v_mul_f32 v76, v76, v40
v_mfma_f32_16x16x32_bf16 v[116:119], v[32:35], a[164:167], v[116:119]
ds_read_b64_tr_b16 v[22:23], v11 offset:18432
v_mul_f32 v76, v76, v204
v_mfma_f32_16x16x32_bf16 v[116:119], v[36:39], a[180:183], v[116:119]
ds_read_b64_tr_b16 v[24:25], v11 offset:20480
v_add_f32 v41, 1.0, v41
v_mfma_f32_16x16x32_bf16 v[120:123], v[28:31], a[152:155], v[120:123]
ds_read_b64_tr_b16 v[26:27], v11 offset:22528
v_add_f32 v42, 1.0, v42
v_mfma_f32_16x16x32_bf16 v[120:123], v[32:35], a[168:171], v[120:123]
v_rcp_f32 v41, v41
v_mfma_f32_16x16x32_bf16 v[120:123], v[36:39], a[184:187], v[120:123]
v_rcp_f32 v42, v42
v_mfma_f32_16x16x32_bf16 v[124:127], v[28:31], a[156:159], v[124:127]
v_mul_f32 v77, v77, v41
v_mul_f32 v77, v77, v205
v_mfma_f32_16x16x32_bf16 v[124:127], v[32:35], a[172:175], v[124:127]
buffer_load_dwordx4 v254, s[12:15], s45 offen offset:1024 lds
v_mfma_f32_16x16x32_bf16 v[124:127], v[36:39], a[188:191], v[124:127]
s_waitcnt lgkmcnt(1)
v_mul_f32 v78, v78, v42
v_mul_f32 v78, v78, v206
v_mfma_f32_16x16x32_bf16 v[96:99], v[16:19], a[192:195], v[96:99]
ds_read_b64_tr_b16 v[28:29], v13 offset:12288
v_mul_f32 v43, v43, v79
v_mfma_f32_16x16x32_bf16 v[96:99], v[20:23], a[208:211], v[96:99]
s_waitcnt lgkmcnt(1)
ds_read_b64_tr_b16 v[30:31], v13 offset:14336
v_cvt_pk_bf16_f32 v60, v76, v77
v_mfma_f32_16x16x32_bf16 v[96:99], v[24:27], a[224:227], v[96:99]
ds_read_b64_tr_b16 v[32:33], v13 offset:16384
v_fma_f32 v44, -v92, v92, s47
v_mfma_f32_16x16x32_bf16 v[100:103], v[16:19], a[196:199], v[100:103]
ds_read_b64_tr_b16 v[34:35], v13 offset:18432
v_mul_f32 v44, v44, v92
v_mfma_f32_16x16x32_bf16 v[100:103], v[20:23], a[212:215], v[100:103]
ds_read_b64_tr_b16 v[36:37], v13 offset:20480
v_fma_f32 v45, -v93, v93, s47
v_mfma_f32_16x16x32_bf16 v[100:103], v[24:27], a[228:231], v[100:103]
ds_read_b64_tr_b16 v[38:39], v13 offset:22528
v_mul_f32 v45, v45, v93
v_mfma_f32_16x16x32_bf16 v[104:107], v[16:19], a[200:203], v[104:107]
buffer_load_dwordx4 v255, s[12:15], s45 offen offset:2048 lds
v_mfma_f32_16x16x32_bf16 v[104:107], v[20:23], a[216:219], v[104:107]
v_exp_f32 v43, v43
v_mfma_f32_16x16x32_bf16 v[104:107], v[24:27], a[232:235], v[104:107]
v_exp_f32 v44, v44
v_mfma_f32_16x16x32_bf16 v[108:111], v[16:19], a[204:207], v[108:111]
v_exp_f32 v45, v45
v_mfma_f32_16x16x32_bf16 v[108:111], v[20:23], a[220:223], v[108:111]
v_add_f32 v43, 1.0, v43
v_add_f32 v44, 1.0, v44
v_mfma_f32_16x16x32_bf16 v[108:111], v[24:27], a[236:239], v[108:111]
s_waitcnt lgkmcnt(0)
v_rcp_f32 v43, v43
v_mfma_f32_16x16x32_bf16 v[112:115], v[28:31], a[192:195], v[112:115]
ds_read_b64_tr_b16 v[16:17], v11 offset:24576
v_mul_f32 v79, v79, v43
v_mfma_f32_16x16x32_bf16 v[112:115], v[32:35], a[208:211], v[112:115]
ds_read_b64_tr_b16 v[18:19], v11 offset:26624
v_mul_f32 v79, v79, v207
s_add_u32 m0, s97, 73728
v_mfma_f32_16x16x32_bf16 v[112:115], v[36:39], a[224:227], v[112:115]
s_add_u32 s45, s41, 2654592
buffer_load_dwordx4 v2, s[12:15], s45 offen offset:0 lds
v_mfma_f32_16x16x32_bf16 v[116:119], v[28:31], a[196:199], v[116:119]
ds_read_b64_tr_b16 v[20:21], v11 offset:28672
v_cvt_pk_bf16_f32 v61, v78, v79
v_mfma_f32_16x16x32_bf16 v[116:119], v[32:35], a[212:215], v[116:119]
ds_read_b64_tr_b16 v[22:23], v11 offset:30720
v_add_f32 v45, 1.0, v45
v_mfma_f32_16x16x32_bf16 v[116:119], v[36:39], a[228:231], v[116:119]
ds_read_b64_tr_b16 v[24:25], v11 offset:32768
v_fma_f32 v46, -v94, v94, s47
v_mfma_f32_16x16x32_bf16 v[120:123], v[28:31], a[200:203], v[120:123]
ds_read_b64_tr_b16 v[26:27], v11 offset:34816
v_mul_f32 v46, v46, v94
v_mfma_f32_16x16x32_bf16 v[120:123], v[32:35], a[216:219], v[120:123]
v_rcp_f32 v44, v44
v_mfma_f32_16x16x32_bf16 v[120:123], v[36:39], a[232:235], v[120:123]
v_rcp_f32 v45, v45
v_mfma_f32_16x16x32_bf16 v[124:127], v[28:31], a[204:207], v[124:127]
v_exp_f32 v46, v46
v_mfma_f32_16x16x32_bf16 v[124:127], v[32:35], a[220:223], v[124:127]
buffer_load_dwordx4 v254, s[12:15], s45 offen offset:1024 lds
v_mfma_f32_16x16x32_bf16 v[124:127], v[36:39], a[236:239], v[124:127]
s_waitcnt lgkmcnt(1)
v_mul_f32 v92, v92, v44
v_mul_f32 v92, v92, v220
v_mfma_f32_16x16x32_bf16 v[96:99], v[16:19], a[240:243], v[96:99]
ds_read_b64_tr_b16 v[28:29], v13 offset:24576
v_mul_f32 v93, v93, v45
v_mfma_f32_16x16x32_bf16 v[96:99], v[20:23], v[160:163], v[96:99]
s_waitcnt lgkmcnt(1)
ds_read_b64_tr_b16 v[30:31], v13 offset:26624
v_mul_f32 v93, v93, v221
v_mfma_f32_16x16x32_bf16 v[96:99], v[24:27], v[176:179], v[96:99]
ds_read_b64_tr_b16 v[32:33], v13 offset:28672
v_add_f32 v46, 1.0, v46
v_mfma_f32_16x16x32_bf16 v[100:103], v[16:19], a[244:247], v[100:103]
ds_read_b64_tr_b16 v[34:35], v13 offset:30720
v_fma_f32 v47, -v95, v95, s47
v_mfma_f32_16x16x32_bf16 v[100:103], v[20:23], v[164:167], v[100:103]
ds_read_b64_tr_b16 v[36:37], v13 offset:32768
v_mul_f32 v47, v47, v95
v_mfma_f32_16x16x32_bf16 v[100:103], v[24:27], v[180:183], v[100:103]
ds_read_b64_tr_b16 v[38:39], v13 offset:34816
v_cvt_pk_bf16_f32 v62, v92, v93
v_mfma_f32_16x16x32_bf16 v[104:107], v[16:19], a[248:251], v[104:107]
buffer_load_dwordx4 v255, s[12:15], s45 offen offset:2048 lds
v_mfma_f32_16x16x32_bf16 v[104:107], v[20:23], v[168:171], v[104:107]
v_rcp_f32 v46, v46
v_mfma_f32_16x16x32_bf16 v[104:107], v[24:27], v[184:187], v[104:107]
v_exp_f32 v47, v47
v_mfma_f32_16x16x32_bf16 v[108:111], v[16:19], a[252:255], v[108:111]
v_mul_f32 v94, v94, v46
v_mul_f32 v94, v94, v222
v_mfma_f32_16x16x32_bf16 v[108:111], v[20:23], v[172:175], v[108:111]
v_add_f32 v47, 1.0, v47
s_add_u32 m0, s97, 86016
v_mfma_f32_16x16x32_bf16 v[108:111], v[24:27], v[188:191], v[108:111]
s_waitcnt lgkmcnt(0)
s_waitcnt vmcnt(6)
s_barrier
v_rcp_f32 v47, v47
v_mfma_f32_16x16x32_bf16 v[112:115], v[28:31], a[240:243], v[112:115]
ds_read_b64_tr_b16 v[16:17], v10 offset:0
v_mul_f32 v95, v95, v47
v_mfma_f32_16x16x32_bf16 v[112:115], v[32:35], v[160:163], v[112:115]
ds_read_b64_tr_b16 v[18:19], v10 offset:2048
v_mul_f32 v95, v95, v223
v_mfma_f32_16x16x32_bf16 v[112:115], v[36:39], v[176:179], v[112:115]
s_add_u32 s45, s41, 3539328
buffer_load_dwordx4 v2, s[12:15], s45 offen offset:0 lds
v_mfma_f32_16x16x32_bf16 v[116:119], v[28:31], a[244:247], v[116:119]
ds_read_b64_tr_b16 v[20:21], v10 offset:4096
v_cvt_pk_bf16_f32 v63, v94, v95
v_mfma_f32_16x16x32_bf16 v[116:119], v[32:35], v[164:167], v[116:119]
ds_read_b64_tr_b16 v[22:23], v10 offset:6144
ds_write_b128 v6, v[60:63] offset:19456
v_mfma_f32_16x16x32_bf16 v[116:119], v[36:39], v[180:183], v[116:119]
ds_read_b64_tr_b16 v[24:25], v10 offset:8192
v_mfma_f32_16x16x32_bf16 v[120:123], v[28:31], a[248:251], v[120:123]
ds_read_b64_tr_b16 v[26:27], v10 offset:10240
ds_read_b128 v[192:195], v7 offset:0
v_mfma_f32_16x16x32_bf16 v[120:123], v[32:35], v[168:171], v[120:123]
ds_read_b128 v[196:199], v7 offset:1024
ds_read_b128 v[200:203], v7 offset:2048
v_mfma_f32_16x16x32_bf16 v[120:123], v[36:39], v[184:187], v[120:123]
ds_read_b128 v[204:207], v7 offset:3072
ds_read_b128 v[208:211], v7 offset:4096
v_mfma_f32_16x16x32_bf16 v[124:127], v[28:31], a[252:255], v[124:127]
ds_read_b128 v[212:215], v7 offset:5120
ds_read_b128 v[216:219], v7 offset:6144
v_mfma_f32_16x16x32_bf16 v[124:127], v[32:35], v[172:175], v[124:127]
buffer_load_dwordx4 v254, s[12:15], s45 offen offset:1024 lds
v_mfma_f32_16x16x32_bf16 v[124:127], v[36:39], v[188:191], v[124:127]
s_waitcnt lgkmcnt(8)
ds_read_b128 v[220:223], v7 offset:7168
ds_read_b128 v[224:227], v7 offset:8192
v_mfma_f32_16x16x32_bf16 v[128:131], v[16:19], a[0:3], 0
ds_read_b64_tr_b16 v[28:29], v12 offset:0
ds_read_b128 v[228:231], v7 offset:9216
v_mfma_f32_16x16x32_bf16 v[128:131], v[20:23], a[16:19], v[128:131]
s_waitcnt lgkmcnt(8)
ds_read_b64_tr_b16 v[30:31], v12 offset:2048
ds_read_b128 v[232:235], v7 offset:10240
v_mfma_f32_16x16x32_bf16 v[128:131], v[24:27], a[32:35], v[128:131]
ds_read_b64_tr_b16 v[32:33], v12 offset:4096
ds_read_b128 v[236:239], v7 offset:11264
v_mfma_f32_16x16x32_bf16 v[132:135], v[16:19], a[4:7], 0
ds_read_b64_tr_b16 v[34:35], v12 offset:6144
v_fma_f32 v240, -v96, v96, s47
v_mfma_f32_16x16x32_bf16 v[132:135], v[20:23], a[20:23], v[132:135]
ds_read_b64_tr_b16 v[36:37], v12 offset:8192
v_mul_f32 v240, v240, v96
v_mfma_f32_16x16x32_bf16 v[132:135], v[24:27], a[36:39], v[132:135]
ds_read_b64_tr_b16 v[38:39], v12 offset:10240
v_fma_f32 v241, -v97, v97, s47
v_mfma_f32_16x16x32_bf16 v[136:139], v[16:19], a[8:11], 0
buffer_load_dwordx4 v255, s[12:15], s45 offen offset:2048 lds
v_mfma_f32_16x16x32_bf16 v[136:139], v[20:23], a[24:27], v[136:139]
v_exp_f32 v240, v240
v_mfma_f32_16x16x32_bf16 v[136:139], v[24:27], a[40:43], v[136:139]
v_add_f32 v240, 1.0, v240
v_mul_f32 v241, v241, v97
v_mfma_f32_16x16x32_bf16 v[140:143], v[16:19], a[12:15], 0
v_rcp_f32 v240, v240
v_mfma_f32_16x16x32_bf16 v[140:143], v[20:23], a[28:31], v[140:143]
v_exp_f32 v241, v241
v_mfma_f32_16x16x32_bf16 v[140:143], v[24:27], a[44:47], v[140:143]
s_waitcnt lgkmcnt(0)
v_mul_f32 v96, v96, v240
v_add_f32 v241, 1.0, v241
v_mfma_f32_16x16x32_bf16 v[144:147], v[28:31], a[0:3], 0
ds_read_b64_tr_b16 v[16:17], v10 offset:12288
v_fma_f32 v242, -v98, v98, s47
v_mfma_f32_16x16x32_bf16 v[144:147], v[32:35], a[16:19], v[144:147]
ds_read_b64_tr_b16 v[18:19], v10 offset:14336
v_mul_f32 v242, v242, v98
s_add_u32 m0, s97, 98304
v_mfma_f32_16x16x32_bf16 v[144:147], v[36:39], a[32:35], v[144:147]
s_add_u32 s45, s41, 4424064
buffer_load_dwordx4 v2, s[12:15], s45 offen offset:0 lds
v_mfma_f32_16x16x32_bf16 v[148:151], v[28:31], a[4:7], 0
ds_read_b64_tr_b16 v[20:21], v10 offset:16384
v_fma_f32 v243, -v99, v99, s47
v_mfma_f32_16x16x32_bf16 v[148:151], v[32:35], a[20:23], v[148:151]
ds_read_b64_tr_b16 v[22:23], v10 offset:18432
v_mul_f32 v243, v243, v99
v_mfma_f32_16x16x32_bf16 v[148:151], v[36:39], a[36:39], v[148:151]
ds_read_b64_tr_b16 v[24:25], v10 offset:20480
v_fma_f32 v244, -v112, v112, s47
v_mfma_f32_16x16x32_bf16 v[152:155], v[28:31], a[8:11], 0
ds_read_b64_tr_b16 v[26:27], v10 offset:22528
v_mul_f32 v244, v244, v112
v_mfma_f32_16x16x32_bf16 v[152:155], v[32:35], a[24:27], v[152:155]
v_rcp_f32 v241, v241
v_mfma_f32_16x16x32_bf16 v[152:155], v[36:39], a[40:43], v[152:155]
v_exp_f32 v242, v242
v_mfma_f32_16x16x32_bf16 v[156:159], v[28:31], a[12:15], 0
v_exp_f32 v243, v243
v_mfma_f32_16x16x32_bf16 v[156:159], v[32:35], a[28:31], v[156:159]
buffer_load_dwordx4 v254, s[12:15], s45 offen offset:1024 lds
v_mfma_f32_16x16x32_bf16 v[156:159], v[36:39], a[44:47], v[156:159]
s_waitcnt lgkmcnt(1)
v_exp_f32 v244, v244
v_mfma_f32_16x16x32_bf16 v[128:131], v[16:19], a[48:51], v[128:131]
ds_read_b64_tr_b16 v[28:29], v12 offset:12288
v_mul_f32 v97, v97, v241
v_mfma_f32_16x16x32_bf16 v[128:131], v[20:23], a[64:67], v[128:131]
s_waitcnt lgkmcnt(1)
ds_read_b64_tr_b16 v[30:31], v12 offset:14336
v_add_f32 v242, 1.0, v242
v_mfma_f32_16x16x32_bf16 v[128:131], v[24:27], a[80:83], v[128:131]
ds_read_b64_tr_b16 v[32:33], v12 offset:16384
v_add_f32 v243, 1.0, v243
v_mfma_f32_16x16x32_bf16 v[132:135], v[16:19], a[52:55], v[132:135]
ds_read_b64_tr_b16 v[34:35], v12 offset:18432
v_add_f32 v244, 1.0, v244
v_mfma_f32_16x16x32_bf16 v[132:135], v[20:23], a[68:71], v[132:135]
ds_read_b64_tr_b16 v[36:37], v12 offset:20480
v_fma_f32 v245, -v113, v113, s47
v_mfma_f32_16x16x32_bf16 v[132:135], v[24:27], a[84:87], v[132:135]
ds_read_b64_tr_b16 v[38:39], v12 offset:22528
v_mul_f32 v245, v245, v113
v_mfma_f32_16x16x32_bf16 v[136:139], v[16:19], a[56:59], v[136:139]
buffer_load_dwordx4 v255, s[12:15], s45 offen offset:2048 lds
v_mfma_f32_16x16x32_bf16 v[136:139], v[20:23], a[72:75], v[136:139]
v_rcp_f32 v242, v242
v_mfma_f32_16x16x32_bf16 v[136:139], v[24:27], a[88:91], v[136:139]
v_rcp_f32 v243, v243
v_mfma_f32_16x16x32_bf16 v[140:143], v[16:19], a[60:63], v[140:143]
v_rcp_f32 v244, v244
v_mfma_f32_16x16x32_bf16 v[140:143], v[20:23], a[76:79], v[140:143]
v_exp_f32 v245, v245
v_mfma_f32_16x16x32_bf16 v[140:143], v[24:27], a[92:95], v[140:143]
s_waitcnt lgkmcnt(0)
s_waitcnt vmcnt(6)
s_barrier
v_mul_f32 v98, v98, v242
v_mul_f32 v99, v99, v243
v_mfma_f32_16x16x32_bf16 v[144:147], v[28:31], a[48:51], v[144:147]
ds_read_b64_tr_b16 v[16:17], v10 offset:24576
v_mul_f32 v112, v112, v244
v_mfma_f32_16x16x32_bf16 v[144:147], v[32:35], a[64:67], v[144:147]
ds_read_b64_tr_b16 v[18:19], v10 offset:26624
v_add_f32 v245, 1.0, v245
s_add_u32 m0, s40, 36864
v_mfma_f32_16x16x32_bf16 v[144:147], v[36:39], a[80:83], v[144:147]
s_add_u32 s45, s42, 0
buffer_load_dwordx4 v4, s[8:11], s45 offen lds
v_mfma_f32_16x16x32_bf16 v[148:151], v[28:31], a[52:55], v[148:151]
ds_read_b64_tr_b16 v[20:21], v10 offset:28672
v_fma_f32 v246, -v114, v114, s47
v_mfma_f32_16x16x32_bf16 v[148:151], v[32:35], a[68:71], v[148:151]
ds_read_b64_tr_b16 v[22:23], v10 offset:30720
v_mul_f32 v246, v246, v114
v_mfma_f32_16x16x32_bf16 v[148:151], v[36:39], a[84:87], v[148:151]
ds_read_b64_tr_b16 v[24:25], v10 offset:32768
v_fma_f32 v247, -v115, v115, s47
v_mfma_f32_16x16x32_bf16 v[152:155], v[28:31], a[56:59], v[152:155]
ds_read_b64_tr_b16 v[26:27], v10 offset:34816
v_mul_f32 v247, v247, v115
v_mfma_f32_16x16x32_bf16 v[152:155], v[32:35], a[72:75], v[152:155]
v_rcp_f32 v245, v245
v_mfma_f32_16x16x32_bf16 v[152:155], v[36:39], a[88:91], v[152:155]
v_exp_f32 v246, v246
v_mfma_f32_16x16x32_bf16 v[156:159], v[28:31], a[60:63], v[156:159]
v_exp_f32 v247, v247
s_add_u32 m0, s40, 40960
v_mfma_f32_16x16x32_bf16 v[156:159], v[32:35], a[76:79], v[156:159]
s_add_u32 s45, s42, 589824
buffer_load_dwordx4 v4, s[8:11], s45 offen lds
v_mfma_f32_16x16x32_bf16 v[156:159], v[36:39], a[92:95], v[156:159]
s_waitcnt lgkmcnt(1)
v_mul_f32 v113, v113, v245
v_add_f32 v246, 1.0, v246
v_mfma_f32_16x16x32_bf16 v[128:131], v[16:19], a[96:99], v[128:131]
ds_read_b64_tr_b16 v[28:29], v12 offset:24576
v_add_f32 v247, 1.0, v247
v_mfma_f32_16x16x32_bf16 v[128:131], v[20:23], a[112:115], v[128:131]
s_waitcnt lgkmcnt(1)
ds_read_b64_tr_b16 v[30:31], v12 offset:26624
v_fma_f32 v248, -v100, v100, s47
v_mfma_f32_16x16x32_bf16 v[128:131], v[24:27], a[128:131], v[128:131]
ds_read_b64_tr_b16 v[32:33], v12 offset:28672
v_mul_f32 v248, v248, v100
v_mfma_f32_16x16x32_bf16 v[132:135], v[16:19], a[100:103], v[132:135]
ds_read_b64_tr_b16 v[34:35], v12 offset:30720
v_fma_f32 v249, -v101, v101, s47
v_mfma_f32_16x16x32_bf16 v[132:135], v[20:23], a[116:119], v[132:135]
ds_read_b64_tr_b16 v[36:37], v12 offset:32768
v_mul_f32 v249, v249, v101
v_mfma_f32_16x16x32_bf16 v[132:135], v[24:27], a[132:135], v[132:135]
ds_read_b64_tr_b16 v[38:39], v12 offset:34816
v_fma_f32 v250, -v102, v102, s47
s_add_u32 m0, s40, 45056
v_mfma_f32_16x16x32_bf16 v[136:139], v[16:19], a[104:107], v[136:139]
s_add_u32 s45, s42, 1179648
buffer_load_dwordx4 v4, s[8:11], s45 offen lds
v_mfma_f32_16x16x32_bf16 v[136:139], v[20:23], a[120:123], v[136:139]
v_rcp_f32 v246, v246
v_mfma_f32_16x16x32_bf16 v[136:139], v[24:27], a[136:139], v[136:139]
v_rcp_f32 v247, v247
v_mfma_f32_16x16x32_bf16 v[140:143], v[16:19], a[108:111], v[140:143]
v_exp_f32 v248, v248
v_mfma_f32_16x16x32_bf16 v[140:143], v[20:23], a[124:127], v[140:143]
v_exp_f32 v249, v249
v_mfma_f32_16x16x32_bf16 v[140:143], v[24:27], a[140:143], v[140:143]
s_waitcnt lgkmcnt(0)
v_mul_f32 v114, v114, v246
v_mul_f32 v115, v115, v247
v_mfma_f32_16x16x32_bf16 v[144:147], v[28:31], a[96:99], v[144:147]
ds_read_b64_tr_b16 v[16:17], v11 offset:0
v_add_f32 v248, 1.0, v248
v_mfma_f32_16x16x32_bf16 v[144:147], v[32:35], a[112:115], v[144:147]
ds_read_b64_tr_b16 v[18:19], v11 offset:2048
v_add_f32 v249, 1.0, v249
s_add_u32 m0, s40, 49152
v_mfma_f32_16x16x32_bf16 v[144:147], v[36:39], a[128:131], v[144:147]
s_add_u32 s45, s42, 1769472
buffer_load_dwordx4 v4, s[8:11], s45 offen lds
v_mfma_f32_16x16x32_bf16 v[148:151], v[28:31], a[100:103], v[148:151]
ds_read_b64_tr_b16 v[20:21], v11 offset:4096
v_mul_f32 v250, v250, v102
v_mfma_f32_16x16x32_bf16 v[148:151], v[32:35], a[116:119], v[148:151]
ds_read_b64_tr_b16 v[22:23], v11 offset:6144
v_fma_f32 v251, -v103, v103, s47
v_mfma_f32_16x16x32_bf16 v[148:151], v[36:39], a[132:135], v[148:151]
ds_read_b64_tr_b16 v[24:25], v11 offset:8192
v_mul_f32 v251, v251, v103
v_mfma_f32_16x16x32_bf16 v[152:155], v[28:31], a[104:107], v[152:155]
ds_read_b64_tr_b16 v[26:27], v11 offset:10240
v_fma_f32 v252, -v116, v116, s47
v_mfma_f32_16x16x32_bf16 v[152:155], v[32:35], a[120:123], v[152:155]
v_rcp_f32 v248, v248
v_mfma_f32_16x16x32_bf16 v[152:155], v[36:39], a[136:139], v[152:155]
v_rcp_f32 v249, v249
v_mfma_f32_16x16x32_bf16 v[156:159], v[28:31], a[108:111], v[156:159]
v_exp_f32 v250, v250
s_add_u32 m0, s40, 53248
v_mfma_f32_16x16x32_bf16 v[156:159], v[32:35], a[124:127], v[156:159]
s_add_u32 s45, s42, 2359296
buffer_load_dwordx4 v4, s[8:11], s45 offen lds
v_mfma_f32_16x16x32_bf16 v[156:159], v[36:39], a[140:143], v[156:159]
s_waitcnt lgkmcnt(1)
v_exp_f32 v251, v251
v_mfma_f32_16x16x32_bf16 v[128:131], v[16:19], a[144:147], v[128:131]
ds_read_b64_tr_b16 v[28:29], v13 offset:0
v_mul_f32 v100, v100, v248
v_mfma_f32_16x16x32_bf16 v[128:131], v[20:23], a[160:163], v[128:131]
s_waitcnt lgkmcnt(1)
ds_read_b64_tr_b16 v[30:31], v13 offset:2048
v_mul_f32 v101, v101, v249
v_mfma_f32_16x16x32_bf16 v[128:131], v[24:27], a[176:179], v[128:131]
ds_read_b64_tr_b16 v[32:33], v13 offset:4096
v_add_f32 v250, 1.0, v250
v_mfma_f32_16x16x32_bf16 v[132:135], v[16:19], a[148:151], v[132:135]
ds_read_b64_tr_b16 v[34:35], v13 offset:6144
v_add_f32 v251, 1.0, v251
v_mfma_f32_16x16x32_bf16 v[132:135], v[20:23], a[164:167], v[132:135]
ds_read_b64_tr_b16 v[36:37], v13 offset:8192
v_mul_f32 v252, v252, v116
v_mfma_f32_16x16x32_bf16 v[132:135], v[24:27], a[180:183], v[132:135]
ds_read_b64_tr_b16 v[38:39], v13 offset:10240
v_fma_f32 v253, -v117, v117, s47
s_add_u32 m0, s40, 57344
v_mfma_f32_16x16x32_bf16 v[136:139], v[16:19], a[152:155], v[136:139]
s_add_u32 s45, s42, 2949120
buffer_load_dwordx4 v4, s[8:11], s45 offen lds
v_mfma_f32_16x16x32_bf16 v[136:139], v[20:23], a[168:171], v[136:139]
v_rcp_f32 v250, v250
v_mfma_f32_16x16x32_bf16 v[136:139], v[24:27], a[184:187], v[136:139]
v_rcp_f32 v251, v251
v_mfma_f32_16x16x32_bf16 v[140:143], v[16:19], a[156:159], v[140:143]
v_exp_f32 v252, v252
v_mfma_f32_16x16x32_bf16 v[140:143], v[20:23], a[172:175], v[140:143]
v_mul_f32 v102, v102, v250
v_mul_f32 v103, v103, v251
v_mfma_f32_16x16x32_bf16 v[140:143], v[24:27], a[188:191], v[140:143]
s_waitcnt lgkmcnt(0)
s_waitcnt vmcnt(6)
s_barrier
v_add_f32 v252, 1.0, v252
v_mul_f32 v253, v253, v117
v_mfma_f32_16x16x32_bf16 v[144:147], v[28:31], a[144:147], v[144:147]
ds_read_b64_tr_b16 v[16:17], v11 offset:12288
v_fma_f32 v40, -v118, v118, s47
v_mfma_f32_16x16x32_bf16 v[144:147], v[32:35], a[160:163], v[144:147]
ds_read_b64_tr_b16 v[18:19], v11 offset:14336
v_mul_f32 v40, v40, v118
s_add_u32 m0, s40, 61440
v_mfma_f32_16x16x32_bf16 v[144:147], v[36:39], a[176:179], v[144:147]
s_add_u32 s45, s42, 3538944
buffer_load_dwordx4 v4, s[8:11], s45 offen lds
v_mfma_f32_16x16x32_bf16 v[148:151], v[28:31], a[148:151], v[148:151]
ds_read_b64_tr_b16 v[20:21], v11 offset:16384
v_fma_f32 v41, -v119, v119, s47
v_mfma_f32_16x16x32_bf16 v[148:151], v[32:35], a[164:167], v[148:151]
ds_read_b64_tr_b16 v[22:23], v11 offset:18432
v_mul_f32 v41, v41, v119
v_mfma_f32_16x16x32_bf16 v[148:151], v[36:39], a[180:183], v[148:151]
ds_read_b64_tr_b16 v[24:25], v11 offset:20480
v_fma_f32 v42, -v104, v104, s47
v_mfma_f32_16x16x32_bf16 v[152:155], v[28:31], a[152:155], v[152:155]
ds_read_b64_tr_b16 v[26:27], v11 offset:22528
v_mul_f32 v42, v42, v104
v_mfma_f32_16x16x32_bf16 v[152:155], v[32:35], a[168:171], v[152:155]
v_rcp_f32 v252, v252
v_mfma_f32_16x16x32_bf16 v[152:155], v[36:39], a[184:187], v[152:155]
v_exp_f32 v253, v253
v_mfma_f32_16x16x32_bf16 v[156:159], v[28:31], a[156:159], v[156:159]
v_exp_f32 v40, v40
s_add_u32 m0, s40, 65536
v_mfma_f32_16x16x32_bf16 v[156:159], v[32:35], a[172:175], v[156:159]
s_add_u32 s45, s42, 4128768
buffer_load_dwordx4 v4, s[8:11], s45 offen lds
v_mfma_f32_16x16x32_bf16 v[156:159], v[36:39], a[188:191], v[156:159]
s_waitcnt lgkmcnt(1)
v_exp_f32 v41, v41
v_mfma_f32_16x16x32_bf16 v[128:131], v[16:19], a[192:195], v[128:131]
ds_read_b64_tr_b16 v[28:29], v13 offset:12288
v_mul_f32 v116, v116, v252
v_mfma_f32_16x16x32_bf16 v[128:131], v[20:23], a[208:211], v[128:131]
s_waitcnt lgkmcnt(1)
ds_read_b64_tr_b16 v[30:31], v13 offset:14336
v_add_f32 v253, 1.0, v253
v_mfma_f32_16x16x32_bf16 v[128:131], v[24:27], a[224:227], v[128:131]
ds_read_b64_tr_b16 v[32:33], v13 offset:16384
v_add_f32 v40, 1.0, v40
v_mfma_f32_16x16x32_bf16 v[132:135], v[16:19], a[196:199], v[132:135]
ds_read_b64_tr_b16 v[34:35], v13 offset:18432
v_add_f32 v41, 1.0, v41
v_mfma_f32_16x16x32_bf16 v[132:135], v[20:23], a[212:215], v[132:135]
ds_read_b64_tr_b16 v[36:37], v13 offset:20480
v_fma_f32 v43, -v105, v105, s47
v_mfma_f32_16x16x32_bf16 v[132:135], v[24:27], a[228:231], v[132:135]
ds_read_b64_tr_b16 v[38:39], v13 offset:22528
v_mul_f32 v43, v43, v105
s_add_u32 m0, s40, 69632
v_mfma_f32_16x16x32_bf16 v[136:139], v[16:19], a[200:203], v[136:139]
s_add_u32 s45, s42, 4718592
buffer_load_dwordx4 v4, s[8:11], s45 offen lds
v_mfma_f32_16x16x32_bf16 v[136:139], v[20:23], a[216:219], v[136:139]
v_rcp_f32 v253, v253
v_mfma_f32_16x16x32_bf16 v[136:139], v[24:27], a[232:235], v[136:139]
v_rcp_f32 v40, v40
v_mfma_f32_16x16x32_bf16 v[140:143], v[16:19], a[204:207], v[140:143]
v_rcp_f32 v41, v41
v_mfma_f32_16x16x32_bf16 v[140:143], v[20:23], a[220:223], v[140:143]
v_exp_f32 v42, v42
v_mfma_f32_16x16x32_bf16 v[140:143], v[24:27], a[236:239], v[140:143]
s_waitcnt lgkmcnt(0)
v_exp_f32 v43, v43
v_mfma_f32_16x16x32_bf16 v[144:147], v[28:31], a[192:195], v[144:147]
ds_read_b64_tr_b16 v[16:17], v11 offset:24576
v_mul_f32 v117, v117, v253
v_mfma_f32_16x16x32_bf16 v[144:147], v[32:35], a[208:211], v[144:147]
ds_read_b64_tr_b16 v[18:19], v11 offset:26624
v_mul_f32 v118, v118, v40
s_add_u32 m0, s40, 73728
v_mfma_f32_16x16x32_bf16 v[144:147], v[36:39], a[224:227], v[144:147]
s_add_u32 s45, s42, 0
buffer_load_dwordx4 v4, s[12:15], s45 offen lds
v_mfma_f32_16x16x32_bf16 v[148:151], v[28:31], a[196:199], v[148:151]
ds_read_b64_tr_b16 v[20:21], v11 offset:28672
v_mul_f32 v119, v119, v41
v_mfma_f32_16x16x32_bf16 v[148:151], v[32:35], a[212:215], v[148:151]
ds_read_b64_tr_b16 v[22:23], v11 offset:30720
v_add_f32 v42, 1.0, v42
v_mfma_f32_16x16x32_bf16 v[148:151], v[36:39], a[228:231], v[148:151]
ds_read_b64_tr_b16 v[24:25], v11 offset:32768
v_add_f32 v43, 1.0, v43
v_mfma_f32_16x16x32_bf16 v[152:155], v[28:31], a[200:203], v[152:155]
ds_read_b64_tr_b16 v[26:27], v11 offset:34816
v_fma_f32 v44, -v106, v106, s47
v_mfma_f32_16x16x32_bf16 v[152:155], v[32:35], a[216:219], v[152:155]
v_rcp_f32 v42, v42
v_mfma_f32_16x16x32_bf16 v[152:155], v[36:39], a[232:235], v[152:155]
v_rcp_f32 v43, v43
v_mfma_f32_16x16x32_bf16 v[156:159], v[28:31], a[204:207], v[156:159]
v_mul_f32 v104, v104, v42
v_mul_f32 v105, v105, v43
s_add_u32 m0, s40, 77824
v_mfma_f32_16x16x32_bf16 v[156:159], v[32:35], a[220:223], v[156:159]
s_add_u32 s45, s42, 589824
buffer_load_dwordx4 v4, s[12:15], s45 offen lds
v_mfma_f32_16x16x32_bf16 v[156:159], v[36:39], a[236:239], v[156:159]
s_waitcnt lgkmcnt(1)
v_mul_f32 v44, v44, v106
v_fma_f32 v45, -v107, v107, s47
v_mfma_f32_16x16x32_bf16 v[128:131], v[16:19], a[240:243], v[128:131]
ds_read_b64_tr_b16 v[28:29], v13 offset:24576
v_mul_f32 v45, v45, v107
v_mfma_f32_16x16x32_bf16 v[128:131], v[20:23], v[160:163], v[128:131]
s_waitcnt lgkmcnt(1)
ds_read_b64_tr_b16 v[30:31], v13 offset:26624
v_fma_f32 v46, -v120, v120, s47
v_mfma_f32_16x16x32_bf16 v[128:131], v[24:27], v[176:179], v[128:131]
ds_read_b64_tr_b16 v[32:33], v13 offset:28672
v_mul_f32 v46, v46, v120
v_mfma_f32_16x16x32_bf16 v[132:135], v[16:19], a[244:247], v[132:135]
ds_read_b64_tr_b16 v[34:35], v13 offset:30720
v_fma_f32 v47, -v121, v121, s47
v_mfma_f32_16x16x32_bf16 v[132:135], v[20:23], v[164:167], v[132:135]
ds_read_b64_tr_b16 v[36:37], v13 offset:32768
v_mul_f32 v47, v47, v121
v_mfma_f32_16x16x32_bf16 v[132:135], v[24:27], v[180:183], v[132:135]
ds_read_b64_tr_b16 v[38:39], v13 offset:34816
v_fma_f32 v240, -v122, v122, s47
s_add_u32 m0, s40, 81920
v_mfma_f32_16x16x32_bf16 v[136:139], v[16:19], a[248:251], v[136:139]
s_add_u32 s45, s42, 1179648
buffer_load_dwordx4 v4, s[12:15], s45 offen lds
v_mfma_f32_16x16x32_bf16 v[136:139], v[20:23], v[168:171], v[136:139]
v_exp_f32 v44, v44
v_mfma_f32_16x16x32_bf16 v[136:139], v[24:27], v[184:187], v[136:139]
v_exp_f32 v45, v45
v_mfma_f32_16x16x32_bf16 v[140:143], v[16:19], a[252:255], v[140:143]
v_exp_f32 v46, v46
v_mfma_f32_16x16x32_bf16 v[140:143], v[20:23], v[172:175], v[140:143]
v_exp_f32 v47, v47
v_mfma_f32_16x16x32_bf16 v[140:143], v[24:27], v[188:191], v[140:143]
s_waitcnt lgkmcnt(0)
s_waitcnt vmcnt(6)
s_barrier
v_add_f32 v44, 1.0, v44
v_add_f32 v45, 1.0, v45
v_mfma_f32_16x16x32_bf16 v[144:147], v[28:31], a[240:243], v[144:147]
ds_read_b64_tr_b16 v[16:17], v14 offset:0
v_add_f32 v46, 1.0, v46
v_mfma_f32_16x16x32_bf16 v[144:147], v[32:35], v[160:163], v[144:147]
ds_read_b64_tr_b16 v[18:19], v14 offset:1024
v_add_f32 v47, 1.0, v47
s_add_u32 m0, s40, 86016
v_mfma_f32_16x16x32_bf16 v[144:147], v[36:39], v[176:179], v[144:147]
s_add_u32 s45, s42, 1769472
buffer_load_dwordx4 v4, s[12:15], s45 offen lds
v_mfma_f32_16x16x32_bf16 v[148:151], v[28:31], a[244:247], v[148:151]
ds_read_b64_tr_b16 v[20:21], v14 offset:2048
v_mul_f32 v240, v240, v122
v_mfma_f32_16x16x32_bf16 v[148:151], v[32:35], v[164:167], v[148:151]
ds_read_b64_tr_b16 v[22:23], v14 offset:3072
v_fma_f32 v241, -v123, v123, s47
v_mfma_f32_16x16x32_bf16 v[148:151], v[36:39], v[180:183], v[148:151]
ds_read_b64_tr_b16 v[24:25], v14 offset:4096
v_mul_f32 v241, v241, v123
v_mfma_f32_16x16x32_bf16 v[152:155], v[28:31], a[248:251], v[152:155]
ds_read_b64_tr_b16 v[26:27], v14 offset:5120
v_fma_f32 v242, -v108, v108, s47
v_mfma_f32_16x16x32_bf16 v[152:155], v[32:35], v[168:171], v[152:155]
v_rcp_f32 v44, v44
v_mfma_f32_16x16x32_bf16 v[152:155], v[36:39], v[184:187], v[152:155]
v_rcp_f32 v45, v45
v_mfma_f32_16x16x32_bf16 v[156:159], v[28:31], a[252:255], v[156:159]
v_rcp_f32 v46, v46
s_add_u32 m0, s40, 90112
v_mfma_f32_16x16x32_bf16 v[156:159], v[32:35], v[172:175], v[156:159]
s_add_u32 s45, s42, 2359296
buffer_load_dwordx4 v4, s[12:15], s45 offen lds
v_mfma_f32_16x16x32_bf16 v[156:159], v[36:39], v[188:191], v[156:159]
s_waitcnt lgkmcnt(1)
v_rcp_f32 v47, v47
v_mfma_f32_16x16x32_bf16 v[64:67], v[16:19], a[0:3], 0
ds_read_b64_tr_b16 v[28:29], v14 offset:6144
v_mul_f32 v106, v106, v44
v_mfma_f32_16x16x32_bf16 v[64:67], v[20:23], a[16:19], v[64:67]
s_waitcnt lgkmcnt(1)
ds_read_b64_tr_b16 v[30:31], v14 offset:7168
v_mul_f32 v107, v107, v45
v_mfma_f32_16x16x32_bf16 v[64:67], v[24:27], a[32:35], v[64:67]
ds_read_b64_tr_b16 v[32:33], v14 offset:8192
v_mul_f32 v120, v120, v46
v_mfma_f32_16x16x32_bf16 v[68:71], v[16:19], a[4:7], 0
ds_read_b64_tr_b16 v[34:35], v14 offset:9216
v_mul_f32 v96, v96, v128
v_mfma_f32_16x16x32_bf16 v[68:71], v[20:23], a[20:23], v[68:71]
ds_read_b64_tr_b16 v[36:37], v14 offset:10240
v_mul_f32 v97, v97, v129
v_mfma_f32_16x16x32_bf16 v[68:71], v[24:27], a[36:39], v[68:71]
ds_read_b64_tr_b16 v[38:39], v14 offset:11264
v_mul_f32 v98, v98, v130
s_add_u32 m0, s40, 94208
v_mfma_f32_16x16x32_bf16 v[72:75], v[16:19], a[8:11], 0
s_add_u32 s45, s42, 2949120
buffer_load_dwordx4 v4, s[12:15], s45 offen lds
v_mfma_f32_16x16x32_bf16 v[72:75], v[20:23], a[24:27], v[72:75]
v_exp_f32 v240, v240
v_mfma_f32_16x16x32_bf16 v[72:75], v[24:27], a[40:43], v[72:75]
v_exp_f32 v241, v241
v_mfma_f32_16x16x32_bf16 v[76:79], v[16:19], a[12:15], 0
v_mul_f32 v99, v99, v131
v_cvt_pk_bf16_f32 v48, v96, v97
v_mfma_f32_16x16x32_bf16 v[76:79], v[20:23], a[28:31], v[76:79]
v_cvt_pk_bf16_f32 v49, v98, v99
v_mul_f32 v112, v112, v144
v_mfma_f32_16x16x32_bf16 v[76:79], v[24:27], a[44:47], v[76:79]
s_waitcnt lgkmcnt(0)
v_mul_f32 v113, v113, v145
v_mul_f32 v114, v114, v146
v_mfma_f32_16x16x32_bf16 v[64:67], v[28:31], a[48:51], v[64:67]
ds_read_b64_tr_b16 v[16:17], v14 offset:12288
v_mul_f32 v115, v115, v147
v_mfma_f32_16x16x32_bf16 v[64:67], v[32:35], a[64:67], v[64:67]
ds_read_b64_tr_b16 v[18:19], v14 offset:13312
v_cvt_pk_bf16_f32 v50, v112, v113
s_add_u32 m0, s40, 98304
v_mfma_f32_16x16x32_bf16 v[64:67], v[36:39], a[80:83], v[64:67]
s_add_u32 s45, s42, 3538944
buffer_load_dwordx4 v4, s[12:15], s45 offen lds
v_mfma_f32_16x16x32_bf16 v[68:71], v[28:31], a[52:55], v[68:71]
ds_read_b64_tr_b16 v[20:21], v14 offset:14336
v_cvt_pk_bf16_f32 v51, v114, v115
v_mfma_f32_16x16x32_bf16 v[68:71], v[32:35], a[68:71], v[68:71]
ds_read_b64_tr_b16 v[22:23], v14 offset:15360
ds_write_b128 v6, v[48:51] offset:24576
v_mfma_f32_16x16x32_bf16 v[68:71], v[36:39], a[84:87], v[68:71]
ds_read_b64_tr_b16 v[24:25], v14 offset:16384
v_mul_f32 v100, v100, v132
v_mfma_f32_16x16x32_bf16 v[72:75], v[28:31], a[56:59], v[72:75]
ds_read_b64_tr_b16 v[26:27], v14 offset:17408
v_mul_f32 v101, v101, v133
v_mfma_f32_16x16x32_bf16 v[72:75], v[32:35], a[72:75], v[72:75]
v_mul_f32 v102, v102, v134
v_mul_f32 v103, v103, v135
v_mfma_f32_16x16x32_bf16 v[72:75], v[36:39], a[88:91], v[72:75]
v_cvt_pk_bf16_f32 v52, v100, v101
v_cvt_pk_bf16_f32 v53, v102, v103
v_mfma_f32_16x16x32_bf16 v[76:79], v[28:31], a[60:63], v[76:79]
v_mul_f32 v116, v116, v148
v_mul_f32 v117, v117, v149
s_add_u32 m0, s40, 102400
v_mfma_f32_16x16x32_bf16 v[76:79], v[32:35], a[76:79], v[76:79]
s_add_u32 s45, s42, 4128768
buffer_load_dwordx4 v4, s[12:15], s45 offen lds
v_mfma_f32_16x16x32_bf16 v[76:79], v[36:39], a[92:95], v[76:79]
s_waitcnt lgkmcnt(1)
v_mul_f32 v118, v118, v150
v_mul_f32 v119, v119, v151
v_mfma_f32_16x16x32_bf16 v[64:67], v[16:19], a[96:99], v[64:67]
ds_read_b64_tr_b16 v[28:29], v14 offset:18432
v_cvt_pk_bf16_f32 v54, v116, v117
v_mfma_f32_16x16x32_bf16 v[64:67], v[20:23], a[112:115], v[64:67]
s_waitcnt lgkmcnt(1)
ds_read_b64_tr_b16 v[30:31], v14 offset:19456
v_cvt_pk_bf16_f32 v55, v118, v119
v_mfma_f32_16x16x32_bf16 v[64:67], v[24:27], a[128:131], v[64:67]
ds_read_b64_tr_b16 v[32:33], v14 offset:20480
ds_write_b128 v6, v[52:55] offset:25600
v_mfma_f32_16x16x32_bf16 v[68:71], v[16:19], a[100:103], v[68:71]
ds_read_b64_tr_b16 v[34:35], v14 offset:21504
v_mul_f32 v104, v104, v136
v_mfma_f32_16x16x32_bf16 v[68:71], v[20:23], a[116:119], v[68:71]
ds_read_b64_tr_b16 v[36:37], v14 offset:22528
v_mul_f32 v105, v105, v137
v_mfma_f32_16x16x32_bf16 v[68:71], v[24:27], a[132:135], v[68:71]
ds_read_b64_tr_b16 v[38:39], v14 offset:23552
v_mul_f32 v106, v106, v138
s_add_u32 m0, s40, 106496
v_mfma_f32_16x16x32_bf16 v[72:75], v[16:19], a[104:107], v[72:75]
s_add_u32 s45, s42, 4718592
buffer_load_dwordx4 v4, s[12:15], s45 offen lds
v_mfma_f32_16x16x32_bf16 v[72:75], v[20:23], a[120:123], v[72:75]
v_add_u32 v2, 8192, v3
v_add_u32 v4, 16384, v3
v_mfma_f32_16x16x32_bf16 v[72:75], v[24:27], a[136:139], v[72:75]
v_mul_f32 v107, v107, v139
v_cvt_pk_bf16_f32 v56, v104, v105
v_mfma_f32_16x16x32_bf16 v[76:79], v[16:19], a[108:111], v[76:79]
v_cvt_pk_bf16_f32 v57, v106, v107
v_mul_f32 v120, v120, v152
v_mfma_f32_16x16x32_bf16 v[76:79], v[20:23], a[124:127], v[76:79]
v_mul_f32 v121, v121, v47
v_mul_f32 v121, v121, v153
v_mfma_f32_16x16x32_bf16 v[76:79], v[24:27], a[140:143], v[76:79]
s_waitcnt lgkmcnt(0)
s_waitcnt vmcnt(6)
s_barrier
v_add_f32 v240, 1.0, v240
v_add_f32 v241, 1.0, v241
v_mfma_f32_16x16x32_bf16 v[64:67], v[28:31], a[144:147], v[64:67]
ds_read_b64_tr_b16 v[16:17], v14 offset:24576
v_cvt_pk_bf16_f32 v58, v120, v121
v_mfma_f32_16x16x32_bf16 v[64:67], v[32:35], a[160:163], v[64:67]
ds_read_b64_tr_b16 v[18:19], v14 offset:25600
v_mul_f32 v242, v242, v108
s_add_u32 m0, s97, 36864
v_mfma_f32_16x16x32_bf16 v[64:67], v[36:39], a[176:179], v[64:67]
s_add_u32 s45, s43, 0
buffer_load_dwordx4 v3, s[16:19], s45 offen offset:0 lds
v_mfma_f32_16x16x32_bf16 v[68:71], v[28:31], a[148:151], v[68:71]
ds_read_b64_tr_b16 v[20:21], v14 offset:26624
v_fma_f32 v243, -v109, v109, s47
v_mfma_f32_16x16x32_bf16 v[68:71], v[32:35], a[164:167], v[68:71]
ds_read_b64_tr_b16 v[22:23], v14 offset:27648
v_mul_f32 v243, v243, v109
v_mfma_f32_16x16x32_bf16 v[68:71], v[36:39], a[180:183], v[68:71]
ds_read_b64_tr_b16 v[24:25], v14 offset:28672
v_fma_f32 v244, -v110, v110, s47
v_mfma_f32_16x16x32_bf16 v[72:75], v[28:31], a[152:155], v[72:75]
ds_read_b64_tr_b16 v[26:27], v14 offset:29696
v_mul_f32 v244, v244, v110
v_mfma_f32_16x16x32_bf16 v[72:75], v[32:35], a[168:171], v[72:75]
v_rcp_f32 v240, v240
v_mfma_f32_16x16x32_bf16 v[72:75], v[36:39], a[184:187], v[72:75]
v_rcp_f32 v241, v241
v_mfma_f32_16x16x32_bf16 v[76:79], v[28:31], a[156:159], v[76:79]
v_exp_f32 v242, v242
v_mfma_f32_16x16x32_bf16 v[76:79], v[32:35], a[172:175], v[76:79]
buffer_load_dwordx4 v2, s[16:19], s45 offen offset:1024 lds
v_mfma_f32_16x16x32_bf16 v[76:79], v[36:39], a[188:191], v[76:79]
s_waitcnt lgkmcnt(1)
v_exp_f32 v243, v243
v_mfma_f32_16x16x32_bf16 v[64:67], v[16:19], a[192:195], v[64:67]
ds_read_b64_tr_b16 v[28:29], v14 offset:30720
v_mul_f32 v122, v122, v240
v_mfma_f32_16x16x32_bf16 v[64:67], v[20:23], a[208:211], v[64:67]
s_waitcnt lgkmcnt(1)
ds_read_b64_tr_b16 v[30:31], v14 offset:31744
v_mul_f32 v122, v122, v154
v_mfma_f32_16x16x32_bf16 v[64:67], v[24:27], a[224:227], v[64:67]
ds_read_b64_tr_b16 v[32:33], v14 offset:32768
v_mul_f32 v123, v123, v241
v_mfma_f32_16x16x32_bf16 v[68:71], v[16:19], a[196:199], v[68:71]
ds_read_b64_tr_b16 v[34:35], v14 offset:33792
v_mul_f32 v123, v123, v155
v_mfma_f32_16x16x32_bf16 v[68:71], v[20:23], a[212:215], v[68:71]
ds_read_b64_tr_b16 v[36:37], v14 offset:34816
v_cvt_pk_bf16_f32 v59, v122, v123
v_mfma_f32_16x16x32_bf16 v[68:71], v[24:27], a[228:231], v[68:71]
ds_read_b64_tr_b16 v[38:39], v14 offset:35840
ds_write_b128 v6, v[56:59] offset:26624
v_mfma_f32_16x16x32_bf16 v[72:75], v[16:19], a[200:203], v[72:75]
buffer_load_dwordx4 v4, s[16:19], s45 offen offset:2048 lds
v_mfma_f32_16x16x32_bf16 v[72:75], v[20:23], a[216:219], v[72:75]
v_exp_f32 v244, v244
v_mfma_f32_16x16x32_bf16 v[72:75], v[24:27], a[232:235], v[72:75]
v_add_f32 v242, 1.0, v242
v_add_f32 v243, 1.0, v243
v_mfma_f32_16x16x32_bf16 v[76:79], v[16:19], a[204:207], v[76:79]
v_rcp_f32 v242, v242
v_mfma_f32_16x16x32_bf16 v[76:79], v[20:23], a[220:223], v[76:79]
v_rcp_f32 v243, v243
v_mfma_f32_16x16x32_bf16 v[76:79], v[24:27], a[236:239], v[76:79]
s_waitcnt lgkmcnt(0)
v_mul_f32 v108, v108, v242
v_mul_f32 v108, v108, v140
v_mfma_f32_16x16x32_bf16 v[64:67], v[28:31], a[240:243], v[64:67]
ds_read_b64_tr_b16 v[16:17], v15 offset:0
v_mul_f32 v109, v109, v243
v_mfma_f32_16x16x32_bf16 v[64:67], v[32:35], v[160:163], v[64:67]
ds_read_b64_tr_b16 v[18:19], v15 offset:1024
v_mul_f32 v109, v109, v141
s_add_u32 m0, s97, 49152
v_mfma_f32_16x16x32_bf16 v[64:67], v[36:39], v[176:179], v[64:67]
s_add_u32 s45, s43, 110592
buffer_load_dwordx4 v3, s[16:19], s45 offen offset:0 lds
v_mfma_f32_16x16x32_bf16 v[68:71], v[28:31], a[244:247], v[68:71]
ds_read_b64_tr_b16 v[20:21], v15 offset:2048
v_add_f32 v244, 1.0, v244
v_mfma_f32_16x16x32_bf16 v[68:71], v[32:35], v[164:167], v[68:71]
ds_read_b64_tr_b16 v[22:23], v15 offset:3072
v_fma_f32 v245, -v111, v111, s47
v_mfma_f32_16x16x32_bf16 v[68:71], v[36:39], v[180:183], v[68:71]
ds_read_b64_tr_b16 v[24:25], v15 offset:4096
v_mul_f32 v245, v245, v111
v_mfma_f32_16x16x32_bf16 v[72:75], v[28:31], a[248:251], v[72:75]
ds_read_b64_tr_b16 v[26:27], v15 offset:5120
v_cvt_pk_bf16_f32 v60, v108, v109
v_mfma_f32_16x16x32_bf16 v[72:75], v[32:35], v[168:171], v[72:75]
v_rcp_f32 v244, v244
v_mfma_f32_16x16x32_bf16 v[72:75], v[36:39], v[184:187], v[72:75]
v_exp_f32 v245, v245
v_mfma_f32_16x16x32_bf16 v[76:79], v[28:31], a[252:255], v[76:79]
v_mul_f32 v110, v110, v244
v_mul_f32 v110, v110, v142
v_mfma_f32_16x16x32_bf16 v[76:79], v[32:35], v[172:175], v[76:79]
buffer_load_dwordx4 v2, s[16:19], s45 offen offset:1024 lds
v_mfma_f32_16x16x32_bf16 v[76:79], v[36:39], v[188:191], v[76:79]
s_waitcnt lgkmcnt(1)
v_add_f32 v245, 1.0, v245
v_fma_f32 v246, -v124, v124, s47
v_mfma_f32_16x16x32_bf16 v[80:83], v[16:19], a[0:3], 0
ds_read_b64_tr_b16 v[28:29], v15 offset:6144
v_mul_f32 v246, v246, v124
v_mfma_f32_16x16x32_bf16 v[80:83], v[20:23], a[16:19], v[80:83]
s_waitcnt lgkmcnt(1)
ds_read_b64_tr_b16 v[30:31], v15 offset:7168
v_fma_f32 v247, -v125, v125, s47
v_mfma_f32_16x16x32_bf16 v[80:83], v[24:27], a[32:35], v[80:83]
ds_read_b64_tr_b16 v[32:33], v15 offset:8192
v_mul_f32 v247, v247, v125
v_mfma_f32_16x16x32_bf16 v[84:87], v[16:19], a[4:7], 0
ds_read_b64_tr_b16 v[34:35], v15 offset:9216
v_fma_f32 v248, -v126, v126, s47
v_mfma_f32_16x16x32_bf16 v[84:87], v[20:23], a[20:23], v[84:87]
ds_read_b64_tr_b16 v[36:37], v15 offset:10240
v_mul_f32 v248, v248, v126
v_mfma_f32_16x16x32_bf16 v[84:87], v[24:27], a[36:39], v[84:87]
ds_read_b64_tr_b16 v[38:39], v15 offset:11264
v_fma_f32 v249, -v127, v127, s47
v_mfma_f32_16x16x32_bf16 v[88:91], v[16:19], a[8:11], 0
buffer_load_dwordx4 v4, s[16:19], s45 offen offset:2048 lds
v_mfma_f32_16x16x32_bf16 v[88:91], v[20:23], a[24:27], v[88:91]
v_rcp_f32 v245, v245
v_mfma_f32_16x16x32_bf16 v[88:91], v[24:27], a[40:43], v[88:91]
v_exp_f32 v246, v246
v_mfma_f32_16x16x32_bf16 v[92:95], v[16:19], a[12:15], 0
v_exp_f32 v247, v247
v_mfma_f32_16x16x32_bf16 v[92:95], v[20:23], a[28:31], v[92:95]
v_exp_f32 v248, v248
v_mfma_f32_16x16x32_bf16 v[92:95], v[24:27], a[44:47], v[92:95]
s_waitcnt lgkmcnt(0)
s_waitcnt vmcnt(6)
s_barrier
v_mul_f32 v111, v111, v245
v_mul_f32 v111, v111, v143
v_mfma_f32_16x16x32_bf16 v[80:83], v[28:31], a[48:51], v[80:83]
ds_read_b64_tr_b16 v[16:17], v15 offset:12288
v_cvt_pk_bf16_f32 v61, v110, v111
v_mfma_f32_16x16x32_bf16 v[80:83], v[32:35], a[64:67], v[80:83]
ds_read_b64_tr_b16 v[18:19], v15 offset:13312
v_add_f32 v246, 1.0, v246
s_add_u32 m0, s97, 61440
v_mfma_f32_16x16x32_bf16 v[80:83], v[36:39], a[80:83], v[80:83]
s_add_u32 s45, s98, 221184
buffer_load_dwordx4 v3, s[16:19], s45 offen offset:0 lds
v_mfma_f32_16x16x32_bf16 v[84:87], v[28:31], a[52:55], v[84:87]
ds_read_b64_tr_b16 v[20:21], v15 offset:14336
v_add_f32 v247, 1.0, v247
v_mfma_f32_16x16x32_bf16 v[84:87], v[32:35], a[68:71], v[84:87]
ds_read_b64_tr_b16 v[22:23], v15 offset:15360
v_add_f32 v248, 1.0, v248
v_mfma_f32_16x16x32_bf16 v[84:87], v[36:39], a[84:87], v[84:87]
ds_read_b64_tr_b16 v[24:25], v15 offset:16384
v_mul_f32 v249, v249, v127
v_mfma_f32_16x16x32_bf16 v[88:91], v[28:31], a[56:59], v[88:91]
ds_read_b64_tr_b16 v[26:27], v15 offset:17408
v_fma_f32 v250, -v64, v64, s47
v_mfma_f32_16x16x32_bf16 v[88:91], v[32:35], a[72:75], v[88:91]
v_rcp_f32 v246, v246
v_mfma_f32_16x16x32_bf16 v[88:91], v[36:39], a[88:91], v[88:91]
v_rcp_f32 v247, v247
v_mfma_f32_16x16x32_bf16 v[92:95], v[28:31], a[60:63], v[92:95]
v_rcp_f32 v248, v248
v_mfma_f32_16x16x32_bf16 v[92:95], v[32:35], a[76:79], v[92:95]
buffer_load_dwordx4 v2, s[16:19], s45 offen offset:1024 lds
v_mfma_f32_16x16x32_bf16 v[92:95], v[36:39], a[92:95], v[92:95]
s_waitcnt lgkmcnt(1)
v_exp_f32 v249, v249
v_mfma_f32_16x16x32_bf16 v[80:83], v[16:19], a[96:99], v[80:83]
ds_read_b64_tr_b16 v[28:29], v15 offset:18432
v_mul_f32 v124, v124, v246
v_mfma_f32_16x16x32_bf16 v[80:83], v[20:23], a[112:115], v[80:83]
s_waitcnt lgkmcnt(1)
ds_read_b64_tr_b16 v[30:31], v15 offset:19456
v_mul_f32 v124, v124, v156
v_mfma_f32_16x16x32_bf16 v[80:83], v[24:27], a[128:131], v[80:83]
ds_read_b64_tr_b16 v[32:33], v15 offset:20480
v_mul_f32 v125, v125, v247
v_mfma_f32_16x16x32_bf16 v[84:87], v[16:19], a[100:103], v[84:87]
ds_read_b64_tr_b16 v[34:35], v15 offset:21504
v_mul_f32 v125, v125, v157
v_mfma_f32_16x16x32_bf16 v[84:87], v[20:23], a[116:119], v[84:87]
ds_read_b64_tr_b16 v[36:37], v15 offset:22528
v_mul_f32 v126, v126, v248
v_mfma_f32_16x16x32_bf16 v[84:87], v[24:27], a[132:135], v[84:87]
ds_read_b64_tr_b16 v[38:39], v15 offset:23552
v_mul_f32 v126, v126, v158
v_mfma_f32_16x16x32_bf16 v[88:91], v[16:19], a[104:107], v[88:91]
s_add_u32 s45, s99, 221184
buffer_load_dwordx4 v4, s[16:19], s45 offen offset:2048 lds
v_mfma_f32_16x16x32_bf16 v[88:91], v[20:23], a[120:123], v[88:91]
v_add_f32 v249, 1.0, v249
v_cvt_pk_bf16_f32 v62, v124, v125
v_mfma_f32_16x16x32_bf16 v[88:91], v[24:27], a[136:139], v[88:91]
v_rcp_f32 v249, v249
v_mfma_f32_16x16x32_bf16 v[92:95], v[16:19], a[108:111], v[92:95]
v_mul_f32 v127, v127, v249
v_mul_f32 v127, v127, v159
v_mfma_f32_16x16x32_bf16 v[92:95], v[20:23], a[124:127], v[92:95]
v_cvt_pk_bf16_f32 v63, v126, v127
v_mul_f32 v250, v250, v64
v_mfma_f32_16x16x32_bf16 v[92:95], v[24:27], a[140:143], v[92:95]
s_waitcnt lgkmcnt(0)
v_exp_f32 v250, v250
v_mfma_f32_16x16x32_bf16 v[80:83], v[28:31], a[144:147], v[80:83]
ds_read_b64_tr_b16 v[16:17], v15 offset:24576
ds_write_b128 v6, v[60:63] offset:27648
v_mfma_f32_16x16x32_bf16 v[80:83], v[32:35], a[160:163], v[80:83]
ds_read_b64_tr_b16 v[18:19], v15 offset:25600
v_add_f32 v250, 1.0, v250
s_add_u32 m0, s97, 73728
v_mfma_f32_16x16x32_bf16 v[80:83], v[36:39], a[176:179], v[80:83]
s_add_u32 s45, s43, 128
buffer_load_dwordx4 v3, s[16:19], s45 offen offset:0 lds
v_mfma_f32_16x16x32_bf16 v[84:87], v[28:31], a[148:151], v[84:87]
ds_read_b64_tr_b16 v[20:21], v15 offset:26624
v_fma_f32 v251, -v65, v65, s47
v_mfma_f32_16x16x32_bf16 v[84:87], v[32:35], a[164:167], v[84:87]
ds_read_b64_tr_b16 v[22:23], v15 offset:27648
v_mul_f32 v251, v251, v65
v_mfma_f32_16x16x32_bf16 v[84:87], v[36:39], a[180:183], v[84:87]
ds_read_b64_tr_b16 v[24:25], v15 offset:28672
v_fma_f32 v252, -v66, v66, s47
v_mfma_f32_16x16x32_bf16 v[88:91], v[28:31], a[152:155], v[88:91]
ds_read_b64_tr_b16 v[26:27], v15 offset:29696
v_mul_f32 v252, v252, v66
v_mfma_f32_16x16x32_bf16 v[88:91], v[32:35], a[168:171], v[88:91]
v_rcp_f32 v250, v250
v_mfma_f32_16x16x32_bf16 v[88:91], v[36:39], a[184:187], v[88:91]
v_exp_f32 v251, v251
v_mfma_f32_16x16x32_bf16 v[92:95], v[28:31], a[156:159], v[92:95]
v_exp_f32 v252, v252
v_mfma_f32_16x16x32_bf16 v[92:95], v[32:35], a[172:175], v[92:95]
buffer_load_dwordx4 v2, s[16:19], s45 offen offset:1024 lds
v_mfma_f32_16x16x32_bf16 v[92:95], v[36:39], a[188:191], v[92:95]
s_waitcnt lgkmcnt(1)
v_mul_f32 v64, v64, v250
v_add_f32 v251, 1.0, v251
v_mfma_f32_16x16x32_bf16 v[80:83], v[16:19], a[192:195], v[80:83]
ds_read_b64_tr_b16 v[28:29], v15 offset:30720
v_add_f32 v252, 1.0, v252
v_mfma_f32_16x16x32_bf16 v[80:83], v[20:23], a[208:211], v[80:83]
s_waitcnt lgkmcnt(1)
ds_read_b64_tr_b16 v[30:31], v15 offset:31744
v_fma_f32 v253, -v67, v67, s47
v_mfma_f32_16x16x32_bf16 v[80:83], v[24:27], a[224:227], v[80:83]
ds_read_b64_tr_b16 v[32:33], v15 offset:32768
v_mul_f32 v253, v253, v67
v_mfma_f32_16x16x32_bf16 v[84:87], v[16:19], a[196:199], v[84:87]
ds_read_b64_tr_b16 v[34:35], v15 offset:33792
v_fma_f32 v40, -v68, v68, s47
v_mfma_f32_16x16x32_bf16 v[84:87], v[20:23], a[212:215], v[84:87]
ds_read_b64_tr_b16 v[36:37], v15 offset:34816
v_mul_f32 v40, v40, v68
v_mfma_f32_16x16x32_bf16 v[84:87], v[24:27], a[228:231], v[84:87]
ds_read_b64_tr_b16 v[38:39], v15 offset:35840
v_fma_f32 v41, -v69, v69, s47
v_mfma_f32_16x16x32_bf16 v[88:91], v[16:19], a[200:203], v[88:91]
buffer_load_dwordx4 v4, s[16:19], s45 offen offset:2048 lds
v_mfma_f32_16x16x32_bf16 v[88:91], v[20:23], a[216:219], v[88:91]
v_rcp_f32 v251, v251
v_mfma_f32_16x16x32_bf16 v[88:91], v[24:27], a[232:235], v[88:91]
v_rcp_f32 v252, v252
v_mfma_f32_16x16x32_bf16 v[92:95], v[16:19], a[204:207], v[92:95]
v_exp_f32 v253, v253
v_mfma_f32_16x16x32_bf16 v[92:95], v[20:23], a[220:223], v[92:95]
v_exp_f32 v40, v40
v_mfma_f32_16x16x32_bf16 v[92:95], v[24:27], a[236:239], v[92:95]
s_waitcnt lgkmcnt(0)
s_waitcnt vmcnt(6)
s_barrier
v_mul_f32 v65, v65, v251
v_mul_f32 v66, v66, v252
v_mfma_f32_16x16x32_bf16 v[80:83], v[28:31], a[240:243], v[80:83]
ds_read_b64_tr_b16 v[16:17], v10 offset:0
v_add_f32 v253, 1.0, v253
v_mfma_f32_16x16x32_bf16 v[80:83], v[32:35], v[160:163], v[80:83]
ds_read_b64_tr_b16 v[18:19], v10 offset:2048
v_add_f32 v40, 1.0, v40
s_add_u32 m0, s97, 86016
v_mfma_f32_16x16x32_bf16 v[80:83], v[36:39], v[176:179], v[80:83]
s_add_u32 s45, s43, 110720
buffer_load_dwordx4 v3, s[16:19], s45 offen offset:0 lds
v_mfma_f32_16x16x32_bf16 v[84:87], v[28:31], a[244:247], v[84:87]
ds_read_b64_tr_b16 v[20:21], v10 offset:4096
v_mul_f32 v41, v41, v69
v_mfma_f32_16x16x32_bf16 v[84:87], v[32:35], v[164:167], v[84:87]
ds_read_b64_tr_b16 v[22:23], v10 offset:6144
v_fma_f32 v42, -v70, v70, s47
v_mfma_f32_16x16x32_bf16 v[84:87], v[36:39], v[180:183], v[84:87]
ds_read_b64_tr_b16 v[24:25], v10 offset:8192
v_mul_f32 v42, v42, v70
v_mfma_f32_16x16x32_bf16 v[88:91], v[28:31], a[248:251], v[88:91]
ds_read_b64_tr_b16 v[26:27], v10 offset:10240
v_fma_f32 v43, -v71, v71, s47
v_mfma_f32_16x16x32_bf16 v[88:91], v[32:35], v[168:171], v[88:91]
v_rcp_f32 v253, v253
v_mfma_f32_16x16x32_bf16 v[88:91], v[36:39], v[184:187], v[88:91]
v_rcp_f32 v40, v40
v_mfma_f32_16x16x32_bf16 v[92:95], v[28:31], a[252:255], v[92:95]
v_exp_f32 v41, v41
v_mfma_f32_16x16x32_bf16 v[92:95], v[32:35], v[172:175], v[92:95]
buffer_load_dwordx4 v2, s[16:19], s45 offen offset:1024 lds
v_mfma_f32_16x16x32_bf16 v[92:95], v[36:39], v[188:191], v[92:95]
s_waitcnt lgkmcnt(1)
v_exp_f32 v42, v42
v_mfma_f32_16x16x32_bf16 v[96:99], v[16:19], v[192:195], 0
ds_read_b64_tr_b16 v[28:29], v12 offset:0
ds_read_b128 a[0:3], v7 offset:12288
v_mfma_f32_16x16x32_bf16 v[96:99], v[20:23], v[208:211], v[96:99]
s_waitcnt lgkmcnt(2)
ds_read_b64_tr_b16 v[30:31], v12 offset:2048
ds_read_b128 a[16:19], v7 offset:16384
v_mfma_f32_16x16x32_bf16 v[96:99], v[24:27], v[224:227], v[96:99]
ds_read_b64_tr_b16 v[32:33], v12 offset:4096
ds_read_b128 a[32:35], v7 offset:20480
v_mul_f32 v64, v64, v80
v_mul_f32 v65, v65, v81
v_mfma_f32_16x16x32_bf16 v[100:103], v[16:19], v[196:199], 0
ds_read_b64_tr_b16 v[34:35], v12 offset:6144
ds_read_b128 a[4:7], v7 offset:13312
v_mul_f32 v66, v66, v82
v_mul_f32 v67, v67, v253
v_mul_f32 v68, v68, v40
v_mfma_f32_16x16x32_bf16 v[100:103], v[20:23], v[212:215], v[100:103]
ds_read_b64_tr_b16 v[36:37], v12 offset:8192
ds_read_b128 a[20:23], v7 offset:17408
v_add_f32 v41, 1.0, v41
v_add_f32 v42, 1.0, v42
v_mul_f32 v43, v43, v71
v_mfma_f32_16x16x32_bf16 v[100:103], v[24:27], v[228:231], v[100:103]
ds_read_b64_tr_b16 v[38:39], v12 offset:10240
ds_read_b128 a[36:39], v7 offset:21504
v_fma_f32 v44, -v72, v72, s47
v_fma_f32 v45, -v73, v73, s47
v_fma_f32 v46, -v74, v74, s47
v_mfma_f32_16x16x32_bf16 v[104:107], v[16:19], v[200:203], 0
buffer_load_dwordx4 v4, s[16:19], s45 offen offset:2048 lds
v_fma_f32 v47, -v75, v75, s47
v_fma_f32 v240, -v76, v76, s47
v_mfma_f32_16x16x32_bf16 v[104:107], v[20:23], v[216:219], v[104:107]
ds_read_b128 a[8:11], v7 offset:14336
ds_read_b128 a[24:27], v7 offset:18432
v_fma_f32 v241, -v77, v77, s47
v_fma_f32 v242, -v78, v78, s47
v_fma_f32 v243, -v79, v79, s47
v_mfma_f32_16x16x32_bf16 v[104:107], v[24:27], v[232:235], v[104:107]
ds_read_b128 a[40:43], v7 offset:22528
ds_read_b128 a[12:15], v7 offset:15360
v_mul_f32 v67, v67, v83
v_cvt_pk_bf16_f32 v48, v64, v65
v_mul_f32 v68, v68, v84
v_mfma_f32_16x16x32_bf16 v[108:111], v[16:19], v[204:207], 0
ds_read_b128 a[28:31], v7 offset:19456
ds_read_b128 a[44:47], v7 offset:23552
v_rcp_f32 v41, v41
v_mfma_f32_16x16x32_bf16 v[108:111], v[20:23], v[220:223], v[108:111]
v_rcp_f32 v42, v42
v_exp_f32 v43, v43
v_mul_f32 v44, v44, v72
v_mfma_f32_16x16x32_bf16 v[108:111], v[24:27], v[236:239], v[108:111]
s_waitcnt lgkmcnt(6)
v_mul_f32 v45, v45, v73
v_mul_f32 v46, v46, v74
v_mul_f32 v47, v47, v75
v_mul_f32 v240, v240, v76
v_mul_f32 v241, v241, v77
v_mfma_f32_16x16x32_bf16 v[112:115], v[28:31], v[192:195], 0
ds_read_b64_tr_b16 v[16:17], v10 offset:12288
v_mul_f32 v242, v242, v78
v_mul_f32 v243, v243, v79
v_cvt_pk_bf16_f32 v49, v66, v67
v_mul_f32 v69, v69, v41
v_mfma_f32_16x16x32_bf16 v[112:115], v[32:35], v[208:211], v[112:115]
ds_read_b64_tr_b16 v[18:19], v10 offset:14336
v_mul_f32 v70, v70, v42
v_add_f32 v43, 1.0, v43
v_exp_f32 v44, v44
s_add_u32 m0, s97, 98304
v_mfma_f32_16x16x32_bf16 v[112:115], v[36:39], v[224:227], v[112:115]
s_add_u32 s45, s98, 221312
buffer_load_dwordx4 v3, s[16:19], s45 offen offset:0 lds
v_exp_f32 v45, v45
v_mfma_f32_16x16x32_bf16 v[116:119], v[28:31], v[196:199], 0
ds_read_b64_tr_b16 v[20:21], v10 offset:16384
v_exp_f32 v46, v46
v_exp_f32 v47, v47
v_mfma_f32_16x16x32_bf16 v[116:119], v[32:35], v[212:215], v[116:119]
ds_read_b64_tr_b16 v[22:23], v10 offset:18432
v_exp_f32 v240, v240
v_exp_f32 v241, v241
v_mfma_f32_16x16x32_bf16 v[116:119], v[36:39], v[228:231], v[116:119]
ds_read_b64_tr_b16 v[24:25], v10 offset:20480
v_exp_f32 v242, v242
v_exp_f32 v243, v243
v_mfma_f32_16x16x32_bf16 v[120:123], v[28:31], v[200:203], 0
ds_read_b64_tr_b16 v[26:27], v10 offset:22528
ds_write_b64 v5, v[48:49] offset:32768
v_mul_f32 v69, v69, v85
v_mul_f32 v70, v70, v86
v_mfma_f32_16x16x32_bf16 v[120:123], v[32:35], v[216:219], v[120:123]
v_rcp_f32 v43, v43
v_add_f32 v44, 1.0, v44
v_add_f32 v45, 1.0, v45
v_add_f32 v46, 1.0, v46
v_mfma_f32_16x16x32_bf16 v[120:123], v[36:39], v[232:235], v[120:123]
v_add_f32 v47, 1.0, v47
v_add_f32 v240, 1.0, v240
v_add_f32 v241, 1.0, v241
v_add_f32 v242, 1.0, v242
v_add_f32 v243, 1.0, v243
v_mfma_f32_16x16x32_bf16 v[124:127], v[28:31], v[204:207], 0
v_mul_f32 v71, v71, v43
v_cvt_pk_bf16_f32 v52, v68, v69
v_rcp_f32 v44, v44
v_mfma_f32_16x16x32_bf16 v[124:127], v[32:35], v[220:223], v[124:127]
buffer_load_dwordx4 v2, s[16:19], s45 offen offset:1024 lds
v_rcp_f32 v45, v45
v_rcp_f32 v46, v46
v_mfma_f32_16x16x32_bf16 v[124:127], v[36:39], v[236:239], v[124:127]
s_waitcnt lgkmcnt(2)
v_rcp_f32 v47, v47
v_rcp_f32 v240, v240
v_mfma_f32_16x16x32_bf16 v[96:99], v[16:19], a[0:3], v[96:99]
ds_read_b64_tr_b16 v[28:29], v12 offset:12288
v_rcp_f32 v241, v241
v_rcp_f32 v242, v242
v_mfma_f32_16x16x32_bf16 v[96:99], v[20:23], a[16:19], v[96:99]
s_waitcnt lgkmcnt(1)
ds_read_b64_tr_b16 v[30:31], v12 offset:14336
v_rcp_f32 v243, v243
v_mul_f32 v71, v71, v87
v_mul_f32 v72, v72, v44
v_mfma_f32_16x16x32_bf16 v[96:99], v[24:27], a[32:35], v[96:99]
ds_read_b64_tr_b16 v[32:33], v12 offset:16384
v_mul_f32 v73, v73, v45
v_mul_f32 v74, v74, v46
v_mul_f32 v75, v75, v47
v_mul_f32 v76, v76, v240
v_mfma_f32_16x16x32_bf16 v[100:103], v[16:19], a[4:7], v[100:103]
ds_read_b64_tr_b16 v[34:35], v12 offset:18432
v_mul_f32 v77, v77, v241
v_mul_f32 v78, v78, v242
v_mul_f32 v79, v79, v243
v_mfma_f32_16x16x32_bf16 v[100:103], v[20:23], a[20:23], v[100:103]
ds_read_b64_tr_b16 v[36:37], v12 offset:20480
v_cvt_pk_bf16_f32 v53, v70, v71
v_mul_f32 v72, v72, v88
v_mul_f32 v73, v73, v89
v_mul_f32 v74, v74, v90
v_mfma_f32_16x16x32_bf16 v[100:103], v[24:27], a[36:39], v[100:103]
ds_read_b64_tr_b16 v[38:39], v12 offset:22528
v_mul_f32 v75, v75, v91
v_mul_f32 v76, v76, v92
v_mul_f32 v77, v77, v93
v_mul_f32 v78, v78, v94
v_mfma_f32_16x16x32_bf16 v[104:107], v[16:19], a[8:11], v[104:107]
s_add_u32 s45, s99, 221312
buffer_load_dwordx4 v4, s[16:19], s45 offen offset:2048 lds
v_mul_f32 v79, v79, v95
ds_write_b64 v5, v[52:53] offset:33792
v_cvt_pk_bf16_f32 v56, v72, v73
v_mfma_f32_16x16x32_bf16 v[104:107], v[20:23], a[24:27], v[104:107]
v_cvt_pk_bf16_f32 v57, v74, v75
v_cvt_pk_bf16_f32 v60, v76, v77
v_cvt_pk_bf16_f32 v61, v78, v79
ds_write_b64 v5, v[56:57] offset:34816
ds_write_b64 v5, v[60:61] offset:35840
v_mfma_f32_16x16x32_bf16 v[104:107], v[24:27], a[40:43], v[104:107]
v_mfma_f32_16x16x32_bf16 v[108:111], v[16:19], a[12:15], v[108:111]
v_mfma_f32_16x16x32_bf16 v[108:111], v[20:23], a[28:31], v[108:111]
s_add_u32 s45, s43, 256
v_mfma_f32_16x16x32_bf16 v[108:111], v[24:27], a[44:47], v[108:111]
s_waitcnt lgkmcnt(0)
s_waitcnt vmcnt(6)
s_barrier
s_add_u32 m0, s97, 36864
v_mfma_f32_16x16x32_bf16 v[112:115], v[28:31], a[0:3], v[112:115]
ds_read_b64_tr_b16 v[16:17], v10 offset:24576
ds_read_b128 a[48:51], v7 offset:24576
v_mfma_f32_16x16x32_bf16 v[112:115], v[32:35], a[16:19], v[112:115]
ds_read_b64_tr_b16 v[18:19], v10 offset:26624
ds_read_b128 a[64:67], v7 offset:28672
v_mfma_f32_16x16x32_bf16 v[112:115], v[36:39], a[32:35], v[112:115]
buffer_load_dwordx4 v3, s[16:19], s45 offen offset:0 lds
v_mfma_f32_16x16x32_bf16 v[116:119], v[28:31], a[4:7], v[116:119]
ds_read_b64_tr_b16 v[20:21], v10 offset:28672
ds_read_b128 a[80:83], v7 offset:32768
v_mfma_f32_16x16x32_bf16 v[116:119], v[32:35], a[20:23], v[116:119]
ds_read_b64_tr_b16 v[22:23], v10 offset:30720
ds_read_b128 a[52:55], v7 offset:25600
v_mfma_f32_16x16x32_bf16 v[116:119], v[36:39], a[36:39], v[116:119]
ds_read_b64_tr_b16 v[24:25], v10 offset:32768
ds_read_b128 a[68:71], v7 offset:29696
v_mfma_f32_16x16x32_bf16 v[120:123], v[28:31], a[8:11], v[120:123]
ds_read_b64_tr_b16 v[26:27], v10 offset:34816
ds_read_b128 a[84:87], v7 offset:33792
v_mfma_f32_16x16x32_bf16 v[120:123], v[32:35], a[24:27], v[120:123]
ds_read_b128 a[56:59], v7 offset:26624
ds_read_b128 a[72:75], v7 offset:30720
v_mfma_f32_16x16x32_bf16 v[120:123], v[36:39], a[40:43], v[120:123]
ds_read_b128 a[88:91], v7 offset:34816
ds_read_b128 a[60:63], v7 offset:27648
v_mfma_f32_16x16x32_bf16 v[124:127], v[28:31], a[12:15], v[124:127]
ds_read_b128 a[76:79], v7 offset:31744
ds_read_b128 a[92:95], v7 offset:35840
v_mfma_f32_16x16x32_bf16 v[124:127], v[32:35], a[28:31], v[124:127]
buffer_load_dwordx4 v2, s[16:19], s45 offen offset:1024 lds
v_mfma_f32_16x16x32_bf16 v[124:127], v[36:39], a[44:47], v[124:127]
s_waitcnt lgkmcnt(8)
s_add_u32 s7, s40, 147456
v_mfma_f32_16x16x32_bf16 v[96:99], v[16:19], a[48:51], v[96:99]
ds_read_b64_tr_b16 v[28:29], v12 offset:24576
v_add_u32 v252, s7, v8
v_mfma_f32_16x16x32_bf16 v[96:99], v[20:23], a[64:67], v[96:99]
s_waitcnt lgkmcnt(5)
ds_read_b64_tr_b16 v[30:31], v12 offset:26624
v_lshrrev_b32 v253, 4, v1
v_mfma_f32_16x16x32_bf16 v[96:99], v[24:27], a[80:83], v[96:99]
ds_read_b64_tr_b16 v[32:33], v12 offset:28672
v_mul_u32_u24 v248, 2359296, v253
v_mfma_f32_16x16x32_bf16 v[100:103], v[16:19], a[52:55], v[100:103]
ds_read_b64_tr_b16 v[34:35], v12 offset:30720
v_and_b32 v254, 15, v1
v_mfma_f32_16x16x32_bf16 v[100:103], v[20:23], a[68:71], v[100:103]
ds_read_b64_tr_b16 v[36:37], v12 offset:32768
v_lshl_add_u32 v248, v254, 4, v248
v_mfma_f32_16x16x32_bf16 v[100:103], v[24:27], a[84:87], v[100:103]
ds_read_b64_tr_b16 v[38:39], v12 offset:34816
v_and_b32 v251, 8, v1
v_mfma_f32_16x16x32_bf16 v[104:107], v[16:19], a[56:59], v[104:107]
buffer_load_dwordx4 v4, s[16:19], s45 offen offset:2048 lds
v_mfma_f32_16x16x32_bf16 v[104:107], v[20:23], a[72:75], v[104:107]
s_waitcnt lgkmcnt(4)
v_lshlrev_b32 v251, 1, v251
v_and_b32 v253, 16, v1
v_mfma_f32_16x16x32_bf16 v[104:107], v[24:27], a[88:91], v[104:107]
v_lshl_add_u32 v251, v253, 2, v251
v_and_b32 v253, 32, v1
v_mfma_f32_16x16x32_bf16 v[108:111], v[16:19], a[60:63], v[108:111]
v_lshl_add_u32 v251, v253, 3, v251
v_and_b32 v249, 7, v1
v_mfma_f32_16x16x32_bf16 v[108:111], v[20:23], a[76:79], v[108:111]
v_mul_u32_u24 v249, 1152, v249
v_lshrrev_b32 v254, 1, v251
v_mfma_f32_16x16x32_bf16 v[108:111], v[24:27], a[92:95], v[108:111]
v_add_u32 v249, v249, v254
v_lshl_add_u32 v250, v253, 25, v249
v_mfma_f32_16x16x32_bf16 v[112:115], v[28:31], a[48:51], v[112:115]
s_waitcnt lgkmcnt(0)
ds_read_b64_tr_b16 v[16:17], v11 offset:0
v_and_b32 v253, 1, v1
v_mfma_f32_16x16x32_bf16 v[112:115], v[32:35], a[64:67], v[112:115]
ds_read_b64_tr_b16 v[18:19], v11 offset:2048
v_lshlrev_b32 v253, 4, v253
s_add_u32 m0, s97, 49152
v_mfma_f32_16x16x32_bf16 v[112:115], v[36:39], a[80:83], v[112:115]
s_add_u32 s45, s43, 110848
buffer_load_dwordx4 v3, s[16:19], s45 offen offset:0 lds
v_mfma_f32_16x16x32_bf16 v[116:119], v[28:31], a[52:55], v[116:119]
ds_read_b64_tr_b16 v[20:21], v11 offset:4096
v_mov_b32 v254, 0x3f80
v_mfma_f32_16x16x32_bf16 v[116:119], v[32:35], a[68:71], v[116:119]
ds_read_b64_tr_b16 v[22:23], v11 offset:6144
v_lshlrev_b32 v253, v253, v254
v_mfma_f32_16x16x32_bf16 v[116:119], v[36:39], a[84:87], v[116:119]
ds_read_b64_tr_b16 v[24:25], v11 offset:8192
v_bfe_u32 v254, v1, 1, 3
v_mfma_f32_16x16x32_bf16 v[120:123], v[28:31], a[56:59], v[120:123]
ds_read_b64_tr_b16 v[26:27], v11 offset:10240
v_cmp_eq_u32 vcc, 0, v254
v_mfma_f32_16x16x32_bf16 v[120:123], v[32:35], a[72:75], v[120:123]
s_nop 0
v_cndmask_b32 v240, 0, v253, vcc
v_cmp_eq_u32 vcc, 1, v254
v_mfma_f32_16x16x32_bf16 v[120:123], v[36:39], a[88:91], v[120:123]
s_nop 0
v_cndmask_b32 v241, 0, v253, vcc
v_cmp_eq_u32 vcc, 2, v254
v_mfma_f32_16x16x32_bf16 v[124:127], v[28:31], a[60:63], v[124:127]
s_nop 0
v_cndmask_b32 v242, 0, v253, vcc
v_cmp_eq_u32 vcc, 3, v254
v_mfma_f32_16x16x32_bf16 v[124:127], v[32:35], a[76:79], v[124:127]
buffer_load_dwordx4 v2, s[16:19], s45 offen offset:1024 lds
v_mfma_f32_16x16x32_bf16 v[124:127], v[36:39], a[92:95], v[124:127]
s_waitcnt lgkmcnt(1)
v_cndmask_b32 v243, 0, v253, vcc
v_cmp_eq_u32 vcc, 4, v254
v_mfma_f32_16x16x32_bf16 v[64:67], v[16:19], v[192:195], 0
ds_read_b64_tr_b16 v[28:29], v13 offset:0
v_cndmask_b32 v244, 0, v253, vcc
v_mfma_f32_16x16x32_bf16 v[64:67], v[20:23], v[208:211], v[64:67]
s_waitcnt lgkmcnt(1)
ds_read_b64_tr_b16 v[30:31], v13 offset:2048
v_cmp_eq_u32 vcc, 5, v254
v_mfma_f32_16x16x32_bf16 v[64:67], v[24:27], v[224:227], v[64:67]
ds_read_b64_tr_b16 v[32:33], v13 offset:4096
v_cndmask_b32 v245, 0, v253, vcc
v_mfma_f32_16x16x32_bf16 v[68:71], v[16:19], v[196:199], 0
ds_read_b64_tr_b16 v[34:35], v13 offset:6144
v_cvt_pk_bf16_f32 v128, v96, v97
v_mfma_f32_16x16x32_bf16 v[68:71], v[20:23], v[212:215], v[68:71]
ds_read_b64_tr_b16 v[36:37], v13 offset:8192
v_cvt_pk_bf16_f32 v129, v98, v99
v_mfma_f32_16x16x32_bf16 v[68:71], v[24:27], v[228:231], v[68:71]
ds_read_b64_tr_b16 v[38:39], v13 offset:10240
v_cvt_pk_bf16_f32 v130, v112, v113
v_mfma_f32_16x16x32_bf16 v[72:75], v[16:19], v[200:203], 0
buffer_load_dwordx4 v4, s[16:19], s45 offen offset:2048 lds
v_mfma_f32_16x16x32_bf16 v[72:75], v[20:23], v[216:219], v[72:75]
v_cvt_pk_bf16_f32 v131, v114, v115
v_cvt_pk_bf16_f32 v132, v100, v101
v_mfma_f32_16x16x32_bf16 v[72:75], v[24:27], v[232:235], v[72:75]
v_cvt_pk_bf16_f32 v133, v102, v103
v_cvt_pk_bf16_f32 v134, v116, v117
v_mfma_f32_16x16x32_bf16 v[76:79], v[16:19], v[204:207], 0
v_cvt_pk_bf16_f32 v135, v118, v119
v_cvt_pk_bf16_f32 v136, v104, v105
v_mfma_f32_16x16x32_bf16 v[76:79], v[20:23], v[220:223], v[76:79]
v_cvt_pk_bf16_f32 v137, v106, v107
v_cvt_pk_bf16_f32 v138, v120, v121
v_mfma_f32_16x16x32_bf16 v[76:79], v[24:27], v[236:239], v[76:79]
s_waitcnt lgkmcnt(0)
s_waitcnt vmcnt(6)
s_barrier
v_cvt_pk_bf16_f32 v139, v122, v123
v_cvt_pk_bf16_f32 v140, v108, v109
v_mfma_f32_16x16x32_bf16 v[80:83], v[28:31], v[192:195], 0
ds_read_b64_tr_b16 v[16:17], v11 offset:12288
v_cvt_pk_bf16_f32 v141, v110, v111
v_mfma_f32_16x16x32_bf16 v[80:83], v[32:35], v[208:211], v[80:83]
ds_read_b64_tr_b16 v[18:19], v11 offset:14336
v_cvt_pk_bf16_f32 v142, v124, v125
s_add_u32 m0, s97, 61440
v_mfma_f32_16x16x32_bf16 v[80:83], v[36:39], v[224:227], v[80:83]
s_add_u32 s45, s98, 221440
buffer_load_dwordx4 v3, s[16:19], s45 offen offset:0 lds
v_mfma_f32_16x16x32_bf16 v[84:87], v[28:31], v[196:199], 0
ds_read_b64_tr_b16 v[20:21], v11 offset:16384
v_cvt_pk_bf16_f32 v143, v126, v127
v_mfma_f32_16x16x32_bf16 v[84:87], v[32:35], v[212:215], v[84:87]
ds_read_b64_tr_b16 v[22:23], v11 offset:18432
v_cmp_eq_u32 vcc, 6, v254
v_mfma_f32_16x16x32_bf16 v[84:87], v[36:39], v[228:231], v[84:87]
ds_read_b64_tr_b16 v[24:25], v11 offset:20480
v_cndmask_b32 v246, 0, v253, vcc
v_mfma_f32_16x16x32_bf16 v[88:91], v[28:31], v[200:203], 0
ds_read_b64_tr_b16 v[26:27], v11 offset:22528
v_cmp_eq_u32 vcc, 7, v254
v_mfma_f32_16x16x32_bf16 v[88:91], v[32:35], v[216:219], v[88:91]
s_add_u32 s51, s50, 0
buffer_store_dwordx4 v[128:131], v9, s[24:27], s51 offen sc1
v_mfma_f32_16x16x32_bf16 v[88:91], v[36:39], v[232:235], v[88:91]
v_cndmask_b32 v247, 0, v253, vcc
v_and_b32 v255, 7, v1
v_mfma_f32_16x16x32_bf16 v[92:95], v[28:31], v[204:207], 0
v_and_b32 v253, 8, v1
v_lshlrev_b32 v255, 2, v255
v_mfma_f32_16x16x32_bf16 v[92:95], v[32:35], v[220:223], v[92:95]
buffer_load_dwordx4 v2, s[16:19], s45 offen offset:1024 lds
v_mfma_f32_16x16x32_bf16 v[92:95], v[36:39], v[236:239], v[92:95]
s_waitcnt lgkmcnt(1)
s_add_u32 s51, s50, 18432
buffer_store_dwordx4 v[132:135], v9, s[24:27], s51 offen sc1
v_mfma_f32_16x16x32_bf16 v[64:67], v[16:19], a[0:3], v[64:67]
ds_read_b64_tr_b16 v[28:29], v13 offset:12288
v_lshl_add_u32 v255, v253, 2, v255
v_mfma_f32_16x16x32_bf16 v[64:67], v[20:23], a[16:19], v[64:67]
s_waitcnt lgkmcnt(1)
ds_read_b64_tr_b16 v[30:31], v13 offset:14336
v_mfma_f32_16x16x32_bf16 v[64:67], v[24:27], a[32:35], v[64:67]
ds_read_b64_tr_b16 v[32:33], v13 offset:16384
v_mfma_f32_16x16x32_bf16 v[68:71], v[16:19], a[4:7], v[68:71]
ds_read_b64_tr_b16 v[34:35], v13 offset:18432
s_add_u32 s7, s61, 11520
v_mfma_f32_16x16x32_bf16 v[68:71], v[20:23], a[20:23], v[68:71]
ds_read_b64_tr_b16 v[36:37], v13 offset:20480
s_add_u32 s51, s50, 36864
v_mfma_f32_16x16x32_bf16 v[68:71], v[24:27], a[36:39], v[68:71]
ds_read_b64_tr_b16 v[38:39], v13 offset:22528
s_add_u32 s45, s99, 221440
v_mfma_f32_16x16x32_bf16 v[72:75], v[16:19], a[8:11], v[72:75]
buffer_load_dwordx4 v4, s[16:19], s45 offen offset:2048 lds
v_mfma_f32_16x16x32_bf16 v[72:75], v[20:23], a[24:27], v[72:75]
buffer_store_dwordx4 v[136:139], v9, s[24:27], s51 offen sc1
v_mfma_f32_16x16x32_bf16 v[72:75], v[24:27], a[40:43], v[72:75]
buffer_load_dwordx4 v[160:163], v251, s[24:27], s7 offen offset:0 sc1
v_mfma_f32_16x16x32_bf16 v[76:79], v[16:19], a[12:15], v[76:79]
s_add_u32 s7, s61, 11520
buffer_load_dwordx4 v[164:167], v251, s[24:27], s7 offen offset:512 sc1
v_mfma_f32_16x16x32_bf16 v[76:79], v[20:23], a[28:31], v[76:79]
s_add_u32 s51, s50, 55296
buffer_store_dwordx4 v[140:143], v9, s[24:27], s51 offen sc1
v_mfma_f32_16x16x32_bf16 v[76:79], v[24:27], a[44:47], v[76:79]
s_waitcnt lgkmcnt(0)
s_add_u32 s7, s61, 11520
buffer_load_dwordx4 v[168:171], v251, s[24:27], s7 offen offset:1024 sc1
v_mfma_f32_16x16x32_bf16 v[80:83], v[28:31], a[0:3], v[80:83]
ds_read_b64_tr_b16 v[16:17], v11 offset:24576
s_add_u32 s45, s43, 384
v_mfma_f32_16x16x32_bf16 v[80:83], v[32:35], a[16:19], v[80:83]
ds_read_b64_tr_b16 v[18:19], v11 offset:26624
s_add_u32 m0, s97, 73728
v_mfma_f32_16x16x32_bf16 v[80:83], v[36:39], a[32:35], v[80:83]
buffer_load_dwordx4 v3, s[16:19], s45 offen offset:0 lds
v_mfma_f32_16x16x32_bf16 v[84:87], v[28:31], a[4:7], v[84:87]
ds_read_b64_tr_b16 v[20:21], v11 offset:28672
v_mfma_f32_16x16x32_bf16 v[84:87], v[32:35], a[20:23], v[84:87]
ds_read_b64_tr_b16 v[22:23], v11 offset:30720
v_mfma_f32_16x16x32_bf16 v[84:87], v[36:39], a[36:39], v[84:87]
ds_read_b64_tr_b16 v[24:25], v11 offset:32768
v_mfma_f32_16x16x32_bf16 v[88:91], v[28:31], a[8:11], v[88:91]
ds_read_b64_tr_b16 v[26:27], v11 offset:34816
s_add_u32 s7, s61, 11520
v_mfma_f32_16x16x32_bf16 v[88:91], v[32:35], a[24:27], v[88:91]
buffer_load_dwordx4 v[172:175], v251, s[24:27], s7 offen offset:1536 sc1
v_mfma_f32_16x16x32_bf16 v[88:91], v[36:39], a[40:43], v[88:91]
s_add_u32 s7, s61, 11520
buffer_load_dwordx4 v[176:179], v251, s[24:27], s7 offen offset:2048 sc1
v_mfma_f32_16x16x32_bf16 v[92:95], v[28:31], a[12:15], v[92:95]
ds_read_b128 v[180:183], v252
ds_read_b128 v[184:187], v252 offset:4096
v_mfma_f32_16x16x32_bf16 v[92:95], v[32:35], a[28:31], v[92:95]
buffer_load_dwordx4 v2, s[16:19], s45 offen offset:1024 lds
v_mfma_f32_16x16x32_bf16 v[92:95], v[36:39], a[44:47], v[92:95]
s_waitcnt lgkmcnt(3)
ds_read_b64 v[188:189], v252 offset:8192
v_mfma_f32_16x16x32_bf16 v[64:67], v[16:19], a[48:51], v[64:67]
ds_read_b64_tr_b16 v[28:29], v13 offset:24576
v_mfma_f32_16x16x32_bf16 v[64:67], v[20:23], a[64:67], v[64:67]
s_waitcnt lgkmcnt(4)
ds_read_b64_tr_b16 v[30:31], v13 offset:26624
v_mfma_f32_16x16x32_bf16 v[64:67], v[24:27], a[80:83], v[64:67]
ds_read_b64_tr_b16 v[32:33], v13 offset:28672
v_mfma_f32_16x16x32_bf16 v[68:71], v[16:19], a[52:55], v[68:71]
ds_read_b64_tr_b16 v[34:35], v13 offset:30720
v_mfma_f32_16x16x32_bf16 v[68:71], v[20:23], a[68:71], v[68:71]
ds_read_b64_tr_b16 v[36:37], v13 offset:32768
v_mfma_f32_16x16x32_bf16 v[68:71], v[24:27], a[84:87], v[68:71]
ds_read_b64_tr_b16 v[38:39], v13 offset:34816
v_mfma_f32_16x16x32_bf16 v[72:75], v[16:19], a[56:59], v[72:75]
buffer_load_dwordx4 v4, s[16:19], s45 offen offset:2048 lds
v_mfma_f32_16x16x32_bf16 v[72:75], v[20:23], a[72:75], v[72:75]
v_mfma_f32_16x16x32_bf16 v[72:75], v[24:27], a[88:91], v[72:75]
v_mfma_f32_16x16x32_bf16 v[76:79], v[16:19], a[60:63], v[76:79]
v_mfma_f32_16x16x32_bf16 v[76:79], v[20:23], a[76:79], v[76:79]
v_mfma_f32_16x16x32_bf16 v[76:79], v[24:27], a[92:95], v[76:79]
s_waitcnt lgkmcnt(0)
s_waitcnt vmcnt(15)
s_barrier
v_mfma_f32_16x16x32_bf16 v[80:83], v[28:31], a[48:51], v[80:83]
ds_read_b64_tr_b16 v[16:17], v10 offset:0
s_add_u32 s45, s43, 110976
v_mfma_f32_16x16x32_bf16 v[80:83], v[32:35], a[64:67], v[80:83]
ds_read_b64_tr_b16 v[18:19], v10 offset:2048
s_add_u32 m0, s97, 86016
v_mfma_f32_16x16x32_bf16 v[80:83], v[36:39], a[80:83], v[80:83]
buffer_load_dwordx4 v3, s[16:19], s45 offen offset:0 lds
v_mfma_f32_16x16x32_bf16 v[84:87], v[28:31], a[52:55], v[84:87]
ds_read_b64_tr_b16 v[20:21], v10 offset:4096
v_mfma_f32_16x16x32_bf16 v[84:87], v[32:35], a[68:71], v[84:87]
ds_read_b64_tr_b16 v[22:23], v10 offset:6144
v_mfma_f32_16x16x32_bf16 v[84:87], v[36:39], a[84:87], v[84:87]
ds_read_b64_tr_b16 v[24:25], v10 offset:8192
v_mfma_f32_16x16x32_bf16 v[88:91], v[28:31], a[56:59], v[88:91]
ds_read_b64_tr_b16 v[26:27], v10 offset:10240
v_mfma_f32_16x16x32_bf16 v[88:91], v[32:35], a[72:75], v[88:91]
v_mfma_f32_16x16x32_bf16 v[88:91], v[36:39], a[88:91], v[88:91]
v_mfma_f32_16x16x32_bf16 v[92:95], v[28:31], a[60:63], v[92:95]
v_mfma_f32_16x16x32_bf16 v[92:95], v[32:35], a[76:79], v[92:95]
buffer_load_dwordx4 v2, s[16:19], s45 offen offset:1024 lds
v_mfma_f32_16x16x32_bf16 v[92:95], v[36:39], a[92:95], v[92:95]
s_waitcnt lgkmcnt(1)
v_mfma_f32_16x16x32_bf16 v[96:99], v[16:19], v[192:195], 0
ds_read_b64_tr_b16 v[28:29], v12 offset:0
v_mfma_f32_16x16x32_bf16 v[96:99], v[20:23], v[208:211], v[96:99]
s_waitcnt lgkmcnt(1)
ds_read_b64_tr_b16 v[30:31], v12 offset:2048
v_mfma_f32_16x16x32_bf16 v[96:99], v[24:27], v[224:227], v[96:99]
ds_read_b64_tr_b16 v[32:33], v12 offset:4096
v_mfma_f32_16x16x32_bf16 v[100:103], v[16:19], v[196:199], 0
ds_read_b64_tr_b16 v[34:35], v12 offset:6144
v_cvt_pk_bf16_f32 v144, v64, v65
v_mfma_f32_16x16x32_bf16 v[100:103], v[20:23], v[212:215], v[100:103]
ds_read_b64_tr_b16 v[36:37], v12 offset:8192
v_cvt_pk_bf16_f32 v145, v66, v67
v_mfma_f32_16x16x32_bf16 v[100:103], v[24:27], v[228:231], v[100:103]
ds_read_b64_tr_b16 v[38:39], v12 offset:10240
v_cvt_pk_bf16_f32 v146, v80, v81
v_mfma_f32_16x16x32_bf16 v[104:107], v[16:19], v[200:203], 0
buffer_load_dwordx4 v4, s[16:19], s45 offen offset:2048 lds
v_mfma_f32_16x16x32_bf16 v[104:107], v[20:23], v[216:219], v[104:107]
v_cvt_pk_bf16_f32 v147, v82, v83
v_cvt_pk_bf16_f32 v148, v68, v69
v_mfma_f32_16x16x32_bf16 v[104:107], v[24:27], v[232:235], v[104:107]
v_cvt_pk_bf16_f32 v149, v70, v71
v_cvt_pk_bf16_f32 v150, v84, v85
v_mfma_f32_16x16x32_bf16 v[108:111], v[16:19], v[204:207], 0
v_cvt_pk_bf16_f32 v151, v86, v87
v_cvt_pk_bf16_f32 v152, v72, v73
v_mfma_f32_16x16x32_bf16 v[108:111], v[20:23], v[220:223], v[108:111]
v_cvt_pk_bf16_f32 v153, v74, v75
v_cvt_pk_bf16_f32 v154, v88, v89
v_mfma_f32_16x16x32_bf16 v[108:111], v[24:27], v[236:239], v[108:111]
s_waitcnt lgkmcnt(0)
v_cvt_pk_bf16_f32 v155, v90, v91
v_cvt_pk_bf16_f32 v156, v76, v77
v_mfma_f32_16x16x32_bf16 v[112:115], v[28:31], v[192:195], 0
ds_read_b64_tr_b16 v[16:17], v10 offset:12288
v_cvt_pk_bf16_f32 v157, v78, v79
v_mfma_f32_16x16x32_bf16 v[112:115], v[32:35], v[208:211], v[112:115]
ds_read_b64_tr_b16 v[18:19], v10 offset:14336
v_cvt_pk_bf16_f32 v158, v92, v93
s_add_u32 m0, s97, 98304
v_mfma_f32_16x16x32_bf16 v[112:115], v[36:39], v[224:227], v[112:115]
s_add_u32 s45, s98, 221568
buffer_load_dwordx4 v3, s[16:19], s45 offen offset:0 lds
v_mfma_f32_16x16x32_bf16 v[116:119], v[28:31], v[196:199], 0
ds_read_b64_tr_b16 v[20:21], v10 offset:16384
v_cvt_pk_bf16_f32 v159, v94, v95
v_mfma_f32_16x16x32_bf16 v[116:119], v[32:35], v[212:215], v[116:119]
ds_read_b64_tr_b16 v[22:23], v10 offset:18432
v_mfma_f32_16x16x32_bf16 v[116:119], v[36:39], v[228:231], v[116:119]
ds_read_b64_tr_b16 v[24:25], v10 offset:20480
v_mfma_f32_16x16x32_bf16 v[120:123], v[28:31], v[200:203], 0
ds_read_b64_tr_b16 v[26:27], v10 offset:22528
s_add_u32 s51, s50, 1024
v_mfma_f32_16x16x32_bf16 v[120:123], v[32:35], v[216:219], v[120:123]
buffer_store_dwordx4 v[144:147], v9, s[24:27], s51 offen sc1
v_mfma_f32_16x16x32_bf16 v[120:123], v[36:39], v[232:235], v[120:123]
v_mfma_f32_16x16x32_bf16 v[124:127], v[28:31], v[204:207], 0
s_add_u32 s51, s50, 19456
v_mfma_f32_16x16x32_bf16 v[124:127], v[32:35], v[220:223], v[124:127]
buffer_load_dwordx4 v2, s[16:19], s45 offen offset:1024 lds
v_mfma_f32_16x16x32_bf16 v[124:127], v[36:39], v[236:239], v[124:127]
s_waitcnt lgkmcnt(1)
buffer_store_dwordx4 v[148:151], v9, s[24:27], s51 offen sc1
v_mfma_f32_16x16x32_bf16 v[96:99], v[16:19], a[0:3], v[96:99]
ds_read_b64_tr_b16 v[28:29], v12 offset:12288
v_mfma_f32_16x16x32_bf16 v[96:99], v[20:23], a[16:19], v[96:99]
s_waitcnt lgkmcnt(1)
ds_read_b64_tr_b16 v[30:31], v12 offset:14336
v_mfma_f32_16x16x32_bf16 v[96:99], v[24:27], a[32:35], v[96:99]
ds_read_b64_tr_b16 v[32:33], v12 offset:16384
v_mfma_f32_16x16x32_bf16 v[100:103], v[16:19], a[4:7], v[100:103]
ds_read_b64_tr_b16 v[34:35], v12 offset:18432
v_mfma_f32_16x16x32_bf16 v[100:103], v[20:23], a[20:23], v[100:103]
ds_read_b64_tr_b16 v[36:37], v12 offset:20480
s_add_u32 s51, s50, 37888
v_mfma_f32_16x16x32_bf16 v[100:103], v[24:27], a[36:39], v[100:103]
ds_read_b64_tr_b16 v[38:39], v12 offset:22528
s_add_u32 s45, s99, 221568
v_mfma_f32_16x16x32_bf16 v[104:107], v[16:19], a[8:11], v[104:107]
buffer_load_dwordx4 v4, s[16:19], s45 offen offset:2048 lds
v_mfma_f32_16x16x32_bf16 v[104:107], v[20:23], a[24:27], v[104:107]
buffer_store_dwordx4 v[152:155], v9, s[24:27], s51 offen sc1
v_mfma_f32_16x16x32_bf16 v[104:107], v[24:27], a[40:43], v[104:107]
v_mfma_f32_16x16x32_bf16 v[108:111], v[16:19], a[12:15], v[108:111]
s_add_u32 s51, s50, 56320
v_mfma_f32_16x16x32_bf16 v[108:111], v[20:23], a[28:31], v[108:111]
buffer_store_dwordx4 v[156:159], v9, s[24:27], s51 offen sc1
v_mfma_f32_16x16x32_bf16 v[108:111], v[24:27], a[44:47], v[108:111]
s_waitcnt lgkmcnt(0)
s_waitcnt vmcnt(10)
s_barrier
v_mfma_f32_16x16x32_bf16 v[112:115], v[28:31], a[0:3], v[112:115]
ds_read_b64_tr_b16 v[16:17], v10 offset:24576
s_add_u32 s45, s43, 512
v_mfma_f32_16x16x32_bf16 v[112:115], v[32:35], a[16:19], v[112:115]
ds_read_b64_tr_b16 v[18:19], v10 offset:26624
s_add_u32 m0, s97, 36864
v_mfma_f32_16x16x32_bf16 v[112:115], v[36:39], a[32:35], v[112:115]
buffer_load_dwordx4 v3, s[16:19], s45 offen offset:0 lds
v_mfma_f32_16x16x32_bf16 v[116:119], v[28:31], a[4:7], v[116:119]
ds_read_b64_tr_b16 v[20:21], v10 offset:28672
v_mfma_f32_16x16x32_bf16 v[116:119], v[32:35], a[20:23], v[116:119]
ds_read_b64_tr_b16 v[22:23], v10 offset:30720
v_mfma_f32_16x16x32_bf16 v[116:119], v[36:39], a[36:39], v[116:119]
ds_read_b64_tr_b16 v[24:25], v10 offset:32768
v_mfma_f32_16x16x32_bf16 v[120:123], v[28:31], a[8:11], v[120:123]
ds_read_b64_tr_b16 v[26:27], v10 offset:34816
v_mfma_f32_16x16x32_bf16 v[120:123], v[32:35], a[24:27], v[120:123]
v_mfma_f32_16x16x32_bf16 v[120:123], v[36:39], a[40:43], v[120:123]
v_mfma_f32_16x16x32_bf16 v[124:127], v[28:31], a[12:15], v[124:127]
v_mfma_f32_16x16x32_bf16 v[124:127], v[32:35], a[28:31], v[124:127]
buffer_load_dwordx4 v2, s[16:19], s45 offen offset:1024 lds
v_mfma_f32_16x16x32_bf16 v[124:127], v[36:39], a[44:47], v[124:127]
s_waitcnt lgkmcnt(1)
v_mfma_f32_16x16x32_bf16 v[96:99], v[16:19], a[48:51], v[96:99]
ds_read_b64_tr_b16 v[28:29], v12 offset:24576
v_mfma_f32_16x16x32_bf16 v[96:99], v[20:23], a[64:67], v[96:99]
s_waitcnt lgkmcnt(1)
ds_read_b64_tr_b16 v[30:31], v12 offset:26624
v_mfma_f32_16x16x32_bf16 v[96:99], v[24:27], a[80:83], v[96:99]
ds_read_b64_tr_b16 v[32:33], v12 offset:28672
v_mfma_f32_16x16x32_bf16 v[100:103], v[16:19], a[52:55], v[100:103]
ds_read_b64_tr_b16 v[34:35], v12 offset:30720
v_mfma_f32_16x16x32_bf16 v[100:103], v[20:23], a[68:71], v[100:103]
ds_read_b64_tr_b16 v[36:37], v12 offset:32768
v_mfma_f32_16x16x32_bf16 v[100:103], v[24:27], a[84:87], v[100:103]
ds_read_b64_tr_b16 v[38:39], v12 offset:34816
v_mfma_f32_16x16x32_bf16 v[104:107], v[16:19], a[56:59], v[104:107]
buffer_load_dwordx4 v4, s[16:19], s45 offen offset:2048 lds
v_mfma_f32_16x16x32_bf16 v[104:107], v[20:23], a[72:75], v[104:107]
v_mfma_f32_16x16x32_bf16 v[104:107], v[24:27], a[88:91], v[104:107]
v_mfma_f32_16x16x32_bf16 v[108:111], v[16:19], a[60:63], v[108:111]
v_mfma_f32_16x16x32_bf16 v[108:111], v[20:23], a[76:79], v[108:111]
v_mfma_f32_16x16x32_bf16 v[108:111], v[24:27], a[92:95], v[108:111]
s_waitcnt lgkmcnt(0)
v_mfma_f32_16x16x32_bf16 v[112:115], v[28:31], a[48:51], v[112:115]
ds_read_b64_tr_b16 v[16:17], v11 offset:0
s_add_u32 s45, s43, 111104
v_mfma_f32_16x16x32_bf16 v[112:115], v[32:35], a[64:67], v[112:115]
ds_read_b64_tr_b16 v[18:19], v11 offset:2048
s_add_u32 m0, s97, 49152
v_mfma_f32_16x16x32_bf16 v[112:115], v[36:39], a[80:83], v[112:115]
buffer_load_dwordx4 v3, s[16:19], s45 offen offset:0 lds
v_mfma_f32_16x16x32_bf16 v[116:119], v[28:31], a[52:55], v[116:119]
ds_read_b64_tr_b16 v[20:21], v11 offset:4096
v_mfma_f32_16x16x32_bf16 v[116:119], v[32:35], a[68:71], v[116:119]
ds_read_b64_tr_b16 v[22:23], v11 offset:6144
v_mfma_f32_16x16x32_bf16 v[116:119], v[36:39], a[84:87], v[116:119]
ds_read_b64_tr_b16 v[24:25], v11 offset:8192
v_mfma_f32_16x16x32_bf16 v[120:123], v[28:31], a[56:59], v[120:123]
ds_read_b64_tr_b16 v[26:27], v11 offset:10240
v_mfma_f32_16x16x32_bf16 v[120:123], v[32:35], a[72:75], v[120:123]
v_mfma_f32_16x16x32_bf16 v[120:123], v[36:39], a[88:91], v[120:123]
v_mfma_f32_16x16x32_bf16 v[124:127], v[28:31], a[60:63], v[124:127]
v_mfma_f32_16x16x32_bf16 v[124:127], v[32:35], a[76:79], v[124:127]
buffer_load_dwordx4 v2, s[16:19], s45 offen offset:1024 lds
v_mfma_f32_16x16x32_bf16 v[124:127], v[36:39], a[92:95], v[124:127]
s_waitcnt lgkmcnt(1)
v_mfma_f32_16x16x32_bf16 v[64:67], v[16:19], v[192:195], 0
ds_read_b64_tr_b16 v[28:29], v13 offset:0
v_mfma_f32_16x16x32_bf16 v[64:67], v[20:23], v[208:211], v[64:67]
s_waitcnt lgkmcnt(1)
ds_read_b64_tr_b16 v[30:31], v13 offset:2048
v_mfma_f32_16x16x32_bf16 v[64:67], v[24:27], v[224:227], v[64:67]
ds_read_b64_tr_b16 v[32:33], v13 offset:4096
v_mfma_f32_16x16x32_bf16 v[68:71], v[16:19], v[196:199], 0
ds_read_b64_tr_b16 v[34:35], v13 offset:6144
v_cvt_pk_bf16_f32 v128, v96, v97
v_mfma_f32_16x16x32_bf16 v[68:71], v[20:23], v[212:215], v[68:71]
ds_read_b64_tr_b16 v[36:37], v13 offset:8192
v_cvt_pk_bf16_f32 v129, v98, v99
v_mfma_f32_16x16x32_bf16 v[68:71], v[24:27], v[228:231], v[68:71]
ds_read_b64_tr_b16 v[38:39], v13 offset:10240
v_cvt_pk_bf16_f32 v130, v112, v113
v_mfma_f32_16x16x32_bf16 v[72:75], v[16:19], v[200:203], 0
buffer_load_dwordx4 v4, s[16:19], s45 offen offset:2048 lds
v_mfma_f32_16x16x32_bf16 v[72:75], v[20:23], v[216:219], v[72:75]
v_cvt_pk_bf16_f32 v131, v114, v115
v_cvt_pk_bf16_f32 v132, v100, v101
v_mfma_f32_16x16x32_bf16 v[72:75], v[24:27], v[232:235], v[72:75]
v_cvt_pk_bf16_f32 v133, v102, v103
v_cvt_pk_bf16_f32 v134, v116, v117
v_mfma_f32_16x16x32_bf16 v[76:79], v[16:19], v[204:207], 0
v_cvt_pk_bf16_f32 v135, v118, v119
v_cvt_pk_bf16_f32 v136, v104, v105
v_mfma_f32_16x16x32_bf16 v[76:79], v[20:23], v[220:223], v[76:79]
v_cvt_pk_bf16_f32 v137, v106, v107
v_cvt_pk_bf16_f32 v138, v120, v121
v_mfma_f32_16x16x32_bf16 v[76:79], v[24:27], v[236:239], v[76:79]
s_waitcnt lgkmcnt(0)
s_waitcnt vmcnt(8)
s_barrier
v_cvt_pk_bf16_f32 v139, v122, v123
v_cvt_pk_bf16_f32 v140, v108, v109
v_mfma_f32_16x16x32_bf16 v[80:83], v[28:31], v[192:195], 0
ds_read_b64_tr_b16 v[16:17], v11 offset:12288
v_cvt_pk_bf16_f32 v141, v110, v111
v_mfma_f32_16x16x32_bf16 v[80:83], v[32:35], v[208:211], v[80:83]
ds_read_b64_tr_b16 v[18:19], v11 offset:14336
v_cvt_pk_bf16_f32 v142, v124, v125
s_add_u32 m0, s97, 61440
v_mfma_f32_16x16x32_bf16 v[80:83], v[36:39], v[224:227], v[80:83]
s_add_u32 s45, s98, 221696
buffer_load_dwordx4 v3, s[16:19], s45 offen offset:0 lds
v_mfma_f32_16x16x32_bf16 v[84:87], v[28:31], v[196:199], 0
ds_read_b64_tr_b16 v[20:21], v11 offset:16384
v_cvt_pk_bf16_f32 v143, v126, v127
v_mfma_f32_16x16x32_bf16 v[84:87], v[32:35], v[212:215], v[84:87]
ds_read_b64_tr_b16 v[22:23], v11 offset:18432
v_mfma_f32_16x16x32_bf16 v[84:87], v[36:39], v[228:231], v[84:87]
ds_read_b64_tr_b16 v[24:25], v11 offset:20480
v_mfma_f32_16x16x32_bf16 v[88:91], v[28:31], v[200:203], 0
ds_read_b64_tr_b16 v[26:27], v11 offset:22528
s_add_u32 s51, s50, 2048
v_mfma_f32_16x16x32_bf16 v[88:91], v[32:35], v[216:219], v[88:91]
buffer_store_dwordx4 v[128:131], v9, s[24:27], s51 offen sc1
v_mfma_f32_16x16x32_bf16 v[88:91], v[36:39], v[232:235], v[88:91]
v_mfma_f32_16x16x32_bf16 v[92:95], v[28:31], v[204:207], 0
s_add_u32 s51, s50, 20480
v_mfma_f32_16x16x32_bf16 v[92:95], v[32:35], v[220:223], v[92:95]
buffer_load_dwordx4 v2, s[16:19], s45 offen offset:1024 lds
v_mfma_f32_16x16x32_bf16 v[92:95], v[36:39], v[236:239], v[92:95]
s_waitcnt lgkmcnt(1)
buffer_store_dwordx4 v[132:135], v9, s[24:27], s51 offen sc1
v_mfma_f32_16x16x32_bf16 v[64:67], v[16:19], a[0:3], v[64:67]
s_waitcnt vmcnt(10)
ds_read_b64_tr_b16 v[28:29], v13 offset:12288
v_mfma_f32_16x16x32_bf16 v[64:67], v[20:23], a[16:19], v[64:67]
s_waitcnt lgkmcnt(1)
ds_read_b64_tr_b16 v[30:31], v13 offset:14336
v_mfma_f32_16x16x32_bf16 v[64:67], v[24:27], a[32:35], v[64:67]
ds_read_b64_tr_b16 v[32:33], v13 offset:16384
v_mfma_f32_16x16x32_bf16 v[68:71], v[16:19], a[4:7], v[68:71]
ds_read_b64_tr_b16 v[34:35], v13 offset:18432
v_mfma_f32_16x16x32_bf16 v[68:71], v[20:23], a[20:23], v[68:71]
ds_read_b64_tr_b16 v[36:37], v13 offset:20480
s_add_u32 s51, s50, 38912
v_mfma_f32_16x16x32_bf16 v[68:71], v[24:27], a[36:39], v[68:71]
ds_read_b64_tr_b16 v[38:39], v13 offset:22528
s_add_u32 s45, s99, 221696
v_mfma_f32_16x16x32_bf16 v[72:75], v[16:19], a[8:11], v[72:75]
buffer_load_dwordx4 v4, s[16:19], s45 offen offset:2048 lds
v_mfma_f32_16x16x32_bf16 v[72:75], v[20:23], a[24:27], v[72:75]
buffer_store_dwordx4 v[136:139], v9, s[24:27], s51 offen sc1
v_mfma_f32_16x16x32_bf16 v[72:75], v[24:27], a[40:43], v[72:75]
buffer_store_dword v0, v0, s[24:27], s55 offen offset:64 sc1
v_mfma_f32_16x16x32_bf16 v[76:79], v[16:19], a[12:15], v[76:79]
s_add_u32 s51, s50, 57344
v_mfma_f32_16x16x32_bf16 v[76:79], v[20:23], a[28:31], v[76:79]
buffer_store_dwordx4 v[140:143], v9, s[24:27], s51 offen sc1
v_mfma_f32_16x16x32_bf16 v[76:79], v[24:27], a[44:47], v[76:79]
s_waitcnt lgkmcnt(0)
v_mfma_f32_16x16x32_bf16 v[80:83], v[28:31], a[0:3], v[80:83]
ds_read_b64_tr_b16 v[16:17], v11 offset:24576
s_add_u32 s45, s43, 640
v_mfma_f32_16x16x32_bf16 v[80:83], v[32:35], a[16:19], v[80:83]
ds_read_b64_tr_b16 v[18:19], v11 offset:26624
s_add_u32 m0, s97, 73728
v_mfma_f32_16x16x32_bf16 v[80:83], v[36:39], a[32:35], v[80:83]
buffer_load_dwordx4 v3, s[16:19], s45 offen offset:0 lds
v_mfma_f32_16x16x32_bf16 v[84:87], v[28:31], a[4:7], v[84:87]
ds_read_b64_tr_b16 v[20:21], v11 offset:28672
v_mfma_f32_16x16x32_bf16 v[84:87], v[32:35], a[20:23], v[84:87]
ds_read_b64_tr_b16 v[22:23], v11 offset:30720
v_mfma_f32_16x16x32_bf16 v[84:87], v[36:39], a[36:39], v[84:87]
ds_read_b64_tr_b16 v[24:25], v11 offset:32768
v_mfma_f32_16x16x32_bf16 v[88:91], v[28:31], a[8:11], v[88:91]
ds_read_b64_tr_b16 v[26:27], v11 offset:34816
v_mfma_f32_16x16x32_bf16 v[88:91], v[32:35], a[24:27], v[88:91]
v_mfma_f32_16x16x32_bf16 v[88:91], v[36:39], a[40:43], v[88:91]
v_mfma_f32_16x16x32_bf16 v[92:95], v[28:31], a[12:15], v[92:95]
v_mfma_f32_16x16x32_bf16 v[92:95], v[32:35], a[28:31], v[92:95]
buffer_load_dwordx4 v2, s[16:19], s45 offen offset:1024 lds
v_mfma_f32_16x16x32_bf16 v[92:95], v[36:39], a[44:47], v[92:95]
s_waitcnt lgkmcnt(1)
v_mfma_f32_16x16x32_bf16 v[64:67], v[16:19], a[48:51], v[64:67]
ds_read_b64_tr_b16 v[28:29], v13 offset:24576
v_mfma_f32_16x16x32_bf16 v[64:67], v[20:23], a[64:67], v[64:67]
s_waitcnt lgkmcnt(1)
ds_read_b64_tr_b16 v[30:31], v13 offset:26624
v_mfma_f32_16x16x32_bf16 v[64:67], v[24:27], a[80:83], v[64:67]
ds_read_b64_tr_b16 v[32:33], v13 offset:28672
v_mfma_f32_16x16x32_bf16 v[68:71], v[16:19], a[52:55], v[68:71]
ds_read_b64_tr_b16 v[34:35], v13 offset:30720
v_mfma_f32_16x16x32_bf16 v[68:71], v[20:23], a[68:71], v[68:71]
ds_read_b64_tr_b16 v[36:37], v13 offset:32768
v_mfma_f32_16x16x32_bf16 v[68:71], v[24:27], a[84:87], v[68:71]
ds_read_b64_tr_b16 v[38:39], v13 offset:34816
v_mfma_f32_16x16x32_bf16 v[72:75], v[16:19], a[56:59], v[72:75]
buffer_load_dwordx4 v4, s[16:19], s45 offen offset:2048 lds
v_mfma_f32_16x16x32_bf16 v[72:75], v[20:23], a[72:75], v[72:75]
v_mfma_f32_16x16x32_bf16 v[72:75], v[24:27], a[88:91], v[72:75]
v_mfma_f32_16x16x32_bf16 v[76:79], v[16:19], a[60:63], v[76:79]
v_mfma_f32_16x16x32_bf16 v[76:79], v[20:23], a[76:79], v[76:79]
v_mfma_f32_16x16x32_bf16 v[76:79], v[24:27], a[92:95], v[76:79]
s_waitcnt lgkmcnt(0)
s_waitcnt vmcnt(11)
s_barrier
v_mfma_f32_16x16x32_bf16 v[80:83], v[28:31], a[48:51], v[80:83]
ds_read_b64_tr_b16 v[16:17], v10 offset:0
s_add_u32 s45, s43, 111232
v_mfma_f32_16x16x32_bf16 v[80:83], v[32:35], a[64:67], v[80:83]
ds_read_b64_tr_b16 v[18:19], v10 offset:2048
s_add_u32 m0, s97, 86016
v_mfma_f32_16x16x32_bf16 v[80:83], v[36:39], a[80:83], v[80:83]
buffer_load_dwordx4 v3, s[16:19], s45 offen offset:0 lds
v_mfma_f32_16x16x32_bf16 v[84:87], v[28:31], a[52:55], v[84:87]
ds_read_b64_tr_b16 v[20:21], v10 offset:4096
v_mfma_f32_16x16x32_bf16 v[84:87], v[32:35], a[68:71], v[84:87]
ds_read_b64_tr_b16 v[22:23], v10 offset:6144
v_mfma_f32_16x16x32_bf16 v[84:87], v[36:39], a[84:87], v[84:87]
ds_read_b64_tr_b16 v[24:25], v10 offset:8192
v_mfma_f32_16x16x32_bf16 v[88:91], v[28:31], a[56:59], v[88:91]
ds_read_b64_tr_b16 v[26:27], v10 offset:10240
v_mfma_f32_16x16x32_bf16 v[88:91], v[32:35], a[72:75], v[88:91]
v_mfma_f32_16x16x32_bf16 v[88:91], v[36:39], a[88:91], v[88:91]
v_mfma_f32_16x16x32_bf16 v[92:95], v[28:31], a[60:63], v[92:95]
v_mfma_f32_16x16x32_bf16 v[92:95], v[32:35], a[76:79], v[92:95]
buffer_load_dwordx4 v2, s[16:19], s45 offen offset:1024 lds
v_mfma_f32_16x16x32_bf16 v[92:95], v[36:39], a[92:95], v[92:95]
s_waitcnt lgkmcnt(1)
v_mfma_f32_16x16x32_bf16 v[96:99], v[16:19], v[192:195], 0
ds_read_b64_tr_b16 v[28:29], v12 offset:0
v_mfma_f32_16x16x32_bf16 v[96:99], v[20:23], v[208:211], v[96:99]
s_waitcnt lgkmcnt(1)
ds_read_b64_tr_b16 v[30:31], v12 offset:2048
v_mfma_f32_16x16x32_bf16 v[96:99], v[24:27], v[224:227], v[96:99]
ds_read_b64_tr_b16 v[32:33], v12 offset:4096
v_mfma_f32_16x16x32_bf16 v[100:103], v[16:19], v[196:199], 0
ds_read_b64_tr_b16 v[34:35], v12 offset:6144
v_cvt_pk_bf16_f32 v144, v64, v65
v_mfma_f32_16x16x32_bf16 v[100:103], v[20:23], v[212:215], v[100:103]
ds_read_b64_tr_b16 v[36:37], v12 offset:8192
v_cvt_pk_bf16_f32 v145, v66, v67
v_mfma_f32_16x16x32_bf16 v[100:103], v[24:27], v[228:231], v[100:103]
ds_read_b64_tr_b16 v[38:39], v12 offset:10240
v_cvt_pk_bf16_f32 v146, v80, v81
v_mfma_f32_16x16x32_bf16 v[104:107], v[16:19], v[200:203], 0
buffer_load_dwordx4 v4, s[16:19], s45 offen offset:2048 lds
v_mfma_f32_16x16x32_bf16 v[104:107], v[20:23], v[216:219], v[104:107]
v_cvt_pk_bf16_f32 v147, v82, v83
v_cvt_pk_bf16_f32 v148, v68, v69
v_mfma_f32_16x16x32_bf16 v[104:107], v[24:27], v[232:235], v[104:107]
v_cvt_pk_bf16_f32 v149, v70, v71
v_cvt_pk_bf16_f32 v150, v84, v85
v_mfma_f32_16x16x32_bf16 v[108:111], v[16:19], v[204:207], 0
v_cvt_pk_bf16_f32 v151, v86, v87
v_cvt_pk_bf16_f32 v152, v72, v73
v_mfma_f32_16x16x32_bf16 v[108:111], v[20:23], v[220:223], v[108:111]
v_cvt_pk_bf16_f32 v153, v74, v75
v_cvt_pk_bf16_f32 v154, v88, v89
v_mfma_f32_16x16x32_bf16 v[108:111], v[24:27], v[236:239], v[108:111]
s_waitcnt lgkmcnt(0)
v_cvt_pk_bf16_f32 v155, v90, v91
v_cvt_pk_bf16_f32 v156, v76, v77
v_mfma_f32_16x16x32_bf16 v[112:115], v[28:31], v[192:195], 0
ds_read_b64_tr_b16 v[16:17], v10 offset:12288
v_cvt_pk_bf16_f32 v157, v78, v79
v_mfma_f32_16x16x32_bf16 v[112:115], v[32:35], v[208:211], v[112:115]
ds_read_b64_tr_b16 v[18:19], v10 offset:14336
v_cvt_pk_bf16_f32 v158, v92, v93
s_add_u32 m0, s97, 98304
v_mfma_f32_16x16x32_bf16 v[112:115], v[36:39], v[224:227], v[112:115]
s_add_u32 s45, s98, 221824
buffer_load_dwordx4 v3, s[16:19], s45 offen offset:0 lds
v_mfma_f32_16x16x32_bf16 v[116:119], v[28:31], v[196:199], 0
ds_read_b64_tr_b16 v[20:21], v10 offset:16384
v_cvt_pk_bf16_f32 v159, v94, v95
v_mfma_f32_16x16x32_bf16 v[116:119], v[32:35], v[212:215], v[116:119]
ds_read_b64_tr_b16 v[22:23], v10 offset:18432
v_mfma_f32_16x16x32_bf16 v[116:119], v[36:39], v[228:231], v[116:119]
ds_read_b64_tr_b16 v[24:25], v10 offset:20480
v_mfma_f32_16x16x32_bf16 v[120:123], v[28:31], v[200:203], 0
ds_read_b64_tr_b16 v[26:27], v10 offset:22528
s_add_u32 s51, s50, 3072
v_mfma_f32_16x16x32_bf16 v[120:123], v[32:35], v[216:219], v[120:123]
buffer_store_dwordx4 v[144:147], v9, s[24:27], s51 offen sc1
v_mfma_f32_16x16x32_bf16 v[120:123], v[36:39], v[232:235], v[120:123]
v_mfma_f32_16x16x32_bf16 v[124:127], v[28:31], v[204:207], 0
s_add_u32 s51, s50, 21504
v_mfma_f32_16x16x32_bf16 v[124:127], v[32:35], v[220:223], v[124:127]
buffer_load_dwordx4 v2, s[16:19], s45 offen offset:1024 lds
v_mfma_f32_16x16x32_bf16 v[124:127], v[36:39], v[236:239], v[124:127]
s_waitcnt lgkmcnt(1)
buffer_store_dwordx4 v[148:151], v9, s[24:27], s51 offen sc1
v_mfma_f32_16x16x32_bf16 v[96:99], v[16:19], a[0:3], v[96:99]
ds_read_b64_tr_b16 v[28:29], v12 offset:12288
v_mfma_f32_16x16x32_bf16 v[96:99], v[20:23], a[16:19], v[96:99]
s_waitcnt lgkmcnt(1)
ds_read_b64_tr_b16 v[30:31], v12 offset:14336
v_mfma_f32_16x16x32_bf16 v[96:99], v[24:27], a[32:35], v[96:99]
ds_read_b64_tr_b16 v[32:33], v12 offset:16384
v_mfma_f32_16x16x32_bf16 v[100:103], v[16:19], a[4:7], v[100:103]
ds_read_b64_tr_b16 v[34:35], v12 offset:18432
v_mfma_f32_16x16x32_bf16 v[100:103], v[20:23], a[20:23], v[100:103]
ds_read_b64_tr_b16 v[36:37], v12 offset:20480
s_add_u32 s51, s50, 39936
v_mfma_f32_16x16x32_bf16 v[100:103], v[24:27], a[36:39], v[100:103]
ds_read_b64_tr_b16 v[38:39], v12 offset:22528
s_add_u32 s45, s99, 221824
v_mfma_f32_16x16x32_bf16 v[104:107], v[16:19], a[8:11], v[104:107]
buffer_load_dwordx4 v4, s[16:19], s45 offen offset:2048 lds
v_mfma_f32_16x16x32_bf16 v[104:107], v[20:23], a[24:27], v[104:107]
buffer_store_dwordx4 v[152:155], v9, s[24:27], s51 offen sc1
v_mfma_f32_16x16x32_bf16 v[104:107], v[24:27], a[40:43], v[104:107]
v_mfma_f32_16x16x32_bf16 v[108:111], v[16:19], a[12:15], v[108:111]
s_add_u32 s51, s50, 58368
v_mfma_f32_16x16x32_bf16 v[108:111], v[20:23], a[28:31], v[108:111]
buffer_store_dwordx4 v[156:159], v9, s[24:27], s51 offen sc1
v_mfma_f32_16x16x32_bf16 v[108:111], v[24:27], a[44:47], v[108:111]
s_waitcnt lgkmcnt(0)
s_waitcnt vmcnt(10)
s_barrier
v_mfma_f32_16x16x32_bf16 v[112:115], v[28:31], a[0:3], v[112:115]
ds_read_b64_tr_b16 v[16:17], v10 offset:24576
s_add_u32 s45, s43, 768
v_mfma_f32_16x16x32_bf16 v[112:115], v[32:35], a[16:19], v[112:115]
ds_read_b64_tr_b16 v[18:19], v10 offset:26624
s_add_u32 m0, s97, 36864
v_mfma_f32_16x16x32_bf16 v[112:115], v[36:39], a[32:35], v[112:115]
buffer_load_dwordx4 v3, s[16:19], s45 offen offset:0 lds
v_mfma_f32_16x16x32_bf16 v[116:119], v[28:31], a[4:7], v[116:119]
ds_read_b64_tr_b16 v[20:21], v10 offset:28672
v_mfma_f32_16x16x32_bf16 v[116:119], v[32:35], a[20:23], v[116:119]
ds_read_b64_tr_b16 v[22:23], v10 offset:30720
v_mfma_f32_16x16x32_bf16 v[116:119], v[36:39], a[36:39], v[116:119]
ds_read_b64_tr_b16 v[24:25], v10 offset:32768
v_mfma_f32_16x16x32_bf16 v[120:123], v[28:31], a[8:11], v[120:123]
ds_read_b64_tr_b16 v[26:27], v10 offset:34816
v_mfma_f32_16x16x32_bf16 v[120:123], v[32:35], a[24:27], v[120:123]
v_mfma_f32_16x16x32_bf16 v[120:123], v[36:39], a[40:43], v[120:123]
v_mfma_f32_16x16x32_bf16 v[124:127], v[28:31], a[12:15], v[124:127]
v_mfma_f32_16x16x32_bf16 v[124:127], v[32:35], a[28:31], v[124:127]
buffer_load_dwordx4 v2, s[16:19], s45 offen offset:1024 lds
v_mfma_f32_16x16x32_bf16 v[124:127], v[36:39], a[44:47], v[124:127]
s_waitcnt lgkmcnt(1)
v_mfma_f32_16x16x32_bf16 v[96:99], v[16:19], a[48:51], v[96:99]
ds_read_b64_tr_b16 v[28:29], v12 offset:24576
v_mfma_f32_16x16x32_bf16 v[96:99], v[20:23], a[64:67], v[96:99]
s_waitcnt lgkmcnt(1)
ds_read_b64_tr_b16 v[30:31], v12 offset:26624
v_mfma_f32_16x16x32_bf16 v[96:99], v[24:27], a[80:83], v[96:99]
ds_read_b64_tr_b16 v[32:33], v12 offset:28672
v_mfma_f32_16x16x32_bf16 v[100:103], v[16:19], a[52:55], v[100:103]
ds_read_b64_tr_b16 v[34:35], v12 offset:30720
v_mfma_f32_16x16x32_bf16 v[100:103], v[20:23], a[68:71], v[100:103]
ds_read_b64_tr_b16 v[36:37], v12 offset:32768
v_mfma_f32_16x16x32_bf16 v[100:103], v[24:27], a[84:87], v[100:103]
ds_read_b64_tr_b16 v[38:39], v12 offset:34816
v_mfma_f32_16x16x32_bf16 v[104:107], v[16:19], a[56:59], v[104:107]
buffer_load_dwordx4 v4, s[16:19], s45 offen offset:2048 lds
v_mfma_f32_16x16x32_bf16 v[104:107], v[20:23], a[72:75], v[104:107]
v_mfma_f32_16x16x32_bf16 v[104:107], v[24:27], a[88:91], v[104:107]
v_mfma_f32_16x16x32_bf16 v[108:111], v[16:19], a[60:63], v[108:111]
v_mfma_f32_16x16x32_bf16 v[108:111], v[20:23], a[76:79], v[108:111]
v_mfma_f32_16x16x32_bf16 v[108:111], v[24:27], a[92:95], v[108:111]
s_waitcnt lgkmcnt(0)
v_mfma_f32_16x16x32_bf16 v[112:115], v[28:31], a[48:51], v[112:115]
ds_read_b64_tr_b16 v[16:17], v11 offset:0
s_add_u32 s45, s43, 111360
v_mfma_f32_16x16x32_bf16 v[112:115], v[32:35], a[64:67], v[112:115]
ds_read_b64_tr_b16 v[18:19], v11 offset:2048
s_add_u32 m0, s97, 49152
v_mfma_f32_16x16x32_bf16 v[112:115], v[36:39], a[80:83], v[112:115]
buffer_load_dwordx4 v3, s[16:19], s45 offen offset:0 lds
v_mfma_f32_16x16x32_bf16 v[116:119], v[28:31], a[52:55], v[116:119]
ds_read_b64_tr_b16 v[20:21], v11 offset:4096
v_mfma_f32_16x16x32_bf16 v[116:119], v[32:35], a[68:71], v[116:119]
ds_read_b64_tr_b16 v[22:23], v11 offset:6144
v_mfma_f32_16x16x32_bf16 v[116:119], v[36:39], a[84:87], v[116:119]
ds_read_b64_tr_b16 v[24:25], v11 offset:8192
v_mfma_f32_16x16x32_bf16 v[120:123], v[28:31], a[56:59], v[120:123]
ds_read_b64_tr_b16 v[26:27], v11 offset:10240
s_add_u32 s7, s33, 131072
v_mfma_f32_16x16x32_bf16 v[120:123], v[32:35], a[72:75], v[120:123]
buffer_load_dword v254, v255, s[24:27], s7 offen offset:64 sc1
v_mfma_f32_16x16x32_bf16 v[120:123], v[36:39], a[88:91], v[120:123]
v_mfma_f32_16x16x32_bf16 v[124:127], v[28:31], a[60:63], v[124:127]
v_mfma_f32_16x16x32_bf16 v[124:127], v[32:35], a[76:79], v[124:127]
buffer_load_dwordx4 v2, s[16:19], s45 offen offset:1024 lds
v_mfma_f32_16x16x32_bf16 v[124:127], v[36:39], a[92:95], v[124:127]
s_waitcnt lgkmcnt(1)
v_mfma_f32_16x16x32_bf16 v[64:67], v[16:19], v[192:195], 0
ds_read_b64_tr_b16 v[28:29], v13 offset:0
v_mfma_f32_16x16x32_bf16 v[64:67], v[20:23], v[208:211], v[64:67]
s_waitcnt lgkmcnt(1)
ds_read_b64_tr_b16 v[30:31], v13 offset:2048
v_mfma_f32_16x16x32_bf16 v[64:67], v[24:27], v[224:227], v[64:67]
ds_read_b64_tr_b16 v[32:33], v13 offset:4096
v_mfma_f32_16x16x32_bf16 v[68:71], v[16:19], v[196:199], 0
ds_read_b64_tr_b16 v[34:35], v13 offset:6144
v_cvt_pk_bf16_f32 v128, v96, v97
v_mfma_f32_16x16x32_bf16 v[68:71], v[20:23], v[212:215], v[68:71]
ds_read_b64_tr_b16 v[36:37], v13 offset:8192
v_cvt_pk_bf16_f32 v129, v98, v99
v_mfma_f32_16x16x32_bf16 v[68:71], v[24:27], v[228:231], v[68:71]
ds_read_b64_tr_b16 v[38:39], v13 offset:10240
v_cvt_pk_bf16_f32 v130, v112, v113
v_mfma_f32_16x16x32_bf16 v[72:75], v[16:19], v[200:203], 0
buffer_load_dwordx4 v4, s[16:19], s45 offen offset:2048 lds
v_mfma_f32_16x16x32_bf16 v[72:75], v[20:23], v[216:219], v[72:75]
v_cvt_pk_bf16_f32 v131, v114, v115
v_cvt_pk_bf16_f32 v132, v100, v101
v_mfma_f32_16x16x32_bf16 v[72:75], v[24:27], v[232:235], v[72:75]
v_cvt_pk_bf16_f32 v133, v102, v103
v_cvt_pk_bf16_f32 v134, v116, v117
v_mfma_f32_16x16x32_bf16 v[76:79], v[16:19], v[204:207], 0
v_cvt_pk_bf16_f32 v135, v118, v119
v_cvt_pk_bf16_f32 v136, v104, v105
v_mfma_f32_16x16x32_bf16 v[76:79], v[20:23], v[220:223], v[76:79]
v_cvt_pk_bf16_f32 v137, v106, v107
v_cvt_pk_bf16_f32 v138, v120, v121
v_mfma_f32_16x16x32_bf16 v[76:79], v[24:27], v[236:239], v[76:79]
s_waitcnt lgkmcnt(0)
s_waitcnt vmcnt(9)
s_barrier
v_cvt_pk_bf16_f32 v139, v122, v123
v_cvt_pk_bf16_f32 v140, v108, v109
v_mfma_f32_16x16x32_bf16 v[80:83], v[28:31], v[192:195], 0
ds_read_b64_tr_b16 v[16:17], v11 offset:12288
v_cvt_pk_bf16_f32 v141, v110, v111
v_mfma_f32_16x16x32_bf16 v[80:83], v[32:35], v[208:211], v[80:83]
ds_read_b64_tr_b16 v[18:19], v11 offset:14336
v_cvt_pk_bf16_f32 v142, v124, v125
s_add_u32 m0, s97, 61440
v_mfma_f32_16x16x32_bf16 v[80:83], v[36:39], v[224:227], v[80:83]
s_add_u32 s45, s98, 221952
buffer_load_dwordx4 v3, s[16:19], s45 offen offset:0 lds
v_mfma_f32_16x16x32_bf16 v[84:87], v[28:31], v[196:199], 0
ds_read_b64_tr_b16 v[20:21], v11 offset:16384
v_cvt_pk_bf16_f32 v143, v126, v127
v_mfma_f32_16x16x32_bf16 v[84:87], v[32:35], v[212:215], v[84:87]
ds_read_b64_tr_b16 v[22:23], v11 offset:18432
v_mfma_f32_16x16x32_bf16 v[84:87], v[36:39], v[228:231], v[84:87]
ds_read_b64_tr_b16 v[24:25], v11 offset:20480
v_mfma_f32_16x16x32_bf16 v[88:91], v[28:31], v[200:203], 0
ds_read_b64_tr_b16 v[26:27], v11 offset:22528
s_add_u32 s51, s50, 4096
v_mfma_f32_16x16x32_bf16 v[88:91], v[32:35], v[216:219], v[88:91]
buffer_store_dwordx4 v[128:131], v9, s[24:27], s51 offen sc1
v_mfma_f32_16x16x32_bf16 v[88:91], v[36:39], v[232:235], v[88:91]
v_mfma_f32_16x16x32_bf16 v[92:95], v[28:31], v[204:207], 0
s_add_u32 s51, s50, 22528
v_mfma_f32_16x16x32_bf16 v[92:95], v[32:35], v[220:223], v[92:95]
buffer_load_dwordx4 v2, s[16:19], s45 offen offset:1024 lds
v_mfma_f32_16x16x32_bf16 v[92:95], v[36:39], v[236:239], v[92:95]
s_waitcnt lgkmcnt(1)
buffer_store_dwordx4 v[132:135], v9, s[24:27], s51 offen sc1
v_mfma_f32_16x16x32_bf16 v[64:67], v[16:19], a[0:3], v[64:67]
s_waitcnt vmcnt(11)
ds_read_b64_tr_b16 v[28:29], v13 offset:12288
v_mfma_f32_16x16x32_bf16 v[64:67], v[20:23], a[16:19], v[64:67]
s_waitcnt lgkmcnt(1)
ds_read_b64_tr_b16 v[30:31], v13 offset:14336
v_mfma_f32_16x16x32_bf16 v[64:67], v[24:27], a[32:35], v[64:67]
ds_read_b64_tr_b16 v[32:33], v13 offset:16384
v_mfma_f32_16x16x32_bf16 v[68:71], v[16:19], a[4:7], v[68:71]
ds_read_b64_tr_b16 v[34:35], v13 offset:18432
v_mfma_f32_16x16x32_bf16 v[68:71], v[20:23], a[20:23], v[68:71]
ds_read_b64_tr_b16 v[36:37], v13 offset:20480
s_add_u32 s51, s50, 40960
v_mfma_f32_16x16x32_bf16 v[68:71], v[24:27], a[36:39], v[68:71]
ds_read_b64_tr_b16 v[38:39], v13 offset:22528
s_add_u32 s45, s99, 221952
v_mfma_f32_16x16x32_bf16 v[72:75], v[16:19], a[8:11], v[72:75]
buffer_load_dwordx4 v4, s[16:19], s45 offen offset:2048 lds
v_mfma_f32_16x16x32_bf16 v[72:75], v[20:23], a[24:27], v[72:75]
buffer_store_dwordx4 v[136:139], v9, s[24:27], s51 offen sc1
v_mfma_f32_16x16x32_bf16 v[72:75], v[24:27], a[40:43], v[72:75]
buffer_store_dword v0, v0, s[24:27], s55 offen offset:576 sc1
v_mfma_f32_16x16x32_bf16 v[76:79], v[16:19], a[12:15], v[76:79]
s_add_u32 s51, s50, 59392
v_mfma_f32_16x16x32_bf16 v[76:79], v[20:23], a[28:31], v[76:79]
buffer_store_dwordx4 v[140:143], v9, s[24:27], s51 offen sc1
v_mfma_f32_16x16x32_bf16 v[76:79], v[24:27], a[44:47], v[76:79]
s_waitcnt lgkmcnt(0)
v_mfma_f32_16x16x32_bf16 v[80:83], v[28:31], a[0:3], v[80:83]
ds_read_b64_tr_b16 v[16:17], v11 offset:24576
s_add_u32 s45, s43, 896
v_mfma_f32_16x16x32_bf16 v[80:83], v[32:35], a[16:19], v[80:83]
ds_read_b64_tr_b16 v[18:19], v11 offset:26624
s_add_u32 m0, s97, 73728
v_mfma_f32_16x16x32_bf16 v[80:83], v[36:39], a[32:35], v[80:83]
buffer_load_dwordx4 v3, s[16:19], s45 offen offset:0 lds
v_mfma_f32_16x16x32_bf16 v[84:87], v[28:31], a[4:7], v[84:87]
ds_read_b64_tr_b16 v[20:21], v11 offset:28672
v_mfma_f32_16x16x32_bf16 v[84:87], v[32:35], a[20:23], v[84:87]
ds_read_b64_tr_b16 v[22:23], v11 offset:30720
v_mfma_f32_16x16x32_bf16 v[84:87], v[36:39], a[36:39], v[84:87]
ds_read_b64_tr_b16 v[24:25], v11 offset:32768
v_mfma_f32_16x16x32_bf16 v[88:91], v[28:31], a[8:11], v[88:91]
ds_read_b64_tr_b16 v[26:27], v11 offset:34816
v_mfma_f32_16x16x32_bf16 v[88:91], v[32:35], a[24:27], v[88:91]
v_mfma_f32_16x16x32_bf16 v[88:91], v[36:39], a[40:43], v[88:91]
v_mfma_f32_16x16x32_bf16 v[92:95], v[28:31], a[12:15], v[92:95]
v_mfma_f32_16x16x32_bf16 v[92:95], v[32:35], a[28:31], v[92:95]
buffer_load_dwordx4 v2, s[16:19], s45 offen offset:1024 lds
v_mfma_f32_16x16x32_bf16 v[92:95], v[36:39], a[44:47], v[92:95]
s_waitcnt lgkmcnt(1)
v_mfma_f32_16x16x32_bf16 v[64:67], v[16:19], a[48:51], v[64:67]
s_waitcnt vmcnt(12)
ds_read_b64_tr_b16 v[28:29], v13 offset:24576
v_cmp_eq_u32 s[30:31], 0, v254
v_mfma_f32_16x16x32_bf16 v[64:67], v[20:23], a[64:67], v[64:67]
s_waitcnt lgkmcnt(1)
ds_read_b64_tr_b16 v[30:31], v13 offset:26624
v_mfma_f32_16x16x32_bf16 v[64:67], v[24:27], a[80:83], v[64:67]
s_cmp_eq_u64 s[30:31], 0
s_cselect_b32 s28, s60, 0x10000000
ds_read_b64_tr_b16 v[32:33], v13 offset:28672
v_mfma_f32_16x16x32_bf16 v[68:71], v[16:19], a[52:55], v[68:71]
ds_read_b64_tr_b16 v[34:35], v13 offset:30720
v_mfma_f32_16x16x32_bf16 v[68:71], v[20:23], a[68:71], v[68:71]
ds_read_b64_tr_b16 v[36:37], v13 offset:32768
v_mfma_f32_16x16x32_bf16 v[68:71], v[24:27], a[84:87], v[68:71]
ds_read_b64_tr_b16 v[38:39], v13 offset:34816
s_add_u32 s7, s28, 67108864
v_mfma_f32_16x16x32_bf16 v[72:75], v[16:19], a[56:59], v[72:75]
buffer_load_dwordx4 v4, s[16:19], s45 offen offset:2048 lds
v_mfma_f32_16x16x32_bf16 v[72:75], v[20:23], a[72:75], v[72:75]
buffer_load_dwordx4 a[96:99], v248, s[24:27], s7 offen sc1
v_mfma_f32_16x16x32_bf16 v[72:75], v[24:27], a[88:91], v[72:75]
s_add_u32 s7, s28, 76546048
buffer_load_dwordx4 a[100:103], v248, s[24:27], s7 offen sc1
v_mfma_f32_16x16x32_bf16 v[76:79], v[16:19], a[60:63], v[76:79]
s_add_u32 s7, s28, 85983232
buffer_load_dwordx4 a[104:107], v248, s[24:27], s7 offen sc1
v_mfma_f32_16x16x32_bf16 v[76:79], v[20:23], a[76:79], v[76:79]
s_add_u32 s7, s28, 95420416
buffer_load_dwordx4 a[108:111], v248, s[24:27], s7 offen sc1
v_mfma_f32_16x16x32_bf16 v[76:79], v[24:27], a[92:95], v[76:79]
s_waitcnt lgkmcnt(0)
s_waitcnt vmcnt(15)
s_barrier
v_mfma_f32_16x16x32_bf16 v[80:83], v[28:31], a[48:51], v[80:83]
ds_read_b64_tr_b16 v[16:17], v10 offset:0
s_add_u32 s45, s43, 111488
v_mfma_f32_16x16x32_bf16 v[80:83], v[32:35], a[64:67], v[80:83]
ds_read_b64_tr_b16 v[18:19], v10 offset:2048
s_add_u32 m0, s97, 86016
v_mfma_f32_16x16x32_bf16 v[80:83], v[36:39], a[80:83], v[80:83]
buffer_load_dwordx4 v3, s[16:19], s45 offen offset:0 lds
v_mfma_f32_16x16x32_bf16 v[84:87], v[28:31], a[52:55], v[84:87]
ds_read_b64_tr_b16 v[20:21], v10 offset:4096
v_mfma_f32_16x16x32_bf16 v[84:87], v[32:35], a[68:71], v[84:87]
ds_read_b64_tr_b16 v[22:23], v10 offset:6144
v_mfma_f32_16x16x32_bf16 v[84:87], v[36:39], a[84:87], v[84:87]
ds_read_b64_tr_b16 v[24:25], v10 offset:8192
v_mfma_f32_16x16x32_bf16 v[88:91], v[28:31], a[56:59], v[88:91]
ds_read_b64_tr_b16 v[26:27], v10 offset:10240
s_add_u32 s7, s28, 67109888
v_mfma_f32_16x16x32_bf16 v[88:91], v[32:35], a[72:75], v[88:91]
buffer_load_dwordx4 a[112:115], v248, s[24:27], s7 offen sc1
v_mfma_f32_16x16x32_bf16 v[88:91], v[36:39], a[88:91], v[88:91]
s_add_u32 s7, s28, 76547072
buffer_load_dwordx4 a[116:119], v248, s[24:27], s7 offen sc1
v_mfma_f32_16x16x32_bf16 v[92:95], v[28:31], a[60:63], v[92:95]
s_add_u32 s7, s28, 85984256
buffer_load_dwordx4 a[120:123], v248, s[24:27], s7 offen sc1
v_mfma_f32_16x16x32_bf16 v[92:95], v[32:35], a[76:79], v[92:95]
buffer_load_dwordx4 v2, s[16:19], s45 offen offset:1024 lds
v_mfma_f32_16x16x32_bf16 v[92:95], v[36:39], a[92:95], v[92:95]
s_waitcnt lgkmcnt(1)
s_add_u32 s7, s28, 95421440
buffer_load_dwordx4 a[124:127], v248, s[24:27], s7 offen sc1
v_mfma_f32_16x16x32_bf16 v[96:99], v[16:19], v[192:195], 0
ds_read_b64_tr_b16 v[28:29], v12 offset:0
v_mfma_f32_16x16x32_bf16 v[96:99], v[20:23], v[208:211], v[96:99]
s_waitcnt lgkmcnt(1)
ds_read_b64_tr_b16 v[30:31], v12 offset:2048
v_mfma_f32_16x16x32_bf16 v[96:99], v[24:27], v[224:227], v[96:99]
ds_read_b64_tr_b16 v[32:33], v12 offset:4096
v_mfma_f32_16x16x32_bf16 v[100:103], v[16:19], v[196:199], 0
ds_read_b64_tr_b16 v[34:35], v12 offset:6144
v_cvt_pk_bf16_f32 v144, v64, v65
v_mfma_f32_16x16x32_bf16 v[100:103], v[20:23], v[212:215], v[100:103]
ds_read_b64_tr_b16 v[36:37], v12 offset:8192
v_cvt_pk_bf16_f32 v145, v66, v67
v_mfma_f32_16x16x32_bf16 v[100:103], v[24:27], v[228:231], v[100:103]
ds_read_b64_tr_b16 v[38:39], v12 offset:10240
v_cvt_pk_bf16_f32 v146, v80, v81
v_mfma_f32_16x16x32_bf16 v[104:107], v[16:19], v[200:203], 0
buffer_load_dwordx4 v4, s[16:19], s45 offen offset:2048 lds
v_mfma_f32_16x16x32_bf16 v[104:107], v[20:23], v[216:219], v[104:107]
v_cvt_pk_bf16_f32 v147, v82, v83
v_cvt_pk_bf16_f32 v148, v68, v69
v_mfma_f32_16x16x32_bf16 v[104:107], v[24:27], v[232:235], v[104:107]
v_cvt_pk_bf16_f32 v149, v70, v71
v_cvt_pk_bf16_f32 v150, v84, v85
v_mfma_f32_16x16x32_bf16 v[108:111], v[16:19], v[204:207], 0
v_cvt_pk_bf16_f32 v151, v86, v87
v_cvt_pk_bf16_f32 v152, v72, v73
v_mfma_f32_16x16x32_bf16 v[108:111], v[20:23], v[220:223], v[108:111]
v_cvt_pk_bf16_f32 v153, v74, v75
v_cvt_pk_bf16_f32 v154, v88, v89
v_mfma_f32_16x16x32_bf16 v[108:111], v[24:27], v[236:239], v[108:111]
s_waitcnt lgkmcnt(0)
v_cvt_pk_bf16_f32 v155, v90, v91
v_cvt_pk_bf16_f32 v156, v76, v77
v_mfma_f32_16x16x32_bf16 v[112:115], v[28:31], v[192:195], 0
ds_read_b64_tr_b16 v[16:17], v10 offset:12288
v_cvt_pk_bf16_f32 v157, v78, v79
v_mfma_f32_16x16x32_bf16 v[112:115], v[32:35], v[208:211], v[112:115]
ds_read_b64_tr_b16 v[18:19], v10 offset:14336
v_cvt_pk_bf16_f32 v158, v92, v93
s_add_u32 m0, s97, 98304
v_mfma_f32_16x16x32_bf16 v[112:115], v[36:39], v[224:227], v[112:115]
s_add_u32 s45, s98, 222080
buffer_load_dwordx4 v3, s[16:19], s45 offen offset:0 lds
v_mfma_f32_16x16x32_bf16 v[116:119], v[28:31], v[196:199], 0
ds_read_b64_tr_b16 v[20:21], v10 offset:16384
v_cvt_pk_bf16_f32 v159, v94, v95
v_mfma_f32_16x16x32_bf16 v[116:119], v[32:35], v[212:215], v[116:119]
ds_read_b64_tr_b16 v[22:23], v10 offset:18432
v_mfma_f32_16x16x32_bf16 v[116:119], v[36:39], v[228:231], v[116:119]
ds_read_b64_tr_b16 v[24:25], v10 offset:20480
v_mfma_f32_16x16x32_bf16 v[120:123], v[28:31], v[200:203], 0
ds_read_b64_tr_b16 v[26:27], v10 offset:22528
s_add_u32 s51, s50, 5120
v_mfma_f32_16x16x32_bf16 v[120:123], v[32:35], v[216:219], v[120:123]
buffer_store_dwordx4 v[144:147], v9, s[24:27], s51 offen sc1
v_mfma_f32_16x16x32_bf16 v[120:123], v[36:39], v[232:235], v[120:123]
v_mfma_f32_16x16x32_bf16 v[124:127], v[28:31], v[204:207], 0
s_add_u32 s51, s50, 23552
v_mfma_f32_16x16x32_bf16 v[124:127], v[32:35], v[220:223], v[124:127]
buffer_load_dwordx4 v2, s[16:19], s45 offen offset:1024 lds
v_mfma_f32_16x16x32_bf16 v[124:127], v[36:39], v[236:239], v[124:127]
s_waitcnt lgkmcnt(1)
buffer_store_dwordx4 v[148:151], v9, s[24:27], s51 offen sc1
v_mfma_f32_16x16x32_bf16 v[96:99], v[16:19], a[0:3], v[96:99]
ds_read_b64_tr_b16 v[28:29], v12 offset:12288
v_mfma_f32_16x16x32_bf16 v[96:99], v[20:23], a[16:19], v[96:99]
s_waitcnt lgkmcnt(1)
ds_read_b64_tr_b16 v[30:31], v12 offset:14336
v_mfma_f32_16x16x32_bf16 v[96:99], v[24:27], a[32:35], v[96:99]
ds_read_b64_tr_b16 v[32:33], v12 offset:16384
v_mfma_f32_16x16x32_bf16 v[100:103], v[16:19], a[4:7], v[100:103]
ds_read_b64_tr_b16 v[34:35], v12 offset:18432
v_mfma_f32_16x16x32_bf16 v[100:103], v[20:23], a[20:23], v[100:103]
ds_read_b64_tr_b16 v[36:37], v12 offset:20480
s_add_u32 s51, s50, 41984
v_mfma_f32_16x16x32_bf16 v[100:103], v[24:27], a[36:39], v[100:103]
ds_read_b64_tr_b16 v[38:39], v12 offset:22528
s_add_u32 s45, s99, 222080
v_mfma_f32_16x16x32_bf16 v[104:107], v[16:19], a[8:11], v[104:107]
buffer_load_dwordx4 v4, s[16:19], s45 offen offset:2048 lds
v_mfma_f32_16x16x32_bf16 v[104:107], v[20:23], a[24:27], v[104:107]
buffer_store_dwordx4 v[152:155], v9, s[24:27], s51 offen sc1
v_mfma_f32_16x16x32_bf16 v[104:107], v[24:27], a[40:43], v[104:107]
v_mfma_f32_16x16x32_bf16 v[108:111], v[16:19], a[12:15], v[108:111]
s_add_u32 s51, s50, 60416
v_mfma_f32_16x16x32_bf16 v[108:111], v[20:23], a[28:31], v[108:111]
buffer_store_dwordx4 v[156:159], v9, s[24:27], s51 offen sc1
v_mfma_f32_16x16x32_bf16 v[108:111], v[24:27], a[44:47], v[108:111]
s_waitcnt lgkmcnt(0)
s_waitcnt vmcnt(18)
s_barrier
v_mfma_f32_16x16x32_bf16 v[112:115], v[28:31], a[0:3], v[112:115]
ds_read_b64_tr_b16 v[16:17], v10 offset:24576
s_add_u32 s45, s43, 1024
v_mfma_f32_16x16x32_bf16 v[112:115], v[32:35], a[16:19], v[112:115]
ds_read_b64_tr_b16 v[18:19], v10 offset:26624
s_add_u32 m0, s97, 36864
v_mfma_f32_16x16x32_bf16 v[112:115], v[36:39], a[32:35], v[112:115]
buffer_load_dwordx4 v3, s[16:19], s45 offen offset:0 lds
v_mfma_f32_16x16x32_bf16 v[116:119], v[28:31], a[4:7], v[116:119]
ds_read_b64_tr_b16 v[20:21], v10 offset:28672
v_mfma_f32_16x16x32_bf16 v[116:119], v[32:35], a[20:23], v[116:119]
ds_read_b64_tr_b16 v[22:23], v10 offset:30720
v_mfma_f32_16x16x32_bf16 v[116:119], v[36:39], a[36:39], v[116:119]
ds_read_b64_tr_b16 v[24:25], v10 offset:32768
v_mfma_f32_16x16x32_bf16 v[120:123], v[28:31], a[8:11], v[120:123]
ds_read_b64_tr_b16 v[26:27], v10 offset:34816
v_mfma_f32_16x16x32_bf16 v[120:123], v[32:35], a[24:27], v[120:123]
v_mfma_f32_16x16x32_bf16 v[120:123], v[36:39], a[40:43], v[120:123]
v_mfma_f32_16x16x32_bf16 v[124:127], v[28:31], a[12:15], v[124:127]
v_mfma_f32_16x16x32_bf16 v[124:127], v[32:35], a[28:31], v[124:127]
buffer_load_dwordx4 v2, s[16:19], s45 offen offset:1024 lds
v_mfma_f32_16x16x32_bf16 v[124:127], v[36:39], a[44:47], v[124:127]
s_waitcnt lgkmcnt(1)
v_mfma_f32_16x16x32_bf16 v[96:99], v[16:19], a[48:51], v[96:99]
ds_read_b64_tr_b16 v[28:29], v12 offset:24576
v_mfma_f32_16x16x32_bf16 v[96:99], v[20:23], a[64:67], v[96:99]
s_waitcnt lgkmcnt(1)
ds_read_b64_tr_b16 v[30:31], v12 offset:26624
v_mfma_f32_16x16x32_bf16 v[96:99], v[24:27], a[80:83], v[96:99]
ds_read_b64_tr_b16 v[32:33], v12 offset:28672
v_mfma_f32_16x16x32_bf16 v[100:103], v[16:19], a[52:55], v[100:103]
ds_read_b64_tr_b16 v[34:35], v12 offset:30720
v_mfma_f32_16x16x32_bf16 v[100:103], v[20:23], a[68:71], v[100:103]
ds_read_b64_tr_b16 v[36:37], v12 offset:32768
v_mfma_f32_16x16x32_bf16 v[100:103], v[24:27], a[84:87], v[100:103]
ds_read_b64_tr_b16 v[38:39], v12 offset:34816
v_mfma_f32_16x16x32_bf16 v[104:107], v[16:19], a[56:59], v[104:107]
buffer_load_dwordx4 v4, s[16:19], s45 offen offset:2048 lds
v_mfma_f32_16x16x32_bf16 v[104:107], v[20:23], a[72:75], v[104:107]
v_mfma_f32_16x16x32_bf16 v[104:107], v[24:27], a[88:91], v[104:107]
v_mfma_f32_16x16x32_bf16 v[108:111], v[16:19], a[60:63], v[108:111]
v_mfma_f32_16x16x32_bf16 v[108:111], v[20:23], a[76:79], v[108:111]
v_mfma_f32_16x16x32_bf16 v[108:111], v[24:27], a[92:95], v[108:111]
s_waitcnt lgkmcnt(0)
v_mfma_f32_16x16x32_bf16 v[112:115], v[28:31], a[48:51], v[112:115]
ds_read_b64_tr_b16 v[16:17], v11 offset:0
s_add_u32 s45, s43, 111616
v_mfma_f32_16x16x32_bf16 v[112:115], v[32:35], a[64:67], v[112:115]
ds_read_b64_tr_b16 v[18:19], v11 offset:2048
s_add_u32 m0, s97, 49152
v_mfma_f32_16x16x32_bf16 v[112:115], v[36:39], a[80:83], v[112:115]
buffer_load_dwordx4 v3, s[16:19], s45 offen offset:0 lds
v_mfma_f32_16x16x32_bf16 v[116:119], v[28:31], a[52:55], v[116:119]
ds_read_b64_tr_b16 v[20:21], v11 offset:4096
v_mfma_f32_16x16x32_bf16 v[116:119], v[32:35], a[68:71], v[116:119]
ds_read_b64_tr_b16 v[22:23], v11 offset:6144
v_mfma_f32_16x16x32_bf16 v[116:119], v[36:39], a[84:87], v[116:119]
ds_read_b64_tr_b16 v[24:25], v11 offset:8192
v_mfma_f32_16x16x32_bf16 v[120:123], v[28:31], a[56:59], v[120:123]
ds_read_b64_tr_b16 v[26:27], v11 offset:10240
s_add_u32 s7, s33, 131072
v_mfma_f32_16x16x32_bf16 v[120:123], v[32:35], a[72:75], v[120:123]
buffer_load_dword v254, v255, s[24:27], s7 offen offset:576 sc1
v_mfma_f32_16x16x32_bf16 v[120:123], v[36:39], a[88:91], v[120:123]
v_mfma_f32_16x16x32_bf16 v[124:127], v[28:31], a[60:63], v[124:127]
v_mfma_f32_16x16x32_bf16 v[124:127], v[32:35], a[76:79], v[124:127]
buffer_load_dwordx4 v2, s[16:19], s45 offen offset:1024 lds
v_mfma_f32_16x16x32_bf16 v[124:127], v[36:39], a[92:95], v[124:127]
s_waitcnt lgkmcnt(1)
v_mfma_f32_16x16x32_bf16 v[64:67], v[16:19], v[192:195], 0
ds_read_b64_tr_b16 v[28:29], v13 offset:0
v_mfma_f32_16x16x32_bf16 v[64:67], v[20:23], v[208:211], v[64:67]
s_waitcnt lgkmcnt(1)
ds_read_b64_tr_b16 v[30:31], v13 offset:2048
v_mfma_f32_16x16x32_bf16 v[64:67], v[24:27], v[224:227], v[64:67]
ds_read_b64_tr_b16 v[32:33], v13 offset:4096
v_mfma_f32_16x16x32_bf16 v[68:71], v[16:19], v[196:199], 0
ds_read_b64_tr_b16 v[34:35], v13 offset:6144
v_cvt_pk_bf16_f32 v128, v96, v97
v_mfma_f32_16x16x32_bf16 v[68:71], v[20:23], v[212:215], v[68:71]
ds_read_b64_tr_b16 v[36:37], v13 offset:8192
v_cvt_pk_bf16_f32 v129, v98, v99
v_mfma_f32_16x16x32_bf16 v[68:71], v[24:27], v[228:231], v[68:71]
ds_read_b64_tr_b16 v[38:39], v13 offset:10240
v_cvt_pk_bf16_f32 v130, v112, v113
v_mfma_f32_16x16x32_bf16 v[72:75], v[16:19], v[200:203], 0
buffer_load_dwordx4 v4, s[16:19], s45 offen offset:2048 lds
v_mfma_f32_16x16x32_bf16 v[72:75], v[20:23], v[216:219], v[72:75]
v_cvt_pk_bf16_f32 v131, v114, v115
v_cvt_pk_bf16_f32 v132, v100, v101
v_mfma_f32_16x16x32_bf16 v[72:75], v[24:27], v[232:235], v[72:75]
v_cvt_pk_bf16_f32 v133, v102, v103
v_cvt_pk_bf16_f32 v134, v116, v117
v_mfma_f32_16x16x32_bf16 v[76:79], v[16:19], v[204:207], 0
v_cvt_pk_bf16_f32 v135, v118, v119
v_cvt_pk_bf16_f32 v136, v104, v105
v_mfma_f32_16x16x32_bf16 v[76:79], v[20:23], v[220:223], v[76:79]
v_cvt_pk_bf16_f32 v137, v106, v107
v_cvt_pk_bf16_f32 v138, v120, v121
v_mfma_f32_16x16x32_bf16 v[76:79], v[24:27], v[236:239], v[76:79]
s_waitcnt lgkmcnt(0)
s_waitcnt vmcnt(9)
s_barrier
v_cvt_pk_bf16_f32 v139, v122, v123
v_cvt_pk_bf16_f32 v140, v108, v109
v_mfma_f32_16x16x32_bf16 v[80:83], v[28:31], v[192:195], 0
ds_read_b64_tr_b16 v[16:17], v11 offset:12288
v_cvt_pk_bf16_f32 v141, v110, v111
v_mfma_f32_16x16x32_bf16 v[80:83], v[32:35], v[208:211], v[80:83]
ds_read_b64_tr_b16 v[18:19], v11 offset:14336
v_cvt_pk_bf16_f32 v142, v124, v125
s_add_u32 m0, s97, 61440
v_mfma_f32_16x16x32_bf16 v[80:83], v[36:39], v[224:227], v[80:83]
s_add_u32 s45, s98, 222208
buffer_load_dwordx4 v3, s[16:19], s45 offen offset:0 lds
v_mfma_f32_16x16x32_bf16 v[84:87], v[28:31], v[196:199], 0
ds_read_b64_tr_b16 v[20:21], v11 offset:16384
v_cvt_pk_bf16_f32 v143, v126, v127
v_mfma_f32_16x16x32_bf16 v[84:87], v[32:35], v[212:215], v[84:87]
ds_read_b64_tr_b16 v[22:23], v11 offset:18432
v_mfma_f32_16x16x32_bf16 v[84:87], v[36:39], v[228:231], v[84:87]
ds_read_b64_tr_b16 v[24:25], v11 offset:20480
v_mfma_f32_16x16x32_bf16 v[88:91], v[28:31], v[200:203], 0
ds_read_b64_tr_b16 v[26:27], v11 offset:22528
s_add_u32 s51, s50, 6144
v_mfma_f32_16x16x32_bf16 v[88:91], v[32:35], v[216:219], v[88:91]
buffer_store_dwordx4 v[128:131], v9, s[24:27], s51 offen sc1
v_mfma_f32_16x16x32_bf16 v[88:91], v[36:39], v[232:235], v[88:91]
v_mfma_f32_16x16x32_bf16 v[92:95], v[28:31], v[204:207], 0
s_add_u32 s51, s50, 24576
v_mfma_f32_16x16x32_bf16 v[92:95], v[32:35], v[220:223], v[92:95]
buffer_load_dwordx4 v2, s[16:19], s45 offen offset:1024 lds
v_mfma_f32_16x16x32_bf16 v[92:95], v[36:39], v[236:239], v[92:95]
s_waitcnt lgkmcnt(1)
buffer_store_dwordx4 v[132:135], v9, s[24:27], s51 offen sc1
v_mfma_f32_16x16x32_bf16 v[64:67], v[16:19], a[0:3], v[64:67]
s_waitcnt vmcnt(11)
ds_read_b64_tr_b16 v[28:29], v13 offset:12288
v_mfma_f32_16x16x32_bf16 v[64:67], v[20:23], a[16:19], v[64:67]
s_waitcnt lgkmcnt(1)
ds_read_b64_tr_b16 v[30:31], v13 offset:14336
v_mfma_f32_16x16x32_bf16 v[64:67], v[24:27], a[32:35], v[64:67]
ds_read_b64_tr_b16 v[32:33], v13 offset:16384
v_mfma_f32_16x16x32_bf16 v[68:71], v[16:19], a[4:7], v[68:71]
ds_read_b64_tr_b16 v[34:35], v13 offset:18432
v_mfma_f32_16x16x32_bf16 v[68:71], v[20:23], a[20:23], v[68:71]
ds_read_b64_tr_b16 v[36:37], v13 offset:20480
s_add_u32 s51, s50, 43008
v_mfma_f32_16x16x32_bf16 v[68:71], v[24:27], a[36:39], v[68:71]
ds_read_b64_tr_b16 v[38:39], v13 offset:22528
s_add_u32 s45, s99, 222208
v_mfma_f32_16x16x32_bf16 v[72:75], v[16:19], a[8:11], v[72:75]
buffer_load_dwordx4 v4, s[16:19], s45 offen offset:2048 lds
v_mfma_f32_16x16x32_bf16 v[72:75], v[20:23], a[24:27], v[72:75]
buffer_store_dwordx4 v[136:139], v9, s[24:27], s51 offen sc1
v_mfma_f32_16x16x32_bf16 v[72:75], v[24:27], a[40:43], v[72:75]
buffer_store_dword v0, v0, s[24:27], s55 offen offset:1088 sc1
v_mfma_f32_16x16x32_bf16 v[76:79], v[16:19], a[12:15], v[76:79]
s_add_u32 s51, s50, 61440
v_mfma_f32_16x16x32_bf16 v[76:79], v[20:23], a[28:31], v[76:79]
buffer_store_dwordx4 v[140:143], v9, s[24:27], s51 offen sc1
v_mfma_f32_16x16x32_bf16 v[76:79], v[24:27], a[44:47], v[76:79]
s_waitcnt lgkmcnt(0)
v_mfma_f32_16x16x32_bf16 v[80:83], v[28:31], a[0:3], v[80:83]
ds_read_b64_tr_b16 v[16:17], v11 offset:24576
v_mfma_f32_16x16x32_bf16 v[80:83], v[32:35], a[16:19], v[80:83]
ds_read_b64_tr_b16 v[18:19], v11 offset:26624
v_mfma_f32_16x16x32_bf16 v[80:83], v[36:39], a[32:35], v[80:83]
ds_read_b64_tr_b16 v[20:21], v11 offset:28672
v_mfma_f32_16x16x32_bf16 v[84:87], v[28:31], a[4:7], v[84:87]
ds_read_b64_tr_b16 v[22:23], v11 offset:30720
v_mfma_f32_16x16x32_bf16 v[84:87], v[32:35], a[20:23], v[84:87]
ds_read_b64_tr_b16 v[24:25], v11 offset:32768
v_mfma_f32_16x16x32_bf16 v[84:87], v[36:39], a[36:39], v[84:87]
ds_read_b64_tr_b16 v[26:27], v11 offset:34816
v_mfma_f32_16x16x32_bf16 v[88:91], v[28:31], a[8:11], v[88:91]
v_mfma_f32_16x16x32_bf16 v[88:91], v[32:35], a[24:27], v[88:91]
v_mfma_f32_16x16x32_bf16 v[88:91], v[36:39], a[40:43], v[88:91]
v_mfma_f32_16x16x32_bf16 v[92:95], v[28:31], a[12:15], v[92:95]
v_mfma_f32_16x16x32_bf16 v[92:95], v[32:35], a[28:31], v[92:95]
v_mfma_f32_16x16x32_bf16 v[92:95], v[36:39], a[44:47], v[92:95]
s_waitcnt lgkmcnt(0)
v_mfma_f32_16x16x32_bf16 v[64:67], v[16:19], a[48:51], v[64:67]
s_waitcnt vmcnt(10)
ds_read_b64_tr_b16 v[28:29], v13 offset:24576
v_cmp_eq_u32 s[30:31], 0, v254
v_mfma_f32_16x16x32_bf16 v[64:67], v[20:23], a[64:67], v[64:67]
ds_read_b64_tr_b16 v[30:31], v13 offset:26624
v_mfma_f32_16x16x32_bf16 v[64:67], v[24:27], a[80:83], v[64:67]
s_cmp_eq_u64 s[30:31], 0
s_cselect_b32 s29, s60, 0x10000000
ds_read_b64_tr_b16 v[32:33], v13 offset:28672
v_mfma_f32_16x16x32_bf16 v[68:71], v[16:19], a[52:55], v[68:71]
ds_read_b64_tr_b16 v[34:35], v13 offset:30720
v_mfma_f32_16x16x32_bf16 v[68:71], v[20:23], a[68:71], v[68:71]
ds_read_b64_tr_b16 v[36:37], v13 offset:32768
v_mfma_f32_16x16x32_bf16 v[68:71], v[24:27], a[84:87], v[68:71]
ds_read_b64_tr_b16 v[38:39], v13 offset:34816
s_add_u32 s7, s29, 67110912
v_mfma_f32_16x16x32_bf16 v[72:75], v[16:19], a[56:59], v[72:75]
buffer_load_dwordx4 a[128:131], v248, s[24:27], s7 offen sc1
v_mfma_f32_16x16x32_bf16 v[72:75], v[20:23], a[72:75], v[72:75]
s_add_u32 s7, s29, 76548096
buffer_load_dwordx4 a[132:135], v248, s[24:27], s7 offen sc1
v_mfma_f32_16x16x32_bf16 v[72:75], v[24:27], a[88:91], v[72:75]
s_add_u32 s7, s29, 85985280
buffer_load_dwordx4 a[136:139], v248, s[24:27], s7 offen sc1
v_mfma_f32_16x16x32_bf16 v[76:79], v[16:19], a[60:63], v[76:79]
s_add_u32 s7, s29, 95422464
buffer_load_dwordx4 a[140:143], v248, s[24:27], s7 offen sc1
v_mfma_f32_16x16x32_bf16 v[76:79], v[20:23], a[76:79], v[76:79]
s_add_u32 s7, s29, 67111936
buffer_load_dwordx4 a[144:147], v248, s[24:27], s7 offen sc1
v_mfma_f32_16x16x32_bf16 v[76:79], v[24:27], a[92:95], v[76:79]
s_waitcnt lgkmcnt(0)
s_waitcnt vmcnt(13)
s_barrier
v_mfma_f32_16x16x32_bf16 v[80:83], v[28:31], a[48:51], v[80:83]
ds_read_b64_tr_b16 v[16:17], v10 offset:0
v_mfma_f32_16x16x32_bf16 v[80:83], v[32:35], a[64:67], v[80:83]
ds_read_b64_tr_b16 v[18:19], v10 offset:2048
v_mfma_f32_16x16x32_bf16 v[80:83], v[36:39], a[80:83], v[80:83]
ds_read_b64_tr_b16 v[20:21], v10 offset:4096
v_mfma_f32_16x16x32_bf16 v[84:87], v[28:31], a[52:55], v[84:87]
ds_read_b64_tr_b16 v[22:23], v10 offset:6144
v_mfma_f32_16x16x32_bf16 v[84:87], v[32:35], a[68:71], v[84:87]
ds_read_b64_tr_b16 v[24:25], v10 offset:8192
v_mfma_f32_16x16x32_bf16 v[84:87], v[36:39], a[84:87], v[84:87]
ds_read_b64_tr_b16 v[26:27], v10 offset:10240
s_add_u32 s7, s29, 76549120
v_mfma_f32_16x16x32_bf16 v[88:91], v[28:31], a[56:59], v[88:91]
buffer_load_dwordx4 a[148:151], v248, s[24:27], s7 offen sc1
v_mfma_f32_16x16x32_bf16 v[88:91], v[32:35], a[72:75], v[88:91]
s_add_u32 s7, s29, 85986304
buffer_load_dwordx4 a[152:155], v248, s[24:27], s7 offen sc1
v_mfma_f32_16x16x32_bf16 v[88:91], v[36:39], a[88:91], v[88:91]
s_add_u32 s7, s29, 95423488
buffer_load_dwordx4 a[156:159], v248, s[24:27], s7 offen sc1
v_mfma_f32_16x16x32_bf16 v[92:95], v[28:31], a[60:63], v[92:95]
v_mfma_f32_16x16x32_bf16 v[92:95], v[32:35], a[76:79], v[92:95]
v_mfma_f32_16x16x32_bf16 v[92:95], v[36:39], a[92:95], v[92:95]
s_waitcnt lgkmcnt(0)
v_mfma_f32_16x16x32_bf16 v[96:99], v[16:19], v[192:195], 0
ds_read_b64_tr_b16 v[28:29], v12 offset:0
v_mfma_f32_16x16x32_bf16 v[96:99], v[20:23], v[208:211], v[96:99]
ds_read_b64_tr_b16 v[30:31], v12 offset:2048
v_mfma_f32_16x16x32_bf16 v[96:99], v[24:27], v[224:227], v[96:99]
ds_read_b64_tr_b16 v[32:33], v12 offset:4096
v_mfma_f32_16x16x32_bf16 v[100:103], v[16:19], v[196:199], 0
ds_read_b64_tr_b16 v[34:35], v12 offset:6144
v_cvt_pk_bf16_f32 v144, v64, v65
v_mfma_f32_16x16x32_bf16 v[100:103], v[20:23], v[212:215], v[100:103]
ds_read_b64_tr_b16 v[36:37], v12 offset:8192
v_cvt_pk_bf16_f32 v145, v66, v67
v_mfma_f32_16x16x32_bf16 v[100:103], v[24:27], v[228:231], v[100:103]
ds_read_b64_tr_b16 v[38:39], v12 offset:10240
v_cvt_pk_bf16_f32 v146, v80, v81
v_mfma_f32_16x16x32_bf16 v[104:107], v[16:19], v[200:203], 0
v_cvt_pk_bf16_f32 v147, v82, v83
v_cvt_pk_bf16_f32 v148, v68, v69
v_mfma_f32_16x16x32_bf16 v[104:107], v[20:23], v[216:219], v[104:107]
v_cvt_pk_bf16_f32 v149, v70, v71
v_cvt_pk_bf16_f32 v150, v84, v85
v_mfma_f32_16x16x32_bf16 v[104:107], v[24:27], v[232:235], v[104:107]
v_cvt_pk_bf16_f32 v151, v86, v87
v_cvt_pk_bf16_f32 v152, v72, v73
v_mfma_f32_16x16x32_bf16 v[108:111], v[16:19], v[204:207], 0
v_cvt_pk_bf16_f32 v153, v74, v75
v_cvt_pk_bf16_f32 v154, v88, v89
v_mfma_f32_16x16x32_bf16 v[108:111], v[20:23], v[220:223], v[108:111]
v_cvt_pk_bf16_f32 v155, v90, v91
v_cvt_pk_bf16_f32 v156, v76, v77
v_mfma_f32_16x16x32_bf16 v[108:111], v[24:27], v[236:239], v[108:111]
s_waitcnt lgkmcnt(0)
v_cvt_pk_bf16_f32 v157, v78, v79
v_cvt_pk_bf16_f32 v158, v92, v93
v_mfma_f32_16x16x32_bf16 v[112:115], v[28:31], v[192:195], 0
ds_read_b64_tr_b16 v[16:17], v10 offset:12288
v_cvt_pk_bf16_f32 v159, v94, v95
v_mfma_f32_16x16x32_bf16 v[112:115], v[32:35], v[208:211], v[112:115]
ds_read_b64_tr_b16 v[18:19], v10 offset:14336
v_mfma_f32_16x16x32_bf16 v[112:115], v[36:39], v[224:227], v[112:115]
ds_read_b64_tr_b16 v[20:21], v10 offset:16384
v_mfma_f32_16x16x32_bf16 v[116:119], v[28:31], v[196:199], 0
ds_read_b64_tr_b16 v[22:23], v10 offset:18432
v_mfma_f32_16x16x32_bf16 v[116:119], v[32:35], v[212:215], v[116:119]
ds_read_b64_tr_b16 v[24:25], v10 offset:20480
v_mfma_f32_16x16x32_bf16 v[116:119], v[36:39], v[228:231], v[116:119]
ds_read_b64_tr_b16 v[26:27], v10 offset:22528
s_add_u32 s51, s50, 7168
v_mfma_f32_16x16x32_bf16 v[120:123], v[28:31], v[200:203], 0
buffer_store_dwordx4 v[144:147], v9, s[24:27], s51 offen sc1
v_mfma_f32_16x16x32_bf16 v[120:123], v[32:35], v[216:219], v[120:123]
v_mfma_f32_16x16x32_bf16 v[120:123], v[36:39], v[232:235], v[120:123]
s_add_u32 s51, s50, 25600
v_mfma_f32_16x16x32_bf16 v[124:127], v[28:31], v[204:207], 0
buffer_store_dwordx4 v[148:151], v9, s[24:27], s51 offen sc1
v_mfma_f32_16x16x32_bf16 v[124:127], v[32:35], v[220:223], v[124:127]
v_mfma_f32_16x16x32_bf16 v[124:127], v[36:39], v[236:239], v[124:127]
s_waitcnt lgkmcnt(0)
v_mfma_f32_16x16x32_bf16 v[96:99], v[16:19], a[0:3], v[96:99]
ds_read_b64_tr_b16 v[28:29], v12 offset:12288
v_mfma_f32_16x16x32_bf16 v[96:99], v[20:23], a[16:19], v[96:99]
ds_read_b64_tr_b16 v[30:31], v12 offset:14336
v_mfma_f32_16x16x32_bf16 v[96:99], v[24:27], a[32:35], v[96:99]
ds_read_b64_tr_b16 v[32:33], v12 offset:16384
v_mfma_f32_16x16x32_bf16 v[100:103], v[16:19], a[4:7], v[100:103]
ds_read_b64_tr_b16 v[34:35], v12 offset:18432
v_mfma_f32_16x16x32_bf16 v[100:103], v[20:23], a[20:23], v[100:103]
ds_read_b64_tr_b16 v[36:37], v12 offset:20480
v_mfma_f32_16x16x32_bf16 v[100:103], v[24:27], a[36:39], v[100:103]
ds_read_b64_tr_b16 v[38:39], v12 offset:22528
s_add_u32 s51, s50, 44032
v_mfma_f32_16x16x32_bf16 v[104:107], v[16:19], a[8:11], v[104:107]
buffer_store_dwordx4 v[152:155], v9, s[24:27], s51 offen sc1
v_mfma_f32_16x16x32_bf16 v[104:107], v[20:23], a[24:27], v[104:107]
v_mfma_f32_16x16x32_bf16 v[104:107], v[24:27], a[40:43], v[104:107]
s_add_u32 s51, s50, 62464
v_mfma_f32_16x16x32_bf16 v[108:111], v[16:19], a[12:15], v[108:111]
buffer_store_dwordx4 v[156:159], v9, s[24:27], s51 offen sc1
v_mfma_f32_16x16x32_bf16 v[108:111], v[20:23], a[28:31], v[108:111]
v_mfma_f32_16x16x32_bf16 v[108:111], v[24:27], a[44:47], v[108:111]
s_waitcnt lgkmcnt(0)
s_waitcnt vmcnt(15)
s_barrier
v_mfma_f32_16x16x32_bf16 v[112:115], v[28:31], a[0:3], v[112:115]
ds_read_b64_tr_b16 v[16:17], v10 offset:24576
v_mfma_f32_16x16x32_bf16 v[112:115], v[32:35], a[16:19], v[112:115]
ds_read_b64_tr_b16 v[18:19], v10 offset:26624
v_mfma_f32_16x16x32_bf16 v[112:115], v[36:39], a[32:35], v[112:115]
ds_read_b64_tr_b16 v[20:21], v10 offset:28672
v_mfma_f32_16x16x32_bf16 v[116:119], v[28:31], a[4:7], v[116:119]
ds_read_b64_tr_b16 v[22:23], v10 offset:30720
v_mfma_f32_16x16x32_bf16 v[116:119], v[32:35], a[20:23], v[116:119]
ds_read_b64_tr_b16 v[24:25], v10 offset:32768
v_mfma_f32_16x16x32_bf16 v[116:119], v[36:39], a[36:39], v[116:119]
ds_read_b64_tr_b16 v[26:27], v10 offset:34816
v_mfma_f32_16x16x32_bf16 v[120:123], v[28:31], a[8:11], v[120:123]
v_mfma_f32_16x16x32_bf16 v[120:123], v[32:35], a[24:27], v[120:123]
v_mfma_f32_16x16x32_bf16 v[120:123], v[36:39], a[40:43], v[120:123]
v_mfma_f32_16x16x32_bf16 v[124:127], v[28:31], a[12:15], v[124:127]
v_mfma_f32_16x16x32_bf16 v[124:127], v[32:35], a[28:31], v[124:127]
v_mfma_f32_16x16x32_bf16 v[124:127], v[36:39], a[44:47], v[124:127]
s_waitcnt lgkmcnt(0)
v_mfma_f32_16x16x32_bf16 v[96:99], v[16:19], a[48:51], v[96:99]
ds_read_b64_tr_b16 v[28:29], v12 offset:24576
v_mfma_f32_16x16x32_bf16 v[96:99], v[20:23], a[64:67], v[96:99]
ds_read_b64_tr_b16 v[30:31], v12 offset:26624
v_mfma_f32_16x16x32_bf16 v[96:99], v[24:27], a[80:83], v[96:99]
ds_read_b64_tr_b16 v[32:33], v12 offset:28672
v_mfma_f32_16x16x32_bf16 v[100:103], v[16:19], a[52:55], v[100:103]
ds_read_b64_tr_b16 v[34:35], v12 offset:30720
v_mfma_f32_16x16x32_bf16 v[100:103], v[20:23], a[68:71], v[100:103]
ds_read_b64_tr_b16 v[36:37], v12 offset:32768
v_mfma_f32_16x16x32_bf16 v[100:103], v[24:27], a[84:87], v[100:103]
ds_read_b64_tr_b16 v[38:39], v12 offset:34816
v_mfma_f32_16x16x32_bf16 v[104:107], v[16:19], a[56:59], v[104:107]
v_mfma_f32_16x16x32_bf16 v[104:107], v[20:23], a[72:75], v[104:107]
v_mfma_f32_16x16x32_bf16 v[104:107], v[24:27], a[88:91], v[104:107]
v_mfma_f32_16x16x32_bf16 v[108:111], v[16:19], a[60:63], v[108:111]
v_mfma_f32_16x16x32_bf16 v[108:111], v[20:23], a[76:79], v[108:111]
v_mfma_f32_16x16x32_bf16 v[108:111], v[24:27], a[92:95], v[108:111]
s_waitcnt lgkmcnt(0)
v_mfma_f32_16x16x32_bf16 v[112:115], v[28:31], a[48:51], v[112:115]
v_mfma_f32_16x16x32_bf16 v[112:115], v[32:35], a[64:67], v[112:115]
v_mfma_f32_16x16x32_bf16 v[112:115], v[36:39], a[80:83], v[112:115]
v_mfma_f32_16x16x32_bf16 v[116:119], v[28:31], a[52:55], v[116:119]
v_mfma_f32_16x16x32_bf16 v[116:119], v[32:35], a[68:71], v[116:119]
v_mfma_f32_16x16x32_bf16 v[116:119], v[36:39], a[84:87], v[116:119]
v_mfma_f32_16x16x32_bf16 v[120:123], v[28:31], a[56:59], v[120:123]
v_mfma_f32_16x16x32_bf16 v[120:123], v[32:35], a[72:75], v[120:123]
v_mfma_f32_16x16x32_bf16 v[120:123], v[36:39], a[88:91], v[120:123]
v_mfma_f32_16x16x32_bf16 v[124:127], v[28:31], a[60:63], v[124:127]
v_mfma_f32_16x16x32_bf16 v[124:127], v[32:35], a[76:79], v[124:127]
v_mfma_f32_16x16x32_bf16 v[124:127], v[36:39], a[92:95], v[124:127]
v_cvt_pk_bf16_f32 v128, v96, v97
v_cvt_pk_bf16_f32 v129, v98, v99
v_cvt_pk_bf16_f32 v130, v112, v113
v_cvt_pk_bf16_f32 v131, v114, v115
v_cvt_pk_bf16_f32 v132, v100, v101
v_cvt_pk_bf16_f32 v133, v102, v103
v_cvt_pk_bf16_f32 v134, v116, v117
v_cvt_pk_bf16_f32 v135, v118, v119
v_cvt_pk_bf16_f32 v136, v104, v105
v_cvt_pk_bf16_f32 v137, v106, v107
v_cvt_pk_bf16_f32 v138, v120, v121
v_cvt_pk_bf16_f32 v139, v122, v123
v_cvt_pk_bf16_f32 v140, v108, v109
v_cvt_pk_bf16_f32 v141, v110, v111
v_cvt_pk_bf16_f32 v142, v124, v125
v_cvt_pk_bf16_f32 v143, v126, v127
s_add_u32 s51, s50, 8192
buffer_store_dwordx4 v[128:131], v9, s[24:27], s51 offen sc1
s_add_u32 s51, s50, 26624
buffer_store_dwordx4 v[132:135], v9, s[24:27], s51 offen sc1
s_add_u32 s51, s50, 45056
buffer_store_dwordx4 v[136:139], v9, s[24:27], s51 offen sc1
s_add_u32 s51, s50, 63488
buffer_store_dwordx4 v[140:143], v9, s[24:27], s51 offen sc1
s_waitcnt vmcnt(4)
buffer_store_dword v0, v0, s[24:27], s55 offen offset:1600 sc1
s_cmp_eq_u32 s28, s60
s_cbranch_scc0 K1_m10
K1_r10:
s_cmp_eq_u32 s29, s60
s_cbranch_scc0 K1_m11
K1_r11:
s_add_u32 s38, s33, 1088
s_mov_b32 s39, 0x20000
s_and_b32 s6, s3, 1
s_cbranch_scc1 K1_poll5d
K1_poll5:
s_load_dwordx16 s[64:79], s[52:53], s38 glc
s_waitcnt lgkmcnt(0)
s_and_b64 s[64:65], s[64:65], s[72:73]
s_and_b64 s[66:67], s[66:67], s[74:75]
s_and_b64 s[68:69], s[68:69], s[76:77]
s_and_b64 s[70:71], s[70:71], s[78:79]
s_and_b64 s[64:65], s[64:65], s[68:69]
s_and_b64 s[66:67], s[66:67], s[70:71]
s_and_b64 s[64:65], s[64:65], s[66:67]
s_and_b32 s64, s64, s65
s_cbranch_scc1 K1_poll5d
s_sub_u32 s39, s39, 1
s_cbranch_scc0 K1_poll5
K1_poll5d:
s_barrier
s_add_u32 s7, s60, 67112960
buffer_load_dwordx4 a[160:163], v248, s[24:27], s7 offen sc1
s_add_u32 s7, s60, 76550144
buffer_load_dwordx4 a[164:167], v248, s[24:27], s7 offen sc1
s_add_u32 s7, s60, 85987328
buffer_load_dwordx4 a[168:171], v248, s[24:27], s7 offen sc1
s_add_u32 s7, s60, 95424512
buffer_load_dwordx4 a[172:175], v248, s[24:27], s7 offen sc1
s_add_u32 s7, s60, 67113984
buffer_load_dwordx4 a[176:179], v248, s[24:27], s7 offen sc1
s_add_u32 s7, s60, 76551168
buffer_load_dwordx4 a[180:183], v248, s[24:27], s7 offen sc1
s_add_u32 s7, s60, 85988352
buffer_load_dwordx4 a[184:187], v248, s[24:27], s7 offen sc1
s_add_u32 s7, s60, 95425536
buffer_load_dwordx4 a[188:191], v248, s[24:27], s7 offen sc1
s_waitcnt vmcnt(9)
buffer_store_dword v0, v0, s[24:27], s55 offen offset:2112 sc1
v_lshlrev_b32 v64, 16, v180
v_and_b32 v65, 0xffff0000, v180
v_lshlrev_b32 v66, 16, v181
v_and_b32 v67, 0xffff0000, v181
v_lshlrev_b32 v68, 16, v182
v_and_b32 v69, 0xffff0000, v182
v_lshlrev_b32 v70, 16, v183
v_and_b32 v71, 0xffff0000, v183
v_lshlrev_b32 v72, 16, v184
v_and_b32 v73, 0xffff0000, v184
v_lshlrev_b32 v74, 16, v185
v_and_b32 v75, 0xffff0000, v185
v_lshlrev_b32 v76, 16, v186
v_and_b32 v77, 0xffff0000, v186
v_lshlrev_b32 v78, 16, v187
v_and_b32 v79, 0xffff0000, v187
v_lshlrev_b32 v80, 16, v188
v_and_b32 v81, 0xffff0000, v188
v_lshlrev_b32 v82, 16, v189
v_and_b32 v83, 0xffff0000, v189
s_add_u32 s38, s33, 1600
s_mov_b32 s39, 0x20000
s_and_b32 s6, s3, 1
s_cbranch_scc1 K1_poll6d
K1_poll6:
s_load_dwordx16 s[64:79], s[52:53], s38 glc
s_waitcnt lgkmcnt(0)
s_and_b64 s[64:65], s[64:65], s[72:73]
s_and_b64 s[66:67], s[66:67], s[74:75]
s_and_b64 s[68:69], s[68:69], s[76:77]
s_and_b64 s[70:71], s[70:71], s[78:79]
s_and_b64 s[64:65], s[64:65], s[68:69]
s_and_b64 s[66:67], s[66:67], s[70:71]
s_and_b64 s[64:65], s[64:65], s[66:67]
s_and_b32 s64, s64, s65
s_cbranch_scc1 K1_poll6d
s_sub_u32 s39, s39, 1
s_cbranch_scc0 K1_poll6
K1_poll6d:
s_barrier
s_add_u32 s7, s60, 67115008
buffer_load_dwordx4 a[192:195], v248, s[24:27], s7 offen sc1
s_add_u32 s7, s60, 76552192
buffer_load_dwordx4 a[196:199], v248, s[24:27], s7 offen sc1
s_add_u32 s7, s60, 85989376
buffer_load_dwordx4 a[200:203], v248, s[24:27], s7 offen sc1
s_add_u32 s7, s60, 95426560
buffer_load_dwordx4 a[204:207], v248, s[24:27], s7 offen sc1
s_add_u32 s7, s60, 67116032
buffer_load_dwordx4 a[208:211], v248, s[24:27], s7 offen sc1
s_add_u32 s7, s60, 76553216
buffer_load_dwordx4 a[212:215], v248, s[24:27], s7 offen sc1
s_add_u32 s7, s60, 85990400
buffer_load_dwordx4 a[216:219], v248, s[24:27], s7 offen sc1
s_add_u32 s7, s60, 95427584
buffer_load_dwordx4 a[220:223], v248, s[24:27], s7 offen sc1
s_add_u32 s38, s33, 2112
s_mov_b32 s39, 0x20000
s_and_b32 s6, s3, 1
s_cbranch_scc1 K1_poll7d
K1_poll7:
s_load_dwordx16 s[64:79], s[52:53], s38 glc
s_waitcnt lgkmcnt(0)
s_and_b64 s[64:65], s[64:65], s[72:73]
s_and_b64 s[66:67], s[66:67], s[74:75]
s_and_b64 s[68:69], s[68:69], s[76:77]
s_and_b64 s[70:71], s[70:71], s[78:79]
s_and_b64 s[64:65], s[64:65], s[68:69]
s_and_b64 s[66:67], s[66:67], s[70:71]
s_and_b64 s[64:65], s[64:65], s[66:67]
s_and_b32 s64, s64, s65
s_cbranch_scc1 K1_poll7d
s_sub_u32 s39, s39, 1
s_cbranch_scc0 K1_poll7
K1_poll7d:
s_barrier
s_add_u32 s7, s60, 67117056
buffer_load_dwordx4 a[224:227], v248, s[24:27], s7 offen sc1
s_add_u32 s7, s60, 76554240
buffer_load_dwordx4 a[228:231], v248, s[24:27], s7 offen sc1
s_add_u32 s7, s60, 85991424
buffer_load_dwordx4 a[232:235], v248, s[24:27], s7 offen sc1
s_add_u32 s7, s60, 95428608
buffer_load_dwordx4 a[236:239], v248, s[24:27], s7 offen sc1
s_waitcnt vmcnt(13)
v_mfma_f32_16x16x32_bf16 v[40:43], v[240:243], a[96:99], 0
v_mfma_f32_16x16x32_bf16 v[40:43], v[240:243], a[100:103], v[40:43]
v_mfma_f32_16x16x32_bf16 v[40:43], v[240:243], a[104:107], v[40:43]
v_mfma_f32_16x16x32_bf16 v[40:43], v[240:243], a[108:111], v[40:43]
v_mfma_f32_16x16x32_bf16 v[40:43], v[244:247], a[112:115], v[40:43]
v_mfma_f32_16x16x32_bf16 v[40:43], v[244:247], a[116:119], v[40:43]
v_mfma_f32_16x16x32_bf16 v[40:43], v[244:247], a[120:123], v[40:43]
v_mfma_f32_16x16x32_bf16 v[40:43], v[244:247], a[124:127], v[40:43]
v_mfma_f32_16x16x32_bf16 v[44:47], v[240:243], a[128:131], 0
v_mfma_f32_16x16x32_bf16 v[44:47], v[240:243], a[132:135], v[44:47]
v_mfma_f32_16x16x32_bf16 v[44:47], v[240:243], a[136:139], v[44:47]
v_mfma_f32_16x16x32_bf16 v[44:47], v[240:243], a[140:143], v[44:47]
v_mfma_f32_16x16x32_bf16 v[44:47], v[244:247], a[144:147], v[44:47]
v_mfma_f32_16x16x32_bf16 v[44:47], v[244:247], a[148:151], v[44:47]
v_mfma_f32_16x16x32_bf16 v[44:47], v[244:247], a[152:155], v[44:47]
v_mfma_f32_16x16x32_bf16 v[44:47], v[244:247], a[156:159], v[44:47]
v_mfma_f32_16x16x32_bf16 v[48:51], v[240:243], a[160:163], 0
v_mfma_f32_16x16x32_bf16 v[48:51], v[240:243], a[164:167], v[48:51]
v_mfma_f32_16x16x32_bf16 v[48:51], v[240:243], a[168:171], v[48:51]
v_mfma_f32_16x16x32_bf16 v[48:51], v[240:243], a[172:175], v[48:51]
v_mfma_f32_16x16x32_bf16 v[48:51], v[244:247], a[176:179], v[48:51]
v_mfma_f32_16x16x32_bf16 v[48:51], v[244:247], a[180:183], v[48:51]
v_mfma_f32_16x16x32_bf16 v[48:51], v[244:247], a[184:187], v[48:51]
v_mfma_f32_16x16x32_bf16 v[48:51], v[244:247], a[188:191], v[48:51]
s_waitcnt vmcnt(11)
v_pk_fma_f32 v[64:65], v[40:41], v[160:161], v[64:65]
v_pk_fma_f32 v[66:67], v[42:43], v[162:163], v[66:67]
v_cvt_pk_bf16_f32 v180, v64, v65
v_cvt_pk_bf16_f32 v181, v66, v67
buffer_store_dwordx2 v[180:181], v249, s[20:23], s46 offen offset:0
v_pk_fma_f32 v[68:69], v[44:45], v[164:165], v[68:69]
v_pk_fma_f32 v[70:71], v[46:47], v[166:167], v[70:71]
v_cvt_pk_bf16_f32 v182, v68, v69
v_cvt_pk_bf16_f32 v183, v70, v71
buffer_store_dwordx2 v[182:183], v249, s[20:23], s46 offen offset:256
v_pk_fma_f32 v[72:73], v[48:49], v[168:169], v[72:73]
v_pk_fma_f32 v[74:75], v[50:51], v[170:171], v[74:75]
v_cvt_pk_bf16_f32 v184, v72, v73
v_cvt_pk_bf16_f32 v185, v74, v75
buffer_store_dwordx2 v[184:185], v249, s[20:23], s46 offen offset:512
v_mfma_f32_16x16x32_bf16 v[52:55], v[240:243], a[192:195], 0
s_waitcnt vmcnt(13)
v_mfma_f32_16x16x32_bf16 v[52:55], v[240:243], a[196:199], v[52:55]
s_waitcnt vmcnt(12)
v_mfma_f32_16x16x32_bf16 v[52:55], v[240:243], a[200:203], v[52:55]
s_waitcnt vmcnt(11)
v_mfma_f32_16x16x32_bf16 v[52:55], v[240:243], a[204:207], v[52:55]
s_waitcnt vmcnt(10)
v_mfma_f32_16x16x32_bf16 v[52:55], v[244:247], a[208:211], v[52:55]
s_waitcnt vmcnt(9)
v_mfma_f32_16x16x32_bf16 v[52:55], v[244:247], a[212:215], v[52:55]
s_waitcnt vmcnt(8)
v_mfma_f32_16x16x32_bf16 v[52:55], v[244:247], a[216:219], v[52:55]
s_waitcnt vmcnt(7)
v_mfma_f32_16x16x32_bf16 v[52:55], v[244:247], a[220:223], v[52:55]
s_waitcnt vmcnt(6)
s_nop 6
v_pk_fma_f32 v[76:77], v[52:53], v[172:173], v[76:77]
v_pk_fma_f32 v[78:79], v[54:55], v[174:175], v[78:79]
v_cvt_pk_bf16_f32 v186, v76, v77
v_cvt_pk_bf16_f32 v187, v78, v79
buffer_store_dwordx2 v[186:187], v249, s[20:23], s46 offen offset:768
v_mfma_f32_16x16x32_bf16 v[56:59], v[240:243], a[224:227], 0
s_waitcnt vmcnt(6)
v_mfma_f32_16x16x32_bf16 v[56:59], v[240:243], a[228:231], v[56:59]
s_waitcnt vmcnt(5)
v_mfma_f32_16x16x32_bf16 v[56:59], v[240:243], a[232:235], v[56:59]
s_waitcnt vmcnt(4)
v_mfma_f32_16x16x32_bf16 v[56:59], v[240:243], a[236:239], v[56:59]
s_nop 7
v_pk_fma_f32 v[80:81], v[56:57], v[176:177], v[80:81]
v_pk_fma_f32 v[82:83], v[58:59], v[178:179], v[82:83]
v_cvt_pk_bf16_f32 v188, v80, v81
v_cvt_pk_bf16_f32 v189, v82, v83
buffer_store_dwordx2 v[188:189], v250, s[20:23], s46 offen offset:1024
K1_end:
s_endpgm
K1_m00:
s_add_u32 s38, s32, 0
s_mov_b32 s39, 0x20000
K1_poll8:
s_load_dwordx16 s[64:79], s[52:53], s38 glc
s_waitcnt lgkmcnt(0)
s_and_b64 s[64:65], s[64:65], s[72:73]
s_and_b64 s[66:67], s[66:67], s[74:75]
s_and_b64 s[68:69], s[68:69], s[76:77]
s_and_b64 s[70:71], s[70:71], s[78:79]
s_and_b64 s[64:65], s[64:65], s[68:69]
s_and_b64 s[66:67], s[66:67], s[70:71]
s_and_b64 s[64:65], s[64:65], s[66:67]
s_and_b32 s64, s64, s65
s_cbranch_scc1 K1_poll8d
s_sub_u32 s39, s39, 1
s_cbranch_scc0 K1_poll8
K1_poll8d:
s_add_u32 s7, s60, 16777216
buffer_load_dwordx4 a[32:35], v56, s[24:27], s7 offen sc1
s_add_u32 s7, s60, 26214400
buffer_load_dwordx4 a[36:39], v56, s[24:27], s7 offen sc1
s_add_u32 s7, s60, 35651584
buffer_load_dwordx4 a[40:43], v56, s[24:27], s7 offen sc1
s_add_u32 s7, s60, 45088768
buffer_load_dwordx4 a[44:47], v56, s[24:27], s7 offen sc1
s_add_u32 s7, s60, 16778240
buffer_load_dwordx4 a[48:51], v56, s[24:27], s7 offen sc1
s_add_u32 s7, s60, 26215424
buffer_load_dwordx4 a[52:55], v56, s[24:27], s7 offen sc1
s_add_u32 s7, s60, 35652608
buffer_load_dwordx4 a[56:59], v56, s[24:27], s7 offen sc1
s_add_u32 s7, s60, 45089792
buffer_load_dwordx4 a[60:63], v56, s[24:27], s7 offen sc1
s_branch K1_r00
K1_m01:
s_add_u32 s38, s32, 512
s_mov_b32 s39, 0x20000
K1_poll9:
s_load_dwordx16 s[64:79], s[52:53], s38 glc
s_waitcnt lgkmcnt(0)
s_and_b64 s[64:65], s[64:65], s[72:73]
s_and_b64 s[66:67], s[66:67], s[74:75]
s_and_b64 s[68:69], s[68:69], s[76:77]
s_and_b64 s[70:71], s[70:71], s[78:79]
s_and_b64 s[64:65], s[64:65], s[68:69]
s_and_b64 s[66:67], s[66:67], s[70:71]
s_and_b64 s[64:65], s[64:65], s[66:67]
s_and_b32 s64, s64, s65
s_cbranch_scc1 K1_poll9d
s_sub_u32 s39, s39, 1
s_cbranch_scc0 K1_poll9
K1_poll9d:
s_add_u32 s7, s60, 16779264
buffer_load_dwordx4 a[64:67], v56, s[24:27], s7 offen sc1
s_add_u32 s7, s60, 26216448
buffer_load_dwordx4 a[68:71], v56, s[24:27], s7 offen sc1
s_add_u32 s7, s60, 35653632
buffer_load_dwordx4 a[72:75], v56, s[24:27], s7 offen sc1
s_add_u32 s7, s60, 45090816
buffer_load_dwordx4 a[76:79], v56, s[24:27], s7 offen sc1
s_add_u32 s7, s60, 16780288
buffer_load_dwordx4 a[80:83], v56, s[24:27], s7 offen sc1
s_add_u32 s7, s60, 26217472
buffer_load_dwordx4 a[84:87], v56, s[24:27], s7 offen sc1
s_add_u32 s7, s60, 35654656
buffer_load_dwordx4 a[88:91], v56, s[24:27], s7 offen sc1
s_add_u32 s7, s60, 45091840
buffer_load_dwordx4 a[92:95], v56, s[24:27], s7 offen sc1
s_branch K1_r01
K1_m10:
s_add_u32 s38, s33, 64
s_mov_b32 s39, 0x20000
K1_poll10:
s_load_dwordx16 s[64:79], s[52:53], s38 glc
s_waitcnt lgkmcnt(0)
s_and_b64 s[64:65], s[64:65], s[72:73]
s_and_b64 s[66:67], s[66:67], s[74:75]
s_and_b64 s[68:69], s[68:69], s[76:77]
s_and_b64 s[70:71], s[70:71], s[78:79]
s_and_b64 s[64:65], s[64:65], s[68:69]
s_and_b64 s[66:67], s[66:67], s[70:71]
s_and_b64 s[64:65], s[64:65], s[66:67]
s_and_b32 s64, s64, s65
s_cbranch_scc1 K1_poll10d
s_sub_u32 s39, s39, 1
s_cbranch_scc0 K1_poll10
K1_poll10d:
s_add_u32 s7, s60, 67108864
buffer_load_dwordx4 a[96:99], v248, s[24:27], s7 offen sc1
s_add_u32 s7, s60, 76546048
buffer_load_dwordx4 a[100:103], v248, s[24:27], s7 offen sc1
s_add_u32 s7, s60, 85983232
buffer_load_dwordx4 a[104:107], v248, s[24:27], s7 offen sc1
s_add_u32 s7, s60, 95420416
buffer_load_dwordx4 a[108:111], v248, s[24:27], s7 offen sc1
s_add_u32 s7, s60, 67109888
buffer_load_dwordx4 a[112:115], v248, s[24:27], s7 offen sc1
s_add_u32 s7, s60, 76547072
buffer_load_dwordx4 a[116:119], v248, s[24:27], s7 offen sc1
s_add_u32 s7, s60, 85984256
buffer_load_dwordx4 a[120:123], v248, s[24:27], s7 offen sc1
s_add_u32 s7, s60, 95421440
buffer_load_dwordx4 a[124:127], v248, s[24:27], s7 offen sc1
s_branch K1_r10
K1_m11:
s_add_u32 s38, s33, 576
s_mov_b32 s39, 0x20000
K1_poll11:
s_load_dwordx16 s[64:79], s[52:53], s38 glc
s_waitcnt lgkmcnt(0)
s_and_b64 s[64:65], s[64:65], s[72:73]
s_and_b64 s[66:67], s[66:67], s[74:75]
s_and_b64 s[68:69], s[68:69], s[76:77]
s_and_b64 s[70:71], s[70:71], s[78:79]
s_and_b64 s[64:65], s[64:65], s[68:69]
s_and_b64 s[66:67], s[66:67], s[70:71]
s_and_b64 s[64:65], s[64:65], s[66:67]
s_and_b32 s64, s64, s65
s_cbranch_scc1 K1_poll11d
s_sub_u32 s39, s39, 1
s_cbranch_scc0 K1_poll11
K1_poll11d:
s_add_u32 s7, s60, 67110912
buffer_load_dwordx4 a[128:131], v248, s[24:27], s7 offen sc1
s_add_u32 s7, s60, 76548096
buffer_load_dwordx4 a[132:135], v248, s[24:27], s7 offen sc1
s_add_u32 s7, s60, 85985280
buffer_load_dwordx4 a[136:139], v248, s[24:27], s7 offen sc1
s_add_u32 s7, s60, 95422464
buffer_load_dwordx4 a[140:143], v248, s[24:27], s7 offen sc1
s_add_u32 s7, s60, 67111936
buffer_load_dwordx4 a[144:147], v248, s[24:27], s7 offen sc1
s_add_u32 s7, s60, 76549120
buffer_load_dwordx4 a[148:151], v248, s[24:27], s7 offen sc1
s_add_u32 s7, s60, 85986304
buffer_load_dwordx4 a[152:155], v248, s[24:27], s7 offen sc1
s_add_u32 s7, s60, 95423488
buffer_load_dwordx4 a[156:159], v248, s[24:27], s7 offen sc1
s_branch K1_r11
K1_rdy0:
s_mov_b32 s39, 0x20000
K1_rdy2:
buffer_load_dwordx4 v[232:235], v236, s[24:27], s70 offen offset:3584 sc1
s_waitcnt vmcnt(0)
v_and_b32 v232, v232, v233
v_and_b32 v234, v234, v235
v_and_b32 v232, v232, v234
v_cmp_eq_u32 s[66:67], 0, v232
s_nop 1
s_cmp_lg_u64 s[66:67], 0
s_cbranch_scc0 K1_rdy1
s_sub_u32 s39, s39, 1
s_cbranch_scc0 K1_rdy2
s_branch K1_rdy1
K1_fb:
s_waitcnt vmcnt(0) lgkmcnt(0)
s_mov_b32 s65, 0x10000000
s_mov_b32 s51, 0x10000000
s_mov_b32 s47, 1
s_mov_b32 s43, 0
v_mov_b32 v32, 0xff800000
v_mov_b32 v33, 0xff800000
v_mov_b32 v34, 0xff800000
v_mov_b32 v35, 0xff800000
K1_fbt:
s_barrier
s_add_u32 m0, s41, 0
s_add_u32 s45, s43, 16
buffer_load_dwordx4 v4, s[12:15], s45 offen offset:0 lds
s_add_u32 m0, s41, 16
s_nop 0
buffer_load_dwordx4 v4, s[12:15], s45 offen offset:1024 lds
s_add_u32 m0, s41, 32
s_nop 0
buffer_load_dwordx4 v4, s[12:15], s45 offen offset:2048 lds
s_add_u32 m0, s41, 48
s_nop 0
buffer_load_dwordx4 v4, s[12:15], s45 offen offset:3072 lds
s_add_u32 m0, s41, 4160
s_add_u32 s45, s43, 4112
buffer_load_dwordx4 v4, s[12:15], s45 offen offset:0 lds
s_add_u32 m0, s41, 4176
s_nop 0
buffer_load_dwordx4 v4, s[12:15], s45 offen offset:1024 lds
s_add_u32 m0, s41, 4192
s_nop 0
buffer_load_dwordx4 v4, s[12:15], s45 offen offset:2048 lds
s_add_u32 m0, s41, 4208
s_nop 0
buffer_load_dwordx4 v4, s[12:15], s45 offen offset:3072 lds
s_waitcnt vmcnt(0)
s_barrier
s_mov_b32 s46, 0
K1_fbk:
s_lshr_b32 s38, s46, 2
s_mul_i32 s38, s38, 16640
s_and_b32 s39, s46, 3
s_lshl_b32 s39, s39, 8
s_add_u32 s38, s38, s39
v_add_u32 v40, s38, v5
ds_read_b128 a[128:131], v40 offset:0
ds_read_b128 a[132:135], v40 offset:64
ds_read_b128 a[136:139], v40 offset:128
ds_read_b128 a[140:143], v40 offset:192
s_waitcnt lgkmcnt(3)
v_mfma_f32_16x16x32_bf16 v[48:51], a[128:131], v[192:195], 0
s_waitcnt lgkmcnt(2)
v_mfma_f32_16x16x32_bf16 v[48:51], a[132:135], v[196:199], v[48:51]
s_waitcnt lgkmcnt(1)
v_mfma_f32_16x16x32_bf16 v[48:51], a[136:139], v[200:203], v[48:51]
s_waitcnt lgkmcnt(0)
v_mfma_f32_16x16x32_bf16 v[48:51], a[140:143], v[204:207], v[48:51]
v_mfma_f32_16x16x32_bf16 v[52:55], a[128:131], v[208:211], 0
v_mfma_f32_16x16x32_bf16 v[52:55], a[132:135], v[212:215], v[52:55]
v_mfma_f32_16x16x32_bf16 v[52:55], a[136:139], v[216:219], v[52:55]
v_mfma_f32_16x16x32_bf16 v[52:55], a[140:143], v[220:223], v[52:55]
v_mfma_f32_16x16x32_bf16 v[56:59], a[128:131], v[224:227], 0
v_mfma_f32_16x16x32_bf16 v[56:59], a[132:135], v[228:231], v[56:59]
v_mfma_f32_16x16x32_bf16 v[56:59], a[136:139], v[232:235], v[56:59]
v_mfma_f32_16x16x32_bf16 v[56:59], a[140:143], v[236:239], v[56:59]
v_mfma_f32_16x16x32_bf16 v[60:63], a[128:131], v[240:243], 0
v_mfma_f32_16x16x32_bf16 v[60:63], a[132:135], v[244:247], v[60:63]
v_mfma_f32_16x16x32_bf16 v[60:63], a[136:139], v[248:251], v[60:63]
v_mfma_f32_16x16x32_bf16 v[60:63], a[140:143], v[252:255], v[60:63]
v_max3_f32 v32, v32, v48, v49
v_max3_f32 v32, v32, v50, v51
v_max3_f32 v33, v33, v52, v53
v_max3_f32 v33, v33, v54, v55
v_max3_f32 v34, v34, v56, v57
v_max3_f32 v34, v34, v58, v59
s_nop 1
v_max3_f32 v35, v35, v60, v61
v_max3_f32 v35, v35, v62, v63
s_add_u32 s46, s46, 1
s_cmp_lt_u32 s46, 8
s_cbranch_scc1 K1_fbk
s_add_u32 s43, s43, 32768
s_cmp_lt_u32 s43, 524288
s_cbranch_scc1 K1_fbt
s_barrier
s_mov_b32 s43, s50
s_mov_b32 s44, s50
s_add_u32 m0, s41, 0
s_add_u32 s45, s43, 16
buffer_load_dwordx4 v4, s[12:15], s45 offen offset:0 lds
s_add_u32 m0, s41, 16
s_nop 0
buffer_load_dwordx4 v4, s[12:15], s45 offen offset:1024 lds
s_add_u32 m0, s41, 32
s_nop 0
buffer_load_dwordx4 v4, s[12:15], s45 offen offset:2048 lds
s_add_u32 m0, s41, 48
s_nop 0
buffer_load_dwordx4 v4, s[12:15], s45 offen offset:3072 lds
s_add_u32 m0, s41, 4160
s_add_u32 s45, s43, 4112
buffer_load_dwordx4 v4, s[12:15], s45 offen offset:0 lds
s_add_u32 m0, s41, 4176
s_nop 0
buffer_load_dwordx4 v4, s[12:15], s45 offen offset:1024 lds
s_add_u32 m0, s41, 4192
s_nop 0
buffer_load_dwordx4 v4, s[12:15], s45 offen offset:2048 lds
s_add_u32 m0, s41, 4208
s_nop 0
buffer_load_dwordx4 v4, s[12:15], s45 offen offset:3072 lds
s_add_u32 s43, s43, 32768
s_and_b32 s43, s43, 0x7ffff
s_add_u32 m0, s41, 36864
s_add_u32 s45, s43, 16
buffer_load_dwordx4 v4, s[12:15], s45 offen offset:0 lds
s_add_u32 m0, s41, 36880
s_nop 0
buffer_load_dwordx4 v4, s[12:15], s45 offen offset:1024 lds
s_add_u32 m0, s41, 36896
s_nop 0
buffer_load_dwordx4 v4, s[12:15], s45 offen offset:2048 lds
s_add_u32 m0, s41, 36912
s_nop 0
buffer_load_dwordx4 v4, s[12:15], s45 offen offset:3072 lds
s_add_u32 m0, s41, 41024
s_add_u32 s45, s43, 4112
buffer_load_dwordx4 v4, s[12:15], s45 offen offset:0 lds
s_add_u32 m0, s41, 41040
s_nop 0
buffer_load_dwordx4 v4, s[12:15], s45 offen offset:1024 lds
s_add_u32 m0, s41, 41056
s_nop 0
buffer_load_dwordx4 v4, s[12:15], s45 offen offset:2048 lds
s_add_u32 m0, s41, 41072
s_nop 0
buffer_load_dwordx4 v4, s[12:15], s45 offen offset:3072 lds
s_add_u32 s43, s43, 32768
s_and_b32 s43, s43, 0x7ffff
s_add_u32 m0, s42, 73728
s_add_u32 s45, s44, 32
buffer_load_dwordx4 v4, s[16:19], s45 offen offset:0 lds
s_add_u32 m0, s42, 73760
s_nop 0
buffer_load_dwordx4 v4, s[16:19], s45 offen offset:1024 lds
s_add_u32 m0, s42, 73792
s_nop 0
buffer_load_dwordx4 v4, s[16:19], s45 offen offset:2048 lds
s_add_u32 m0, s42, 73824
s_nop 0
buffer_load_dwordx4 v4, s[16:19], s45 offen offset:3072 lds
s_add_u32 m0, s42, 77952
s_add_u32 s45, s44, 4128
buffer_load_dwordx4 v4, s[16:19], s45 offen offset:0 lds
s_add_u32 m0, s42, 77984
s_nop 0
buffer_load_dwordx4 v4, s[16:19], s45 offen offset:1024 lds
s_add_u32 m0, s42, 78016
s_nop 0
buffer_load_dwordx4 v4, s[16:19], s45 offen offset:2048 lds
s_add_u32 m0, s42, 78048
s_nop 0
buffer_load_dwordx4 v4, s[16:19], s45 offen offset:3072 lds
s_add_u32 s44, s44, 32768
s_and_b32 s44, s44, 0x7ffff
v_mov_b32 v36, v32
s_nop 1
v_permlane16_swap_b32 v32, v36
v_max_f32 v32, v32, v36
v_mov_b32 v36, v32
s_nop 1
v_permlane32_swap_b32 v32, v36
v_max_f32 v32, v32, v36
v_mov_b32 v37, v33
s_nop 1
v_permlane16_swap_b32 v33, v37
v_max_f32 v33, v33, v37
v_mov_b32 v37, v33
s_nop 1
v_permlane32_swap_b32 v33, v37
v_max_f32 v33, v33, v37
v_mov_b32 v38, v34
s_nop 1
v_permlane16_swap_b32 v34, v38
v_max_f32 v34, v34, v38
v_mov_b32 v38, v34
s_nop 1
v_permlane32_swap_b32 v34, v38
v_max_f32 v34, v34, v38
v_mov_b32 v39, v35
s_nop 1
v_permlane16_swap_b32 v35, v39
v_max_f32 v35, v35, v39
v_mov_b32 v39, v35
s_nop 1
v_permlane32_swap_b32 v35, v39
v_max_f32 v35, v35, v39
v_sub_f32 v16, 0, v32
v_sub_f32 v17, 0, v32
v_sub_f32 v18, 0, v32
v_sub_f32 v19, 0, v32
v_sub_f32 v20, 0, v33
v_sub_f32 v21, 0, v33
v_sub_f32 v22, 0, v33
v_sub_f32 v23, 0, v33
v_sub_f32 v24, 0, v34
v_sub_f32 v25, 0, v34
v_sub_f32 v26, 0, v34
v_sub_f32 v27, 0, v34
v_sub_f32 v28, 0, v35
v_sub_f32 v29, 0, v35
v_sub_f32 v30, 0, v35
v_sub_f32 v31, 0, v35
v_accvgpr_write_b32 a0, 0
v_accvgpr_write_b32 a1, 0
v_accvgpr_write_b32 a2, 0
v_accvgpr_write_b32 a3, 0
v_accvgpr_write_b32 a4, 0
v_accvgpr_write_b32 a5, 0
v_accvgpr_write_b32 a6, 0
v_accvgpr_write_b32 a7, 0
v_accvgpr_write_b32 a8, 0
v_accvgpr_write_b32 a9, 0
v_accvgpr_write_b32 a10, 0
v_accvgpr_write_b32 a11, 0
v_accvgpr_write_b32 a12, 0
v_accvgpr_write_b32 a13, 0
v_accvgpr_write_b32 a14, 0
v_accvgpr_write_b32 a15, 0
v_accvgpr_write_b32 a16, 0
v_accvgpr_write_b32 a17, 0
v_accvgpr_write_b32 a18, 0
v_accvgpr_write_b32 a19, 0
v_accvgpr_write_b32 a20, 0
v_accvgpr_write_b32 a21, 0
v_accvgpr_write_b32 a22, 0
v_accvgpr_write_b32 a23, 0
v_accvgpr_write_b32 a24, 0
v_accvgpr_write_b32 a25, 0
v_accvgpr_write_b32 a26, 0
v_accvgpr_write_b32 a27, 0
v_accvgpr_write_b32 a28, 0
v_accvgpr_write_b32 a29, 0
v_accvgpr_write_b32 a30, 0
v_accvgpr_write_b32 a31, 0
v_accvgpr_write_b32 a32, 0
v_accvgpr_write_b32 a33, 0
v_accvgpr_write_b32 a34, 0
v_accvgpr_write_b32 a35, 0
v_accvgpr_write_b32 a36, 0
v_accvgpr_write_b32 a37, 0
v_accvgpr_write_b32 a38, 0
v_accvgpr_write_b32 a39, 0
v_accvgpr_write_b32 a40, 0
v_accvgpr_write_b32 a41, 0
v_accvgpr_write_b32 a42, 0
v_accvgpr_write_b32 a43, 0
v_accvgpr_write_b32 a44, 0
v_accvgpr_write_b32 a45, 0
v_accvgpr_write_b32 a46, 0
v_accvgpr_write_b32 a47, 0
v_accvgpr_write_b32 a48, 0
v_accvgpr_write_b32 a49, 0
v_accvgpr_write_b32 a50, 0
v_accvgpr_write_b32 a51, 0
v_accvgpr_write_b32 a52, 0
v_accvgpr_write_b32 a53, 0
v_accvgpr_write_b32 a54, 0
v_accvgpr_write_b32 a55, 0
v_accvgpr_write_b32 a56, 0
v_accvgpr_write_b32 a57, 0
v_accvgpr_write_b32 a58, 0
v_accvgpr_write_b32 a59, 0
v_accvgpr_write_b32 a60, 0
v_accvgpr_write_b32 a61, 0
v_accvgpr_write_b32 a62, 0
v_accvgpr_write_b32 a63, 0
v_accvgpr_write_b32 a64, 0
v_accvgpr_write_b32 a65, 0
v_accvgpr_write_b32 a66, 0
v_accvgpr_write_b32 a67, 0
v_accvgpr_write_b32 a68, 0
v_accvgpr_write_b32 a69, 0
v_accvgpr_write_b32 a70, 0
v_accvgpr_write_b32 a71, 0
v_accvgpr_write_b32 a72, 0
v_accvgpr_write_b32 a73, 0
v_accvgpr_write_b32 a74, 0
v_accvgpr_write_b32 a75, 0
v_accvgpr_write_b32 a76, 0
v_accvgpr_write_b32 a77, 0
v_accvgpr_write_b32 a78, 0
v_accvgpr_write_b32 a79, 0
v_accvgpr_write_b32 a80, 0
v_accvgpr_write_b32 a81, 0
v_accvgpr_write_b32 a82, 0
v_accvgpr_write_b32 a83, 0
v_accvgpr_write_b32 a84, 0
v_accvgpr_write_b32 a85, 0
v_accvgpr_write_b32 a86, 0
v_accvgpr_write_b32 a87, 0
v_accvgpr_write_b32 a88, 0
v_accvgpr_write_b32 a89, 0
v_accvgpr_write_b32 a90, 0
v_accvgpr_write_b32 a91, 0
v_accvgpr_write_b32 a92, 0
v_accvgpr_write_b32 a93, 0
v_accvgpr_write_b32 a94, 0
v_accvgpr_write_b32 a95, 0
v_accvgpr_write_b32 a96, 0
v_accvgpr_write_b32 a97, 0
v_accvgpr_write_b32 a98, 0
v_accvgpr_write_b32 a99, 0
v_accvgpr_write_b32 a100, 0
v_accvgpr_write_b32 a101, 0
v_accvgpr_write_b32 a102, 0
v_accvgpr_write_b32 a103, 0
v_accvgpr_write_b32 a104, 0
v_accvgpr_write_b32 a105, 0
v_accvgpr_write_b32 a106, 0
v_accvgpr_write_b32 a107, 0
v_accvgpr_write_b32 a108, 0
v_accvgpr_write_b32 a109, 0
v_accvgpr_write_b32 a110, 0
v_accvgpr_write_b32 a111, 0
v_accvgpr_write_b32 a112, 0
v_accvgpr_write_b32 a113, 0
v_accvgpr_write_b32 a114, 0
v_accvgpr_write_b32 a115, 0
v_accvgpr_write_b32 a116, 0
v_accvgpr_write_b32 a117, 0
v_accvgpr_write_b32 a118, 0
v_accvgpr_write_b32 a119, 0
v_accvgpr_write_b32 a120, 0
v_accvgpr_write_b32 a121, 0
v_accvgpr_write_b32 a122, 0
v_accvgpr_write_b32 a123, 0
v_accvgpr_write_b32 a124, 0
v_accvgpr_write_b32 a125, 0
v_accvgpr_write_b32 a126, 0
v_accvgpr_write_b32 a127, 0
v_accvgpr_write_b32 a200, 0
v_accvgpr_write_b32 a201, 0
v_accvgpr_write_b32 a202, 0
v_accvgpr_write_b32 a203, 0
v_accvgpr_write_b32 a204, 0
v_accvgpr_write_b32 a205, 0
v_accvgpr_write_b32 a206, 0
v_accvgpr_write_b32 a207, 0
v_accvgpr_write_b32 a208, 0
v_accvgpr_write_b32 a209, 0
v_accvgpr_write_b32 a210, 0
v_accvgpr_write_b32 a211, 0
v_accvgpr_write_b32 a212, 0
v_accvgpr_write_b32 a213, 0
v_accvgpr_write_b32 a214, 0
v_accvgpr_write_b32 a215, 0
s_waitcnt vmcnt(0)
s_barrier
ds_read_b128 a[128:131], v5 offset:0
ds_read_b128 a[132:135], v5 offset:64
ds_read_b128 a[136:139], v5 offset:128
ds_read_b128 a[140:143], v5 offset:192
ds_read_b128 a[144:147], v5 offset:256
ds_read_b128 a[148:151], v5 offset:320
ds_read_b128 a[152:155], v5 offset:384
ds_read_b128 a[156:159], v5 offset:448
s_waitcnt lgkmcnt(0)
s_branch K1_stageP
K1_last:
.section .rodata,"a"
.p2align 6
.amdhsa_kernel adaLN_cond__gqa_block_cached__glu_gated_geglu__prompt_kernel
  .amdhsa_next_free_vgpr 512
  .amdhsa_next_free_sgpr 102
  .amdhsa_accum_offset 256
  .amdhsa_group_segment_fixed_size 0
  .amdhsa_kernarg_size 112
  .amdhsa_user_sgpr_count 2
  .amdhsa_user_sgpr_kernarg_segment_ptr 1
  .amdhsa_system_sgpr_workgroup_id_x 1
  .amdhsa_float_denorm_mode_32 3
.end_amdhsa_kernel
```
